```python
import torch

def _softmax(x, axis=-1):
    return torch.softmax(x, dim=axis)
def _gelu(x):
    return torch.nn.functional.gelu(x, approximate="tanh")
def _silu(x):
    return torch.nn.functional.silu(x)
def _sigmoid(x):
    return torch.sigmoid(x)
def _layernorm(x, axis=-1, eps=1e-5):
    m = x.mean(dim=axis, keepdim=True)
    v = x.var(dim=axis, keepdim=True, unbiased=False)
    return (x - m) / torch.sqrt(v + eps)
def _scatter_add(tgt, idx, src, axis=0):
    return tgt.clone().index_add_(axis, idx, src)
def _segment_sum(src, seg, n):
    out = torch.zeros((n,) + src.shape[1:], dtype=src.dtype)
    return out.index_add_(0, seg, src)
def _pad(x, pw):
    flat = tuple(v for pair in reversed(pw) for v in pair)
    return torch.nn.functional.pad(x, flat)

kernel_name = 'concat_heads__gqa_block_cached__gqa_block_cached__near_ridge'

def setup_inputs():

    _w = (lambda a: (lambda t: t.to(torch.bfloat16) if t.is_floating_point() else t)(torch.as_tensor(a)))
    def _A_setup():
        B, Sq, D = 8, 160, 512
        Hq, Hkv, Sk, Dh = 32, 32, 1024, 128
        assert Hq % Hkv == 0, (Hq, Hkv)
        return {
            "x": _w((lambda *s: torch.randn(*s, dtype=torch.bfloat16) * 0.8)(B, Sq, D)),
            "k_cache": _w((lambda *s: torch.randn(*s, dtype=torch.bfloat16) * 0.8)(B, Hkv, Sk, Dh)),
            "v_cache": _w((lambda *s: torch.randn(*s, dtype=torch.bfloat16) * 0.05)(B, Hkv, Sk, Dh)),
            "wq": _w((lambda *s: torch.randn(*s, dtype=torch.bfloat16) * 0.8)(D, Hq * Dh) * (D ** -0.5)),
            "wo": _w((lambda *s: torch.randn(*s, dtype=torch.bfloat16) * 0.05)(Hq * Dh, D) * ((Hq * Dh) ** -0.5)),
        }
    _A_in = _A_setup()

    def _B_setup():
        B, Sq, D = 8, 160, 512
        Hq, Hkv, Sk, Dh = 32, 32, 1024, 128
        assert Hq % Hkv == 0, (Hq, Hkv)
        return {
            "x": _w((lambda *s: torch.randn(*s, dtype=torch.bfloat16) * 0.8)(B, Sq, D)),
            "k_cache": _w((lambda *s: torch.randn(*s, dtype=torch.bfloat16) * 0.8)(B, Hkv, Sk, Dh)),
            "v_cache": _w((lambda *s: torch.randn(*s, dtype=torch.bfloat16) * 0.05)(B, Hkv, Sk, Dh)),
            "wq": _w((lambda *s: torch.randn(*s, dtype=torch.bfloat16) * 0.8)(D, Hq * Dh) * (D ** -0.5)),
            "wo": _w((lambda *s: torch.randn(*s, dtype=torch.bfloat16) * 0.05)(Hq * Dh, D) * ((Hq * Dh) ** -0.5)),
        }
    _B_in = _B_setup()

    return {
        "A_x": _A_in["x"],
        "A_k_cache": _A_in["k_cache"],
        "A_v_cache": _A_in["v_cache"],
        "A_wq": _A_in["wq"],
        "A_wo": _A_in["wo"],
        "B_x": _B_in["x"],
        "B_k_cache": _B_in["k_cache"],
        "B_v_cache": _B_in["v_cache"],
        "B_wq": _B_in["wq"],
        "B_wo": _B_in["wo"],
    }

def reference(A_x, A_k_cache, A_v_cache, A_wq, A_wo, B_x, B_k_cache, B_v_cache, B_wq, B_wo):
    def _A_ref(x, k_cache, v_cache, wq, wo):
        B, Sq, D = x.shape
        Hq, Dh = 32, 128
        Hkv = k_cache.shape[1]
        rep = Hq // Hkv
        q = (lambda x, *d: x.permute(*d))((x @ wq).reshape(B, Sq, Hq, Dh), 0, 2, 1, 3)
        k = (lambda x, n, axis: torch.repeat_interleave(x, n, dim=axis))(k_cache, rep, axis=1)
        v = (lambda x, n, axis: torch.repeat_interleave(x, n, dim=axis))(v_cache, rep, axis=1)
        scores = torch.einsum("bhqd,bhkd->bhqk", q, k) * (Dh ** -0.5)
        p = _softmax(scores, axis=-1)
        o = torch.einsum("bhqk,bhkd->bhqd", p, v)
        return (lambda x, *d: x.permute(*d))(o, 0, 2, 1, 3).reshape(B, Sq, Hq * Dh) @ wo

    def _B_ref(x, k_cache, v_cache, wq, wo):
        B, Sq, D = x.shape
        Hq, Dh = 32, 128
        Hkv = k_cache.shape[1]
        rep = Hq // Hkv
        q = (lambda x, *d: x.permute(*d))((x @ wq).reshape(B, Sq, Hq, Dh), 0, 2, 1, 3)
        k = (lambda x, n, axis: torch.repeat_interleave(x, n, dim=axis))(k_cache, rep, axis=1)
        v = (lambda x, n, axis: torch.repeat_interleave(x, n, dim=axis))(v_cache, rep, axis=1)
        scores = torch.einsum("bhqd,bhkd->bhqk", q, k) * (Dh ** -0.5)
        p = _softmax(scores, axis=-1)
        o = torch.einsum("bhqk,bhkd->bhqd", p, v)
        return (lambda x, *d: x.permute(*d))(o, 0, 2, 1, 3).reshape(B, Sq, Hq * Dh) @ wo

    a = _A_ref(A_x, A_k_cache, A_v_cache, A_wq, A_wo)
    b = _B_ref(B_x, B_k_cache, B_v_cache, B_wq, B_wo)
    return torch.concatenate([a, b], axis=-1)
```

```asm
; @launch grid=(256,1,1) block=(256,1,1) lds=163840
.amdgcn_target "amdgcn-amd-amdhsa--gfx950"
.text
.globl concat_heads__gqa_block_cached__gqa_block_cached__near_ridge_kernel
.p2align 8
.type concat_heads__gqa_block_cached__gqa_block_cached__near_ridge_kernel,@function
concat_heads__gqa_block_cached__gqa_block_cached__near_ridge_kernel:
 s_cmp_ge_u32 s2,256
 s_cbranch_scc1 L_done
 v_mov_b32 v64,v0
 s_and_b32 s3,s2,7
 s_lshr_b32 s36,s2,3
 s_and_b32 s37,s3,1
 s_lshr_b32 s38,s3,1
 s_mul_i32 s3,s37,40
 s_add_u32 s42,s0,s3
 s_addc_u32 s43,s1,0
 s_load_dwordx8 s[44:51],s[42:43],0
 s_load_dwordx2 s[52:53],s[42:43],32
 s_load_dwordx2 s[40:41],s[0:1],96
 s_load_dwordx4 s[92:95],s[0:1],80
 s_lshl_b32 s38,s38,2
 s_and_b32 s39,s36,3
 s_or_b32 s38,s38,s39
 s_lshr_b32 s39,s36,2
 v_lshrrev_b32 v71,6,v64
 v_and_b32 v65,63,v64
 v_readfirstlane_b32 s4,v71
 v_lshrrev_b32 v66,4,v65
 v_and_b32 v67,15,v65
 v_and_b32 v69,7,v65
 s_lshl_b32 s60,s4,10
 s_lshl_b32 s34,s4,12
 s_lshr_b32 s5,s4,1
 s_and_b32 s61,s4,1
 s_lshl_b32 s3,s61,2
 v_add_u32 v73,s3,v66
 v_xor_b32 v69,v73,v69
 v_lshlrev_b32 v69,4,v69
 v_lshrrev_b32 v68,3,v64
 v_lshl_add_u32 v50,v68,10,v69
 v_lshlrev_b32 v70,1,v66
 v_xor_b32 v70,v70,v67
 v_lshlrev_b32 v70,4,v70
 v_lshl_add_u32 v68,v73,13,v70
 s_lshl_b32 s3,s5,8
 v_add_u32 v51,s3,v68
 v_xor_b32 v68,0x80,v51
 v_add_u32 v52,0xfc00,v68
 v_add_u32 v53,0x1f800,v51
 v_add_u32 v54,0x2f400,v68
 s_and_b32 s3,s38,3
 s_lshl_b32 s3,s3,1
 s_add_u32 s3,s3,s39
 s_and_b32 s3,s3,7
 s_lshl_b32 s90,s3,7
 s_lshl_b32 s91,s3,19
 s_mul_i32 s3,s39,163840
 s_lshl_b32 s36,s38,9
 s_waitcnt lgkmcnt(0)
 s_add_u32 s8,s44,s3
 s_addc_u32 s9,s45,0
 s_mov_b32 s10,0x28000
 s_mov_b32 s11,0x20000
 s_add_u32 s12,s50,s36
 s_addc_u32 s13,s51,0
 s_mov_b32 s15,0x20000
 s_sub_u32 s14,0x400000,s36
 s_add_u32 m0,s60,0x8000
 s_add_u32 s58,s90,0x0
 buffer_load_dwordx4 v50,s[8:11],s58 offen offset:0  lds
 s_add_u32 m0,s60,0x9000
 s_add_u32 s58,s90,0x8000
 buffer_load_dwordx4 v50,s[8:11],s58 offen offset:0  lds
 s_add_u32 m0,s60,0xa000
 s_add_u32 s58,s90,0x10000
 buffer_load_dwordx4 v50,s[8:11],s58 offen offset:0  lds
 s_add_u32 m0,s60,0xb000
 s_add_u32 s58,s90,0x18000
 buffer_load_dwordx4 v50,s[8:11],s58 offen offset:0  lds
 s_add_u32 m0,s60,0xc000
 s_add_u32 s58,s90,0x20000
 buffer_load_dwordx4 v50,s[8:11],s58 offen offset:0  lds
 s_add_u32 s90,s90,128
 s_and_b32 s90,s90,0x3ff
 s_add_u32 m0,s34,0x1c000
 s_nop 0
 buffer_load_dwordx4 v51,s[12:15],s91 offen offset:0  lds
 buffer_load_dwordx4 v52,s[12:15],s91 offen offset:1024  lds
 buffer_load_dwordx4 v53,s[12:15],s91 offen offset:2048  lds
 buffer_load_dwordx4 v54,s[12:15],s91 offen offset:3072  lds
 s_add_u32 s91,s91,0x40000
 s_and_b32 s91,s91,0x3fffff
 s_add_u32 m0,s34,0x14000
 s_nop 0
 buffer_load_dwordx4 v51,s[12:15],s91 offen offset:0  lds
 buffer_load_dwordx4 v52,s[12:15],s91 offen offset:1024  lds
 buffer_load_dwordx4 v53,s[12:15],s91 offen offset:2048  lds
 buffer_load_dwordx4 v54,s[12:15],s91 offen offset:3072  lds
 s_add_u32 s91,s91,0x40000
 s_and_b32 s91,s91,0x3fffff
 s_getpc_b64 s[62:63]
L_pc:
 v_lshrrev_b32 v71,2,v64
 v_and_b32 v71,0x30,v71
 v_and_b32 v72,15,v64
 v_or_b32 v71,v71,v72
 s_and_b32 s3,s2,0x78
 s_lshl_b32 s3,s3,3
 v_add_lshl_u32 v71,s3,v71,7
 v_min_u32 v71,L_code_end-L_pc-4,v71
 global_load_dword v59,v71,s[62:63]
 s_mov_b32 s76,s94
 s_mov_b32 s77,s95
 s_mov_b32 s78,0x100
 s_mov_b32 s79,0x20000
 v_lshlrev_b32 v135,4,v65
 s_mov_b32 s3,0x2a00000
 s_add_u32 s72,s40,s3
 s_addc_u32 s73,s41,0
 s_mov_b32 s74,0x11000
 s_mov_b32 s75,0x20000
 s_lshl_b32 s84,s37,3
 s_add_u32 s84,s84,s39
 s_lshl_b32 s36,s84,4
 s_add_u32 s36,s36,s38
 s_min_u32 s3,s4,1
 s_lshl_b32 s3,s3,30
 s_lshl_b32 s62,s36,8
 s_add_u32 s62,s62,s3
 v_lshlrev_b32 v72,2,v65
 v_add_u32 v73,s62,v72
 v_mov_b32 v74,0
 buffer_store_dword v74,v73,s[72:75],0 offen sc1
 s_lshl_b32 s3,s84,8
 s_add_u32 s3,s3,0x10000
 s_min_u32 s62,s38,1
 s_lshl_b32 s62,s62,30
 s_add_u32 s3,s3,s62
 v_lshrrev_b32 v73,1,v64
 v_min_u32 v73,1,v73
 v_lshlrev_b32 v73,29,v73
 v_lshl_add_u32 v73,v64,7,v73
 v_add_u32 v73,s3,v73
 buffer_store_dword v74,v73,s[72:75],0 offen sc1
 s_mul_i32 s3,s36,172032
 s_add_u32 s28,s40,s3
 s_addc_u32 s29,s41,0
 s_mov_b32 s30,0x28000
 s_mov_b32 s31,0x20000
 s_mul_i32 s3,s84,2752512
 s_add_u32 s96,s40,s3
 s_addc_u32 s97,s41,0
 s_mov_b32 s98,0x2a0000
 s_mov_b32 s99,0x20000
 s_lshl_b32 s3,s39,4
 s_add_u32 s3,s3,s38
 s_lshl_b32 s3,s3,1
 s_add_u32 s3,s3,s5
 s_lshl_b32 s3,s3,18
 s_add_u32 s16,s46,s3
 s_addc_u32 s17,s47,0
 s_mov_b32 s18,0x40000
 s_mov_b32 s19,0x20000
 s_add_u32 s20,s48,s3
 s_addc_u32 s21,s49,0
 s_mov_b32 s22,0x40000
 s_mov_b32 s23,0x20000
 s_lshl_b32 s3,s38,18
 s_add_u32 s24,s52,s3
 s_addc_u32 s25,s53,0
 s_mov_b32 s26,0x40000
 s_mov_b32 s27,0x20000
 s_mov_b32 s80,s92
 s_mov_b32 s81,s93
 s_mov_b32 s82,0x280000
 s_mov_b32 s83,0x20000
 s_mul_i32 s3,s5,0x2000
 s_lshl_b32 s36,s61,12
 s_add_u32 s57,s3,s36
 s_add_u32 s3,s39,0
 s_and_b32 s3,s3,3
 s_lshl_b32 s44,s3,7
 s_mul_i32 s48,s3,20480
 s_add_u32 s3,s39,1
 s_and_b32 s3,s3,3
 s_lshl_b32 s45,s3,7
 s_mul_i32 s49,s3,20480
 s_add_u32 s3,s39,2
 s_and_b32 s3,s3,3
 s_lshl_b32 s46,s3,7
 s_mul_i32 s50,s3,20480
 s_add_u32 s3,s39,3
 s_and_b32 s3,s3,3
 s_lshl_b32 s47,s3,7
 s_mul_i32 s51,s3,20480
 s_mov_b32 s54,0x3e0293ee
 s_mov_b32 s55,0x3e0293ee
 s_mov_b32 s56,0x4b800000
 s_mov_b32 s6,0
 s_lshl_b32 s3,s84,12
 s_lshl_b32 s36,s38,4
 s_add_u32 s3,s3,s36
 s_lshl_b32 s36,s4,2
 s_add_u32 s3,s3,s36
 v_lshlrev_b32 v68,8,v67
 v_add_u32 v68,s3,v68
 v_and_b32 v69,51,v65
 v_min_u32 v69,1,v69
 v_lshl_add_u32 v137,v69,30,v68
 v_min_u32 v69,1,v64
 v_lshlrev_b32 v69,30,v69
 s_lshl_b32 s3,s84,3
 s_add_u32 s3,s3,128
 v_add_u32 v138,s3,v69
 v_mov_b32 v136,1
 v_xor_b32 v68,v66,v67
 v_lshlrev_b32 v68,4,v68
 v_lshl_add_u32 v129,v66,8,v68
 v_xor_b32 v130,64,v129
 v_xor_b32 v131,128,v129
 v_xor_b32 v132,192,v129
 v_lshl_add_u32 v133,v66,8,v70
 v_xor_b32 v134,0x80,v133
 v_lshl_add_u32 v68,v67,8,v68
 s_lshl_b32 s36,s5,13
 v_add_u32 v105,s36,v68
 v_xor_b32 v106,64,v105
 v_xor_b32 v107,128,v105
 v_xor_b32 v108,192,v105
 v_add_u32 v109,0x10000,v105
 v_add_u32 v110,0x10000,v106
 v_add_u32 v111,0x10000,v107
 v_add_u32 v112,0x10000,v108
 s_lshl_b32 s36,s5,13
 v_lshrrev_b32 v68,1,v67
 v_xor_b32 v68,v68,v66
 v_lshlrev_b32 v68,4,v68
 v_lshl_add_u32 v68,v67,7,v68
 s_mul_i32 s3,s61,10240
 v_add_u32 v48,s3,v68
 v_xor_b32 v49,64,v48
 v_lshrrev_b32 v68,2,v65
 v_and_b32 v69,7,v68
 v_lshlrev_b32 v69,5,v69
 v_lshl_add_u32 v69,v68,8,v69
 v_and_b32 v68,3,v65
 v_lshl_add_u32 v69,v68,3,v69
 s_add_u32 s36,s36,0x18000
 v_add_u32 v113,s36,v69
 v_xor_b32 v114,32,v113
 v_xor_b32 v115,64,v113
 v_xor_b32 v116,96,v113
 v_xor_b32 v117,128,v113
 v_xor_b32 v118,160,v113
 v_xor_b32 v119,192,v113
 v_xor_b32 v120,224,v113
 v_subrev_u32 v121,0x4000,v113
 v_subrev_u32 v122,0x4000,v114
 v_subrev_u32 v123,0x4000,v115
 v_subrev_u32 v124,0x4000,v116
 v_subrev_u32 v125,0x4000,v117
 v_subrev_u32 v126,0x4000,v118
 v_subrev_u32 v127,0x4000,v119
 v_subrev_u32 v128,0x4000,v120
 s_waitcnt vmcnt(7)
 s_barrier
 ds_read_b128 a[144:147],v48 offset:32768
 ds_read_b128 a[148:151],v48 offset:34816
 ds_read_b128 a[152:155],v48 offset:36864
 ds_read_b128 a[156:159],v48 offset:38912
 ds_read_b128 a[160:163],v48 offset:40960
 ds_read_b64_tr_b16 a[80:81],v113 offset:16384
 ds_read_b64_tr_b16 a[82:83],v113 offset:20480
 ds_read_b64_tr_b16 a[84:85],v114 offset:16384
 ds_read_b64_tr_b16 a[86:87],v114 offset:20480
 ds_read_b64_tr_b16 a[88:89],v115 offset:16384
 ds_read_b64_tr_b16 a[90:91],v115 offset:20480
 ds_read_b64_tr_b16 a[92:93],v116 offset:16384
 ds_read_b64_tr_b16 a[94:95],v116 offset:20480
 ds_read_b64_tr_b16 a[96:97],v117 offset:16384
 ds_read_b64_tr_b16 a[98:99],v117 offset:20480
 ds_read_b64_tr_b16 a[100:101],v118 offset:16384
 ds_read_b64_tr_b16 a[102:103],v118 offset:20480
 ds_read_b64_tr_b16 a[104:105],v119 offset:16384
 ds_read_b64_tr_b16 a[106:107],v119 offset:20480
 ds_read_b64_tr_b16 a[108:109],v120 offset:16384
 ds_read_b64_tr_b16 a[110:111],v120 offset:20480
 s_waitcnt lgkmcnt(0)
 v_mfma_f32_16x16x32_bf16 v[0:3],a[80:83],a[144:147],0
 s_add_u32 m0,s34,0x18000
 v_mfma_f32_16x16x32_bf16 v[32:35],a[80:83],a[148:151],0
 s_waitcnt vmcnt(3)
 s_barrier
 v_mfma_f32_16x16x32_bf16 v[160:163],a[80:83],a[152:155],0
 ds_read_b128 a[164:167],v49 offset:32768
 buffer_load_dwordx4 v51,s[12:15],s91 offen offset:0  lds
 v_mfma_f32_16x16x32_bf16 v[192:195],a[80:83],a[156:159],0
 ds_read_b128 a[168:171],v49 offset:34816
 v_mfma_f32_16x16x32_bf16 v[224:227],a[80:83],a[160:163],0
 ds_read_b128 a[172:175],v49 offset:36864
 v_mfma_f32_16x16x32_bf16 v[4:7],a[84:87],a[144:147],0
 ds_read_b128 a[176:179],v49 offset:38912
 buffer_load_dwordx4 v52,s[12:15],s91 offen offset:1024  lds
 v_mfma_f32_16x16x32_bf16 v[36:39],a[84:87],a[148:151],0
 ds_read_b128 a[180:183],v49 offset:40960
 v_mfma_f32_16x16x32_bf16 v[164:167],a[84:87],a[152:155],0
 ds_read_b64_tr_b16 a[112:113],v121 offset:0
 v_mfma_f32_16x16x32_bf16 v[196:199],a[84:87],a[156:159],0
 ds_read_b64_tr_b16 a[114:115],v121 offset:4096
 buffer_load_dwordx4 v53,s[12:15],s91 offen offset:2048  lds
 v_mfma_f32_16x16x32_bf16 v[228:231],a[84:87],a[160:163],0
 ds_read_b64_tr_b16 a[116:117],v122 offset:0
 v_mfma_f32_16x16x32_bf16 v[8:11],a[88:91],a[144:147],0
 ds_read_b64_tr_b16 a[118:119],v122 offset:4096
 v_mfma_f32_16x16x32_bf16 v[40:43],a[88:91],a[148:151],0
 ds_read_b64_tr_b16 a[120:121],v123 offset:0
 buffer_load_dwordx4 v54,s[12:15],s91 offen offset:3072  lds
 v_mfma_f32_16x16x32_bf16 v[168:171],a[88:91],a[152:155],0
 ds_read_b64_tr_b16 a[122:123],v123 offset:4096
 s_add_u32 s91,s91,0x40000
 v_mfma_f32_16x16x32_bf16 v[200:203],a[88:91],a[156:159],0
 ds_read_b64_tr_b16 a[124:125],v124 offset:0
 s_and_b32 s91,s91,0x3fffff
 v_mfma_f32_16x16x32_bf16 v[232:235],a[88:91],a[160:163],0
 ds_read_b64_tr_b16 a[126:127],v124 offset:4096
 s_add_u32 m0,s60,0xd000
 v_mfma_f32_16x16x32_bf16 v[12:15],a[92:95],a[144:147],0
 ds_read_b64_tr_b16 a[128:129],v125 offset:0
 s_add_u32 s58,s90,0x0
 v_mfma_f32_16x16x32_bf16 v[44:47],a[92:95],a[148:151],0
 ds_read_b64_tr_b16 a[130:131],v125 offset:4096
 buffer_load_dwordx4 v50,s[8:11],s58 offen offset:0  lds
 v_mfma_f32_16x16x32_bf16 v[172:175],a[92:95],a[152:155],0
 ds_read_b64_tr_b16 a[132:133],v126 offset:0
 s_add_u32 m0,s60,0xe000
 v_mfma_f32_16x16x32_bf16 v[204:207],a[92:95],a[156:159],0
 ds_read_b64_tr_b16 a[134:135],v126 offset:4096
 s_add_u32 s58,s90,0x8000
 v_mfma_f32_16x16x32_bf16 v[236:239],a[92:95],a[160:163],0
 ds_read_b64_tr_b16 a[136:137],v127 offset:0
 buffer_load_dwordx4 v50,s[8:11],s58 offen offset:0  lds
 v_mfma_f32_16x16x32_bf16 v[16:19],a[96:99],a[144:147],0
 ds_read_b64_tr_b16 a[138:139],v127 offset:4096
 s_add_u32 m0,s60,0xf000
 v_mfma_f32_16x16x32_bf16 v[144:147],a[96:99],a[148:151],0
 ds_read_b64_tr_b16 a[140:141],v128 offset:0
 s_add_u32 s58,s90,0x10000
 v_mfma_f32_16x16x32_bf16 v[176:179],a[96:99],a[152:155],0
 ds_read_b64_tr_b16 a[142:143],v128 offset:4096
 buffer_load_dwordx4 v50,s[8:11],s58 offen offset:0  lds
 v_mfma_f32_16x16x32_bf16 v[208:211],a[96:99],a[156:159],0
 s_add_u32 m0,s60,0x10000
 s_add_u32 s58,s90,0x18000
 v_mfma_f32_16x16x32_bf16 v[240:243],a[96:99],a[160:163],0
 v_mfma_f32_16x16x32_bf16 v[20:23],a[100:103],a[144:147],0
 buffer_load_dwordx4 v50,s[8:11],s58 offen offset:0  lds
 s_add_u32 m0,s60,0x11000
 v_mfma_f32_16x16x32_bf16 v[148:151],a[100:103],a[148:151],0
 s_add_u32 s58,s90,0x20000
 v_mfma_f32_16x16x32_bf16 v[180:183],a[100:103],a[152:155],0
 v_mfma_f32_16x16x32_bf16 v[212:215],a[100:103],a[156:159],0
 buffer_load_dwordx4 v50,s[8:11],s58 offen offset:0  lds
 s_add_u32 s90,s90,128
 v_mfma_f32_16x16x32_bf16 v[244:247],a[100:103],a[160:163],0
 s_and_b32 s90,s90,0x3ff
 s_add_u32 m0,s34,0x1c000
 v_mfma_f32_16x16x32_bf16 v[24:27],a[104:107],a[144:147],0
 v_mfma_f32_16x16x32_bf16 v[152:155],a[104:107],a[148:151],0
 buffer_load_dwordx4 v51,s[12:15],s91 offen offset:0  lds
 v_mfma_f32_16x16x32_bf16 v[184:187],a[104:107],a[152:155],0
 v_mfma_f32_16x16x32_bf16 v[216:219],a[104:107],a[156:159],0
 v_mfma_f32_16x16x32_bf16 v[248:251],a[104:107],a[160:163],0
 buffer_load_dwordx4 v52,s[12:15],s91 offen offset:1024  lds
 v_mfma_f32_16x16x32_bf16 v[28:31],a[108:111],a[144:147],0
 v_mfma_f32_16x16x32_bf16 v[156:159],a[108:111],a[148:151],0
 v_mfma_f32_16x16x32_bf16 v[188:191],a[108:111],a[152:155],0
 buffer_load_dwordx4 v53,s[12:15],s91 offen offset:2048  lds
 v_mfma_f32_16x16x32_bf16 v[220:223],a[108:111],a[156:159],0
 v_mfma_f32_16x16x32_bf16 v[252:255],a[108:111],a[160:163],0
 s_waitcnt lgkmcnt(0)
 v_mfma_f32_16x16x32_bf16 v[0:3],a[112:115],a[164:167],v[0:3]
 buffer_load_dwordx4 v54,s[12:15],s91 offen offset:3072  lds
 s_add_u32 s91,s91,0x40000
 v_mfma_f32_16x16x32_bf16 v[32:35],a[112:115],a[168:171],v[32:35]
 s_waitcnt vmcnt(4)
 s_barrier
 v_mfma_f32_16x16x32_bf16 v[160:163],a[112:115],a[172:175],v[160:163]
 ds_read_b128 a[144:147],v48 offset:53248
 s_and_b32 s91,s91,0x3fffff
 v_mfma_f32_16x16x32_bf16 v[192:195],a[112:115],a[176:179],v[192:195]
 ds_read_b128 a[148:151],v48 offset:55296
 s_add_u32 m0,s34,0x14000
 v_mfma_f32_16x16x32_bf16 v[224:227],a[112:115],a[180:183],v[224:227]
 ds_read_b128 a[152:155],v48 offset:57344
 buffer_load_dwordx4 v51,s[12:15],s91 offen offset:0  lds
 v_mfma_f32_16x16x32_bf16 v[4:7],a[116:119],a[164:167],v[4:7]
 ds_read_b128 a[156:159],v48 offset:59392
 v_mfma_f32_16x16x32_bf16 v[36:39],a[116:119],a[168:171],v[36:39]
 ds_read_b128 a[160:163],v48 offset:61440
 v_mfma_f32_16x16x32_bf16 v[164:167],a[116:119],a[172:175],v[164:167]
 ds_read_b64_tr_b16 a[80:81],v113 offset:0
 buffer_load_dwordx4 v52,s[12:15],s91 offen offset:1024  lds
 v_mfma_f32_16x16x32_bf16 v[196:199],a[116:119],a[176:179],v[196:199]
 ds_read_b64_tr_b16 a[82:83],v113 offset:4096
 v_mfma_f32_16x16x32_bf16 v[228:231],a[116:119],a[180:183],v[228:231]
 ds_read_b64_tr_b16 a[84:85],v114 offset:0
 v_mfma_f32_16x16x32_bf16 v[8:11],a[120:123],a[164:167],v[8:11]
 ds_read_b64_tr_b16 a[86:87],v114 offset:4096
 buffer_load_dwordx4 v53,s[12:15],s91 offen offset:2048  lds
 v_mfma_f32_16x16x32_bf16 v[40:43],a[120:123],a[168:171],v[40:43]
 ds_read_b64_tr_b16 a[88:89],v115 offset:0
 v_mfma_f32_16x16x32_bf16 v[168:171],a[120:123],a[172:175],v[168:171]
 ds_read_b64_tr_b16 a[90:91],v115 offset:4096
 v_mfma_f32_16x16x32_bf16 v[200:203],a[120:123],a[176:179],v[200:203]
 ds_read_b64_tr_b16 a[92:93],v116 offset:0
 buffer_load_dwordx4 v54,s[12:15],s91 offen offset:3072  lds
 v_mfma_f32_16x16x32_bf16 v[232:235],a[120:123],a[180:183],v[232:235]
 ds_read_b64_tr_b16 a[94:95],v116 offset:4096
 s_add_u32 s91,s91,0x40000
 v_mfma_f32_16x16x32_bf16 v[12:15],a[124:127],a[164:167],v[12:15]
 ds_read_b64_tr_b16 a[96:97],v117 offset:0
 s_and_b32 s91,s91,0x3fffff
 v_mfma_f32_16x16x32_bf16 v[44:47],a[124:127],a[168:171],v[44:47]
 ds_read_b64_tr_b16 a[98:99],v117 offset:4096
 s_add_u32 m0,s60,0x8000
 v_mfma_f32_16x16x32_bf16 v[172:175],a[124:127],a[172:175],v[172:175]
 ds_read_b64_tr_b16 a[100:101],v118 offset:0
 s_add_u32 s58,s90,0x0
 v_mfma_f32_16x16x32_bf16 v[204:207],a[124:127],a[176:179],v[204:207]
 ds_read_b64_tr_b16 a[102:103],v118 offset:4096
 buffer_load_dwordx4 v50,s[8:11],s58 offen offset:0  lds
 v_mfma_f32_16x16x32_bf16 v[236:239],a[124:127],a[180:183],v[236:239]
 ds_read_b64_tr_b16 a[104:105],v119 offset:0
 s_add_u32 m0,s60,0x9000
 v_mfma_f32_16x16x32_bf16 v[16:19],a[128:131],a[164:167],v[16:19]
 ds_read_b64_tr_b16 a[106:107],v119 offset:4096
 s_add_u32 s58,s90,0x8000
 v_mfma_f32_16x16x32_bf16 v[144:147],a[128:131],a[168:171],v[144:147]
 ds_read_b64_tr_b16 a[108:109],v120 offset:0
 buffer_load_dwordx4 v50,s[8:11],s58 offen offset:0  lds
 v_mfma_f32_16x16x32_bf16 v[176:179],a[128:131],a[172:175],v[176:179]
 ds_read_b64_tr_b16 a[110:111],v120 offset:4096
 s_add_u32 m0,s60,0xa000
 v_mfma_f32_16x16x32_bf16 v[208:211],a[128:131],a[176:179],v[208:211]
 s_add_u32 s58,s90,0x10000
 v_mfma_f32_16x16x32_bf16 v[240:243],a[128:131],a[180:183],v[240:243]
 buffer_load_dwordx4 v50,s[8:11],s58 offen offset:0  lds
 s_add_u32 m0,s60,0xb000
 v_mfma_f32_16x16x32_bf16 v[20:23],a[132:135],a[164:167],v[20:23]
 s_add_u32 s58,s90,0x18000
 v_mfma_f32_16x16x32_bf16 v[148:151],a[132:135],a[168:171],v[148:151]
 v_mfma_f32_16x16x32_bf16 v[180:183],a[132:135],a[172:175],v[180:183]
 buffer_load_dwordx4 v50,s[8:11],s58 offen offset:0  lds
 s_add_u32 m0,s60,0xc000
 v_mfma_f32_16x16x32_bf16 v[212:215],a[132:135],a[176:179],v[212:215]
 s_add_u32 s58,s90,0x20000
 v_mfma_f32_16x16x32_bf16 v[244:247],a[132:135],a[180:183],v[244:247]
 v_mfma_f32_16x16x32_bf16 v[24:27],a[136:139],a[164:167],v[24:27]
 buffer_load_dwordx4 v50,s[8:11],s58 offen offset:0  lds
 s_add_u32 s90,s90,128
 v_mfma_f32_16x16x32_bf16 v[152:155],a[136:139],a[168:171],v[152:155]
 s_and_b32 s90,s90,0x3ff
 v_mfma_f32_16x16x32_bf16 v[184:187],a[136:139],a[172:175],v[184:187]
 v_mfma_f32_16x16x32_bf16 v[216:219],a[136:139],a[176:179],v[216:219]
 v_mfma_f32_16x16x32_bf16 v[248:251],a[136:139],a[180:183],v[248:251]
 v_mfma_f32_16x16x32_bf16 v[28:31],a[140:143],a[164:167],v[28:31]
 v_mfma_f32_16x16x32_bf16 v[156:159],a[140:143],a[168:171],v[156:159]
 v_mfma_f32_16x16x32_bf16 v[188:191],a[140:143],a[172:175],v[188:191]
 v_mfma_f32_16x16x32_bf16 v[220:223],a[140:143],a[176:179],v[220:223]
 v_mfma_f32_16x16x32_bf16 v[252:255],a[140:143],a[180:183],v[252:255]
 s_waitcnt lgkmcnt(0)
 v_mfma_f32_16x16x32_bf16 v[0:3],a[80:83],a[144:147],v[0:3]
 v_mfma_f32_16x16x32_bf16 v[32:35],a[80:83],a[148:151],v[32:35]
 s_waitcnt vmcnt(9)
 s_barrier
 v_mfma_f32_16x16x32_bf16 v[160:163],a[80:83],a[152:155],v[160:163]
 ds_read_b128 a[164:167],v49 offset:53248
 s_add_u32 m0,s34,0x18000
 v_mfma_f32_16x16x32_bf16 v[192:195],a[80:83],a[156:159],v[192:195]
 ds_read_b128 a[168:171],v49 offset:55296
 buffer_load_dwordx4 v51,s[12:15],s91 offen offset:0  lds
 v_mfma_f32_16x16x32_bf16 v[224:227],a[80:83],a[160:163],v[224:227]
 ds_read_b128 a[172:175],v49 offset:57344
 v_mfma_f32_16x16x32_bf16 v[4:7],a[84:87],a[144:147],v[4:7]
 ds_read_b128 a[176:179],v49 offset:59392
 v_mfma_f32_16x16x32_bf16 v[36:39],a[84:87],a[148:151],v[36:39]
 ds_read_b128 a[180:183],v49 offset:61440
 buffer_load_dwordx4 v52,s[12:15],s91 offen offset:1024  lds
 v_mfma_f32_16x16x32_bf16 v[164:167],a[84:87],a[152:155],v[164:167]
 ds_read_b64_tr_b16 a[112:113],v113 offset:16384
 v_mfma_f32_16x16x32_bf16 v[196:199],a[84:87],a[156:159],v[196:199]
 ds_read_b64_tr_b16 a[114:115],v113 offset:20480
 v_mfma_f32_16x16x32_bf16 v[228:231],a[84:87],a[160:163],v[228:231]
 ds_read_b64_tr_b16 a[116:117],v114 offset:16384
 buffer_load_dwordx4 v53,s[12:15],s91 offen offset:2048  lds
 v_mfma_f32_16x16x32_bf16 v[8:11],a[88:91],a[144:147],v[8:11]
 ds_read_b64_tr_b16 a[118:119],v114 offset:20480
 v_mfma_f32_16x16x32_bf16 v[40:43],a[88:91],a[148:151],v[40:43]
 ds_read_b64_tr_b16 a[120:121],v115 offset:16384
 v_mfma_f32_16x16x32_bf16 v[168:171],a[88:91],a[152:155],v[168:171]
 ds_read_b64_tr_b16 a[122:123],v115 offset:20480
 buffer_load_dwordx4 v54,s[12:15],s91 offen offset:3072  lds
 v_mfma_f32_16x16x32_bf16 v[200:203],a[88:91],a[156:159],v[200:203]
 ds_read_b64_tr_b16 a[124:125],v116 offset:16384
 s_add_u32 s91,s91,0x40000
 v_mfma_f32_16x16x32_bf16 v[232:235],a[88:91],a[160:163],v[232:235]
 ds_read_b64_tr_b16 a[126:127],v116 offset:20480
 s_and_b32 s91,s91,0x3fffff
 v_mfma_f32_16x16x32_bf16 v[12:15],a[92:95],a[144:147],v[12:15]
 ds_read_b64_tr_b16 a[128:129],v117 offset:16384
 v_mfma_f32_16x16x32_bf16 v[44:47],a[92:95],a[148:151],v[44:47]
 ds_read_b64_tr_b16 a[130:131],v117 offset:20480
 v_mfma_f32_16x16x32_bf16 v[172:175],a[92:95],a[152:155],v[172:175]
 ds_read_b64_tr_b16 a[132:133],v118 offset:16384
 v_mfma_f32_16x16x32_bf16 v[204:207],a[92:95],a[156:159],v[204:207]
 ds_read_b64_tr_b16 a[134:135],v118 offset:20480
 v_mfma_f32_16x16x32_bf16 v[236:239],a[92:95],a[160:163],v[236:239]
 ds_read_b64_tr_b16 a[136:137],v119 offset:16384
 v_mfma_f32_16x16x32_bf16 v[16:19],a[96:99],a[144:147],v[16:19]
 ds_read_b64_tr_b16 a[138:139],v119 offset:20480
 v_mfma_f32_16x16x32_bf16 v[144:147],a[96:99],a[148:151],v[144:147]
 ds_read_b64_tr_b16 a[140:141],v120 offset:16384
 v_mfma_f32_16x16x32_bf16 v[176:179],a[96:99],a[152:155],v[176:179]
 ds_read_b64_tr_b16 a[142:143],v120 offset:20480
 v_mfma_f32_16x16x32_bf16 v[208:211],a[96:99],a[156:159],v[208:211]
 v_mfma_f32_16x16x32_bf16 v[240:243],a[96:99],a[160:163],v[240:243]
 v_mfma_f32_16x16x32_bf16 v[20:23],a[100:103],a[144:147],v[20:23]
 v_mfma_f32_16x16x32_bf16 v[148:151],a[100:103],a[148:151],v[148:151]
 v_mfma_f32_16x16x32_bf16 v[180:183],a[100:103],a[152:155],v[180:183]
 v_mfma_f32_16x16x32_bf16 v[212:215],a[100:103],a[156:159],v[212:215]
 v_mfma_f32_16x16x32_bf16 v[244:247],a[100:103],a[160:163],v[244:247]
 v_mfma_f32_16x16x32_bf16 v[24:27],a[104:107],a[144:147],v[24:27]
 v_mfma_f32_16x16x32_bf16 v[152:155],a[104:107],a[148:151],v[152:155]
 v_mfma_f32_16x16x32_bf16 v[184:187],a[104:107],a[152:155],v[184:187]
 v_mfma_f32_16x16x32_bf16 v[216:219],a[104:107],a[156:159],v[216:219]
 v_mfma_f32_16x16x32_bf16 v[248:251],a[104:107],a[160:163],v[248:251]
 v_mfma_f32_16x16x32_bf16 v[28:31],a[108:111],a[144:147],v[28:31]
 v_mfma_f32_16x16x32_bf16 v[156:159],a[108:111],a[148:151],v[156:159]
 v_mfma_f32_16x16x32_bf16 v[188:191],a[108:111],a[152:155],v[188:191]
 v_mfma_f32_16x16x32_bf16 v[220:223],a[108:111],a[156:159],v[220:223]
 v_mfma_f32_16x16x32_bf16 v[252:255],a[108:111],a[160:163],v[252:255]
 s_waitcnt lgkmcnt(0)
 v_mfma_f32_16x16x32_bf16 v[0:3],a[112:115],a[164:167],v[0:3]
 v_mfma_f32_16x16x32_bf16 v[32:35],a[112:115],a[168:171],v[32:35]
 s_waitcnt vmcnt(4)
 s_barrier
 v_mfma_f32_16x16x32_bf16 v[160:163],a[112:115],a[172:175],v[160:163]
 ds_read_b128 a[144:147],v48 offset:32768
 s_add_u32 m0,s34,0x1c000
 v_mfma_f32_16x16x32_bf16 v[192:195],a[112:115],a[176:179],v[192:195]
 ds_read_b128 a[148:151],v48 offset:34816
 buffer_load_dwordx4 v51,s[12:15],s91 offen offset:0  lds
 v_mfma_f32_16x16x32_bf16 v[224:227],a[112:115],a[180:183],v[224:227]
 ds_read_b128 a[152:155],v48 offset:36864
 v_mfma_f32_16x16x32_bf16 v[4:7],a[116:119],a[164:167],v[4:7]
 ds_read_b128 a[156:159],v48 offset:38912
 v_mfma_f32_16x16x32_bf16 v[36:39],a[116:119],a[168:171],v[36:39]
 ds_read_b128 a[160:163],v48 offset:40960
 buffer_load_dwordx4 v52,s[12:15],s91 offen offset:1024  lds
 v_mfma_f32_16x16x32_bf16 v[164:167],a[116:119],a[172:175],v[164:167]
 ds_read_b64_tr_b16 a[80:81],v121 offset:0
 v_mfma_f32_16x16x32_bf16 v[196:199],a[116:119],a[176:179],v[196:199]
 ds_read_b64_tr_b16 a[82:83],v121 offset:4096
 v_mfma_f32_16x16x32_bf16 v[228:231],a[116:119],a[180:183],v[228:231]
 ds_read_b64_tr_b16 a[84:85],v122 offset:0
 buffer_load_dwordx4 v53,s[12:15],s91 offen offset:2048  lds
 v_mfma_f32_16x16x32_bf16 v[8:11],a[120:123],a[164:167],v[8:11]
 ds_read_b64_tr_b16 a[86:87],v122 offset:4096
 v_mfma_f32_16x16x32_bf16 v[40:43],a[120:123],a[168:171],v[40:43]
 ds_read_b64_tr_b16 a[88:89],v123 offset:0
 v_mfma_f32_16x16x32_bf16 v[168:171],a[120:123],a[172:175],v[168:171]
 ds_read_b64_tr_b16 a[90:91],v123 offset:4096
 buffer_load_dwordx4 v54,s[12:15],s91 offen offset:3072  lds
 v_mfma_f32_16x16x32_bf16 v[200:203],a[120:123],a[176:179],v[200:203]
 ds_read_b64_tr_b16 a[92:93],v124 offset:0
 s_add_u32 s91,s91,0x40000
 v_mfma_f32_16x16x32_bf16 v[232:235],a[120:123],a[180:183],v[232:235]
 ds_read_b64_tr_b16 a[94:95],v124 offset:4096
 s_and_b32 s91,s91,0x3fffff
 v_mfma_f32_16x16x32_bf16 v[12:15],a[124:127],a[164:167],v[12:15]
 ds_read_b64_tr_b16 a[96:97],v125 offset:0
 s_add_u32 m0,s60,0xd000
 v_mfma_f32_16x16x32_bf16 v[44:47],a[124:127],a[168:171],v[44:47]
 ds_read_b64_tr_b16 a[98:99],v125 offset:4096
 s_add_u32 s58,s90,0x0
 v_mfma_f32_16x16x32_bf16 v[172:175],a[124:127],a[172:175],v[172:175]
 ds_read_b64_tr_b16 a[100:101],v126 offset:0
 buffer_load_dwordx4 v50,s[8:11],s58 offen offset:0  lds
 v_mfma_f32_16x16x32_bf16 v[204:207],a[124:127],a[176:179],v[204:207]
 ds_read_b64_tr_b16 a[102:103],v126 offset:4096
 s_add_u32 m0,s60,0xe000
 v_mfma_f32_16x16x32_bf16 v[236:239],a[124:127],a[180:183],v[236:239]
 ds_read_b64_tr_b16 a[104:105],v127 offset:0
 s_add_u32 s58,s90,0x8000
 v_mfma_f32_16x16x32_bf16 v[16:19],a[128:131],a[164:167],v[16:19]
 ds_read_b64_tr_b16 a[106:107],v127 offset:4096
 buffer_load_dwordx4 v50,s[8:11],s58 offen offset:0  lds
 v_mfma_f32_16x16x32_bf16 v[144:147],a[128:131],a[168:171],v[144:147]
 ds_read_b64_tr_b16 a[108:109],v128 offset:0
 s_add_u32 m0,s60,0xf000
 v_mfma_f32_16x16x32_bf16 v[176:179],a[128:131],a[172:175],v[176:179]
 ds_read_b64_tr_b16 a[110:111],v128 offset:4096
 s_add_u32 s58,s90,0x10000
 v_mfma_f32_16x16x32_bf16 v[208:211],a[128:131],a[176:179],v[208:211]
 buffer_load_dwordx4 v50,s[8:11],s58 offen offset:0  lds
 s_add_u32 m0,s60,0x10000
 v_mfma_f32_16x16x32_bf16 v[240:243],a[128:131],a[180:183],v[240:243]
 s_add_u32 s58,s90,0x18000
 v_mfma_f32_16x16x32_bf16 v[20:23],a[132:135],a[164:167],v[20:23]
 v_mfma_f32_16x16x32_bf16 v[148:151],a[132:135],a[168:171],v[148:151]
 buffer_load_dwordx4 v50,s[8:11],s58 offen offset:0  lds
 s_add_u32 m0,s60,0x11000
 v_mfma_f32_16x16x32_bf16 v[180:183],a[132:135],a[172:175],v[180:183]
 s_add_u32 s58,s90,0x20000
 v_mfma_f32_16x16x32_bf16 v[212:215],a[132:135],a[176:179],v[212:215]
 v_mfma_f32_16x16x32_bf16 v[244:247],a[132:135],a[180:183],v[244:247]
 buffer_load_dwordx4 v50,s[8:11],s58 offen offset:0  lds
 s_add_u32 s90,s90,128
 v_mfma_f32_16x16x32_bf16 v[24:27],a[136:139],a[164:167],v[24:27]
 s_and_b32 s90,s90,0x3ff
 v_mfma_f32_16x16x32_bf16 v[152:155],a[136:139],a[168:171],v[152:155]
 v_mfma_f32_16x16x32_bf16 v[184:187],a[136:139],a[172:175],v[184:187]
 v_mfma_f32_16x16x32_bf16 v[216:219],a[136:139],a[176:179],v[216:219]
 v_mfma_f32_16x16x32_bf16 v[248:251],a[136:139],a[180:183],v[248:251]
 v_mfma_f32_16x16x32_bf16 v[28:31],a[140:143],a[164:167],v[28:31]
 v_mfma_f32_16x16x32_bf16 v[156:159],a[140:143],a[168:171],v[156:159]
 v_mfma_f32_16x16x32_bf16 v[188:191],a[140:143],a[172:175],v[188:191]
 v_mfma_f32_16x16x32_bf16 v[220:223],a[140:143],a[176:179],v[220:223]
 v_mfma_f32_16x16x32_bf16 v[252:255],a[140:143],a[180:183],v[252:255]
 s_waitcnt lgkmcnt(0)
 v_mfma_f32_16x16x32_bf16 v[0:3],a[80:83],a[144:147],v[0:3]
 v_mfma_f32_16x16x32_bf16 v[32:35],a[80:83],a[148:151],v[32:35]
 s_waitcnt vmcnt(9)
 s_barrier
 v_mfma_f32_16x16x32_bf16 v[160:163],a[80:83],a[152:155],v[160:163]
 ds_read_b128 a[164:167],v49 offset:32768
 s_add_u32 m0,s34,0x14000
 v_mfma_f32_16x16x32_bf16 v[192:195],a[80:83],a[156:159],v[192:195]
 ds_read_b128 a[168:171],v49 offset:34816
 buffer_load_dwordx4 v51,s[12:15],s91 offen offset:0  lds
 v_mfma_f32_16x16x32_bf16 v[224:227],a[80:83],a[160:163],v[224:227]
 ds_read_b128 a[172:175],v49 offset:36864
 v_mfma_f32_16x16x32_bf16 v[4:7],a[84:87],a[144:147],v[4:7]
 ds_read_b128 a[176:179],v49 offset:38912
 v_mfma_f32_16x16x32_bf16 v[36:39],a[84:87],a[148:151],v[36:39]
 ds_read_b128 a[180:183],v49 offset:40960
 buffer_load_dwordx4 v52,s[12:15],s91 offen offset:1024  lds
 v_mfma_f32_16x16x32_bf16 v[164:167],a[84:87],a[152:155],v[164:167]
 ds_read_b64_tr_b16 a[112:113],v113 offset:0
 v_mfma_f32_16x16x32_bf16 v[196:199],a[84:87],a[156:159],v[196:199]
 ds_read_b64_tr_b16 a[114:115],v113 offset:4096
 v_mfma_f32_16x16x32_bf16 v[228:231],a[84:87],a[160:163],v[228:231]
 ds_read_b64_tr_b16 a[116:117],v114 offset:0
 buffer_load_dwordx4 v53,s[12:15],s91 offen offset:2048  lds
 v_mfma_f32_16x16x32_bf16 v[8:11],a[88:91],a[144:147],v[8:11]
 ds_read_b64_tr_b16 a[118:119],v114 offset:4096
 v_mfma_f32_16x16x32_bf16 v[40:43],a[88:91],a[148:151],v[40:43]
 ds_read_b64_tr_b16 a[120:121],v115 offset:0
 v_mfma_f32_16x16x32_bf16 v[168:171],a[88:91],a[152:155],v[168:171]
 ds_read_b64_tr_b16 a[122:123],v115 offset:4096
 buffer_load_dwordx4 v54,s[12:15],s91 offen offset:3072  lds
 v_mfma_f32_16x16x32_bf16 v[200:203],a[88:91],a[156:159],v[200:203]
 ds_read_b64_tr_b16 a[124:125],v116 offset:0
 s_add_u32 s91,s91,0x40000
 v_mfma_f32_16x16x32_bf16 v[232:235],a[88:91],a[160:163],v[232:235]
 ds_read_b64_tr_b16 a[126:127],v116 offset:4096
 s_and_b32 s91,s91,0x3fffff
 v_mfma_f32_16x16x32_bf16 v[12:15],a[92:95],a[144:147],v[12:15]
 ds_read_b64_tr_b16 a[128:129],v117 offset:0
 s_add_u32 m0,s34,0x0
 v_mfma_f32_16x16x32_bf16 v[44:47],a[92:95],a[148:151],v[44:47]
 ds_read_b64_tr_b16 a[130:131],v117 offset:4096
 s_xor_b32 s32,s57,0x0
 v_mfma_f32_16x16x32_bf16 v[172:175],a[92:95],a[152:155],v[172:175]
 ds_read_b64_tr_b16 a[132:133],v118 offset:0
 buffer_load_dwordx4 v129,s[16:19],s32 offen offset:0 nt lds
 v_mfma_f32_16x16x32_bf16 v[204:207],a[92:95],a[156:159],v[204:207]
 ds_read_b64_tr_b16 a[134:135],v118 offset:4096
 v_mfma_f32_16x16x32_bf16 v[236:239],a[92:95],a[160:163],v[236:239]
 ds_read_b64_tr_b16 a[136:137],v119 offset:0
 v_mfma_f32_16x16x32_bf16 v[16:19],a[96:99],a[144:147],v[16:19]
 ds_read_b64_tr_b16 a[138:139],v119 offset:4096
 buffer_load_dwordx4 v130,s[16:19],s32 offen offset:1024 nt lds
 v_mfma_f32_16x16x32_bf16 v[144:147],a[96:99],a[148:151],v[144:147]
 ds_read_b64_tr_b16 a[140:141],v120 offset:0
 v_mfma_f32_16x16x32_bf16 v[176:179],a[96:99],a[152:155],v[176:179]
 ds_read_b64_tr_b16 a[142:143],v120 offset:4096
 v_mfma_f32_16x16x32_bf16 v[208:211],a[96:99],a[156:159],v[208:211]
 buffer_load_dwordx4 v131,s[16:19],s32 offen offset:2048 nt lds
 v_mfma_f32_16x16x32_bf16 v[240:243],a[96:99],a[160:163],v[240:243]
 v_mfma_f32_16x16x32_bf16 v[20:23],a[100:103],a[144:147],v[20:23]
 v_mfma_f32_16x16x32_bf16 v[148:151],a[100:103],a[148:151],v[148:151]
 buffer_load_dwordx4 v132,s[16:19],s32 offen offset:3072 nt lds
 v_mfma_f32_16x16x32_bf16 v[180:183],a[100:103],a[152:155],v[180:183]
 v_mfma_f32_16x16x32_bf16 v[212:215],a[100:103],a[156:159],v[212:215]
 v_mfma_f32_16x16x32_bf16 v[244:247],a[100:103],a[160:163],v[244:247]
 v_mfma_f32_16x16x32_bf16 v[24:27],a[104:107],a[144:147],v[24:27]
 v_mfma_f32_16x16x32_bf16 v[152:155],a[104:107],a[148:151],v[152:155]
 v_mfma_f32_16x16x32_bf16 v[184:187],a[104:107],a[152:155],v[184:187]
 v_mfma_f32_16x16x32_bf16 v[216:219],a[104:107],a[156:159],v[216:219]
 v_mfma_f32_16x16x32_bf16 v[248:251],a[104:107],a[160:163],v[248:251]
 v_mfma_f32_16x16x32_bf16 v[28:31],a[108:111],a[144:147],v[28:31]
 v_mfma_f32_16x16x32_bf16 v[156:159],a[108:111],a[148:151],v[156:159]
 v_mfma_f32_16x16x32_bf16 v[188:191],a[108:111],a[152:155],v[188:191]
 v_mfma_f32_16x16x32_bf16 v[220:223],a[108:111],a[156:159],v[220:223]
 v_mfma_f32_16x16x32_bf16 v[252:255],a[108:111],a[160:163],v[252:255]
 s_waitcnt lgkmcnt(0)
 v_mfma_f32_16x16x32_bf16 v[0:3],a[112:115],a[164:167],v[0:3]
 v_mfma_f32_16x16x32_bf16 v[32:35],a[112:115],a[168:171],v[32:35]
 s_waitcnt vmcnt(8)
 s_barrier
 v_mfma_f32_16x16x32_bf16 v[160:163],a[112:115],a[172:175],v[160:163]
 ds_read_b128 a[144:147],v48 offset:53248
 s_add_u32 m0,s34,0x18000
 v_mfma_f32_16x16x32_bf16 v[192:195],a[112:115],a[176:179],v[192:195]
 ds_read_b128 a[148:151],v48 offset:55296
 buffer_load_dwordx4 v51,s[12:15],s91 offen offset:0  lds
 v_mfma_f32_16x16x32_bf16 v[224:227],a[112:115],a[180:183],v[224:227]
 ds_read_b128 a[152:155],v48 offset:57344
 v_mfma_f32_16x16x32_bf16 v[4:7],a[116:119],a[164:167],v[4:7]
 ds_read_b128 a[156:159],v48 offset:59392
 v_mfma_f32_16x16x32_bf16 v[36:39],a[116:119],a[168:171],v[36:39]
 ds_read_b128 a[160:163],v48 offset:61440
 buffer_load_dwordx4 v52,s[12:15],s91 offen offset:1024  lds
 v_mfma_f32_16x16x32_bf16 v[164:167],a[116:119],a[172:175],v[164:167]
 ds_read_b64_tr_b16 a[80:81],v113 offset:16384
 v_mfma_f32_16x16x32_bf16 v[196:199],a[116:119],a[176:179],v[196:199]
 ds_read_b64_tr_b16 a[82:83],v113 offset:20480
 v_mfma_f32_16x16x32_bf16 v[228:231],a[116:119],a[180:183],v[228:231]
 ds_read_b64_tr_b16 a[84:85],v114 offset:16384
 buffer_load_dwordx4 v53,s[12:15],s91 offen offset:2048  lds
 v_mfma_f32_16x16x32_bf16 v[8:11],a[120:123],a[164:167],v[8:11]
 ds_read_b64_tr_b16 a[86:87],v114 offset:20480
 v_mfma_f32_16x16x32_bf16 v[40:43],a[120:123],a[168:171],v[40:43]
 ds_read_b64_tr_b16 a[88:89],v115 offset:16384
 v_mfma_f32_16x16x32_bf16 v[168:171],a[120:123],a[172:175],v[168:171]
 ds_read_b64_tr_b16 a[90:91],v115 offset:20480
 buffer_load_dwordx4 v54,s[12:15],s91 offen offset:3072  lds
 v_mfma_f32_16x16x32_bf16 v[200:203],a[120:123],a[176:179],v[200:203]
 ds_read_b64_tr_b16 a[92:93],v116 offset:16384
 s_add_u32 s91,s91,0x40000
 v_mfma_f32_16x16x32_bf16 v[232:235],a[120:123],a[180:183],v[232:235]
 ds_read_b64_tr_b16 a[94:95],v116 offset:20480
 s_and_b32 s91,s91,0x3fffff
 v_mfma_f32_16x16x32_bf16 v[12:15],a[124:127],a[164:167],v[12:15]
 ds_read_b64_tr_b16 a[96:97],v117 offset:16384
 s_add_u32 m0,s60,0x8000
 v_mfma_f32_16x16x32_bf16 v[44:47],a[124:127],a[168:171],v[44:47]
 ds_read_b64_tr_b16 a[98:99],v117 offset:20480
 s_add_u32 s58,s90,0x0
 v_mfma_f32_16x16x32_bf16 v[172:175],a[124:127],a[172:175],v[172:175]
 ds_read_b64_tr_b16 a[100:101],v118 offset:16384
 buffer_load_dwordx4 v50,s[8:11],s58 offen offset:0  lds
 v_mfma_f32_16x16x32_bf16 v[204:207],a[124:127],a[176:179],v[204:207]
 ds_read_b64_tr_b16 a[102:103],v118 offset:20480
 s_add_u32 m0,s60,0x9000
 v_mfma_f32_16x16x32_bf16 v[236:239],a[124:127],a[180:183],v[236:239]
 ds_read_b64_tr_b16 a[104:105],v119 offset:16384
 s_add_u32 s58,s90,0x8000
 v_mfma_f32_16x16x32_bf16 v[16:19],a[128:131],a[164:167],v[16:19]
 ds_read_b64_tr_b16 a[106:107],v119 offset:20480
 buffer_load_dwordx4 v50,s[8:11],s58 offen offset:0  lds
 v_mfma_f32_16x16x32_bf16 v[144:147],a[128:131],a[168:171],v[144:147]
 ds_read_b64_tr_b16 a[108:109],v120 offset:16384
 s_add_u32 m0,s60,0xa000
 v_mfma_f32_16x16x32_bf16 v[176:179],a[128:131],a[172:175],v[176:179]
 ds_read_b64_tr_b16 a[110:111],v120 offset:20480
 s_add_u32 s58,s90,0x10000
 v_mfma_f32_16x16x32_bf16 v[208:211],a[128:131],a[176:179],v[208:211]
 buffer_load_dwordx4 v50,s[8:11],s58 offen offset:0  lds
 s_add_u32 m0,s60,0xb000
 v_mfma_f32_16x16x32_bf16 v[240:243],a[128:131],a[180:183],v[240:243]
 s_add_u32 s58,s90,0x18000
 v_mfma_f32_16x16x32_bf16 v[20:23],a[132:135],a[164:167],v[20:23]
 v_mfma_f32_16x16x32_bf16 v[148:151],a[132:135],a[168:171],v[148:151]
 buffer_load_dwordx4 v50,s[8:11],s58 offen offset:0  lds
 s_add_u32 m0,s60,0xc000
 v_mfma_f32_16x16x32_bf16 v[180:183],a[132:135],a[172:175],v[180:183]
 s_add_u32 s58,s90,0x20000
 v_mfma_f32_16x16x32_bf16 v[212:215],a[132:135],a[176:179],v[212:215]
 v_mfma_f32_16x16x32_bf16 v[244:247],a[132:135],a[180:183],v[244:247]
 buffer_load_dwordx4 v50,s[8:11],s58 offen offset:0  lds
 s_add_u32 s90,s90,128
 v_mfma_f32_16x16x32_bf16 v[24:27],a[136:139],a[164:167],v[24:27]
 s_and_b32 s90,s90,0x3ff
 v_mfma_f32_16x16x32_bf16 v[152:155],a[136:139],a[168:171],v[152:155]
 v_mfma_f32_16x16x32_bf16 v[184:187],a[136:139],a[172:175],v[184:187]
 v_mfma_f32_16x16x32_bf16 v[216:219],a[136:139],a[176:179],v[216:219]
 v_mfma_f32_16x16x32_bf16 v[248:251],a[136:139],a[180:183],v[248:251]
 v_mfma_f32_16x16x32_bf16 v[28:31],a[140:143],a[164:167],v[28:31]
 v_mfma_f32_16x16x32_bf16 v[156:159],a[140:143],a[168:171],v[156:159]
 v_mfma_f32_16x16x32_bf16 v[188:191],a[140:143],a[172:175],v[188:191]
 v_mfma_f32_16x16x32_bf16 v[220:223],a[140:143],a[176:179],v[220:223]
 v_mfma_f32_16x16x32_bf16 v[252:255],a[140:143],a[180:183],v[252:255]
 s_waitcnt lgkmcnt(0)
 v_mfma_f32_16x16x32_bf16 v[0:3],a[80:83],a[144:147],v[0:3]
 v_mfma_f32_16x16x32_bf16 v[32:35],a[80:83],a[148:151],v[32:35]
 s_waitcnt vmcnt(13)
 s_barrier
 v_mfma_f32_16x16x32_bf16 v[160:163],a[80:83],a[152:155],v[160:163]
 ds_read_b128 a[164:167],v49 offset:53248
 s_add_u32 m0,s34,0x1c000
 v_mfma_f32_16x16x32_bf16 v[192:195],a[80:83],a[156:159],v[192:195]
 ds_read_b128 a[168:171],v49 offset:55296
 buffer_load_dwordx4 v51,s[12:15],s91 offen offset:0  lds
 v_mfma_f32_16x16x32_bf16 v[224:227],a[80:83],a[160:163],v[224:227]
 ds_read_b128 a[172:175],v49 offset:57344
 v_mfma_f32_16x16x32_bf16 v[4:7],a[84:87],a[144:147],v[4:7]
 ds_read_b128 a[176:179],v49 offset:59392
 v_mfma_f32_16x16x32_bf16 v[36:39],a[84:87],a[148:151],v[36:39]
 ds_read_b128 a[180:183],v49 offset:61440
 buffer_load_dwordx4 v52,s[12:15],s91 offen offset:1024  lds
 v_mfma_f32_16x16x32_bf16 v[164:167],a[84:87],a[152:155],v[164:167]
 ds_read_b64_tr_b16 a[112:113],v121 offset:0
 v_mfma_f32_16x16x32_bf16 v[196:199],a[84:87],a[156:159],v[196:199]
 ds_read_b64_tr_b16 a[114:115],v121 offset:4096
 v_mfma_f32_16x16x32_bf16 v[228:231],a[84:87],a[160:163],v[228:231]
 ds_read_b64_tr_b16 a[116:117],v122 offset:0
 buffer_load_dwordx4 v53,s[12:15],s91 offen offset:2048  lds
 v_mfma_f32_16x16x32_bf16 v[8:11],a[88:91],a[144:147],v[8:11]
 ds_read_b64_tr_b16 a[118:119],v122 offset:4096
 v_mfma_f32_16x16x32_bf16 v[40:43],a[88:91],a[148:151],v[40:43]
 ds_read_b64_tr_b16 a[120:121],v123 offset:0
 v_mfma_f32_16x16x32_bf16 v[168:171],a[88:91],a[152:155],v[168:171]
 ds_read_b64_tr_b16 a[122:123],v123 offset:4096
 buffer_load_dwordx4 v54,s[12:15],s91 offen offset:3072  lds
 v_mfma_f32_16x16x32_bf16 v[200:203],a[88:91],a[156:159],v[200:203]
 ds_read_b64_tr_b16 a[124:125],v124 offset:0
 s_add_u32 s91,s91,0x40000
 v_mfma_f32_16x16x32_bf16 v[232:235],a[88:91],a[160:163],v[232:235]
 ds_read_b64_tr_b16 a[126:127],v124 offset:4096
 s_and_b32 s91,s91,0x3fffff
 v_mfma_f32_16x16x32_bf16 v[12:15],a[92:95],a[144:147],v[12:15]
 ds_read_b64_tr_b16 a[128:129],v125 offset:0
 s_add_u32 m0,s34,0x20000
 v_mfma_f32_16x16x32_bf16 v[44:47],a[92:95],a[148:151],v[44:47]
 ds_read_b64_tr_b16 a[130:131],v125 offset:4096
 s_xor_b32 s33,s57,0x0
 v_mfma_f32_16x16x32_bf16 v[172:175],a[92:95],a[152:155],v[172:175]
 ds_read_b64_tr_b16 a[132:133],v126 offset:0
 buffer_load_dwordx4 v133,s[20:23],s33 offen offset:0 nt lds
 v_mfma_f32_16x16x32_bf16 v[204:207],a[92:95],a[156:159],v[204:207]
 ds_read_b64_tr_b16 a[134:135],v126 offset:4096
 v_mfma_f32_16x16x32_bf16 v[236:239],a[92:95],a[160:163],v[236:239]
 ds_read_b64_tr_b16 a[136:137],v127 offset:0
 v_mfma_f32_16x16x32_bf16 v[16:19],a[96:99],a[144:147],v[16:19]
 ds_read_b64_tr_b16 a[138:139],v127 offset:4096
 buffer_load_dwordx4 v134,s[20:23],s33 offen offset:1024 nt lds
 v_mfma_f32_16x16x32_bf16 v[144:147],a[96:99],a[148:151],v[144:147]
 ds_read_b64_tr_b16 a[140:141],v128 offset:0
 v_mfma_f32_16x16x32_bf16 v[176:179],a[96:99],a[152:155],v[176:179]
 ds_read_b64_tr_b16 a[142:143],v128 offset:4096
 v_mfma_f32_16x16x32_bf16 v[208:211],a[96:99],a[156:159],v[208:211]
 buffer_load_dwordx4 v133,s[20:23],s33 offen offset:2048 nt lds
 v_mfma_f32_16x16x32_bf16 v[240:243],a[96:99],a[160:163],v[240:243]
 v_mfma_f32_16x16x32_bf16 v[20:23],a[100:103],a[144:147],v[20:23]
 v_mfma_f32_16x16x32_bf16 v[148:151],a[100:103],a[148:151],v[148:151]
 buffer_load_dwordx4 v134,s[20:23],s33 offen offset:3072 nt lds
 v_mfma_f32_16x16x32_bf16 v[180:183],a[100:103],a[152:155],v[180:183]
 v_mfma_f32_16x16x32_bf16 v[212:215],a[100:103],a[156:159],v[212:215]
 v_mfma_f32_16x16x32_bf16 v[244:247],a[100:103],a[160:163],v[244:247]
 v_mfma_f32_16x16x32_bf16 v[24:27],a[104:107],a[144:147],v[24:27]
 v_mfma_f32_16x16x32_bf16 v[152:155],a[104:107],a[148:151],v[152:155]
 v_mfma_f32_16x16x32_bf16 v[184:187],a[104:107],a[152:155],v[184:187]
 v_mfma_f32_16x16x32_bf16 v[216:219],a[104:107],a[156:159],v[216:219]
 v_mfma_f32_16x16x32_bf16 v[248:251],a[104:107],a[160:163],v[248:251]
 v_mfma_f32_16x16x32_bf16 v[28:31],a[108:111],a[144:147],v[28:31]
 v_mfma_f32_16x16x32_bf16 v[156:159],a[108:111],a[148:151],v[156:159]
 v_mfma_f32_16x16x32_bf16 v[188:191],a[108:111],a[152:155],v[188:191]
 v_mfma_f32_16x16x32_bf16 v[220:223],a[108:111],a[156:159],v[220:223]
 v_mfma_f32_16x16x32_bf16 v[252:255],a[108:111],a[160:163],v[252:255]
 s_waitcnt lgkmcnt(0)
 v_mfma_f32_16x16x32_bf16 v[0:3],a[112:115],a[164:167],v[0:3]
 v_mfma_f32_16x16x32_bf16 v[32:35],a[112:115],a[168:171],v[32:35]
 s_waitcnt vmcnt(8)
 s_barrier
 v_mfma_f32_16x16x32_bf16 v[160:163],a[112:115],a[172:175],v[160:163]
 ds_read_b128 a[144:147],v48 offset:32768
 s_add_u32 m0,s34,0x14000
 v_mfma_f32_16x16x32_bf16 v[192:195],a[112:115],a[176:179],v[192:195]
 ds_read_b128 a[148:151],v48 offset:34816
 buffer_load_dwordx4 v51,s[12:15],s91 offen offset:0  lds
 v_mfma_f32_16x16x32_bf16 v[224:227],a[112:115],a[180:183],v[224:227]
 ds_read_b128 a[152:155],v48 offset:36864
 v_mfma_f32_16x16x32_bf16 v[4:7],a[116:119],a[164:167],v[4:7]
 ds_read_b128 a[156:159],v48 offset:38912
 v_mfma_f32_16x16x32_bf16 v[36:39],a[116:119],a[168:171],v[36:39]
 ds_read_b128 a[160:163],v48 offset:40960
 buffer_load_dwordx4 v52,s[12:15],s91 offen offset:1024  lds
 v_mfma_f32_16x16x32_bf16 v[164:167],a[116:119],a[172:175],v[164:167]
 ds_read_b64_tr_b16 a[80:81],v113 offset:0
 v_mfma_f32_16x16x32_bf16 v[196:199],a[116:119],a[176:179],v[196:199]
 ds_read_b64_tr_b16 a[82:83],v113 offset:4096
 v_mfma_f32_16x16x32_bf16 v[228:231],a[116:119],a[180:183],v[228:231]
 ds_read_b64_tr_b16 a[84:85],v114 offset:0
 buffer_load_dwordx4 v53,s[12:15],s91 offen offset:2048  lds
 v_mfma_f32_16x16x32_bf16 v[8:11],a[120:123],a[164:167],v[8:11]
 ds_read_b64_tr_b16 a[86:87],v114 offset:4096
 v_mfma_f32_16x16x32_bf16 v[40:43],a[120:123],a[168:171],v[40:43]
 ds_read_b64_tr_b16 a[88:89],v115 offset:0
 v_mfma_f32_16x16x32_bf16 v[168:171],a[120:123],a[172:175],v[168:171]
 ds_read_b64_tr_b16 a[90:91],v115 offset:4096
 buffer_load_dwordx4 v54,s[12:15],s91 offen offset:3072  lds
 v_mfma_f32_16x16x32_bf16 v[200:203],a[120:123],a[176:179],v[200:203]
 ds_read_b64_tr_b16 a[92:93],v116 offset:0
 s_add_u32 s91,s91,0x40000
 v_mfma_f32_16x16x32_bf16 v[232:235],a[120:123],a[180:183],v[232:235]
 ds_read_b64_tr_b16 a[94:95],v116 offset:4096
 s_and_b32 s91,s91,0x3fffff
 v_mfma_f32_16x16x32_bf16 v[12:15],a[124:127],a[164:167],v[12:15]
 ds_read_b64_tr_b16 a[96:97],v117 offset:0
 s_add_u32 m0,s60,0xd000
 v_mfma_f32_16x16x32_bf16 v[44:47],a[124:127],a[168:171],v[44:47]
 ds_read_b64_tr_b16 a[98:99],v117 offset:4096
 s_add_u32 s58,s90,0x0
 v_mfma_f32_16x16x32_bf16 v[172:175],a[124:127],a[172:175],v[172:175]
 ds_read_b64_tr_b16 a[100:101],v118 offset:0
 buffer_load_dwordx4 v50,s[8:11],s58 offen offset:0  lds
 v_mfma_f32_16x16x32_bf16 v[204:207],a[124:127],a[176:179],v[204:207]
 ds_read_b64_tr_b16 a[102:103],v118 offset:4096
 s_add_u32 m0,s60,0xe000
 v_mfma_f32_16x16x32_bf16 v[236:239],a[124:127],a[180:183],v[236:239]
 ds_read_b64_tr_b16 a[104:105],v119 offset:0
 s_add_u32 s58,s90,0x8000
 v_mfma_f32_16x16x32_bf16 v[16:19],a[128:131],a[164:167],v[16:19]
 ds_read_b64_tr_b16 a[106:107],v119 offset:4096
 buffer_load_dwordx4 v50,s[8:11],s58 offen offset:0  lds
 v_mfma_f32_16x16x32_bf16 v[144:147],a[128:131],a[168:171],v[144:147]
 ds_read_b64_tr_b16 a[108:109],v120 offset:0
 s_add_u32 m0,s60,0xf000
 v_mfma_f32_16x16x32_bf16 v[176:179],a[128:131],a[172:175],v[176:179]
 ds_read_b64_tr_b16 a[110:111],v120 offset:4096
 s_add_u32 s58,s90,0x10000
 v_mfma_f32_16x16x32_bf16 v[208:211],a[128:131],a[176:179],v[208:211]
 buffer_load_dwordx4 v50,s[8:11],s58 offen offset:0  lds
 s_add_u32 m0,s60,0x10000
 v_mfma_f32_16x16x32_bf16 v[240:243],a[128:131],a[180:183],v[240:243]
 s_add_u32 s58,s90,0x18000
 v_mfma_f32_16x16x32_bf16 v[20:23],a[132:135],a[164:167],v[20:23]
 v_mfma_f32_16x16x32_bf16 v[148:151],a[132:135],a[168:171],v[148:151]
 buffer_load_dwordx4 v50,s[8:11],s58 offen offset:0  lds
 s_add_u32 m0,s60,0x11000
 v_mfma_f32_16x16x32_bf16 v[180:183],a[132:135],a[172:175],v[180:183]
 s_add_u32 s58,s90,0x20000
 v_mfma_f32_16x16x32_bf16 v[212:215],a[132:135],a[176:179],v[212:215]
 v_mfma_f32_16x16x32_bf16 v[244:247],a[132:135],a[180:183],v[244:247]
 buffer_load_dwordx4 v50,s[8:11],s58 offen offset:0  lds
 s_add_u32 s90,s90,128
 v_mfma_f32_16x16x32_bf16 v[24:27],a[136:139],a[164:167],v[24:27]
 s_and_b32 s90,s90,0x3ff
 v_mfma_f32_16x16x32_bf16 v[152:155],a[136:139],a[168:171],v[152:155]
 v_mfma_f32_16x16x32_bf16 v[184:187],a[136:139],a[172:175],v[184:187]
 v_mfma_f32_16x16x32_bf16 v[216:219],a[136:139],a[176:179],v[216:219]
 v_mfma_f32_16x16x32_bf16 v[248:251],a[136:139],a[180:183],v[248:251]
 v_mfma_f32_16x16x32_bf16 v[28:31],a[140:143],a[164:167],v[28:31]
 v_mfma_f32_16x16x32_bf16 v[156:159],a[140:143],a[168:171],v[156:159]
 v_mfma_f32_16x16x32_bf16 v[188:191],a[140:143],a[172:175],v[188:191]
 v_mfma_f32_16x16x32_bf16 v[220:223],a[140:143],a[176:179],v[220:223]
 v_mfma_f32_16x16x32_bf16 v[252:255],a[140:143],a[180:183],v[252:255]
 s_waitcnt lgkmcnt(0)
 v_mfma_f32_16x16x32_bf16 v[0:3],a[80:83],a[144:147],v[0:3]
 v_mfma_f32_16x16x32_bf16 v[32:35],a[80:83],a[148:151],v[32:35]
 s_waitcnt vmcnt(13)
 s_barrier
 v_mfma_f32_16x16x32_bf16 v[160:163],a[80:83],a[152:155],v[160:163]
 ds_read_b128 a[164:167],v49 offset:32768
 s_add_u32 m0,s34,0x18000
 v_mfma_f32_16x16x32_bf16 v[192:195],a[80:83],a[156:159],v[192:195]
 ds_read_b128 a[168:171],v49 offset:34816
 buffer_load_dwordx4 v51,s[12:15],s91 offen offset:0  lds
 v_mfma_f32_16x16x32_bf16 v[224:227],a[80:83],a[160:163],v[224:227]
 ds_read_b128 a[172:175],v49 offset:36864
 v_mfma_f32_16x16x32_bf16 v[4:7],a[84:87],a[144:147],v[4:7]
 ds_read_b128 a[176:179],v49 offset:38912
 v_mfma_f32_16x16x32_bf16 v[36:39],a[84:87],a[148:151],v[36:39]
 ds_read_b128 a[180:183],v49 offset:40960
 buffer_load_dwordx4 v52,s[12:15],s91 offen offset:1024  lds
 v_mfma_f32_16x16x32_bf16 v[164:167],a[84:87],a[152:155],v[164:167]
 ds_read_b64_tr_b16 a[112:113],v113 offset:16384
 v_mfma_f32_16x16x32_bf16 v[196:199],a[84:87],a[156:159],v[196:199]
 ds_read_b64_tr_b16 a[114:115],v113 offset:20480
 v_mfma_f32_16x16x32_bf16 v[228:231],a[84:87],a[160:163],v[228:231]
 ds_read_b64_tr_b16 a[116:117],v114 offset:16384
 buffer_load_dwordx4 v53,s[12:15],s91 offen offset:2048  lds
 v_mfma_f32_16x16x32_bf16 v[8:11],a[88:91],a[144:147],v[8:11]
 ds_read_b64_tr_b16 a[118:119],v114 offset:20480
 v_mfma_f32_16x16x32_bf16 v[40:43],a[88:91],a[148:151],v[40:43]
 ds_read_b64_tr_b16 a[120:121],v115 offset:16384
 v_mfma_f32_16x16x32_bf16 v[168:171],a[88:91],a[152:155],v[168:171]
 ds_read_b64_tr_b16 a[122:123],v115 offset:20480
 buffer_load_dwordx4 v54,s[12:15],s91 offen offset:3072  lds
 v_mfma_f32_16x16x32_bf16 v[200:203],a[88:91],a[156:159],v[200:203]
 ds_read_b64_tr_b16 a[124:125],v116 offset:16384
 s_add_u32 s91,s91,0x40000
 v_mfma_f32_16x16x32_bf16 v[232:235],a[88:91],a[160:163],v[232:235]
 ds_read_b64_tr_b16 a[126:127],v116 offset:20480
 s_and_b32 s91,s91,0x3fffff
 v_mfma_f32_16x16x32_bf16 v[12:15],a[92:95],a[144:147],v[12:15]
 ds_read_b64_tr_b16 a[128:129],v117 offset:16384
 s_add_u32 m0,s34,0x4000
 v_mfma_f32_16x16x32_bf16 v[44:47],a[92:95],a[148:151],v[44:47]
 ds_read_b64_tr_b16 a[130:131],v117 offset:20480
 s_xor_b32 s32,s57,0x2000
 v_mfma_f32_16x16x32_bf16 v[172:175],a[92:95],a[152:155],v[172:175]
 ds_read_b64_tr_b16 a[132:133],v118 offset:16384
 buffer_load_dwordx4 v129,s[16:19],s32 offen offset:0 nt lds
 v_mfma_f32_16x16x32_bf16 v[204:207],a[92:95],a[156:159],v[204:207]
 ds_read_b64_tr_b16 a[134:135],v118 offset:20480
 v_mfma_f32_16x16x32_bf16 v[236:239],a[92:95],a[160:163],v[236:239]
 ds_read_b64_tr_b16 a[136:137],v119 offset:16384
 v_mfma_f32_16x16x32_bf16 v[16:19],a[96:99],a[144:147],v[16:19]
 ds_read_b64_tr_b16 a[138:139],v119 offset:20480
 buffer_load_dwordx4 v130,s[16:19],s32 offen offset:1024 nt lds
 v_mfma_f32_16x16x32_bf16 v[144:147],a[96:99],a[148:151],v[144:147]
 ds_read_b64_tr_b16 a[140:141],v120 offset:16384
 v_mfma_f32_16x16x32_bf16 v[176:179],a[96:99],a[152:155],v[176:179]
 ds_read_b64_tr_b16 a[142:143],v120 offset:20480
 v_mfma_f32_16x16x32_bf16 v[208:211],a[96:99],a[156:159],v[208:211]
 buffer_load_dwordx4 v131,s[16:19],s32 offen offset:2048 nt lds
 v_mfma_f32_16x16x32_bf16 v[240:243],a[96:99],a[160:163],v[240:243]
 v_mfma_f32_16x16x32_bf16 v[20:23],a[100:103],a[144:147],v[20:23]
 v_mfma_f32_16x16x32_bf16 v[148:151],a[100:103],a[148:151],v[148:151]
 buffer_load_dwordx4 v132,s[16:19],s32 offen offset:3072 nt lds
 v_mfma_f32_16x16x32_bf16 v[180:183],a[100:103],a[152:155],v[180:183]
 v_mfma_f32_16x16x32_bf16 v[212:215],a[100:103],a[156:159],v[212:215]
 v_mfma_f32_16x16x32_bf16 v[244:247],a[100:103],a[160:163],v[244:247]
 v_mfma_f32_16x16x32_bf16 v[24:27],a[104:107],a[144:147],v[24:27]
 v_mfma_f32_16x16x32_bf16 v[152:155],a[104:107],a[148:151],v[152:155]
 v_mfma_f32_16x16x32_bf16 v[184:187],a[104:107],a[152:155],v[184:187]
 v_mfma_f32_16x16x32_bf16 v[216:219],a[104:107],a[156:159],v[216:219]
 v_mfma_f32_16x16x32_bf16 v[248:251],a[104:107],a[160:163],v[248:251]
 v_mfma_f32_16x16x32_bf16 v[28:31],a[108:111],a[144:147],v[28:31]
 v_mfma_f32_16x16x32_bf16 v[156:159],a[108:111],a[148:151],v[156:159]
 v_mfma_f32_16x16x32_bf16 v[188:191],a[108:111],a[152:155],v[188:191]
 v_mfma_f32_16x16x32_bf16 v[220:223],a[108:111],a[156:159],v[220:223]
 v_mfma_f32_16x16x32_bf16 v[252:255],a[108:111],a[160:163],v[252:255]
 s_waitcnt lgkmcnt(0)
 v_mfma_f32_16x16x32_bf16 v[0:3],a[112:115],a[164:167],v[0:3]
 v_mfma_f32_16x16x32_bf16 v[32:35],a[112:115],a[168:171],v[32:35]
 s_waitcnt vmcnt(8)
 s_barrier
 v_mfma_f32_16x16x32_bf16 v[160:163],a[112:115],a[172:175],v[160:163]
 ds_read_b128 a[144:147],v48 offset:53248
 s_add_u32 m0,s34,0x1c000
 v_mfma_f32_16x16x32_bf16 v[192:195],a[112:115],a[176:179],v[192:195]
 ds_read_b128 a[148:151],v48 offset:55296
 buffer_load_dwordx4 v51,s[12:15],s91 offen offset:0  lds
 v_mfma_f32_16x16x32_bf16 v[224:227],a[112:115],a[180:183],v[224:227]
 ds_read_b128 a[152:155],v48 offset:57344
 v_mfma_f32_16x16x32_bf16 v[4:7],a[116:119],a[164:167],v[4:7]
 ds_read_b128 a[156:159],v48 offset:59392
 v_mfma_f32_16x16x32_bf16 v[36:39],a[116:119],a[168:171],v[36:39]
 ds_read_b128 a[160:163],v48 offset:61440
 buffer_load_dwordx4 v52,s[12:15],s91 offen offset:1024  lds
 v_mfma_f32_16x16x32_bf16 v[164:167],a[116:119],a[172:175],v[164:167]
 ds_read_b64_tr_b16 a[80:81],v121 offset:0
 v_mfma_f32_16x16x32_bf16 v[196:199],a[116:119],a[176:179],v[196:199]
 ds_read_b64_tr_b16 a[82:83],v121 offset:4096
 v_mfma_f32_16x16x32_bf16 v[228:231],a[116:119],a[180:183],v[228:231]
 ds_read_b64_tr_b16 a[84:85],v122 offset:0
 buffer_load_dwordx4 v53,s[12:15],s91 offen offset:2048  lds
 v_mfma_f32_16x16x32_bf16 v[8:11],a[120:123],a[164:167],v[8:11]
 ds_read_b64_tr_b16 a[86:87],v122 offset:4096
 v_mfma_f32_16x16x32_bf16 v[40:43],a[120:123],a[168:171],v[40:43]
 ds_read_b64_tr_b16 a[88:89],v123 offset:0
 v_mfma_f32_16x16x32_bf16 v[168:171],a[120:123],a[172:175],v[168:171]
 ds_read_b64_tr_b16 a[90:91],v123 offset:4096
 buffer_load_dwordx4 v54,s[12:15],s91 offen offset:3072  lds
 v_mfma_f32_16x16x32_bf16 v[200:203],a[120:123],a[176:179],v[200:203]
 ds_read_b64_tr_b16 a[92:93],v124 offset:0
 s_add_u32 s91,s91,0x40000
 v_mfma_f32_16x16x32_bf16 v[232:235],a[120:123],a[180:183],v[232:235]
 ds_read_b64_tr_b16 a[94:95],v124 offset:4096
 s_and_b32 s91,s91,0x3fffff
 v_mfma_f32_16x16x32_bf16 v[12:15],a[124:127],a[164:167],v[12:15]
 ds_read_b64_tr_b16 a[96:97],v125 offset:0
 s_add_u32 m0,s60,0x8000
 v_mfma_f32_16x16x32_bf16 v[44:47],a[124:127],a[168:171],v[44:47]
 ds_read_b64_tr_b16 a[98:99],v125 offset:4096
 s_add_u32 s58,s90,0x0
 v_mfma_f32_16x16x32_bf16 v[172:175],a[124:127],a[172:175],v[172:175]
 ds_read_b64_tr_b16 a[100:101],v126 offset:0
 buffer_load_dwordx4 v50,s[8:11],s58 offen offset:0  lds
 v_mfma_f32_16x16x32_bf16 v[204:207],a[124:127],a[176:179],v[204:207]
 ds_read_b64_tr_b16 a[102:103],v126 offset:4096
 s_add_u32 m0,s60,0x9000
 v_mfma_f32_16x16x32_bf16 v[236:239],a[124:127],a[180:183],v[236:239]
 ds_read_b64_tr_b16 a[104:105],v127 offset:0
 s_add_u32 s58,s90,0x8000
 v_mfma_f32_16x16x32_bf16 v[16:19],a[128:131],a[164:167],v[16:19]
 ds_read_b64_tr_b16 a[106:107],v127 offset:4096
 buffer_load_dwordx4 v50,s[8:11],s58 offen offset:0  lds
 v_mfma_f32_16x16x32_bf16 v[144:147],a[128:131],a[168:171],v[144:147]
 ds_read_b64_tr_b16 a[108:109],v128 offset:0
 s_add_u32 m0,s60,0xa000
 v_mfma_f32_16x16x32_bf16 v[176:179],a[128:131],a[172:175],v[176:179]
 ds_read_b64_tr_b16 a[110:111],v128 offset:4096
 s_add_u32 s58,s90,0x10000
 v_mfma_f32_16x16x32_bf16 v[208:211],a[128:131],a[176:179],v[208:211]
 buffer_load_dwordx4 v50,s[8:11],s58 offen offset:0  lds
 s_add_u32 m0,s60,0xb000
 v_mfma_f32_16x16x32_bf16 v[240:243],a[128:131],a[180:183],v[240:243]
 s_add_u32 s58,s90,0x18000
 v_mfma_f32_16x16x32_bf16 v[20:23],a[132:135],a[164:167],v[20:23]
 v_mfma_f32_16x16x32_bf16 v[148:151],a[132:135],a[168:171],v[148:151]
 buffer_load_dwordx4 v50,s[8:11],s58 offen offset:0  lds
 s_add_u32 m0,s60,0xc000
 v_mfma_f32_16x16x32_bf16 v[180:183],a[132:135],a[172:175],v[180:183]
 s_add_u32 s58,s90,0x20000
 v_mfma_f32_16x16x32_bf16 v[212:215],a[132:135],a[176:179],v[212:215]
 v_mfma_f32_16x16x32_bf16 v[244:247],a[132:135],a[180:183],v[244:247]
 buffer_load_dwordx4 v50,s[8:11],s58 offen offset:0  lds
 s_add_u32 s90,s90,128
 v_mfma_f32_16x16x32_bf16 v[24:27],a[136:139],a[164:167],v[24:27]
 s_and_b32 s90,s90,0x3ff
 v_mfma_f32_16x16x32_bf16 v[152:155],a[136:139],a[168:171],v[152:155]
 v_mfma_f32_16x16x32_bf16 v[184:187],a[136:139],a[172:175],v[184:187]
 v_mfma_f32_16x16x32_bf16 v[216:219],a[136:139],a[176:179],v[216:219]
 v_mfma_f32_16x16x32_bf16 v[248:251],a[136:139],a[180:183],v[248:251]
 v_mfma_f32_16x16x32_bf16 v[28:31],a[140:143],a[164:167],v[28:31]
 v_mfma_f32_16x16x32_bf16 v[156:159],a[140:143],a[168:171],v[156:159]
 v_mfma_f32_16x16x32_bf16 v[188:191],a[140:143],a[172:175],v[188:191]
 v_mfma_f32_16x16x32_bf16 v[220:223],a[140:143],a[176:179],v[220:223]
 v_mfma_f32_16x16x32_bf16 v[252:255],a[140:143],a[180:183],v[252:255]
 s_waitcnt lgkmcnt(0)
 v_mfma_f32_16x16x32_bf16 v[0:3],a[80:83],a[144:147],v[0:3]
 v_mfma_f32_16x16x32_bf16 v[32:35],a[80:83],a[148:151],v[32:35]
 s_waitcnt vmcnt(13)
 s_barrier
 v_mfma_f32_16x16x32_bf16 v[160:163],a[80:83],a[152:155],v[160:163]
 ds_read_b128 a[164:167],v49 offset:53248
 s_add_u32 m0,s34,0x14000
 v_mfma_f32_16x16x32_bf16 v[192:195],a[80:83],a[156:159],v[192:195]
 ds_read_b128 a[168:171],v49 offset:55296
 buffer_load_dwordx4 v51,s[12:15],s91 offen offset:0  lds
 v_mfma_f32_16x16x32_bf16 v[224:227],a[80:83],a[160:163],v[224:227]
 ds_read_b128 a[172:175],v49 offset:57344
 v_mfma_f32_16x16x32_bf16 v[4:7],a[84:87],a[144:147],v[4:7]
 ds_read_b128 a[176:179],v49 offset:59392
 v_mfma_f32_16x16x32_bf16 v[36:39],a[84:87],a[148:151],v[36:39]
 ds_read_b128 a[180:183],v49 offset:61440
 buffer_load_dwordx4 v52,s[12:15],s91 offen offset:1024  lds
 v_mfma_f32_16x16x32_bf16 v[164:167],a[84:87],a[152:155],v[164:167]
 ds_read_b64_tr_b16 a[112:113],v113 offset:0
 v_mfma_f32_16x16x32_bf16 v[196:199],a[84:87],a[156:159],v[196:199]
 ds_read_b64_tr_b16 a[114:115],v113 offset:4096
 v_mfma_f32_16x16x32_bf16 v[228:231],a[84:87],a[160:163],v[228:231]
 ds_read_b64_tr_b16 a[116:117],v114 offset:0
 buffer_load_dwordx4 v53,s[12:15],s91 offen offset:2048  lds
 v_mfma_f32_16x16x32_bf16 v[8:11],a[88:91],a[144:147],v[8:11]
 ds_read_b64_tr_b16 a[118:119],v114 offset:4096
 v_mfma_f32_16x16x32_bf16 v[40:43],a[88:91],a[148:151],v[40:43]
 ds_read_b64_tr_b16 a[120:121],v115 offset:0
 v_mfma_f32_16x16x32_bf16 v[168:171],a[88:91],a[152:155],v[168:171]
 ds_read_b64_tr_b16 a[122:123],v115 offset:4096
 buffer_load_dwordx4 v54,s[12:15],s91 offen offset:3072  lds
 v_mfma_f32_16x16x32_bf16 v[200:203],a[88:91],a[156:159],v[200:203]
 ds_read_b64_tr_b16 a[124:125],v116 offset:0
 s_add_u32 s91,s91,0x40000
 v_mfma_f32_16x16x32_bf16 v[232:235],a[88:91],a[160:163],v[232:235]
 ds_read_b64_tr_b16 a[126:127],v116 offset:4096
 s_and_b32 s91,s91,0x3fffff
 v_mfma_f32_16x16x32_bf16 v[12:15],a[92:95],a[144:147],v[12:15]
 ds_read_b64_tr_b16 a[128:129],v117 offset:0
 s_add_u32 m0,s34,0x24000
 v_mfma_f32_16x16x32_bf16 v[44:47],a[92:95],a[148:151],v[44:47]
 ds_read_b64_tr_b16 a[130:131],v117 offset:4096
 s_xor_b32 s33,s57,0x2000
 v_mfma_f32_16x16x32_bf16 v[172:175],a[92:95],a[152:155],v[172:175]
 ds_read_b64_tr_b16 a[132:133],v118 offset:0
 buffer_load_dwordx4 v133,s[20:23],s33 offen offset:0 nt lds
 v_mfma_f32_16x16x32_bf16 v[204:207],a[92:95],a[156:159],v[204:207]
 ds_read_b64_tr_b16 a[134:135],v118 offset:4096
 v_mfma_f32_16x16x32_bf16 v[236:239],a[92:95],a[160:163],v[236:239]
 ds_read_b64_tr_b16 a[136:137],v119 offset:0
 v_mfma_f32_16x16x32_bf16 v[16:19],a[96:99],a[144:147],v[16:19]
 ds_read_b64_tr_b16 a[138:139],v119 offset:4096
 buffer_load_dwordx4 v134,s[20:23],s33 offen offset:1024 nt lds
 v_mfma_f32_16x16x32_bf16 v[144:147],a[96:99],a[148:151],v[144:147]
 ds_read_b64_tr_b16 a[140:141],v120 offset:0
 v_mfma_f32_16x16x32_bf16 v[176:179],a[96:99],a[152:155],v[176:179]
 ds_read_b64_tr_b16 a[142:143],v120 offset:4096
 v_mfma_f32_16x16x32_bf16 v[208:211],a[96:99],a[156:159],v[208:211]
 buffer_load_dwordx4 v133,s[20:23],s33 offen offset:2048 nt lds
 v_mfma_f32_16x16x32_bf16 v[240:243],a[96:99],a[160:163],v[240:243]
 v_mfma_f32_16x16x32_bf16 v[20:23],a[100:103],a[144:147],v[20:23]
 v_mfma_f32_16x16x32_bf16 v[148:151],a[100:103],a[148:151],v[148:151]
 buffer_load_dwordx4 v134,s[20:23],s33 offen offset:3072 nt lds
 v_mfma_f32_16x16x32_bf16 v[180:183],a[100:103],a[152:155],v[180:183]
 v_mfma_f32_16x16x32_bf16 v[212:215],a[100:103],a[156:159],v[212:215]
 v_mfma_f32_16x16x32_bf16 v[244:247],a[100:103],a[160:163],v[244:247]
 v_mfma_f32_16x16x32_bf16 v[24:27],a[104:107],a[144:147],v[24:27]
 v_mfma_f32_16x16x32_bf16 v[152:155],a[104:107],a[148:151],v[152:155]
 v_mfma_f32_16x16x32_bf16 v[184:187],a[104:107],a[152:155],v[184:187]
 v_mfma_f32_16x16x32_bf16 v[216:219],a[104:107],a[156:159],v[216:219]
 v_mfma_f32_16x16x32_bf16 v[248:251],a[104:107],a[160:163],v[248:251]
 v_mfma_f32_16x16x32_bf16 v[28:31],a[108:111],a[144:147],v[28:31]
 v_mfma_f32_16x16x32_bf16 v[156:159],a[108:111],a[148:151],v[156:159]
 v_mfma_f32_16x16x32_bf16 v[188:191],a[108:111],a[152:155],v[188:191]
 v_mfma_f32_16x16x32_bf16 v[220:223],a[108:111],a[156:159],v[220:223]
 v_mfma_f32_16x16x32_bf16 v[252:255],a[108:111],a[160:163],v[252:255]
 s_waitcnt lgkmcnt(0)
 v_mfma_f32_16x16x32_bf16 v[0:3],a[112:115],a[164:167],v[0:3]
 v_mfma_f32_16x16x32_bf16 v[32:35],a[112:115],a[168:171],v[32:35]
 s_waitcnt vmcnt(8)
 s_barrier
 v_mfma_f32_16x16x32_bf16 v[160:163],a[112:115],a[172:175],v[160:163]
 ds_read_b128 a[144:147],v48 offset:32768
 s_add_u32 m0,s34,0x18000
 v_mfma_f32_16x16x32_bf16 v[192:195],a[112:115],a[176:179],v[192:195]
 ds_read_b128 a[148:151],v48 offset:34816
 buffer_load_dwordx4 v51,s[12:15],s91 offen offset:0  lds
 v_mfma_f32_16x16x32_bf16 v[224:227],a[112:115],a[180:183],v[224:227]
 ds_read_b128 a[152:155],v48 offset:36864
 v_mfma_f32_16x16x32_bf16 v[4:7],a[116:119],a[164:167],v[4:7]
 ds_read_b128 a[156:159],v48 offset:38912
 v_mfma_f32_16x16x32_bf16 v[36:39],a[116:119],a[168:171],v[36:39]
 ds_read_b128 a[160:163],v48 offset:40960
 buffer_load_dwordx4 v52,s[12:15],s91 offen offset:1024  lds
 v_mfma_f32_16x16x32_bf16 v[164:167],a[116:119],a[172:175],v[164:167]
 ds_read_b64_tr_b16 a[80:81],v113 offset:16384
 v_mfma_f32_16x16x32_bf16 v[196:199],a[116:119],a[176:179],v[196:199]
 ds_read_b64_tr_b16 a[82:83],v113 offset:20480
 v_mfma_f32_16x16x32_bf16 v[228:231],a[116:119],a[180:183],v[228:231]
 ds_read_b64_tr_b16 a[84:85],v114 offset:16384
 buffer_load_dwordx4 v53,s[12:15],s91 offen offset:2048  lds
 v_mfma_f32_16x16x32_bf16 v[8:11],a[120:123],a[164:167],v[8:11]
 ds_read_b64_tr_b16 a[86:87],v114 offset:20480
 v_mfma_f32_16x16x32_bf16 v[40:43],a[120:123],a[168:171],v[40:43]
 ds_read_b64_tr_b16 a[88:89],v115 offset:16384
 v_mfma_f32_16x16x32_bf16 v[168:171],a[120:123],a[172:175],v[168:171]
 ds_read_b64_tr_b16 a[90:91],v115 offset:20480
 buffer_load_dwordx4 v54,s[12:15],s91 offen offset:3072  lds
 v_mfma_f32_16x16x32_bf16 v[200:203],a[120:123],a[176:179],v[200:203]
 ds_read_b64_tr_b16 a[92:93],v116 offset:16384
 s_add_u32 s91,s91,0x40000
 v_mfma_f32_16x16x32_bf16 v[232:235],a[120:123],a[180:183],v[232:235]
 ds_read_b64_tr_b16 a[94:95],v116 offset:20480
 s_and_b32 s91,s91,0x3fffff
 v_mfma_f32_16x16x32_bf16 v[12:15],a[124:127],a[164:167],v[12:15]
 ds_read_b64_tr_b16 a[96:97],v117 offset:16384
 s_add_u32 m0,s60,0xd000
 v_mfma_f32_16x16x32_bf16 v[44:47],a[124:127],a[168:171],v[44:47]
 ds_read_b64_tr_b16 a[98:99],v117 offset:20480
 s_add_u32 s58,s90,0x0
 v_mfma_f32_16x16x32_bf16 v[172:175],a[124:127],a[172:175],v[172:175]
 ds_read_b64_tr_b16 a[100:101],v118 offset:16384
 buffer_load_dwordx4 v50,s[8:11],s58 offen offset:0  lds
 v_mfma_f32_16x16x32_bf16 v[204:207],a[124:127],a[176:179],v[204:207]
 ds_read_b64_tr_b16 a[102:103],v118 offset:20480
 s_add_u32 m0,s60,0xe000
 v_mfma_f32_16x16x32_bf16 v[236:239],a[124:127],a[180:183],v[236:239]
 ds_read_b64_tr_b16 a[104:105],v119 offset:16384
 s_add_u32 s58,s90,0x8000
 v_mfma_f32_16x16x32_bf16 v[16:19],a[128:131],a[164:167],v[16:19]
 ds_read_b64_tr_b16 a[106:107],v119 offset:20480
 buffer_load_dwordx4 v50,s[8:11],s58 offen offset:0  lds
 v_mfma_f32_16x16x32_bf16 v[144:147],a[128:131],a[168:171],v[144:147]
 ds_read_b64_tr_b16 a[108:109],v120 offset:16384
 s_add_u32 m0,s60,0xf000
 v_mfma_f32_16x16x32_bf16 v[176:179],a[128:131],a[172:175],v[176:179]
 ds_read_b64_tr_b16 a[110:111],v120 offset:20480
 s_add_u32 s58,s90,0x10000
 v_mfma_f32_16x16x32_bf16 v[208:211],a[128:131],a[176:179],v[208:211]
 buffer_load_dwordx4 v50,s[8:11],s58 offen offset:0  lds
 s_add_u32 m0,s60,0x10000
 v_mfma_f32_16x16x32_bf16 v[240:243],a[128:131],a[180:183],v[240:243]
 s_add_u32 s58,s90,0x18000
 v_mfma_f32_16x16x32_bf16 v[20:23],a[132:135],a[164:167],v[20:23]
 v_mfma_f32_16x16x32_bf16 v[148:151],a[132:135],a[168:171],v[148:151]
 buffer_load_dwordx4 v50,s[8:11],s58 offen offset:0  lds
 s_add_u32 m0,s60,0x11000
 v_mfma_f32_16x16x32_bf16 v[180:183],a[132:135],a[172:175],v[180:183]
 s_add_u32 s58,s90,0x20000
 v_mfma_f32_16x16x32_bf16 v[212:215],a[132:135],a[176:179],v[212:215]
 v_mfma_f32_16x16x32_bf16 v[244:247],a[132:135],a[180:183],v[244:247]
 buffer_load_dwordx4 v50,s[8:11],s58 offen offset:0  lds
 s_add_u32 s90,s90,128
 v_mfma_f32_16x16x32_bf16 v[24:27],a[136:139],a[164:167],v[24:27]
 s_and_b32 s90,s90,0x3ff
 v_mfma_f32_16x16x32_bf16 v[152:155],a[136:139],a[168:171],v[152:155]
 v_mfma_f32_16x16x32_bf16 v[184:187],a[136:139],a[172:175],v[184:187]
 v_mfma_f32_16x16x32_bf16 v[216:219],a[136:139],a[176:179],v[216:219]
 v_mfma_f32_16x16x32_bf16 v[248:251],a[136:139],a[180:183],v[248:251]
 v_mfma_f32_16x16x32_bf16 v[28:31],a[140:143],a[164:167],v[28:31]
 v_mfma_f32_16x16x32_bf16 v[156:159],a[140:143],a[168:171],v[156:159]
 v_mfma_f32_16x16x32_bf16 v[188:191],a[140:143],a[172:175],v[188:191]
 v_mfma_f32_16x16x32_bf16 v[220:223],a[140:143],a[176:179],v[220:223]
 v_mfma_f32_16x16x32_bf16 v[252:255],a[140:143],a[180:183],v[252:255]
 s_waitcnt lgkmcnt(0)
 v_mfma_f32_16x16x32_bf16 v[0:3],a[80:83],a[144:147],v[0:3]
 v_mfma_f32_16x16x32_bf16 v[32:35],a[80:83],a[148:151],v[32:35]
 s_waitcnt vmcnt(13)
 s_barrier
 v_mfma_f32_16x16x32_bf16 v[160:163],a[80:83],a[152:155],v[160:163]
 ds_read_b128 a[164:167],v49 offset:32768
 s_add_u32 m0,s34,0x1c000
 v_mfma_f32_16x16x32_bf16 v[192:195],a[80:83],a[156:159],v[192:195]
 ds_read_b128 a[168:171],v49 offset:34816
 buffer_load_dwordx4 v51,s[12:15],s91 offen offset:0  lds
 v_mfma_f32_16x16x32_bf16 v[224:227],a[80:83],a[160:163],v[224:227]
 ds_read_b128 a[172:175],v49 offset:36864
 v_mfma_f32_16x16x32_bf16 v[4:7],a[84:87],a[144:147],v[4:7]
 ds_read_b128 a[176:179],v49 offset:38912
 v_mfma_f32_16x16x32_bf16 v[36:39],a[84:87],a[148:151],v[36:39]
 ds_read_b128 a[180:183],v49 offset:40960
 buffer_load_dwordx4 v52,s[12:15],s91 offen offset:1024  lds
 v_mfma_f32_16x16x32_bf16 v[164:167],a[84:87],a[152:155],v[164:167]
 ds_read_b64_tr_b16 a[112:113],v121 offset:0
 v_mfma_f32_16x16x32_bf16 v[196:199],a[84:87],a[156:159],v[196:199]
 ds_read_b64_tr_b16 a[114:115],v121 offset:4096
 v_mfma_f32_16x16x32_bf16 v[228:231],a[84:87],a[160:163],v[228:231]
 ds_read_b64_tr_b16 a[116:117],v122 offset:0
 buffer_load_dwordx4 v53,s[12:15],s91 offen offset:2048  lds
 v_mfma_f32_16x16x32_bf16 v[8:11],a[88:91],a[144:147],v[8:11]
 ds_read_b64_tr_b16 a[118:119],v122 offset:4096
 v_mfma_f32_16x16x32_bf16 v[40:43],a[88:91],a[148:151],v[40:43]
 ds_read_b64_tr_b16 a[120:121],v123 offset:0
 v_mfma_f32_16x16x32_bf16 v[168:171],a[88:91],a[152:155],v[168:171]
 ds_read_b64_tr_b16 a[122:123],v123 offset:4096
 buffer_load_dwordx4 v54,s[12:15],s91 offen offset:3072  lds
 v_mfma_f32_16x16x32_bf16 v[200:203],a[88:91],a[156:159],v[200:203]
 ds_read_b64_tr_b16 a[124:125],v124 offset:0
 s_add_u32 s91,s91,0x40000
 v_mfma_f32_16x16x32_bf16 v[232:235],a[88:91],a[160:163],v[232:235]
 ds_read_b64_tr_b16 a[126:127],v124 offset:4096
 s_and_b32 s91,s91,0x3fffff
 v_mfma_f32_16x16x32_bf16 v[12:15],a[92:95],a[144:147],v[12:15]
 ds_read_b64_tr_b16 a[128:129],v125 offset:0
 v_mfma_f32_16x16x32_bf16 v[44:47],a[92:95],a[148:151],v[44:47]
 ds_read_b64_tr_b16 a[130:131],v125 offset:4096
 v_mfma_f32_16x16x32_bf16 v[172:175],a[92:95],a[152:155],v[172:175]
 ds_read_b64_tr_b16 a[132:133],v126 offset:0
 v_mfma_f32_16x16x32_bf16 v[204:207],a[92:95],a[156:159],v[204:207]
 ds_read_b64_tr_b16 a[134:135],v126 offset:4096
 v_mfma_f32_16x16x32_bf16 v[236:239],a[92:95],a[160:163],v[236:239]
 ds_read_b64_tr_b16 a[136:137],v127 offset:0
 v_mfma_f32_16x16x32_bf16 v[16:19],a[96:99],a[144:147],v[16:19]
 ds_read_b64_tr_b16 a[138:139],v127 offset:4096
 v_mfma_f32_16x16x32_bf16 v[144:147],a[96:99],a[148:151],v[144:147]
 ds_read_b64_tr_b16 a[140:141],v128 offset:0
 v_mfma_f32_16x16x32_bf16 v[176:179],a[96:99],a[152:155],v[176:179]
 ds_read_b64_tr_b16 a[142:143],v128 offset:4096
 v_mfma_f32_16x16x32_bf16 v[208:211],a[96:99],a[156:159],v[208:211]
 v_mfma_f32_16x16x32_bf16 v[240:243],a[96:99],a[160:163],v[240:243]
 v_mfma_f32_16x16x32_bf16 v[20:23],a[100:103],a[144:147],v[20:23]
 v_mfma_f32_16x16x32_bf16 v[148:151],a[100:103],a[148:151],v[148:151]
 v_mfma_f32_16x16x32_bf16 v[180:183],a[100:103],a[152:155],v[180:183]
 v_mfma_f32_16x16x32_bf16 v[212:215],a[100:103],a[156:159],v[212:215]
 v_mfma_f32_16x16x32_bf16 v[244:247],a[100:103],a[160:163],v[244:247]
 v_mfma_f32_16x16x32_bf16 v[24:27],a[104:107],a[144:147],v[24:27]
 v_mfma_f32_16x16x32_bf16 v[152:155],a[104:107],a[148:151],v[152:155]
 v_mfma_f32_16x16x32_bf16 v[184:187],a[104:107],a[152:155],v[184:187]
 v_mfma_f32_16x16x32_bf16 v[216:219],a[104:107],a[156:159],v[216:219]
 v_mfma_f32_16x16x32_bf16 v[248:251],a[104:107],a[160:163],v[248:251]
 v_mfma_f32_16x16x32_bf16 v[28:31],a[108:111],a[144:147],v[28:31]
 v_mfma_f32_16x16x32_bf16 v[156:159],a[108:111],a[148:151],v[156:159]
 v_mfma_f32_16x16x32_bf16 v[188:191],a[108:111],a[152:155],v[188:191]
 v_mfma_f32_16x16x32_bf16 v[220:223],a[108:111],a[156:159],v[220:223]
 v_mfma_f32_16x16x32_bf16 v[252:255],a[108:111],a[160:163],v[252:255]
 s_waitcnt lgkmcnt(0)
 v_mfma_f32_16x16x32_bf16 v[0:3],a[112:115],a[164:167],v[0:3]
 v_mfma_f32_16x16x32_bf16 v[32:35],a[112:115],a[168:171],v[32:35]
 s_waitcnt vmcnt(4)
 s_barrier
 v_mfma_f32_16x16x32_bf16 v[160:163],a[112:115],a[172:175],v[160:163]
 ds_read_b128 a[144:147],v48 offset:53248
 s_add_u32 m0,s34,0x8000
 v_mfma_f32_16x16x32_bf16 v[192:195],a[112:115],a[176:179],v[192:195]
 ds_read_b128 a[148:151],v48 offset:55296
 s_xor_b32 s32,s57,0x4000
 v_mfma_f32_16x16x32_bf16 v[224:227],a[112:115],a[180:183],v[224:227]
 ds_read_b128 a[152:155],v48 offset:57344
 buffer_load_dwordx4 v129,s[16:19],s32 offen offset:0 nt lds
 v_mfma_f32_16x16x32_bf16 v[4:7],a[116:119],a[164:167],v[4:7]
 ds_read_b128 a[156:159],v48 offset:59392
 v_mfma_f32_16x16x32_bf16 v[36:39],a[116:119],a[168:171],v[36:39]
 ds_read_b128 a[160:163],v48 offset:61440
 v_mfma_f32_16x16x32_bf16 v[164:167],a[116:119],a[172:175],v[164:167]
 ds_read_b64_tr_b16 a[80:81],v113 offset:0
 buffer_load_dwordx4 v130,s[16:19],s32 offen offset:1024 nt lds
 v_mfma_f32_16x16x32_bf16 v[196:199],a[116:119],a[176:179],v[196:199]
 ds_read_b64_tr_b16 a[82:83],v113 offset:4096
 v_mfma_f32_16x16x32_bf16 v[228:231],a[116:119],a[180:183],v[228:231]
 ds_read_b64_tr_b16 a[84:85],v114 offset:0
 v_mfma_f32_16x16x32_bf16 v[8:11],a[120:123],a[164:167],v[8:11]
 ds_read_b64_tr_b16 a[86:87],v114 offset:4096
 buffer_load_dwordx4 v131,s[16:19],s32 offen offset:2048 nt lds
 v_mfma_f32_16x16x32_bf16 v[40:43],a[120:123],a[168:171],v[40:43]
 ds_read_b64_tr_b16 a[88:89],v115 offset:0
 v_mfma_f32_16x16x32_bf16 v[168:171],a[120:123],a[172:175],v[168:171]
 ds_read_b64_tr_b16 a[90:91],v115 offset:4096
 v_mfma_f32_16x16x32_bf16 v[200:203],a[120:123],a[176:179],v[200:203]
 ds_read_b64_tr_b16 a[92:93],v116 offset:0
 buffer_load_dwordx4 v132,s[16:19],s32 offen offset:3072 nt lds
 v_mfma_f32_16x16x32_bf16 v[232:235],a[120:123],a[180:183],v[232:235]
 ds_read_b64_tr_b16 a[94:95],v116 offset:4096
 s_add_u32 m0,s34,0x14000
 v_mfma_f32_16x16x32_bf16 v[12:15],a[124:127],a[164:167],v[12:15]
 ds_read_b64_tr_b16 a[96:97],v117 offset:0
 s_xor_b32 s33,s57,0x4000
 v_mfma_f32_16x16x32_bf16 v[44:47],a[124:127],a[168:171],v[44:47]
 ds_read_b64_tr_b16 a[98:99],v117 offset:4096
 buffer_load_dwordx4 v133,s[20:23],s33 offen offset:0 nt lds
 v_mfma_f32_16x16x32_bf16 v[172:175],a[124:127],a[172:175],v[172:175]
 ds_read_b64_tr_b16 a[100:101],v118 offset:0
 v_mfma_f32_16x16x32_bf16 v[204:207],a[124:127],a[176:179],v[204:207]
 ds_read_b64_tr_b16 a[102:103],v118 offset:4096
 v_mfma_f32_16x16x32_bf16 v[236:239],a[124:127],a[180:183],v[236:239]
 ds_read_b64_tr_b16 a[104:105],v119 offset:0
 buffer_load_dwordx4 v134,s[20:23],s33 offen offset:1024 nt lds
 v_mfma_f32_16x16x32_bf16 v[16:19],a[128:131],a[164:167],v[16:19]
 ds_read_b64_tr_b16 a[106:107],v119 offset:4096
 v_mfma_f32_16x16x32_bf16 v[144:147],a[128:131],a[168:171],v[144:147]
 ds_read_b64_tr_b16 a[108:109],v120 offset:0
 v_mfma_f32_16x16x32_bf16 v[176:179],a[128:131],a[172:175],v[176:179]
 ds_read_b64_tr_b16 a[110:111],v120 offset:4096
 buffer_load_dwordx4 v133,s[20:23],s33 offen offset:2048 nt lds
 v_mfma_f32_16x16x32_bf16 v[208:211],a[128:131],a[176:179],v[208:211]
 v_mfma_f32_16x16x32_bf16 v[240:243],a[128:131],a[180:183],v[240:243]
 v_mfma_f32_16x16x32_bf16 v[20:23],a[132:135],a[164:167],v[20:23]
 buffer_load_dwordx4 v134,s[20:23],s33 offen offset:3072 nt lds
 v_mfma_f32_16x16x32_bf16 v[148:151],a[132:135],a[168:171],v[148:151]
 v_mfma_f32_16x16x32_bf16 v[180:183],a[132:135],a[172:175],v[180:183]
 v_mfma_f32_16x16x32_bf16 v[212:215],a[132:135],a[176:179],v[212:215]
 v_mfma_f32_16x16x32_bf16 v[244:247],a[132:135],a[180:183],v[244:247]
 v_mfma_f32_16x16x32_bf16 v[24:27],a[136:139],a[164:167],v[24:27]
 v_mfma_f32_16x16x32_bf16 v[152:155],a[136:139],a[168:171],v[152:155]
 v_mfma_f32_16x16x32_bf16 v[184:187],a[136:139],a[172:175],v[184:187]
 v_mfma_f32_16x16x32_bf16 v[216:219],a[136:139],a[176:179],v[216:219]
 v_mfma_f32_16x16x32_bf16 v[248:251],a[136:139],a[180:183],v[248:251]
 v_mfma_f32_16x16x32_bf16 v[28:31],a[140:143],a[164:167],v[28:31]
 v_mfma_f32_16x16x32_bf16 v[156:159],a[140:143],a[168:171],v[156:159]
 v_mfma_f32_16x16x32_bf16 v[188:191],a[140:143],a[172:175],v[188:191]
 v_mfma_f32_16x16x32_bf16 v[220:223],a[140:143],a[176:179],v[220:223]
 v_mfma_f32_16x16x32_bf16 v[252:255],a[140:143],a[180:183],v[252:255]
 s_waitcnt lgkmcnt(0)
 v_mfma_f32_16x16x32_bf16 v[0:3],a[80:83],a[144:147],v[0:3]
 v_mfma_f32_16x16x32_bf16 v[32:35],a[80:83],a[148:151],v[32:35]
 s_waitcnt vmcnt(8)
 s_barrier
 v_mfma_f32_16x16x32_bf16 v[160:163],a[80:83],a[152:155],v[160:163]
 ds_read_b128 a[164:167],v49 offset:53248
 v_mfma_f32_16x16x32_bf16 v[192:195],a[80:83],a[156:159],v[192:195]
 ds_read_b128 a[168:171],v49 offset:55296
 v_mfma_f32_16x16x32_bf16 v[224:227],a[80:83],a[160:163],v[224:227]
 ds_read_b128 a[172:175],v49 offset:57344
 v_mfma_f32_16x16x32_bf16 v[4:7],a[84:87],a[144:147],v[4:7]
 ds_read_b128 a[176:179],v49 offset:59392
 v_mfma_f32_16x16x32_bf16 v[36:39],a[84:87],a[148:151],v[36:39]
 ds_read_b128 a[180:183],v49 offset:61440
 v_mfma_f32_16x16x32_bf16 v[164:167],a[84:87],a[152:155],v[164:167]
 ds_read_b64_tr_b16 a[112:113],v113 offset:16384
 v_mfma_f32_16x16x32_bf16 v[196:199],a[84:87],a[156:159],v[196:199]
 ds_read_b64_tr_b16 a[114:115],v113 offset:20480
 v_mfma_f32_16x16x32_bf16 v[228:231],a[84:87],a[160:163],v[228:231]
 ds_read_b64_tr_b16 a[116:117],v114 offset:16384
 v_mfma_f32_16x16x32_bf16 v[8:11],a[88:91],a[144:147],v[8:11]
 ds_read_b64_tr_b16 a[118:119],v114 offset:20480
 v_mfma_f32_16x16x32_bf16 v[40:43],a[88:91],a[148:151],v[40:43]
 ds_read_b64_tr_b16 a[120:121],v115 offset:16384
 v_mfma_f32_16x16x32_bf16 v[168:171],a[88:91],a[152:155],v[168:171]
 ds_read_b64_tr_b16 a[122:123],v115 offset:20480
 v_mfma_f32_16x16x32_bf16 v[200:203],a[88:91],a[156:159],v[200:203]
 ds_read_b64_tr_b16 a[124:125],v116 offset:16384
 v_mfma_f32_16x16x32_bf16 v[232:235],a[88:91],a[160:163],v[232:235]
 ds_read_b64_tr_b16 a[126:127],v116 offset:20480
 v_mfma_f32_16x16x32_bf16 v[12:15],a[92:95],a[144:147],v[12:15]
 ds_read_b64_tr_b16 a[128:129],v117 offset:16384
 v_mfma_f32_16x16x32_bf16 v[44:47],a[92:95],a[148:151],v[44:47]
 ds_read_b64_tr_b16 a[130:131],v117 offset:20480
 v_mfma_f32_16x16x32_bf16 v[172:175],a[92:95],a[152:155],v[172:175]
 ds_read_b64_tr_b16 a[132:133],v118 offset:16384
 v_mfma_f32_16x16x32_bf16 v[204:207],a[92:95],a[156:159],v[204:207]
 ds_read_b64_tr_b16 a[134:135],v118 offset:20480
 v_mfma_f32_16x16x32_bf16 v[236:239],a[92:95],a[160:163],v[236:239]
 ds_read_b64_tr_b16 a[136:137],v119 offset:16384
 v_mfma_f32_16x16x32_bf16 v[16:19],a[96:99],a[144:147],v[16:19]
 ds_read_b64_tr_b16 a[138:139],v119 offset:20480
 v_mfma_f32_16x16x32_bf16 v[144:147],a[96:99],a[148:151],v[144:147]
 ds_read_b64_tr_b16 a[140:141],v120 offset:16384
 v_mfma_f32_16x16x32_bf16 v[176:179],a[96:99],a[152:155],v[176:179]
 ds_read_b64_tr_b16 a[142:143],v120 offset:20480
 v_mfma_f32_16x16x32_bf16 v[208:211],a[96:99],a[156:159],v[208:211]
 v_mfma_f32_16x16x32_bf16 v[240:243],a[96:99],a[160:163],v[240:243]
 v_mfma_f32_16x16x32_bf16 v[20:23],a[100:103],a[144:147],v[20:23]
 v_mfma_f32_16x16x32_bf16 v[148:151],a[100:103],a[148:151],v[148:151]
 v_mfma_f32_16x16x32_bf16 v[180:183],a[100:103],a[152:155],v[180:183]
 v_mfma_f32_16x16x32_bf16 v[212:215],a[100:103],a[156:159],v[212:215]
 v_mfma_f32_16x16x32_bf16 v[244:247],a[100:103],a[160:163],v[244:247]
 v_mfma_f32_16x16x32_bf16 v[24:27],a[104:107],a[144:147],v[24:27]
 v_mfma_f32_16x16x32_bf16 v[152:155],a[104:107],a[148:151],v[152:155]
 v_mfma_f32_16x16x32_bf16 v[184:187],a[104:107],a[152:155],v[184:187]
 v_mfma_f32_16x16x32_bf16 v[216:219],a[104:107],a[156:159],v[216:219]
 v_mfma_f32_16x16x32_bf16 v[248:251],a[104:107],a[160:163],v[248:251]
 v_mfma_f32_16x16x32_bf16 v[28:31],a[108:111],a[144:147],v[28:31]
 v_mfma_f32_16x16x32_bf16 v[156:159],a[108:111],a[148:151],v[156:159]
 v_mfma_f32_16x16x32_bf16 v[188:191],a[108:111],a[152:155],v[188:191]
 v_mfma_f32_16x16x32_bf16 v[220:223],a[108:111],a[156:159],v[220:223]
 v_mfma_f32_16x16x32_bf16 v[252:255],a[108:111],a[160:163],v[252:255]
 s_waitcnt lgkmcnt(0)
 v_mfma_f32_16x16x32_bf16 v[0:3],a[112:115],a[164:167],v[0:3]
 v_mfma_f32_16x16x32_bf16 v[4:7],a[116:119],a[164:167],v[4:7]
 s_barrier
 v_mfma_f32_16x16x32_bf16 v[8:11],a[120:123],a[164:167],v[8:11]
 ds_read_b128 a[80:83],v105 offset:0
 s_add_u32 m0,s34,0xc000
 v_mfma_f32_16x16x32_bf16 v[12:15],a[124:127],a[164:167],v[12:15]
 ds_read_b128 a[96:99],v105 offset:4096
 s_xor_b32 s32,s57,0x6000
 v_mfma_f32_16x16x32_bf16 v[16:19],a[128:131],a[164:167],v[16:19]
 ds_read_b128 a[84:87],v106 offset:0
 buffer_load_dwordx4 v129,s[16:19],s32 offen offset:0 nt lds
 v_mfma_f32_16x16x32_bf16 v[20:23],a[132:135],a[164:167],v[20:23]
 ds_read_b128 a[100:103],v106 offset:4096
 v_mfma_f32_16x16x32_bf16 v[24:27],a[136:139],a[164:167],v[24:27]
 ds_read_b128 a[88:91],v107 offset:0
 v_mfma_f32_16x16x32_bf16 v[28:31],a[140:143],a[164:167],v[28:31]
 ds_read_b128 a[104:107],v107 offset:4096
 buffer_load_dwordx4 v130,s[16:19],s32 offen offset:1024 nt lds
 v_mfma_f32_16x16x32_bf16 v[32:35],a[112:115],a[168:171],v[32:35]
 ds_read_b128 a[92:95],v108 offset:0
 v_mfma_f32_16x16x32_bf16 v[36:39],a[116:119],a[168:171],v[36:39]
 ds_read_b128 a[108:111],v108 offset:4096
 v_mfma_f32_16x16x32_bf16 v[40:43],a[120:123],a[168:171],v[40:43]
 buffer_load_dwordx4 v131,s[16:19],s32 offen offset:2048 nt lds
 v_mfma_f32_16x16x32_bf16 v[44:47],a[124:127],a[168:171],v[44:47]
 v_mfma_f32_16x16x32_bf16 v[144:147],a[128:131],a[168:171],v[144:147]
 v_mfma_f32_16x16x32_bf16 v[148:151],a[132:135],a[168:171],v[148:151]
 buffer_load_dwordx4 v132,s[16:19],s32 offen offset:3072 nt lds
 v_mfma_f32_16x16x32_bf16 v[152:155],a[136:139],a[168:171],v[152:155]
 v_mfma_f32_16x16x32_bf16 v[156:159],a[140:143],a[168:171],v[156:159]
 v_mfma_f32_16x16x32_bf16 v[160:163],a[112:115],a[172:175],v[160:163]
 v_mfma_f32_16x16x32_bf16 v[164:167],a[116:119],a[172:175],v[164:167]
 v_mul_f32 v0,s54,v0
 v_mul_f32 v1,s54,v1
 v_mfma_f32_16x16x32_bf16 v[168:171],a[120:123],a[172:175],v[168:171]
 v_mul_f32 v2,s54,v2
 v_mul_f32 v3,s54,v3
 v_mfma_f32_16x16x32_bf16 v[172:175],a[124:127],a[172:175],v[172:175]
 v_mul_f32 v4,s54,v4
 v_mul_f32 v5,s54,v5
 v_mfma_f32_16x16x32_bf16 v[176:179],a[128:131],a[172:175],v[176:179]
 v_mul_f32 v6,s54,v6
 v_mul_f32 v7,s54,v7
 v_mfma_f32_16x16x32_bf16 v[180:183],a[132:135],a[172:175],v[180:183]
 v_cvt_pk_bf16_f32 v60,v0,v1
 v_cvt_pk_bf16_f32 v61,v2,v3
 v_mfma_f32_16x16x32_bf16 v[184:187],a[136:139],a[172:175],v[184:187]
 v_cvt_pk_bf16_f32 v62,v4,v5
 v_cvt_pk_bf16_f32 v63,v6,v7
 v_mfma_f32_16x16x32_bf16 v[188:191],a[140:143],a[172:175],v[188:191]
 v_mul_f32 v8,s54,v8
 v_mul_f32 v9,s54,v9
 v_mfma_f32_16x16x32_bf16 v[192:195],a[112:115],a[176:179],v[192:195]
 v_mul_f32 v10,s54,v10
 v_mul_f32 v11,s54,v11
 v_mfma_f32_16x16x32_bf16 v[196:199],a[116:119],a[176:179],v[196:199]
 v_mul_f32 v12,s54,v12
 v_mul_f32 v13,s54,v13
 v_mfma_f32_16x16x32_bf16 v[200:203],a[120:123],a[176:179],v[200:203]
 v_mul_f32 v14,s54,v14
 v_mul_f32 v15,s54,v15
 v_mfma_f32_16x16x32_bf16 v[204:207],a[124:127],a[176:179],v[204:207]
 v_cvt_pk_bf16_f32 v64,v8,v9
 v_cvt_pk_bf16_f32 v65,v10,v11
 v_mfma_f32_16x16x32_bf16 v[208:211],a[128:131],a[176:179],v[208:211]
 v_cvt_pk_bf16_f32 v66,v12,v13
 v_cvt_pk_bf16_f32 v67,v14,v15
 v_mfma_f32_16x16x32_bf16 v[212:215],a[132:135],a[176:179],v[212:215]
 v_permlane32_swap_b32 v60,v62
 v_permlane32_swap_b32 v61,v63
 v_mfma_f32_16x16x32_bf16 v[216:219],a[136:139],a[176:179],v[216:219]
 v_mul_f32 v16,s54,v16
 v_mul_f32 v17,s54,v17
 v_mfma_f32_16x16x32_bf16 v[220:223],a[140:143],a[176:179],v[220:223]
 v_mul_f32 v18,s54,v18
 v_mul_f32 v19,s54,v19
 v_mfma_f32_16x16x32_bf16 v[224:227],a[112:115],a[180:183],v[224:227]
 v_mul_f32 v20,s54,v20
 v_mul_f32 v21,s54,v21
 v_mfma_f32_16x16x32_bf16 v[228:231],a[116:119],a[180:183],v[228:231]
 v_mul_f32 v22,s54,v22
 v_mul_f32 v23,s54,v23
 v_mfma_f32_16x16x32_bf16 v[232:235],a[120:123],a[180:183],v[232:235]
 v_cvt_pk_bf16_f32 v68,v16,v17
 v_cvt_pk_bf16_f32 v69,v18,v19
 v_mfma_f32_16x16x32_bf16 v[236:239],a[124:127],a[180:183],v[236:239]
 v_cvt_pk_bf16_f32 v70,v20,v21
 v_cvt_pk_bf16_f32 v71,v22,v23
 v_mfma_f32_16x16x32_bf16 v[240:243],a[128:131],a[180:183],v[240:243]
 v_permlane16_swap_b32 v60,v62
 v_permlane16_swap_b32 v61,v63
 v_mfma_f32_16x16x32_bf16 v[244:247],a[132:135],a[180:183],v[244:247]
 v_permlane32_swap_b32 v64,v66
 v_permlane32_swap_b32 v65,v67
 v_mfma_f32_16x16x32_bf16 v[248:251],a[136:139],a[180:183],v[248:251]
 v_mfma_f32_16x16x32_bf16 v[252:255],a[140:143],a[180:183],v[252:255]
 s_add_u32 m0,s34,0x18000
 s_xor_b32 s33,s57,0x6000
 buffer_load_dwordx4 v133,s[20:23],s33 offen offset:0 nt lds
 v_pk_mul_f32 v[24:25],v[24:25],s[54:55]
 v_pk_mul_f32 v[26:27],v[26:27],s[54:55]
 v_pk_mul_f32 v[28:29],v[28:29],s[54:55]
 v_pk_mul_f32 v[30:31],v[30:31],s[54:55]
 v_cvt_pk_bf16_f32 v72,v24,v25
 v_cvt_pk_bf16_f32 v73,v26,v27
 v_cvt_pk_bf16_f32 v74,v28,v29
 v_cvt_pk_bf16_f32 v75,v30,v31
 v_accvgpr_write_b32 a0,v60
 v_accvgpr_write_b32 a1,v61
 v_accvgpr_write_b32 a2,v62
 v_accvgpr_write_b32 a3,v63
 v_permlane16_swap_b32 v64,v66
 v_permlane16_swap_b32 v65,v67
 v_permlane32_swap_b32 v68,v70
 v_permlane32_swap_b32 v69,v71
 buffer_load_dwordx4 v134,s[20:23],s33 offen offset:1024 nt lds
 v_pk_mul_f32 v[32:33],v[32:33],s[54:55]
 v_pk_mul_f32 v[34:35],v[34:35],s[54:55]
 v_pk_mul_f32 v[36:37],v[36:37],s[54:55]
 v_pk_mul_f32 v[38:39],v[38:39],s[54:55]
 v_cvt_pk_bf16_f32 v60,v32,v33
 v_cvt_pk_bf16_f32 v61,v34,v35
 v_cvt_pk_bf16_f32 v62,v36,v37
 v_cvt_pk_bf16_f32 v63,v38,v39
 v_accvgpr_write_b32 a4,v64
 v_accvgpr_write_b32 a5,v65
 v_accvgpr_write_b32 a6,v66
 v_accvgpr_write_b32 a7,v67
 v_permlane16_swap_b32 v68,v70
 v_permlane16_swap_b32 v69,v71
 v_permlane32_swap_b32 v72,v74
 v_permlane32_swap_b32 v73,v75
 buffer_load_dwordx4 v133,s[20:23],s33 offen offset:2048 nt lds
 v_pk_mul_f32 v[40:41],v[40:41],s[54:55]
 v_pk_mul_f32 v[42:43],v[42:43],s[54:55]
 v_pk_mul_f32 v[44:45],v[44:45],s[54:55]
 v_pk_mul_f32 v[46:47],v[46:47],s[54:55]
 v_cvt_pk_bf16_f32 v64,v40,v41
 v_cvt_pk_bf16_f32 v65,v42,v43
 v_cvt_pk_bf16_f32 v66,v44,v45
 v_cvt_pk_bf16_f32 v67,v46,v47
 v_accvgpr_write_b32 a8,v68
 v_accvgpr_write_b32 a9,v69
 v_accvgpr_write_b32 a10,v70
 v_accvgpr_write_b32 a11,v71
 v_permlane16_swap_b32 v72,v74
 v_permlane16_swap_b32 v73,v75
 v_permlane32_swap_b32 v60,v62
 v_permlane32_swap_b32 v61,v63
 buffer_load_dwordx4 v134,s[20:23],s33 offen offset:3072 nt lds
 v_pk_mul_f32 v[144:145],v[144:145],s[54:55]
 v_pk_mul_f32 v[146:147],v[146:147],s[54:55]
 v_pk_mul_f32 v[148:149],v[148:149],s[54:55]
 v_pk_mul_f32 v[150:151],v[150:151],s[54:55]
 v_cvt_pk_bf16_f32 v68,v144,v145
 v_cvt_pk_bf16_f32 v69,v146,v147
 v_cvt_pk_bf16_f32 v70,v148,v149
 v_cvt_pk_bf16_f32 v71,v150,v151
 v_accvgpr_write_b32 a12,v72
 v_accvgpr_write_b32 a13,v73
 v_accvgpr_write_b32 a14,v74
 v_accvgpr_write_b32 a15,v75
 v_permlane16_swap_b32 v60,v62
 v_permlane16_swap_b32 v61,v63
 v_permlane32_swap_b32 v64,v66
 v_permlane32_swap_b32 v65,v67
 s_add_u32 m0,s34,0x10000
 s_xor_b32 s32,s57,0x8000
 buffer_load_dwordx4 v129,s[16:19],s32 offen offset:0 nt lds
 v_pk_mul_f32 v[152:153],v[152:153],s[54:55]
 v_pk_mul_f32 v[154:155],v[154:155],s[54:55]
 v_pk_mul_f32 v[156:157],v[156:157],s[54:55]
 v_pk_mul_f32 v[158:159],v[158:159],s[54:55]
 v_cvt_pk_bf16_f32 v72,v152,v153
 v_cvt_pk_bf16_f32 v73,v154,v155
 v_cvt_pk_bf16_f32 v74,v156,v157
 v_cvt_pk_bf16_f32 v75,v158,v159
 v_accvgpr_write_b32 a16,v60
 v_accvgpr_write_b32 a17,v61
 v_accvgpr_write_b32 a18,v62
 v_accvgpr_write_b32 a19,v63
 v_permlane16_swap_b32 v64,v66
 v_permlane16_swap_b32 v65,v67
 v_permlane32_swap_b32 v68,v70
 v_permlane32_swap_b32 v69,v71
 buffer_load_dwordx4 v130,s[16:19],s32 offen offset:1024 nt lds
 v_mul_f32 v160,s54,v160
 v_mul_f32 v161,s54,v161
 s_waitcnt lgkmcnt(0)
 v_mfma_f32_16x16x32_bf16 v[0:3],a[80:83],a[0:3],0
 v_mul_f32 v162,s54,v162
 v_mul_f32 v163,s54,v163
 v_mfma_f32_16x16x32_bf16 v[4:7],a[96:99],a[0:3],0
 v_mul_f32 v164,s54,v164
 v_mul_f32 v165,s54,v165
 v_mfma_f32_16x16x32_bf16 v[0:3],a[84:87],a[4:7],v[0:3]
 v_mul_f32 v166,s54,v166
 v_mul_f32 v167,s54,v167
 v_mfma_f32_16x16x32_bf16 v[4:7],a[100:103],a[4:7],v[4:7]
 v_cvt_pk_bf16_f32 v60,v160,v161
 v_cvt_pk_bf16_f32 v61,v162,v163
 v_mfma_f32_16x16x32_bf16 v[0:3],a[88:91],a[8:11],v[0:3]
 v_cvt_pk_bf16_f32 v62,v164,v165
 v_cvt_pk_bf16_f32 v63,v166,v167
 v_mfma_f32_16x16x32_bf16 v[4:7],a[104:107],a[8:11],v[4:7]
 v_accvgpr_write_b32 a20,v64
 v_accvgpr_write_b32 a21,v65
 v_mfma_f32_16x16x32_bf16 v[0:3],a[92:95],a[12:15],v[0:3]
 v_accvgpr_write_b32 a22,v66
 v_accvgpr_write_b32 a23,v67
 v_mfma_f32_16x16x32_bf16 v[4:7],a[108:111],a[12:15],v[4:7]
 v_permlane16_swap_b32 v68,v70
 v_permlane16_swap_b32 v69,v71
 v_permlane32_swap_b32 v72,v74
 v_permlane32_swap_b32 v73,v75
 buffer_load_dwordx4 v131,s[16:19],s32 offen offset:2048 nt lds
 v_pk_mul_f32 v[168:169],v[168:169],s[54:55]
 v_pk_mul_f32 v[170:171],v[170:171],s[54:55]
 v_pk_mul_f32 v[172:173],v[172:173],s[54:55]
 v_pk_mul_f32 v[174:175],v[174:175],s[54:55]
 v_cvt_pk_bf16_f32 v64,v168,v169
 v_cvt_pk_bf16_f32 v65,v170,v171
 v_cvt_pk_bf16_f32 v66,v172,v173
 v_cvt_pk_bf16_f32 v67,v174,v175
 v_accvgpr_write_b32 a24,v68
 v_accvgpr_write_b32 a25,v69
 v_accvgpr_write_b32 a26,v70
 v_accvgpr_write_b32 a27,v71
 v_permlane16_swap_b32 v72,v74
 v_permlane16_swap_b32 v73,v75
 v_permlane32_swap_b32 v60,v62
 v_permlane32_swap_b32 v61,v63
 buffer_load_dwordx4 v132,s[16:19],s32 offen offset:3072 nt lds
 v_pk_mul_f32 v[176:177],v[176:177],s[54:55]
 v_pk_mul_f32 v[178:179],v[178:179],s[54:55]
 v_pk_mul_f32 v[180:181],v[180:181],s[54:55]
 v_pk_mul_f32 v[182:183],v[182:183],s[54:55]
 v_cvt_pk_bf16_f32 v68,v176,v177
 v_cvt_pk_bf16_f32 v69,v178,v179
 v_cvt_pk_bf16_f32 v70,v180,v181
 v_cvt_pk_bf16_f32 v71,v182,v183
 v_accvgpr_write_b32 a28,v72
 v_accvgpr_write_b32 a29,v73
 v_accvgpr_write_b32 a30,v74
 v_accvgpr_write_b32 a31,v75
 v_permlane16_swap_b32 v60,v62
 v_permlane16_swap_b32 v61,v63
 v_permlane32_swap_b32 v64,v66
 v_permlane32_swap_b32 v65,v67
 s_add_u32 m0,s34,0x1c000
 s_xor_b32 s33,s57,0x8000
 buffer_load_dwordx4 v133,s[20:23],s33 offen offset:0 nt lds
 v_pk_mul_f32 v[184:185],v[184:185],s[54:55]
 v_pk_mul_f32 v[186:187],v[186:187],s[54:55]
 v_pk_mul_f32 v[188:189],v[188:189],s[54:55]
 v_pk_mul_f32 v[190:191],v[190:191],s[54:55]
 v_cvt_pk_bf16_f32 v72,v184,v185
 v_cvt_pk_bf16_f32 v73,v186,v187
 v_cvt_pk_bf16_f32 v74,v188,v189
 v_cvt_pk_bf16_f32 v75,v190,v191
 v_accvgpr_write_b32 a32,v60
 v_accvgpr_write_b32 a33,v61
 v_accvgpr_write_b32 a34,v62
 v_accvgpr_write_b32 a35,v63
 v_permlane16_swap_b32 v64,v66
 v_permlane16_swap_b32 v65,v67
 v_permlane32_swap_b32 v68,v70
 v_permlane32_swap_b32 v69,v71
 v_max_f32 v100,v0,v1
 v_max3_f32 v100,v100,v2,v3
 v_max3_f32 v100,v100,v4,v5
 v_max3_f32 v100,v100,v6,v7
 buffer_load_dwordx4 v134,s[20:23],s33 offen offset:1024 nt lds
 v_mul_f32 v192,s54,v192
 v_mul_f32 v193,s54,v193
 v_mfma_f32_16x16x32_bf16 v[8:11],a[80:83],a[16:19],0
 v_mul_f32 v194,s54,v194
 v_mul_f32 v195,s54,v195
 v_mfma_f32_16x16x32_bf16 v[12:15],a[96:99],a[16:19],0
 v_mul_f32 v196,s54,v196
 v_mul_f32 v197,s54,v197
 v_mfma_f32_16x16x32_bf16 v[8:11],a[84:87],a[20:23],v[8:11]
 v_mul_f32 v198,s54,v198
 v_mul_f32 v199,s54,v199
 v_mfma_f32_16x16x32_bf16 v[12:15],a[100:103],a[20:23],v[12:15]
 v_cvt_pk_bf16_f32 v60,v192,v193
 v_cvt_pk_bf16_f32 v61,v194,v195
 v_mfma_f32_16x16x32_bf16 v[8:11],a[88:91],a[24:27],v[8:11]
 v_cvt_pk_bf16_f32 v62,v196,v197
 v_cvt_pk_bf16_f32 v63,v198,v199
 v_mfma_f32_16x16x32_bf16 v[12:15],a[104:107],a[24:27],v[12:15]
 v_accvgpr_write_b32 a36,v64
 v_accvgpr_write_b32 a37,v65
 v_mfma_f32_16x16x32_bf16 v[8:11],a[92:95],a[28:31],v[8:11]
 v_accvgpr_write_b32 a38,v66
 v_accvgpr_write_b32 a39,v67
 v_mfma_f32_16x16x32_bf16 v[12:15],a[108:111],a[28:31],v[12:15]
 v_permlane16_swap_b32 v68,v70
 v_permlane16_swap_b32 v69,v71
 v_permlane32_swap_b32 v72,v74
 v_permlane32_swap_b32 v73,v75
 buffer_load_dwordx4 v133,s[20:23],s33 offen offset:2048 nt lds
 v_pk_mul_f32 v[200:201],v[200:201],s[54:55]
 v_pk_mul_f32 v[202:203],v[202:203],s[54:55]
 v_pk_mul_f32 v[204:205],v[204:205],s[54:55]
 v_pk_mul_f32 v[206:207],v[206:207],s[54:55]
 v_cvt_pk_bf16_f32 v64,v200,v201
 v_cvt_pk_bf16_f32 v65,v202,v203
 v_cvt_pk_bf16_f32 v66,v204,v205
 v_cvt_pk_bf16_f32 v67,v206,v207
 v_accvgpr_write_b32 a40,v68
 v_accvgpr_write_b32 a41,v69
 v_accvgpr_write_b32 a42,v70
 v_accvgpr_write_b32 a43,v71
 v_permlane16_swap_b32 v72,v74
 v_permlane16_swap_b32 v73,v75
 v_permlane32_swap_b32 v60,v62
 v_permlane32_swap_b32 v61,v63
 buffer_load_dwordx4 v134,s[20:23],s33 offen offset:3072 nt lds
 v_pk_mul_f32 v[208:209],v[208:209],s[54:55]
 v_pk_mul_f32 v[210:211],v[210:211],s[54:55]
 v_pk_mul_f32 v[212:213],v[212:213],s[54:55]
 v_pk_mul_f32 v[214:215],v[214:215],s[54:55]
 v_cvt_pk_bf16_f32 v68,v208,v209
 v_cvt_pk_bf16_f32 v69,v210,v211
 v_cvt_pk_bf16_f32 v70,v212,v213
 v_cvt_pk_bf16_f32 v71,v214,v215
 v_accvgpr_write_b32 a44,v72
 v_accvgpr_write_b32 a45,v73
 v_accvgpr_write_b32 a46,v74
 v_accvgpr_write_b32 a47,v75
 v_permlane16_swap_b32 v60,v62
 v_permlane16_swap_b32 v61,v63
 v_permlane32_swap_b32 v64,v66
 v_permlane32_swap_b32 v65,v67
 v_pk_mul_f32 v[216:217],v[216:217],s[54:55]
 v_pk_mul_f32 v[218:219],v[218:219],s[54:55]
 v_pk_mul_f32 v[220:221],v[220:221],s[54:55]
 v_pk_mul_f32 v[222:223],v[222:223],s[54:55]
 v_cvt_pk_bf16_f32 v72,v216,v217
 v_cvt_pk_bf16_f32 v73,v218,v219
 v_cvt_pk_bf16_f32 v74,v220,v221
 v_cvt_pk_bf16_f32 v75,v222,v223
 v_accvgpr_write_b32 a48,v60
 v_accvgpr_write_b32 a49,v61
 v_accvgpr_write_b32 a50,v62
 v_accvgpr_write_b32 a51,v63
 v_permlane16_swap_b32 v64,v66
 v_permlane16_swap_b32 v65,v67
 v_permlane32_swap_b32 v68,v70
 v_permlane32_swap_b32 v69,v71
 v_max_f32 v101,v8,v9
 v_max3_f32 v101,v101,v10,v11
 v_max3_f32 v101,v101,v12,v13
 v_max3_f32 v101,v101,v14,v15
 v_mul_f32 v224,s54,v224
 v_mul_f32 v225,s54,v225
 v_mfma_f32_16x16x32_bf16 v[16:19],a[80:83],a[32:35],0
 v_mul_f32 v226,s54,v226
 v_mul_f32 v227,s54,v227
 v_mfma_f32_16x16x32_bf16 v[20:23],a[96:99],a[32:35],0
 v_mul_f32 v228,s54,v228
 v_mul_f32 v229,s54,v229
 v_mfma_f32_16x16x32_bf16 v[16:19],a[84:87],a[36:39],v[16:19]
 v_mul_f32 v230,s54,v230
 v_mul_f32 v231,s54,v231
 v_mfma_f32_16x16x32_bf16 v[20:23],a[100:103],a[36:39],v[20:23]
 v_cvt_pk_bf16_f32 v60,v224,v225
 v_cvt_pk_bf16_f32 v61,v226,v227
 v_mfma_f32_16x16x32_bf16 v[16:19],a[88:91],a[40:43],v[16:19]
 v_cvt_pk_bf16_f32 v62,v228,v229
 v_cvt_pk_bf16_f32 v63,v230,v231
 v_mfma_f32_16x16x32_bf16 v[20:23],a[104:107],a[40:43],v[20:23]
 v_accvgpr_write_b32 a52,v64
 v_accvgpr_write_b32 a53,v65
 v_mfma_f32_16x16x32_bf16 v[16:19],a[92:95],a[44:47],v[16:19]
 v_accvgpr_write_b32 a54,v66
 v_accvgpr_write_b32 a55,v67
 v_mfma_f32_16x16x32_bf16 v[20:23],a[108:111],a[44:47],v[20:23]
 v_permlane16_swap_b32 v68,v70
 v_permlane16_swap_b32 v69,v71
 v_permlane32_swap_b32 v72,v74
 v_permlane32_swap_b32 v73,v75
 v_pk_mul_f32 v[232:233],v[232:233],s[54:55]
 v_pk_mul_f32 v[234:235],v[234:235],s[54:55]
 v_pk_mul_f32 v[236:237],v[236:237],s[54:55]
 v_pk_mul_f32 v[238:239],v[238:239],s[54:55]
 v_cvt_pk_bf16_f32 v64,v232,v233
 v_cvt_pk_bf16_f32 v65,v234,v235
 v_cvt_pk_bf16_f32 v66,v236,v237
 v_cvt_pk_bf16_f32 v67,v238,v239
 v_accvgpr_write_b32 a56,v68
 v_accvgpr_write_b32 a57,v69
 v_accvgpr_write_b32 a58,v70
 v_accvgpr_write_b32 a59,v71
 v_permlane16_swap_b32 v72,v74
 v_permlane16_swap_b32 v73,v75
 v_permlane32_swap_b32 v60,v62
 v_permlane32_swap_b32 v61,v63
 v_pk_mul_f32 v[240:241],v[240:241],s[54:55]
 v_pk_mul_f32 v[242:243],v[242:243],s[54:55]
 v_pk_mul_f32 v[244:245],v[244:245],s[54:55]
 v_pk_mul_f32 v[246:247],v[246:247],s[54:55]
 v_cvt_pk_bf16_f32 v68,v240,v241
 v_cvt_pk_bf16_f32 v69,v242,v243
 v_cvt_pk_bf16_f32 v70,v244,v245
 v_cvt_pk_bf16_f32 v71,v246,v247
 v_accvgpr_write_b32 a60,v72
 v_accvgpr_write_b32 a61,v73
 v_accvgpr_write_b32 a62,v74
 v_accvgpr_write_b32 a63,v75
 v_permlane16_swap_b32 v60,v62
 v_permlane16_swap_b32 v61,v63
 v_permlane32_swap_b32 v64,v66
 v_permlane32_swap_b32 v65,v67
 v_pk_mul_f32 v[248:249],v[248:249],s[54:55]
 v_pk_mul_f32 v[250:251],v[250:251],s[54:55]
 v_pk_mul_f32 v[252:253],v[252:253],s[54:55]
 v_pk_mul_f32 v[254:255],v[254:255],s[54:55]
 v_cvt_pk_bf16_f32 v72,v248,v249
 v_cvt_pk_bf16_f32 v73,v250,v251
 v_cvt_pk_bf16_f32 v74,v252,v253
 v_cvt_pk_bf16_f32 v75,v254,v255
 v_accvgpr_write_b32 a64,v60
 v_accvgpr_write_b32 a65,v61
 v_accvgpr_write_b32 a66,v62
 v_accvgpr_write_b32 a67,v63
 v_permlane16_swap_b32 v64,v66
 v_permlane16_swap_b32 v65,v67
 v_permlane32_swap_b32 v68,v70
 v_permlane32_swap_b32 v69,v71
 v_max_f32 v102,v16,v17
 v_max3_f32 v102,v102,v18,v19
 v_max3_f32 v102,v102,v20,v21
 v_max3_f32 v102,v102,v22,v23
 s_nop 1
 v_accvgpr_write_b32 a68,v64
 v_mfma_f32_16x16x32_bf16 v[24:27],a[80:83],a[48:51],0
 v_accvgpr_write_b32 a69,v65
 v_accvgpr_write_b32 a70,v66
 v_mfma_f32_16x16x32_bf16 v[28:31],a[96:99],a[48:51],0
 v_accvgpr_write_b32 a71,v67
 v_permlane16_swap_b32 v68,v70
 v_mfma_f32_16x16x32_bf16 v[24:27],a[84:87],a[52:55],v[24:27]
 v_permlane16_swap_b32 v69,v71
 v_permlane32_swap_b32 v72,v74
 v_mfma_f32_16x16x32_bf16 v[28:31],a[100:103],a[52:55],v[28:31]
 v_permlane32_swap_b32 v73,v75
 s_nop 1
 v_accvgpr_write_b32 a72,v68
 v_mfma_f32_16x16x32_bf16 v[24:27],a[88:91],a[56:59],v[24:27]
 v_accvgpr_write_b32 a73,v69
 v_accvgpr_write_b32 a74,v70
 v_mfma_f32_16x16x32_bf16 v[28:31],a[104:107],a[56:59],v[28:31]
 v_accvgpr_write_b32 a75,v71
 v_permlane16_swap_b32 v72,v74
 v_mfma_f32_16x16x32_bf16 v[24:27],a[92:95],a[60:63],v[24:27]
 v_permlane16_swap_b32 v73,v75
 s_nop 1
 v_accvgpr_write_b32 a76,v72
 v_mfma_f32_16x16x32_bf16 v[28:31],a[108:111],a[60:63],v[28:31]
 v_accvgpr_write_b32 a77,v73
 v_accvgpr_write_b32 a78,v74
 v_accvgpr_write_b32 a79,v75
 s_nop 0
 v_mfma_f32_16x16x32_bf16 v[32:35],a[80:83],a[64:67],0
 v_mfma_f32_16x16x32_bf16 v[36:39],a[96:99],a[64:67],0
 v_mfma_f32_16x16x32_bf16 v[32:35],a[84:87],a[68:71],v[32:35]
 v_max_f32 v103,v24,v25
 v_mfma_f32_16x16x32_bf16 v[36:39],a[100:103],a[68:71],v[36:39]
 v_max3_f32 v103,v103,v26,v27
 v_mfma_f32_16x16x32_bf16 v[32:35],a[88:91],a[72:75],v[32:35]
 v_max3_f32 v103,v103,v28,v29
 v_mfma_f32_16x16x32_bf16 v[36:39],a[104:107],a[72:75],v[36:39]
 v_max3_f32 v103,v103,v30,v31
 v_mfma_f32_16x16x32_bf16 v[32:35],a[92:95],a[76:79],v[32:35]
 v_mfma_f32_16x16x32_bf16 v[36:39],a[108:111],a[76:79],v[36:39]
 s_nop 6
 v_max_f32 v104,v32,v33
 v_max3_f32 v104,v104,v34,v35
 v_max3_f32 v104,v104,v36,v37
 v_max3_f32 v104,v104,v38,v39
 v_mov_b32 v48,v100
 v_mov_b32 v49,v101
 v_mov_b32 v50,v102
 v_mov_b32 v51,v103
 v_mov_b32 v52,v104
 v_permlane32_swap_b32 v48,v100
 v_permlane32_swap_b32 v49,v101
 v_permlane32_swap_b32 v50,v102
 v_permlane32_swap_b32 v51,v103
 v_permlane32_swap_b32 v52,v104
 v_max_f32 v100,v100,v48
 v_max_f32 v101,v101,v49
 v_max_f32 v102,v102,v50
 v_max_f32 v103,v103,v51
 v_max_f32 v104,v104,v52
 v_mov_b32 v48,v100
 v_mov_b32 v49,v101
 v_mov_b32 v50,v102
 v_mov_b32 v51,v103
 v_mov_b32 v52,v104
 v_permlane16_swap_b32 v48,v100
 v_permlane16_swap_b32 v49,v101
 v_permlane16_swap_b32 v50,v102
 v_permlane16_swap_b32 v51,v103
 v_permlane16_swap_b32 v52,v104
 v_max_f32 v100,v100,v48
 v_max_f32 v101,v101,v49
 v_max_f32 v102,v102,v50
 v_max_f32 v103,v103,v51
 v_max_f32 v104,v104,v52
 v_sub_f32 v80,0,v100
 v_sub_f32 v84,0,v101
 v_sub_f32 v88,0,v102
 v_sub_f32 v92,0,v103
 v_sub_f32 v96,0,v104
 v_mov_b32 v81,v80
 v_mov_b32 v82,v80
 v_mov_b32 v83,v80
 v_mov_b32 v85,v84
 v_mov_b32 v86,v84
 v_mov_b32 v87,v84
 v_mov_b32 v89,v88
 v_mov_b32 v90,v88
 v_mov_b32 v91,v88
 v_mov_b32 v93,v92
 v_mov_b32 v94,v92
 v_mov_b32 v95,v92
 v_mov_b32 v97,v96
 v_mov_b32 v98,v96
 v_mov_b32 v99,v96
 v_pk_add_f32 v[0:1],v[0:1],v[80:81]
 v_pk_add_f32 v[2:3],v[2:3],v[80:81]
 v_pk_add_f32 v[4:5],v[4:5],v[80:81]
 v_pk_add_f32 v[6:7],v[6:7],v[80:81]
 v_pk_add_f32 v[8:9],v[8:9],v[84:85]
 v_pk_add_f32 v[10:11],v[10:11],v[84:85]
 v_pk_add_f32 v[12:13],v[12:13],v[84:85]
 v_pk_add_f32 v[14:15],v[14:15],v[84:85]
 v_pk_add_f32 v[16:17],v[16:17],v[88:89]
 v_pk_add_f32 v[18:19],v[18:19],v[88:89]
 v_pk_add_f32 v[20:21],v[20:21],v[88:89]
 v_pk_add_f32 v[22:23],v[22:23],v[88:89]
 v_pk_add_f32 v[24:25],v[24:25],v[92:93]
 v_pk_add_f32 v[26:27],v[26:27],v[92:93]
 v_pk_add_f32 v[28:29],v[28:29],v[92:93]
 v_pk_add_f32 v[30:31],v[30:31],v[92:93]
 v_pk_add_f32 v[32:33],v[32:33],v[96:97]
 v_pk_add_f32 v[34:35],v[34:35],v[96:97]
 v_pk_add_f32 v[36:37],v[36:37],v[96:97]
 v_pk_add_f32 v[38:39],v[38:39],v[96:97]
L_s0:
 v_mov_b32 v100,0x3f803f80
 v_accvgpr_write_b32 a212,v100
 v_accvgpr_write_b32 a213,v100
 v_accvgpr_write_b32 a214,v100
 v_accvgpr_write_b32 a215,v100
 s_waitcnt vmcnt(28)
 s_barrier
 ds_read_b128 a[80:83],v105 offset:16384
 ds_read_b128 a[96:99],v105 offset:20480
 ds_read_b128 a[84:87],v106 offset:16384
 ds_read_b128 a[100:103],v106 offset:20480
 ds_read_b128 a[88:91],v107 offset:16384
 ds_read_b128 a[104:107],v107 offset:20480
 ds_read_b128 a[92:95],v108 offset:16384
 ds_read_b128 a[108:111],v108 offset:20480
 v_exp_f32 v0,v0
 v_exp_f32 v1,v1
 s_add_u32 m0,s34,0x0
 s_xor_b32 s32,s57,0xa000
 s_waitcnt vmcnt(4)
 buffer_load_dwordx4 v129,s[16:19],s32 offen offset:0 nt lds
 v_exp_f32 v2,v2
 v_cvt_pk_bf16_f32 v40,v0,v1
 v_exp_f32 v3,v3
 v_exp_f32 v4,v4
 v_cvt_pk_bf16_f32 v41,v2,v3
 v_exp_f32 v5,v5
 v_exp_f32 v6,v6
 v_cvt_pk_bf16_f32 v42,v4,v5
 v_exp_f32 v7,v7
 v_exp_f32 v8,v8
 v_cvt_pk_bf16_f32 v43,v6,v7
 s_waitcnt vmcnt(4)
 buffer_load_dwordx4 v130,s[16:19],s32 offen offset:1024 nt lds
 v_exp_f32 v9,v9
 v_exp_f32 v10,v10
 v_cvt_pk_bf16_f32 v44,v8,v9
 v_exp_f32 v11,v11
 v_exp_f32 v12,v12
 v_cvt_pk_bf16_f32 v45,v10,v11
 v_exp_f32 v13,v13
 v_exp_f32 v14,v14
 v_cvt_pk_bf16_f32 v46,v12,v13
 v_exp_f32 v15,v15
 s_waitcnt vmcnt(4)
 buffer_load_dwordx4 v131,s[16:19],s32 offen offset:2048 nt lds
 v_exp_f32 v16,v16
 v_cvt_pk_bf16_f32 v47,v14,v15
 v_exp_f32 v17,v17
 v_exp_f32 v18,v18
 v_cvt_pk_bf16_f32 v48,v16,v17
 v_exp_f32 v19,v19
 v_exp_f32 v20,v20
 v_cvt_pk_bf16_f32 v49,v18,v19
 v_exp_f32 v21,v21
 v_exp_f32 v22,v22
 v_cvt_pk_bf16_f32 v50,v20,v21
 s_waitcnt vmcnt(4)
 buffer_load_dwordx4 v132,s[16:19],s32 offen offset:3072 nt lds
 v_exp_f32 v23,v23
 v_exp_f32 v24,v24
 v_cvt_pk_bf16_f32 v51,v22,v23
 v_exp_f32 v25,v25
 v_exp_f32 v26,v26
 v_cvt_pk_bf16_f32 v52,v24,v25
 v_exp_f32 v27,v27
 v_exp_f32 v28,v28
 v_cvt_pk_bf16_f32 v53,v26,v27
 v_exp_f32 v29,v29
 buffer_atomic_add v136,v138,s[76:79],0 offen
 v_exp_f32 v30,v30
 v_cvt_pk_bf16_f32 v54,v28,v29
 v_exp_f32 v31,v31
 v_exp_f32 v32,v32
 v_cvt_pk_bf16_f32 v55,v30,v31
 v_exp_f32 v33,v33
 s_nop 0
 v_cvt_pk_bf16_f32 v56,v32,v33
 s_waitcnt lgkmcnt(0)
 v_mfma_f32_16x16x32_bf16 v[0:3],a[80:83],a[0:3],v[80:83]
 v_exp_f32 v34,v34
 v_mfma_f32_16x16x32_bf16 v[4:7],a[96:99],a[0:3],v[80:83]
 ds_read_b64_tr_b16 a[112:113],v113 offset:32768
 ds_read_b64_tr_b16 a[114:115],v113 offset:36864
 v_mfma_f32_16x16x32_bf16 v[0:3],a[84:87],a[4:7],v[0:3]
 v_exp_f32 v35,v35
 v_mfma_f32_16x16x32_bf16 v[4:7],a[100:103],a[4:7],v[4:7]
 v_cvt_pk_bf16_f32 v57,v34,v35
 v_mfma_f32_16x16x32_bf16 v[0:3],a[88:91],a[8:11],v[0:3]
 v_exp_f32 v36,v36
 v_mfma_f32_16x16x32_bf16 v[4:7],a[104:107],a[8:11],v[4:7]
 ds_read_b64_tr_b16 a[116:117],v114 offset:32768
 ds_read_b64_tr_b16 a[118:119],v114 offset:36864
 v_mfma_f32_16x16x32_bf16 v[0:3],a[92:95],a[12:15],v[0:3]
 v_exp_f32 v37,v37
 v_mfma_f32_16x16x32_bf16 v[4:7],a[108:111],a[12:15],v[4:7]
 v_cvt_pk_bf16_f32 v58,v36,v37
 v_mfma_f32_16x16x32_bf16 v[8:11],a[80:83],a[16:19],v[84:87]
 v_exp_f32 v38,v38
 v_mfma_f32_16x16x32_bf16 v[12:15],a[96:99],a[16:19],v[84:87]
 ds_read_b64_tr_b16 a[120:121],v115 offset:32768
 ds_read_b64_tr_b16 a[122:123],v115 offset:36864
 v_mfma_f32_16x16x32_bf16 v[8:11],a[84:87],a[20:23],v[8:11]
 v_exp_f32 v39,v39
 v_mfma_f32_16x16x32_bf16 v[12:15],a[100:103],a[20:23],v[12:15]
 v_cvt_pk_bf16_f32 v59,v38,v39
 v_mfma_f32_16x16x32_bf16 v[8:11],a[88:91],a[24:27],v[8:11]
 v_exp_f32 v0,v0
 v_mfma_f32_16x16x32_bf16 v[12:15],a[104:107],a[24:27],v[12:15]
 ds_read_b64_tr_b16 a[124:125],v116 offset:32768
 ds_read_b64_tr_b16 a[126:127],v116 offset:36864
 v_mfma_f32_16x16x32_bf16 v[8:11],a[92:95],a[28:31],v[8:11]
 v_exp_f32 v1,v1
 v_mfma_f32_16x16x32_bf16 v[12:15],a[108:111],a[28:31],v[12:15]
 v_cvt_pk_bf16_f32 v60,v0,v1
 v_mfma_f32_16x16x32_bf16 v[16:19],a[80:83],a[32:35],v[88:91]
 v_exp_f32 v2,v2
 v_mfma_f32_16x16x32_bf16 v[20:23],a[96:99],a[32:35],v[88:91]
 ds_read_b64_tr_b16 a[128:129],v117 offset:32768
 ds_read_b64_tr_b16 a[130:131],v117 offset:36864
 v_mfma_f32_16x16x32_bf16 v[16:19],a[84:87],a[36:39],v[16:19]
 v_exp_f32 v3,v3
 v_mfma_f32_16x16x32_bf16 v[20:23],a[100:103],a[36:39],v[20:23]
 v_cvt_pk_bf16_f32 v61,v2,v3
 v_mfma_f32_16x16x32_bf16 v[16:19],a[88:91],a[40:43],v[16:19]
 v_exp_f32 v4,v4
 v_mfma_f32_16x16x32_bf16 v[20:23],a[104:107],a[40:43],v[20:23]
 ds_read_b64_tr_b16 a[132:133],v118 offset:32768
 ds_read_b64_tr_b16 a[134:135],v118 offset:36864
 v_mfma_f32_16x16x32_bf16 v[16:19],a[92:95],a[44:47],v[16:19]
 v_exp_f32 v5,v5
 v_mfma_f32_16x16x32_bf16 v[20:23],a[108:111],a[44:47],v[20:23]
 v_cvt_pk_bf16_f32 v62,v4,v5
 v_mfma_f32_16x16x32_bf16 v[24:27],a[80:83],a[48:51],v[92:95]
 v_exp_f32 v6,v6
 v_mfma_f32_16x16x32_bf16 v[28:31],a[96:99],a[48:51],v[92:95]
 ds_read_b64_tr_b16 a[136:137],v119 offset:32768
 ds_read_b64_tr_b16 a[138:139],v119 offset:36864
 v_mfma_f32_16x16x32_bf16 v[24:27],a[84:87],a[52:55],v[24:27]
 v_exp_f32 v7,v7
 v_mfma_f32_16x16x32_bf16 v[28:31],a[100:103],a[52:55],v[28:31]
 v_cvt_pk_bf16_f32 v63,v6,v7
 v_mfma_f32_16x16x32_bf16 v[24:27],a[88:91],a[56:59],v[24:27]
 v_exp_f32 v8,v8
 v_mfma_f32_16x16x32_bf16 v[28:31],a[104:107],a[56:59],v[28:31]
 ds_read_b64_tr_b16 a[140:141],v120 offset:32768
 ds_read_b64_tr_b16 a[142:143],v120 offset:36864
 v_mfma_f32_16x16x32_bf16 v[24:27],a[92:95],a[60:63],v[24:27]
 v_exp_f32 v9,v9
 v_mfma_f32_16x16x32_bf16 v[28:31],a[108:111],a[60:63],v[28:31]
 v_cvt_pk_bf16_f32 v64,v8,v9
 v_mfma_f32_16x16x32_bf16 v[32:35],a[80:83],a[64:67],v[96:99]
 v_exp_f32 v10,v10
 v_mfma_f32_16x16x32_bf16 v[36:39],a[96:99],a[64:67],v[96:99]
 v_mfma_f32_16x16x32_bf16 v[32:35],a[84:87],a[68:71],v[32:35]
 v_exp_f32 v11,v11
 v_mfma_f32_16x16x32_bf16 v[36:39],a[100:103],a[68:71],v[36:39]
 v_cvt_pk_bf16_f32 v65,v10,v11
 v_mfma_f32_16x16x32_bf16 v[32:35],a[88:91],a[72:75],v[32:35]
 v_exp_f32 v12,v12
 v_mfma_f32_16x16x32_bf16 v[36:39],a[104:107],a[72:75],v[36:39]
 v_mfma_f32_16x16x32_bf16 v[32:35],a[92:95],a[76:79],v[32:35]
 v_exp_f32 v13,v13
 v_mfma_f32_16x16x32_bf16 v[36:39],a[108:111],a[76:79],v[36:39]
 v_cvt_pk_bf16_f32 v66,v12,v13
 s_waitcnt lgkmcnt(0)
 v_mfma_f32_16x16x32_bf16 v[144:147],a[112:115],v[40:43],0
 s_barrier
 v_exp_f32 v14,v14
 v_mfma_f32_16x16x32_bf16 v[148:151],a[116:119],v[40:43],0
 v_mfma_f32_16x16x32_bf16 v[152:155],a[120:123],v[40:43],0
 v_exp_f32 v15,v15
 v_mfma_f32_16x16x32_bf16 v[156:159],a[124:127],v[40:43],0
 v_cvt_pk_bf16_f32 v67,v14,v15
 s_add_u32 m0,s34,0x20000
 v_mfma_f32_16x16x32_bf16 v[160:163],a[128:131],v[40:43],0
 v_exp_f32 v16,v16
 s_xor_b32 s33,s57,0xa000
 v_mfma_f32_16x16x32_bf16 v[164:167],a[132:135],v[40:43],0
 ds_read_b128 a[80:83],v105 offset:32768
 s_waitcnt vmcnt(4)
 buffer_load_dwordx4 v133,s[20:23],s33 offen offset:0 nt lds
 v_mfma_f32_16x16x32_bf16 v[168:171],a[136:139],v[40:43],0
 v_exp_f32 v17,v17
 v_mfma_f32_16x16x32_bf16 v[172:175],a[140:143],v[40:43],0
 v_cvt_pk_bf16_f32 v68,v16,v17
 v_mfma_f32_16x16x32_bf16 a[192:195],a[212:215],v[40:43],0
 ds_read_b128 a[96:99],v105 offset:36864
 v_mfma_f32_16x16x32_bf16 v[176:179],a[112:115],v[44:47],0
 v_exp_f32 v18,v18
 v_mfma_f32_16x16x32_bf16 v[180:183],a[116:119],v[44:47],0
 ds_read_b128 a[84:87],v106 offset:32768
 v_mfma_f32_16x16x32_bf16 v[184:187],a[120:123],v[44:47],0
 v_exp_f32 v19,v19
 v_mfma_f32_16x16x32_bf16 v[188:191],a[124:127],v[44:47],0
 v_cvt_pk_bf16_f32 v69,v18,v19
 v_mfma_f32_16x16x32_bf16 v[192:195],a[128:131],v[44:47],0
 v_exp_f32 v20,v20
 v_mfma_f32_16x16x32_bf16 v[196:199],a[132:135],v[44:47],0
 s_waitcnt vmcnt(4)
 buffer_load_dwordx4 v134,s[20:23],s33 offen offset:1024 nt lds
 v_mfma_f32_16x16x32_bf16 v[200:203],a[136:139],v[44:47],0
 v_exp_f32 v21,v21
 v_mfma_f32_16x16x32_bf16 v[204:207],a[140:143],v[44:47],0
 v_cvt_pk_bf16_f32 v70,v20,v21
 v_mfma_f32_16x16x32_bf16 a[196:199],a[212:215],v[44:47],0
 ds_read_b128 a[100:103],v106 offset:36864
 v_mfma_f32_16x16x32_bf16 v[208:211],a[112:115],v[48:51],0
 v_exp_f32 v22,v22
 v_mfma_f32_16x16x32_bf16 v[212:215],a[116:119],v[48:51],0
 ds_read_b128 a[88:91],v107 offset:32768
 v_mfma_f32_16x16x32_bf16 v[216:219],a[120:123],v[48:51],0
 v_exp_f32 v23,v23
 v_mfma_f32_16x16x32_bf16 v[220:223],a[124:127],v[48:51],0
 v_cvt_pk_bf16_f32 v71,v22,v23
 v_mfma_f32_16x16x32_bf16 v[224:227],a[128:131],v[48:51],0
 v_exp_f32 v24,v24
 v_mfma_f32_16x16x32_bf16 v[228:231],a[132:135],v[48:51],0
 ds_read_b128 a[104:107],v107 offset:36864
 v_mfma_f32_16x16x32_bf16 v[232:235],a[136:139],v[48:51],0
 v_exp_f32 v25,v25
 v_mfma_f32_16x16x32_bf16 v[236:239],a[140:143],v[48:51],0
 v_cvt_pk_bf16_f32 v72,v24,v25
 s_waitcnt vmcnt(4)
 buffer_load_dwordx4 v133,s[20:23],s33 offen offset:2048 nt lds
 v_mfma_f32_16x16x32_bf16 a[200:203],a[212:215],v[48:51],0
 v_mfma_f32_16x16x32_bf16 v[240:243],a[112:115],v[52:55],0
 v_exp_f32 v26,v26
 v_mfma_f32_16x16x32_bf16 v[244:247],a[116:119],v[52:55],0
 ds_read_b128 a[92:95],v108 offset:32768
 v_mfma_f32_16x16x32_bf16 v[248:251],a[120:123],v[52:55],0
 v_exp_f32 v27,v27
 v_mfma_f32_16x16x32_bf16 v[252:255],a[124:127],v[52:55],0
 v_cvt_pk_bf16_f32 v73,v26,v27
 v_mfma_f32_16x16x32_bf16 a[144:147],a[128:131],v[52:55],0
 v_exp_f32 v28,v28
 v_mfma_f32_16x16x32_bf16 a[148:151],a[132:135],v[52:55],0
 ds_read_b128 a[108:111],v108 offset:36864
 v_mfma_f32_16x16x32_bf16 a[152:155],a[136:139],v[52:55],0
 v_exp_f32 v29,v29
 v_mfma_f32_16x16x32_bf16 a[156:159],a[140:143],v[52:55],0
 v_cvt_pk_bf16_f32 v74,v28,v29
 s_waitcnt vmcnt(4)
 buffer_load_dwordx4 v134,s[20:23],s33 offen offset:3072 nt lds
 v_mfma_f32_16x16x32_bf16 a[204:207],a[212:215],v[52:55],0
 v_mfma_f32_16x16x32_bf16 a[160:163],a[112:115],v[56:59],0
 v_exp_f32 v30,v30
 v_mfma_f32_16x16x32_bf16 a[164:167],a[116:119],v[56:59],0
 v_mfma_f32_16x16x32_bf16 a[168:171],a[120:123],v[56:59],0
 v_exp_f32 v31,v31
 v_mfma_f32_16x16x32_bf16 a[172:175],a[124:127],v[56:59],0
 v_cvt_pk_bf16_f32 v75,v30,v31
 v_mfma_f32_16x16x32_bf16 a[176:179],a[128:131],v[56:59],0
 v_exp_f32 v32,v32
 v_mfma_f32_16x16x32_bf16 a[180:183],a[132:135],v[56:59],0
 v_mfma_f32_16x16x32_bf16 a[184:187],a[136:139],v[56:59],0
 v_exp_f32 v33,v33
 v_mfma_f32_16x16x32_bf16 a[188:191],a[140:143],v[56:59],0
 v_cvt_pk_bf16_f32 v76,v32,v33
 v_mfma_f32_16x16x32_bf16 a[208:211],a[212:215],v[56:59],0
 s_waitcnt lgkmcnt(0)
 v_mfma_f32_16x16x32_bf16 v[0:3],a[80:83],a[0:3],v[80:83]
 v_exp_f32 v34,v34
 v_mfma_f32_16x16x32_bf16 v[4:7],a[96:99],a[0:3],v[80:83]
 ds_read_b64_tr_b16 a[112:113],v113 offset:49152
 ds_read_b64_tr_b16 a[114:115],v113 offset:53248
 v_mfma_f32_16x16x32_bf16 v[0:3],a[84:87],a[4:7],v[0:3]
 v_exp_f32 v35,v35
 v_mfma_f32_16x16x32_bf16 v[4:7],a[100:103],a[4:7],v[4:7]
 v_cvt_pk_bf16_f32 v77,v34,v35
 v_mfma_f32_16x16x32_bf16 v[0:3],a[88:91],a[8:11],v[0:3]
 v_exp_f32 v36,v36
 v_mfma_f32_16x16x32_bf16 v[4:7],a[104:107],a[8:11],v[4:7]
 ds_read_b64_tr_b16 a[116:117],v114 offset:49152
 ds_read_b64_tr_b16 a[118:119],v114 offset:53248
 s_add_u32 m0,s34,0x4000
 v_mfma_f32_16x16x32_bf16 v[0:3],a[92:95],a[12:15],v[0:3]
 v_exp_f32 v37,v37
 s_xor_b32 s32,s57,0xc000
 v_mfma_f32_16x16x32_bf16 v[4:7],a[108:111],a[12:15],v[4:7]
 v_cvt_pk_bf16_f32 v78,v36,v37
 s_waitcnt vmcnt(3)
 buffer_load_dwordx4 v129,s[16:19],s32 offen offset:0 nt lds
 v_mfma_f32_16x16x32_bf16 v[8:11],a[80:83],a[16:19],v[84:87]
 v_exp_f32 v38,v38
 v_mfma_f32_16x16x32_bf16 v[12:15],a[96:99],a[16:19],v[84:87]
 ds_read_b64_tr_b16 a[120:121],v115 offset:49152
 ds_read_b64_tr_b16 a[122:123],v115 offset:53248
 v_mfma_f32_16x16x32_bf16 v[8:11],a[84:87],a[20:23],v[8:11]
 v_exp_f32 v39,v39
 v_mfma_f32_16x16x32_bf16 v[12:15],a[100:103],a[20:23],v[12:15]
 v_cvt_pk_bf16_f32 v79,v38,v39
 v_mfma_f32_16x16x32_bf16 v[8:11],a[88:91],a[24:27],v[8:11]
 v_exp_f32 v0,v0
 v_mfma_f32_16x16x32_bf16 v[12:15],a[104:107],a[24:27],v[12:15]
 ds_read_b64_tr_b16 a[124:125],v116 offset:49152
 ds_read_b64_tr_b16 a[126:127],v116 offset:53248
 v_mfma_f32_16x16x32_bf16 v[8:11],a[92:95],a[28:31],v[8:11]
 v_exp_f32 v1,v1
 v_mfma_f32_16x16x32_bf16 v[12:15],a[108:111],a[28:31],v[12:15]
 v_cvt_pk_bf16_f32 v40,v0,v1
 s_waitcnt vmcnt(4)
 buffer_load_dwordx4 v130,s[16:19],s32 offen offset:1024 nt lds
 v_mfma_f32_16x16x32_bf16 v[16:19],a[80:83],a[32:35],v[88:91]
 v_exp_f32 v2,v2
 v_mfma_f32_16x16x32_bf16 v[20:23],a[96:99],a[32:35],v[88:91]
 ds_read_b64_tr_b16 a[128:129],v117 offset:49152
 ds_read_b64_tr_b16 a[130:131],v117 offset:53248
 v_mfma_f32_16x16x32_bf16 v[16:19],a[84:87],a[36:39],v[16:19]
 v_exp_f32 v3,v3
 v_mfma_f32_16x16x32_bf16 v[20:23],a[100:103],a[36:39],v[20:23]
 v_cvt_pk_bf16_f32 v41,v2,v3
 v_mfma_f32_16x16x32_bf16 v[16:19],a[88:91],a[40:43],v[16:19]
 v_exp_f32 v4,v4
 v_mfma_f32_16x16x32_bf16 v[20:23],a[104:107],a[40:43],v[20:23]
 ds_read_b64_tr_b16 a[132:133],v118 offset:49152
 ds_read_b64_tr_b16 a[134:135],v118 offset:53248
 v_mfma_f32_16x16x32_bf16 v[16:19],a[92:95],a[44:47],v[16:19]
 v_exp_f32 v5,v5
 v_mfma_f32_16x16x32_bf16 v[20:23],a[108:111],a[44:47],v[20:23]
 v_cvt_pk_bf16_f32 v42,v4,v5
 s_waitcnt vmcnt(4)
 buffer_load_dwordx4 v131,s[16:19],s32 offen offset:2048 nt lds
 v_mfma_f32_16x16x32_bf16 v[24:27],a[80:83],a[48:51],v[92:95]
 v_exp_f32 v6,v6
 v_mfma_f32_16x16x32_bf16 v[28:31],a[96:99],a[48:51],v[92:95]
 ds_read_b64_tr_b16 a[136:137],v119 offset:49152
 ds_read_b64_tr_b16 a[138:139],v119 offset:53248
 v_mfma_f32_16x16x32_bf16 v[24:27],a[84:87],a[52:55],v[24:27]
 v_exp_f32 v7,v7
 v_mfma_f32_16x16x32_bf16 v[28:31],a[100:103],a[52:55],v[28:31]
 v_cvt_pk_bf16_f32 v43,v6,v7
 v_mfma_f32_16x16x32_bf16 v[24:27],a[88:91],a[56:59],v[24:27]
 v_exp_f32 v8,v8
 v_mfma_f32_16x16x32_bf16 v[28:31],a[104:107],a[56:59],v[28:31]
 ds_read_b64_tr_b16 a[140:141],v120 offset:49152
 ds_read_b64_tr_b16 a[142:143],v120 offset:53248
 v_mfma_f32_16x16x32_bf16 v[24:27],a[92:95],a[60:63],v[24:27]
 v_exp_f32 v9,v9
 v_mfma_f32_16x16x32_bf16 v[28:31],a[108:111],a[60:63],v[28:31]
 v_cvt_pk_bf16_f32 v44,v8,v9
 s_waitcnt vmcnt(4)
 buffer_load_dwordx4 v132,s[16:19],s32 offen offset:3072 nt lds
 v_mfma_f32_16x16x32_bf16 v[32:35],a[80:83],a[64:67],v[96:99]
 v_exp_f32 v10,v10
 v_mfma_f32_16x16x32_bf16 v[36:39],a[96:99],a[64:67],v[96:99]
 v_mfma_f32_16x16x32_bf16 v[32:35],a[84:87],a[68:71],v[32:35]
 v_exp_f32 v11,v11
 v_mfma_f32_16x16x32_bf16 v[36:39],a[100:103],a[68:71],v[36:39]
 v_cvt_pk_bf16_f32 v45,v10,v11
 v_mfma_f32_16x16x32_bf16 v[32:35],a[88:91],a[72:75],v[32:35]
 v_exp_f32 v12,v12
 v_mfma_f32_16x16x32_bf16 v[36:39],a[104:107],a[72:75],v[36:39]
 v_mfma_f32_16x16x32_bf16 v[32:35],a[92:95],a[76:79],v[32:35]
 v_exp_f32 v13,v13
 v_mfma_f32_16x16x32_bf16 v[36:39],a[108:111],a[76:79],v[36:39]
 v_cvt_pk_bf16_f32 v46,v12,v13
 s_waitcnt lgkmcnt(0)
 v_mfma_f32_16x16x32_bf16 v[144:147],a[112:115],v[60:63],v[144:147]
 s_barrier
 v_exp_f32 v14,v14
 v_mfma_f32_16x16x32_bf16 v[148:151],a[116:119],v[60:63],v[148:151]
 v_mfma_f32_16x16x32_bf16 v[152:155],a[120:123],v[60:63],v[152:155]
 v_exp_f32 v15,v15
 v_mfma_f32_16x16x32_bf16 v[156:159],a[124:127],v[60:63],v[156:159]
 v_cvt_pk_bf16_f32 v47,v14,v15
 s_add_u32 m0,s34,0x24000
 v_mfma_f32_16x16x32_bf16 v[160:163],a[128:131],v[60:63],v[160:163]
 v_exp_f32 v16,v16
 s_xor_b32 s33,s57,0xc000
 v_mfma_f32_16x16x32_bf16 v[164:167],a[132:135],v[60:63],v[164:167]
 ds_read_b128 a[80:83],v105 offset:49152
 s_waitcnt vmcnt(3)
 buffer_load_dwordx4 v133,s[20:23],s33 offen offset:0 nt lds
 v_mfma_f32_16x16x32_bf16 v[168:171],a[136:139],v[60:63],v[168:171]
 v_exp_f32 v17,v17
 v_mfma_f32_16x16x32_bf16 v[172:175],a[140:143],v[60:63],v[172:175]
 v_cvt_pk_bf16_f32 v48,v16,v17
 v_mfma_f32_16x16x32_bf16 a[192:195],a[212:215],v[60:63],a[192:195]
 ds_read_b128 a[96:99],v105 offset:53248
 v_mfma_f32_16x16x32_bf16 v[176:179],a[112:115],v[64:67],v[176:179]
 v_exp_f32 v18,v18
 v_mfma_f32_16x16x32_bf16 v[180:183],a[116:119],v[64:67],v[180:183]
 ds_read_b128 a[84:87],v106 offset:49152
 v_mfma_f32_16x16x32_bf16 v[184:187],a[120:123],v[64:67],v[184:187]
 v_exp_f32 v19,v19
 v_mfma_f32_16x16x32_bf16 v[188:191],a[124:127],v[64:67],v[188:191]
 v_cvt_pk_bf16_f32 v49,v18,v19
 v_mfma_f32_16x16x32_bf16 v[192:195],a[128:131],v[64:67],v[192:195]
 v_exp_f32 v20,v20
 v_mfma_f32_16x16x32_bf16 v[196:199],a[132:135],v[64:67],v[196:199]
 s_waitcnt vmcnt(4)
 buffer_load_dwordx4 v134,s[20:23],s33 offen offset:1024 nt lds
 v_mfma_f32_16x16x32_bf16 v[200:203],a[136:139],v[64:67],v[200:203]
 v_exp_f32 v21,v21
 v_mfma_f32_16x16x32_bf16 v[204:207],a[140:143],v[64:67],v[204:207]
 v_cvt_pk_bf16_f32 v50,v20,v21
 v_mfma_f32_16x16x32_bf16 a[196:199],a[212:215],v[64:67],a[196:199]
 ds_read_b128 a[100:103],v106 offset:53248
 v_mfma_f32_16x16x32_bf16 v[208:211],a[112:115],v[68:71],v[208:211]
 v_exp_f32 v22,v22
 v_mfma_f32_16x16x32_bf16 v[212:215],a[116:119],v[68:71],v[212:215]
 ds_read_b128 a[88:91],v107 offset:49152
 v_mfma_f32_16x16x32_bf16 v[216:219],a[120:123],v[68:71],v[216:219]
 v_exp_f32 v23,v23
 v_mfma_f32_16x16x32_bf16 v[220:223],a[124:127],v[68:71],v[220:223]
 v_cvt_pk_bf16_f32 v51,v22,v23
 v_mfma_f32_16x16x32_bf16 v[224:227],a[128:131],v[68:71],v[224:227]
 v_exp_f32 v24,v24
 v_mfma_f32_16x16x32_bf16 v[228:231],a[132:135],v[68:71],v[228:231]
 ds_read_b128 a[104:107],v107 offset:53248
 v_mfma_f32_16x16x32_bf16 v[232:235],a[136:139],v[68:71],v[232:235]
 v_exp_f32 v25,v25
 v_mfma_f32_16x16x32_bf16 v[236:239],a[140:143],v[68:71],v[236:239]
 v_cvt_pk_bf16_f32 v52,v24,v25
 s_waitcnt vmcnt(4)
 buffer_load_dwordx4 v133,s[20:23],s33 offen offset:2048 nt lds
 v_mfma_f32_16x16x32_bf16 a[200:203],a[212:215],v[68:71],a[200:203]
 v_mfma_f32_16x16x32_bf16 v[240:243],a[112:115],v[72:75],v[240:243]
 v_exp_f32 v26,v26
 v_mfma_f32_16x16x32_bf16 v[244:247],a[116:119],v[72:75],v[244:247]
 ds_read_b128 a[92:95],v108 offset:49152
 v_mfma_f32_16x16x32_bf16 v[248:251],a[120:123],v[72:75],v[248:251]
 v_exp_f32 v27,v27
 v_mfma_f32_16x16x32_bf16 v[252:255],a[124:127],v[72:75],v[252:255]
 v_cvt_pk_bf16_f32 v53,v26,v27
 v_mfma_f32_16x16x32_bf16 a[144:147],a[128:131],v[72:75],a[144:147]
 v_exp_f32 v28,v28
 v_mfma_f32_16x16x32_bf16 a[148:151],a[132:135],v[72:75],a[148:151]
 ds_read_b128 a[108:111],v108 offset:53248
 v_mfma_f32_16x16x32_bf16 a[152:155],a[136:139],v[72:75],a[152:155]
 v_exp_f32 v29,v29
 v_mfma_f32_16x16x32_bf16 a[156:159],a[140:143],v[72:75],a[156:159]
 v_cvt_pk_bf16_f32 v54,v28,v29
 s_waitcnt vmcnt(4)
 buffer_load_dwordx4 v134,s[20:23],s33 offen offset:3072 nt lds
 v_mfma_f32_16x16x32_bf16 a[204:207],a[212:215],v[72:75],a[204:207]
 v_mfma_f32_16x16x32_bf16 a[160:163],a[112:115],v[76:79],a[160:163]
 v_exp_f32 v30,v30
 v_mfma_f32_16x16x32_bf16 a[164:167],a[116:119],v[76:79],a[164:167]
 v_mfma_f32_16x16x32_bf16 a[168:171],a[120:123],v[76:79],a[168:171]
 v_exp_f32 v31,v31
 v_mfma_f32_16x16x32_bf16 a[172:175],a[124:127],v[76:79],a[172:175]
 v_cvt_pk_bf16_f32 v55,v30,v31
 v_mfma_f32_16x16x32_bf16 a[176:179],a[128:131],v[76:79],a[176:179]
 v_exp_f32 v32,v32
 v_mfma_f32_16x16x32_bf16 a[180:183],a[132:135],v[76:79],a[180:183]
 v_mfma_f32_16x16x32_bf16 a[184:187],a[136:139],v[76:79],a[184:187]
 v_exp_f32 v33,v33
 v_mfma_f32_16x16x32_bf16 a[188:191],a[140:143],v[76:79],a[188:191]
 v_cvt_pk_bf16_f32 v56,v32,v33
 v_mfma_f32_16x16x32_bf16 a[208:211],a[212:215],v[76:79],a[208:211]
 s_waitcnt lgkmcnt(0)
 v_mfma_f32_16x16x32_bf16 v[0:3],a[80:83],a[0:3],v[80:83]
 v_exp_f32 v34,v34
 v_mfma_f32_16x16x32_bf16 v[4:7],a[96:99],a[0:3],v[80:83]
 ds_read_b64_tr_b16 a[112:113],v121 offset:0
 ds_read_b64_tr_b16 a[114:115],v121 offset:4096
 v_mfma_f32_16x16x32_bf16 v[0:3],a[84:87],a[4:7],v[0:3]
 v_exp_f32 v35,v35
 v_mfma_f32_16x16x32_bf16 v[4:7],a[100:103],a[4:7],v[4:7]
 v_cvt_pk_bf16_f32 v57,v34,v35
 v_mfma_f32_16x16x32_bf16 v[0:3],a[88:91],a[8:11],v[0:3]
 v_exp_f32 v36,v36
 v_mfma_f32_16x16x32_bf16 v[4:7],a[104:107],a[8:11],v[4:7]
 ds_read_b64_tr_b16 a[116:117],v122 offset:0
 ds_read_b64_tr_b16 a[118:119],v122 offset:4096
 s_add_u32 m0,s34,0x8000
 v_mfma_f32_16x16x32_bf16 v[0:3],a[92:95],a[12:15],v[0:3]
 v_exp_f32 v37,v37
 s_xor_b32 s32,s57,0xe000
 v_mfma_f32_16x16x32_bf16 v[4:7],a[108:111],a[12:15],v[4:7]
 v_cvt_pk_bf16_f32 v58,v36,v37
 s_waitcnt vmcnt(4)
 buffer_load_dwordx4 v129,s[16:19],s32 offen offset:0 nt lds
 v_mfma_f32_16x16x32_bf16 v[8:11],a[80:83],a[16:19],v[84:87]
 v_exp_f32 v38,v38
 v_mfma_f32_16x16x32_bf16 v[12:15],a[96:99],a[16:19],v[84:87]
 ds_read_b64_tr_b16 a[120:121],v123 offset:0
 ds_read_b64_tr_b16 a[122:123],v123 offset:4096
 v_mfma_f32_16x16x32_bf16 v[8:11],a[84:87],a[20:23],v[8:11]
 v_exp_f32 v39,v39
 v_mfma_f32_16x16x32_bf16 v[12:15],a[100:103],a[20:23],v[12:15]
 v_cvt_pk_bf16_f32 v59,v38,v39
 v_mfma_f32_16x16x32_bf16 v[8:11],a[88:91],a[24:27],v[8:11]
 v_exp_f32 v0,v0
 v_mfma_f32_16x16x32_bf16 v[12:15],a[104:107],a[24:27],v[12:15]
 ds_read_b64_tr_b16 a[124:125],v124 offset:0
 ds_read_b64_tr_b16 a[126:127],v124 offset:4096
 v_mfma_f32_16x16x32_bf16 v[8:11],a[92:95],a[28:31],v[8:11]
 v_exp_f32 v1,v1
 v_mfma_f32_16x16x32_bf16 v[12:15],a[108:111],a[28:31],v[12:15]
 v_cvt_pk_bf16_f32 v60,v0,v1
 s_waitcnt vmcnt(4)
 buffer_load_dwordx4 v130,s[16:19],s32 offen offset:1024 nt lds
 v_mfma_f32_16x16x32_bf16 v[16:19],a[80:83],a[32:35],v[88:91]
 v_exp_f32 v2,v2
 v_mfma_f32_16x16x32_bf16 v[20:23],a[96:99],a[32:35],v[88:91]
 ds_read_b64_tr_b16 a[128:129],v125 offset:0
 ds_read_b64_tr_b16 a[130:131],v125 offset:4096
 v_mfma_f32_16x16x32_bf16 v[16:19],a[84:87],a[36:39],v[16:19]
 v_exp_f32 v3,v3
 v_mfma_f32_16x16x32_bf16 v[20:23],a[100:103],a[36:39],v[20:23]
 v_cvt_pk_bf16_f32 v61,v2,v3
 v_mfma_f32_16x16x32_bf16 v[16:19],a[88:91],a[40:43],v[16:19]
 v_exp_f32 v4,v4
 v_mfma_f32_16x16x32_bf16 v[20:23],a[104:107],a[40:43],v[20:23]
 ds_read_b64_tr_b16 a[132:133],v126 offset:0
 ds_read_b64_tr_b16 a[134:135],v126 offset:4096
 v_mfma_f32_16x16x32_bf16 v[16:19],a[92:95],a[44:47],v[16:19]
 v_exp_f32 v5,v5
 v_mfma_f32_16x16x32_bf16 v[20:23],a[108:111],a[44:47],v[20:23]
 v_cvt_pk_bf16_f32 v62,v4,v5
 s_waitcnt vmcnt(4)
 buffer_load_dwordx4 v131,s[16:19],s32 offen offset:2048 nt lds
 v_mfma_f32_16x16x32_bf16 v[24:27],a[80:83],a[48:51],v[92:95]
 v_exp_f32 v6,v6
 v_mfma_f32_16x16x32_bf16 v[28:31],a[96:99],a[48:51],v[92:95]
 ds_read_b64_tr_b16 a[136:137],v127 offset:0
 ds_read_b64_tr_b16 a[138:139],v127 offset:4096
 v_mfma_f32_16x16x32_bf16 v[24:27],a[84:87],a[52:55],v[24:27]
 v_exp_f32 v7,v7
 v_mfma_f32_16x16x32_bf16 v[28:31],a[100:103],a[52:55],v[28:31]
 v_cvt_pk_bf16_f32 v63,v6,v7
 v_mfma_f32_16x16x32_bf16 v[24:27],a[88:91],a[56:59],v[24:27]
 v_exp_f32 v8,v8
 v_mfma_f32_16x16x32_bf16 v[28:31],a[104:107],a[56:59],v[28:31]
 ds_read_b64_tr_b16 a[140:141],v128 offset:0
 ds_read_b64_tr_b16 a[142:143],v128 offset:4096
 v_mfma_f32_16x16x32_bf16 v[24:27],a[92:95],a[60:63],v[24:27]
 v_exp_f32 v9,v9
 v_mfma_f32_16x16x32_bf16 v[28:31],a[108:111],a[60:63],v[28:31]
 v_cvt_pk_bf16_f32 v64,v8,v9
 s_waitcnt vmcnt(4)
 buffer_load_dwordx4 v132,s[16:19],s32 offen offset:3072 nt lds
 v_mfma_f32_16x16x32_bf16 v[32:35],a[80:83],a[64:67],v[96:99]
 v_exp_f32 v10,v10
 v_mfma_f32_16x16x32_bf16 v[36:39],a[96:99],a[64:67],v[96:99]
 v_mfma_f32_16x16x32_bf16 v[32:35],a[84:87],a[68:71],v[32:35]
 v_exp_f32 v11,v11
 v_mfma_f32_16x16x32_bf16 v[36:39],a[100:103],a[68:71],v[36:39]
 v_cvt_pk_bf16_f32 v65,v10,v11
 v_mfma_f32_16x16x32_bf16 v[32:35],a[88:91],a[72:75],v[32:35]
 v_exp_f32 v12,v12
 v_mfma_f32_16x16x32_bf16 v[36:39],a[104:107],a[72:75],v[36:39]
 v_mfma_f32_16x16x32_bf16 v[32:35],a[92:95],a[76:79],v[32:35]
 v_exp_f32 v13,v13
 v_mfma_f32_16x16x32_bf16 v[36:39],a[108:111],a[76:79],v[36:39]
 v_cvt_pk_bf16_f32 v66,v12,v13
 s_waitcnt lgkmcnt(0)
 v_mfma_f32_16x16x32_bf16 v[144:147],a[112:115],v[40:43],v[144:147]
 s_barrier
 v_exp_f32 v14,v14
 v_mfma_f32_16x16x32_bf16 v[148:151],a[116:119],v[40:43],v[148:151]
 v_mfma_f32_16x16x32_bf16 v[152:155],a[120:123],v[40:43],v[152:155]
 v_exp_f32 v15,v15
 v_mfma_f32_16x16x32_bf16 v[156:159],a[124:127],v[40:43],v[156:159]
 v_cvt_pk_bf16_f32 v67,v14,v15
 s_add_u32 m0,s34,0x14000
 v_mfma_f32_16x16x32_bf16 v[160:163],a[128:131],v[40:43],v[160:163]
 v_exp_f32 v16,v16
 s_xor_b32 s33,s57,0xe000
 v_mfma_f32_16x16x32_bf16 v[164:167],a[132:135],v[40:43],v[164:167]
 ds_read_b128 a[80:83],v109 offset:0
 s_waitcnt vmcnt(4)
 buffer_load_dwordx4 v133,s[20:23],s33 offen offset:0 nt lds
 v_mfma_f32_16x16x32_bf16 v[168:171],a[136:139],v[40:43],v[168:171]
 v_exp_f32 v17,v17
 v_mfma_f32_16x16x32_bf16 v[172:175],a[140:143],v[40:43],v[172:175]
 v_cvt_pk_bf16_f32 v68,v16,v17
 v_mfma_f32_16x16x32_bf16 a[192:195],a[212:215],v[40:43],a[192:195]
 ds_read_b128 a[96:99],v109 offset:4096
 v_mfma_f32_16x16x32_bf16 v[176:179],a[112:115],v[44:47],v[176:179]
 v_exp_f32 v18,v18
 v_mfma_f32_16x16x32_bf16 v[180:183],a[116:119],v[44:47],v[180:183]
 ds_read_b128 a[84:87],v110 offset:0
 v_mfma_f32_16x16x32_bf16 v[184:187],a[120:123],v[44:47],v[184:187]
 v_exp_f32 v19,v19
 v_mfma_f32_16x16x32_bf16 v[188:191],a[124:127],v[44:47],v[188:191]
 v_cvt_pk_bf16_f32 v69,v18,v19
 v_mfma_f32_16x16x32_bf16 v[192:195],a[128:131],v[44:47],v[192:195]
 v_exp_f32 v20,v20
 v_mfma_f32_16x16x32_bf16 v[196:199],a[132:135],v[44:47],v[196:199]
 s_waitcnt vmcnt(4)
 buffer_load_dwordx4 v134,s[20:23],s33 offen offset:1024 nt lds
 v_mfma_f32_16x16x32_bf16 v[200:203],a[136:139],v[44:47],v[200:203]
 v_exp_f32 v21,v21
 v_mfma_f32_16x16x32_bf16 v[204:207],a[140:143],v[44:47],v[204:207]
 v_cvt_pk_bf16_f32 v70,v20,v21
 v_mfma_f32_16x16x32_bf16 a[196:199],a[212:215],v[44:47],a[196:199]
 ds_read_b128 a[100:103],v110 offset:4096
 v_mfma_f32_16x16x32_bf16 v[208:211],a[112:115],v[48:51],v[208:211]
 v_exp_f32 v22,v22
 v_mfma_f32_16x16x32_bf16 v[212:215],a[116:119],v[48:51],v[212:215]
 ds_read_b128 a[88:91],v111 offset:0
 v_mfma_f32_16x16x32_bf16 v[216:219],a[120:123],v[48:51],v[216:219]
 v_exp_f32 v23,v23
 v_mfma_f32_16x16x32_bf16 v[220:223],a[124:127],v[48:51],v[220:223]
 v_cvt_pk_bf16_f32 v71,v22,v23
 v_mfma_f32_16x16x32_bf16 v[224:227],a[128:131],v[48:51],v[224:227]
 v_exp_f32 v24,v24
 v_mfma_f32_16x16x32_bf16 v[228:231],a[132:135],v[48:51],v[228:231]
 ds_read_b128 a[104:107],v111 offset:4096
 v_mfma_f32_16x16x32_bf16 v[232:235],a[136:139],v[48:51],v[232:235]
 v_exp_f32 v25,v25
 v_mfma_f32_16x16x32_bf16 v[236:239],a[140:143],v[48:51],v[236:239]
 v_cvt_pk_bf16_f32 v72,v24,v25
 s_waitcnt vmcnt(4)
 buffer_load_dwordx4 v133,s[20:23],s33 offen offset:2048 nt lds
 v_mfma_f32_16x16x32_bf16 a[200:203],a[212:215],v[48:51],a[200:203]
 v_mfma_f32_16x16x32_bf16 v[240:243],a[112:115],v[52:55],v[240:243]
 v_exp_f32 v26,v26
 v_mfma_f32_16x16x32_bf16 v[244:247],a[116:119],v[52:55],v[244:247]
 ds_read_b128 a[92:95],v112 offset:0
 v_mfma_f32_16x16x32_bf16 v[248:251],a[120:123],v[52:55],v[248:251]
 v_exp_f32 v27,v27
 v_mfma_f32_16x16x32_bf16 v[252:255],a[124:127],v[52:55],v[252:255]
 v_cvt_pk_bf16_f32 v73,v26,v27
 v_mfma_f32_16x16x32_bf16 a[144:147],a[128:131],v[52:55],a[144:147]
 v_exp_f32 v28,v28
 v_mfma_f32_16x16x32_bf16 a[148:151],a[132:135],v[52:55],a[148:151]
 ds_read_b128 a[108:111],v112 offset:4096
 v_mfma_f32_16x16x32_bf16 a[152:155],a[136:139],v[52:55],a[152:155]
 v_exp_f32 v29,v29
 v_mfma_f32_16x16x32_bf16 a[156:159],a[140:143],v[52:55],a[156:159]
 v_cvt_pk_bf16_f32 v74,v28,v29
 s_waitcnt vmcnt(4)
 buffer_load_dwordx4 v134,s[20:23],s33 offen offset:3072 nt lds
 v_mfma_f32_16x16x32_bf16 a[204:207],a[212:215],v[52:55],a[204:207]
 v_mfma_f32_16x16x32_bf16 a[160:163],a[112:115],v[56:59],a[160:163]
 v_exp_f32 v30,v30
 v_mfma_f32_16x16x32_bf16 a[164:167],a[116:119],v[56:59],a[164:167]
 v_mfma_f32_16x16x32_bf16 a[168:171],a[120:123],v[56:59],a[168:171]
 v_exp_f32 v31,v31
 v_mfma_f32_16x16x32_bf16 a[172:175],a[124:127],v[56:59],a[172:175]
 v_cvt_pk_bf16_f32 v75,v30,v31
 v_mfma_f32_16x16x32_bf16 a[176:179],a[128:131],v[56:59],a[176:179]
 v_exp_f32 v32,v32
 v_mfma_f32_16x16x32_bf16 a[180:183],a[132:135],v[56:59],a[180:183]
 v_mfma_f32_16x16x32_bf16 a[184:187],a[136:139],v[56:59],a[184:187]
 v_exp_f32 v33,v33
 v_mfma_f32_16x16x32_bf16 a[188:191],a[140:143],v[56:59],a[188:191]
 v_cvt_pk_bf16_f32 v76,v32,v33
 v_mfma_f32_16x16x32_bf16 a[208:211],a[212:215],v[56:59],a[208:211]
 s_waitcnt lgkmcnt(0)
 v_mfma_f32_16x16x32_bf16 v[0:3],a[80:83],a[0:3],v[80:83]
 v_exp_f32 v34,v34
 v_mfma_f32_16x16x32_bf16 v[4:7],a[96:99],a[0:3],v[80:83]
 ds_read_b64_tr_b16 a[112:113],v113 offset:0
 ds_read_b64_tr_b16 a[114:115],v113 offset:4096
 v_mfma_f32_16x16x32_bf16 v[0:3],a[84:87],a[4:7],v[0:3]
 v_exp_f32 v35,v35
 v_mfma_f32_16x16x32_bf16 v[4:7],a[100:103],a[4:7],v[4:7]
 v_cvt_pk_bf16_f32 v77,v34,v35
 v_mfma_f32_16x16x32_bf16 v[0:3],a[88:91],a[8:11],v[0:3]
 v_exp_f32 v36,v36
 v_mfma_f32_16x16x32_bf16 v[4:7],a[104:107],a[8:11],v[4:7]
 ds_read_b64_tr_b16 a[116:117],v114 offset:0
 ds_read_b64_tr_b16 a[118:119],v114 offset:4096
 s_add_u32 m0,s34,0xc000
 v_mfma_f32_16x16x32_bf16 v[0:3],a[92:95],a[12:15],v[0:3]
 v_exp_f32 v37,v37
 s_xor_b32 s32,s57,0x10000
 v_mfma_f32_16x16x32_bf16 v[4:7],a[108:111],a[12:15],v[4:7]
 v_cvt_pk_bf16_f32 v78,v36,v37
 s_waitcnt vmcnt(4)
 buffer_load_dwordx4 v129,s[16:19],s32 offen offset:0 nt lds
 v_mfma_f32_16x16x32_bf16 v[8:11],a[80:83],a[16:19],v[84:87]
 v_exp_f32 v38,v38
 v_mfma_f32_16x16x32_bf16 v[12:15],a[96:99],a[16:19],v[84:87]
 ds_read_b64_tr_b16 a[120:121],v115 offset:0
 ds_read_b64_tr_b16 a[122:123],v115 offset:4096
 v_mfma_f32_16x16x32_bf16 v[8:11],a[84:87],a[20:23],v[8:11]
 v_exp_f32 v39,v39
 v_mfma_f32_16x16x32_bf16 v[12:15],a[100:103],a[20:23],v[12:15]
 v_cvt_pk_bf16_f32 v79,v38,v39
 v_mfma_f32_16x16x32_bf16 v[8:11],a[88:91],a[24:27],v[8:11]
 v_exp_f32 v0,v0
 v_mfma_f32_16x16x32_bf16 v[12:15],a[104:107],a[24:27],v[12:15]
 ds_read_b64_tr_b16 a[124:125],v116 offset:0
 ds_read_b64_tr_b16 a[126:127],v116 offset:4096
 v_mfma_f32_16x16x32_bf16 v[8:11],a[92:95],a[28:31],v[8:11]
 v_exp_f32 v1,v1
 v_mfma_f32_16x16x32_bf16 v[12:15],a[108:111],a[28:31],v[12:15]
 v_cvt_pk_bf16_f32 v40,v0,v1
 s_waitcnt vmcnt(4)
 buffer_load_dwordx4 v130,s[16:19],s32 offen offset:1024 nt lds
 v_mfma_f32_16x16x32_bf16 v[16:19],a[80:83],a[32:35],v[88:91]
 v_exp_f32 v2,v2
 v_mfma_f32_16x16x32_bf16 v[20:23],a[96:99],a[32:35],v[88:91]
 ds_read_b64_tr_b16 a[128:129],v117 offset:0
 ds_read_b64_tr_b16 a[130:131],v117 offset:4096
 v_mfma_f32_16x16x32_bf16 v[16:19],a[84:87],a[36:39],v[16:19]
 v_exp_f32 v3,v3
 v_mfma_f32_16x16x32_bf16 v[20:23],a[100:103],a[36:39],v[20:23]
 v_cvt_pk_bf16_f32 v41,v2,v3
 v_mfma_f32_16x16x32_bf16 v[16:19],a[88:91],a[40:43],v[16:19]
 v_exp_f32 v4,v4
 v_mfma_f32_16x16x32_bf16 v[20:23],a[104:107],a[40:43],v[20:23]
 ds_read_b64_tr_b16 a[132:133],v118 offset:0
 ds_read_b64_tr_b16 a[134:135],v118 offset:4096
 v_mfma_f32_16x16x32_bf16 v[16:19],a[92:95],a[44:47],v[16:19]
 v_exp_f32 v5,v5
 v_mfma_f32_16x16x32_bf16 v[20:23],a[108:111],a[44:47],v[20:23]
 v_cvt_pk_bf16_f32 v42,v4,v5
 s_waitcnt vmcnt(4)
 buffer_load_dwordx4 v131,s[16:19],s32 offen offset:2048 nt lds
 v_mfma_f32_16x16x32_bf16 v[24:27],a[80:83],a[48:51],v[92:95]
 v_exp_f32 v6,v6
 v_mfma_f32_16x16x32_bf16 v[28:31],a[96:99],a[48:51],v[92:95]
 ds_read_b64_tr_b16 a[136:137],v119 offset:0
 ds_read_b64_tr_b16 a[138:139],v119 offset:4096
 v_mfma_f32_16x16x32_bf16 v[24:27],a[84:87],a[52:55],v[24:27]
 v_exp_f32 v7,v7
 v_mfma_f32_16x16x32_bf16 v[28:31],a[100:103],a[52:55],v[28:31]
 v_cvt_pk_bf16_f32 v43,v6,v7
 v_mfma_f32_16x16x32_bf16 v[24:27],a[88:91],a[56:59],v[24:27]
 v_exp_f32 v8,v8
 v_mfma_f32_16x16x32_bf16 v[28:31],a[104:107],a[56:59],v[28:31]
 ds_read_b64_tr_b16 a[140:141],v120 offset:0
 ds_read_b64_tr_b16 a[142:143],v120 offset:4096
 v_mfma_f32_16x16x32_bf16 v[24:27],a[92:95],a[60:63],v[24:27]
 v_exp_f32 v9,v9
 v_mfma_f32_16x16x32_bf16 v[28:31],a[108:111],a[60:63],v[28:31]
 v_cvt_pk_bf16_f32 v44,v8,v9
 s_waitcnt vmcnt(4)
 buffer_load_dwordx4 v132,s[16:19],s32 offen offset:3072 nt lds
 v_mfma_f32_16x16x32_bf16 v[32:35],a[80:83],a[64:67],v[96:99]
 v_exp_f32 v10,v10
 v_mfma_f32_16x16x32_bf16 v[36:39],a[96:99],a[64:67],v[96:99]
 v_mfma_f32_16x16x32_bf16 v[32:35],a[84:87],a[68:71],v[32:35]
 v_exp_f32 v11,v11
 v_mfma_f32_16x16x32_bf16 v[36:39],a[100:103],a[68:71],v[36:39]
 v_cvt_pk_bf16_f32 v45,v10,v11
 v_mfma_f32_16x16x32_bf16 v[32:35],a[88:91],a[72:75],v[32:35]
 v_exp_f32 v12,v12
 v_mfma_f32_16x16x32_bf16 v[36:39],a[104:107],a[72:75],v[36:39]
 v_mfma_f32_16x16x32_bf16 v[32:35],a[92:95],a[76:79],v[32:35]
 v_exp_f32 v13,v13
 v_mfma_f32_16x16x32_bf16 v[36:39],a[108:111],a[76:79],v[36:39]
 v_cvt_pk_bf16_f32 v46,v12,v13
 s_waitcnt lgkmcnt(0)
 v_mfma_f32_16x16x32_bf16 v[144:147],a[112:115],v[60:63],v[144:147]
 s_barrier
 v_exp_f32 v14,v14
 v_mfma_f32_16x16x32_bf16 v[148:151],a[116:119],v[60:63],v[148:151]
 v_mfma_f32_16x16x32_bf16 v[152:155],a[120:123],v[60:63],v[152:155]
 v_exp_f32 v15,v15
 v_mfma_f32_16x16x32_bf16 v[156:159],a[124:127],v[60:63],v[156:159]
 v_cvt_pk_bf16_f32 v47,v14,v15
 s_add_u32 m0,s34,0x18000
 v_mfma_f32_16x16x32_bf16 v[160:163],a[128:131],v[60:63],v[160:163]
 v_exp_f32 v16,v16
 s_xor_b32 s33,s57,0x10000
 v_mfma_f32_16x16x32_bf16 v[164:167],a[132:135],v[60:63],v[164:167]
 ds_read_b128 a[80:83],v105 offset:0
 s_waitcnt vmcnt(4)
 buffer_load_dwordx4 v133,s[20:23],s33 offen offset:0 nt lds
 v_mfma_f32_16x16x32_bf16 v[168:171],a[136:139],v[60:63],v[168:171]
 v_exp_f32 v17,v17
 v_mfma_f32_16x16x32_bf16 v[172:175],a[140:143],v[60:63],v[172:175]
 v_cvt_pk_bf16_f32 v48,v16,v17
 v_mfma_f32_16x16x32_bf16 a[192:195],a[212:215],v[60:63],a[192:195]
 ds_read_b128 a[96:99],v105 offset:4096
 v_mfma_f32_16x16x32_bf16 v[176:179],a[112:115],v[64:67],v[176:179]
 v_exp_f32 v18,v18
 v_mfma_f32_16x16x32_bf16 v[180:183],a[116:119],v[64:67],v[180:183]
 ds_read_b128 a[84:87],v106 offset:0
 v_mfma_f32_16x16x32_bf16 v[184:187],a[120:123],v[64:67],v[184:187]
 v_exp_f32 v19,v19
 v_mfma_f32_16x16x32_bf16 v[188:191],a[124:127],v[64:67],v[188:191]
 v_cvt_pk_bf16_f32 v49,v18,v19
 v_mfma_f32_16x16x32_bf16 v[192:195],a[128:131],v[64:67],v[192:195]
 v_exp_f32 v20,v20
 v_mfma_f32_16x16x32_bf16 v[196:199],a[132:135],v[64:67],v[196:199]
 s_waitcnt vmcnt(4)
 buffer_load_dwordx4 v134,s[20:23],s33 offen offset:1024 nt lds
 v_mfma_f32_16x16x32_bf16 v[200:203],a[136:139],v[64:67],v[200:203]
 v_exp_f32 v21,v21
 v_mfma_f32_16x16x32_bf16 v[204:207],a[140:143],v[64:67],v[204:207]
 v_cvt_pk_bf16_f32 v50,v20,v21
 v_mfma_f32_16x16x32_bf16 a[196:199],a[212:215],v[64:67],a[196:199]
 ds_read_b128 a[100:103],v106 offset:4096
 v_mfma_f32_16x16x32_bf16 v[208:211],a[112:115],v[68:71],v[208:211]
 v_exp_f32 v22,v22
 v_mfma_f32_16x16x32_bf16 v[212:215],a[116:119],v[68:71],v[212:215]
 ds_read_b128 a[88:91],v107 offset:0
 v_mfma_f32_16x16x32_bf16 v[216:219],a[120:123],v[68:71],v[216:219]
 v_exp_f32 v23,v23
 v_mfma_f32_16x16x32_bf16 v[220:223],a[124:127],v[68:71],v[220:223]
 v_cvt_pk_bf16_f32 v51,v22,v23
 v_mfma_f32_16x16x32_bf16 v[224:227],a[128:131],v[68:71],v[224:227]
 v_exp_f32 v24,v24
 v_mfma_f32_16x16x32_bf16 v[228:231],a[132:135],v[68:71],v[228:231]
 ds_read_b128 a[104:107],v107 offset:4096
 v_mfma_f32_16x16x32_bf16 v[232:235],a[136:139],v[68:71],v[232:235]
 v_exp_f32 v25,v25
 v_mfma_f32_16x16x32_bf16 v[236:239],a[140:143],v[68:71],v[236:239]
 v_cvt_pk_bf16_f32 v52,v24,v25
 s_waitcnt vmcnt(4)
 buffer_load_dwordx4 v133,s[20:23],s33 offen offset:2048 nt lds
 v_mfma_f32_16x16x32_bf16 a[200:203],a[212:215],v[68:71],a[200:203]
 v_mfma_f32_16x16x32_bf16 v[240:243],a[112:115],v[72:75],v[240:243]
 v_exp_f32 v26,v26
 v_mfma_f32_16x16x32_bf16 v[244:247],a[116:119],v[72:75],v[244:247]
 ds_read_b128 a[92:95],v108 offset:0
 v_mfma_f32_16x16x32_bf16 v[248:251],a[120:123],v[72:75],v[248:251]
 v_exp_f32 v27,v27
 v_mfma_f32_16x16x32_bf16 v[252:255],a[124:127],v[72:75],v[252:255]
 v_cvt_pk_bf16_f32 v53,v26,v27
 v_mfma_f32_16x16x32_bf16 a[144:147],a[128:131],v[72:75],a[144:147]
 v_exp_f32 v28,v28
 v_mfma_f32_16x16x32_bf16 a[148:151],a[132:135],v[72:75],a[148:151]
 ds_read_b128 a[108:111],v108 offset:4096
 v_mfma_f32_16x16x32_bf16 a[152:155],a[136:139],v[72:75],a[152:155]
 v_exp_f32 v29,v29
 v_mfma_f32_16x16x32_bf16 a[156:159],a[140:143],v[72:75],a[156:159]
 v_cvt_pk_bf16_f32 v54,v28,v29
 s_waitcnt vmcnt(4)
 buffer_load_dwordx4 v134,s[20:23],s33 offen offset:3072 nt lds
 v_mfma_f32_16x16x32_bf16 a[204:207],a[212:215],v[72:75],a[204:207]
 v_mfma_f32_16x16x32_bf16 a[160:163],a[112:115],v[76:79],a[160:163]
 v_exp_f32 v30,v30
 v_mfma_f32_16x16x32_bf16 a[164:167],a[116:119],v[76:79],a[164:167]
 v_mfma_f32_16x16x32_bf16 a[168:171],a[120:123],v[76:79],a[168:171]
 v_exp_f32 v31,v31
 v_mfma_f32_16x16x32_bf16 a[172:175],a[124:127],v[76:79],a[172:175]
 v_cvt_pk_bf16_f32 v55,v30,v31
 v_mfma_f32_16x16x32_bf16 a[176:179],a[128:131],v[76:79],a[176:179]
 v_exp_f32 v32,v32
 v_mfma_f32_16x16x32_bf16 a[180:183],a[132:135],v[76:79],a[180:183]
 v_mfma_f32_16x16x32_bf16 a[184:187],a[136:139],v[76:79],a[184:187]
 v_exp_f32 v33,v33
 v_mfma_f32_16x16x32_bf16 a[188:191],a[140:143],v[76:79],a[188:191]
 v_cvt_pk_bf16_f32 v56,v32,v33
 v_mfma_f32_16x16x32_bf16 a[208:211],a[212:215],v[76:79],a[208:211]
 s_waitcnt lgkmcnt(0)
 v_mfma_f32_16x16x32_bf16 v[0:3],a[80:83],a[0:3],v[80:83]
 v_exp_f32 v34,v34
 v_mfma_f32_16x16x32_bf16 v[4:7],a[96:99],a[0:3],v[80:83]
 ds_read_b64_tr_b16 a[112:113],v113 offset:16384
 ds_read_b64_tr_b16 a[114:115],v113 offset:20480
 v_mfma_f32_16x16x32_bf16 v[0:3],a[84:87],a[4:7],v[0:3]
 v_exp_f32 v35,v35
 v_mfma_f32_16x16x32_bf16 v[4:7],a[100:103],a[4:7],v[4:7]
 v_cvt_pk_bf16_f32 v57,v34,v35
 v_mfma_f32_16x16x32_bf16 v[0:3],a[88:91],a[8:11],v[0:3]
 v_exp_f32 v36,v36
 v_mfma_f32_16x16x32_bf16 v[4:7],a[104:107],a[8:11],v[4:7]
 ds_read_b64_tr_b16 a[116:117],v114 offset:16384
 ds_read_b64_tr_b16 a[118:119],v114 offset:20480
 s_add_u32 m0,s34,0x10000
 v_mfma_f32_16x16x32_bf16 v[0:3],a[92:95],a[12:15],v[0:3]
 v_exp_f32 v37,v37
 s_xor_b32 s32,s57,0x12000
 v_mfma_f32_16x16x32_bf16 v[4:7],a[108:111],a[12:15],v[4:7]
 v_cvt_pk_bf16_f32 v58,v36,v37
 s_waitcnt vmcnt(3)
 buffer_load_dwordx4 v129,s[16:19],s32 offen offset:0 nt lds
 v_mfma_f32_16x16x32_bf16 v[8:11],a[80:83],a[16:19],v[84:87]
 v_exp_f32 v38,v38
 v_mfma_f32_16x16x32_bf16 v[12:15],a[96:99],a[16:19],v[84:87]
 ds_read_b64_tr_b16 a[120:121],v115 offset:16384
 ds_read_b64_tr_b16 a[122:123],v115 offset:20480
 v_mfma_f32_16x16x32_bf16 v[8:11],a[84:87],a[20:23],v[8:11]
 v_exp_f32 v39,v39
 v_mfma_f32_16x16x32_bf16 v[12:15],a[100:103],a[20:23],v[12:15]
 v_cvt_pk_bf16_f32 v59,v38,v39
 v_mfma_f32_16x16x32_bf16 v[8:11],a[88:91],a[24:27],v[8:11]
 v_exp_f32 v0,v0
 v_mfma_f32_16x16x32_bf16 v[12:15],a[104:107],a[24:27],v[12:15]
 ds_read_b64_tr_b16 a[124:125],v116 offset:16384
 ds_read_b64_tr_b16 a[126:127],v116 offset:20480
 v_mfma_f32_16x16x32_bf16 v[8:11],a[92:95],a[28:31],v[8:11]
 v_exp_f32 v1,v1
 v_mfma_f32_16x16x32_bf16 v[12:15],a[108:111],a[28:31],v[12:15]
 v_cvt_pk_bf16_f32 v60,v0,v1
 s_waitcnt vmcnt(4)
 buffer_load_dwordx4 v130,s[16:19],s32 offen offset:1024 nt lds
 v_mfma_f32_16x16x32_bf16 v[16:19],a[80:83],a[32:35],v[88:91]
 v_exp_f32 v2,v2
 v_mfma_f32_16x16x32_bf16 v[20:23],a[96:99],a[32:35],v[88:91]
 ds_read_b64_tr_b16 a[128:129],v117 offset:16384
 ds_read_b64_tr_b16 a[130:131],v117 offset:20480
 v_mfma_f32_16x16x32_bf16 v[16:19],a[84:87],a[36:39],v[16:19]
 v_exp_f32 v3,v3
 v_mfma_f32_16x16x32_bf16 v[20:23],a[100:103],a[36:39],v[20:23]
 v_cvt_pk_bf16_f32 v61,v2,v3
 v_mfma_f32_16x16x32_bf16 v[16:19],a[88:91],a[40:43],v[16:19]
 v_exp_f32 v4,v4
 v_mfma_f32_16x16x32_bf16 v[20:23],a[104:107],a[40:43],v[20:23]
 ds_read_b64_tr_b16 a[132:133],v118 offset:16384
 ds_read_b64_tr_b16 a[134:135],v118 offset:20480
 v_mfma_f32_16x16x32_bf16 v[16:19],a[92:95],a[44:47],v[16:19]
 v_exp_f32 v5,v5
 v_mfma_f32_16x16x32_bf16 v[20:23],a[108:111],a[44:47],v[20:23]
 v_cvt_pk_bf16_f32 v62,v4,v5
 s_waitcnt vmcnt(4)
 buffer_load_dwordx4 v131,s[16:19],s32 offen offset:2048 nt lds
 v_mfma_f32_16x16x32_bf16 v[24:27],a[80:83],a[48:51],v[92:95]
 v_exp_f32 v6,v6
 v_mfma_f32_16x16x32_bf16 v[28:31],a[96:99],a[48:51],v[92:95]
 ds_read_b64_tr_b16 a[136:137],v119 offset:16384
 ds_read_b64_tr_b16 a[138:139],v119 offset:20480
 v_mfma_f32_16x16x32_bf16 v[24:27],a[84:87],a[52:55],v[24:27]
 v_exp_f32 v7,v7
 v_mfma_f32_16x16x32_bf16 v[28:31],a[100:103],a[52:55],v[28:31]
 v_cvt_pk_bf16_f32 v63,v6,v7
 v_mfma_f32_16x16x32_bf16 v[24:27],a[88:91],a[56:59],v[24:27]
 v_exp_f32 v8,v8
 v_mfma_f32_16x16x32_bf16 v[28:31],a[104:107],a[56:59],v[28:31]
 ds_read_b64_tr_b16 a[140:141],v120 offset:16384
 ds_read_b64_tr_b16 a[142:143],v120 offset:20480
 v_mfma_f32_16x16x32_bf16 v[24:27],a[92:95],a[60:63],v[24:27]
 v_exp_f32 v9,v9
 v_mfma_f32_16x16x32_bf16 v[28:31],a[108:111],a[60:63],v[28:31]
 v_cvt_pk_bf16_f32 v64,v8,v9
 s_waitcnt vmcnt(4)
 buffer_load_dwordx4 v132,s[16:19],s32 offen offset:3072 nt lds
 v_mfma_f32_16x16x32_bf16 v[32:35],a[80:83],a[64:67],v[96:99]
 v_exp_f32 v10,v10
 v_mfma_f32_16x16x32_bf16 v[36:39],a[96:99],a[64:67],v[96:99]
 v_mfma_f32_16x16x32_bf16 v[32:35],a[84:87],a[68:71],v[32:35]
 v_exp_f32 v11,v11
 v_mfma_f32_16x16x32_bf16 v[36:39],a[100:103],a[68:71],v[36:39]
 v_cvt_pk_bf16_f32 v65,v10,v11
 v_mfma_f32_16x16x32_bf16 v[32:35],a[88:91],a[72:75],v[32:35]
 v_exp_f32 v12,v12
 v_mfma_f32_16x16x32_bf16 v[36:39],a[104:107],a[72:75],v[36:39]
 v_mfma_f32_16x16x32_bf16 v[32:35],a[92:95],a[76:79],v[32:35]
 v_exp_f32 v13,v13
 v_mfma_f32_16x16x32_bf16 v[36:39],a[108:111],a[76:79],v[36:39]
 v_cvt_pk_bf16_f32 v66,v12,v13
 s_waitcnt lgkmcnt(0)
 v_mfma_f32_16x16x32_bf16 v[144:147],a[112:115],v[40:43],v[144:147]
 s_barrier
 v_exp_f32 v14,v14
 v_mfma_f32_16x16x32_bf16 v[148:151],a[116:119],v[40:43],v[148:151]
 v_mfma_f32_16x16x32_bf16 v[152:155],a[120:123],v[40:43],v[152:155]
 v_exp_f32 v15,v15
 v_mfma_f32_16x16x32_bf16 v[156:159],a[124:127],v[40:43],v[156:159]
 v_cvt_pk_bf16_f32 v67,v14,v15
 s_add_u32 m0,s34,0x1c000
 v_mfma_f32_16x16x32_bf16 v[160:163],a[128:131],v[40:43],v[160:163]
 v_exp_f32 v16,v16
 s_xor_b32 s33,s57,0x12000
 v_mfma_f32_16x16x32_bf16 v[164:167],a[132:135],v[40:43],v[164:167]
 ds_read_b128 a[80:83],v105 offset:16384
 s_waitcnt vmcnt(3)
 buffer_load_dwordx4 v133,s[20:23],s33 offen offset:0 nt lds
 v_mfma_f32_16x16x32_bf16 v[168:171],a[136:139],v[40:43],v[168:171]
 v_exp_f32 v17,v17
 v_mfma_f32_16x16x32_bf16 v[172:175],a[140:143],v[40:43],v[172:175]
 v_cvt_pk_bf16_f32 v68,v16,v17
 v_mfma_f32_16x16x32_bf16 a[192:195],a[212:215],v[40:43],a[192:195]
 ds_read_b128 a[96:99],v105 offset:20480
 v_mfma_f32_16x16x32_bf16 v[176:179],a[112:115],v[44:47],v[176:179]
 v_exp_f32 v18,v18
 v_mfma_f32_16x16x32_bf16 v[180:183],a[116:119],v[44:47],v[180:183]
 ds_read_b128 a[84:87],v106 offset:16384
 v_mfma_f32_16x16x32_bf16 v[184:187],a[120:123],v[44:47],v[184:187]
 v_exp_f32 v19,v19
 v_mfma_f32_16x16x32_bf16 v[188:191],a[124:127],v[44:47],v[188:191]
 v_cvt_pk_bf16_f32 v69,v18,v19
 v_mfma_f32_16x16x32_bf16 v[192:195],a[128:131],v[44:47],v[192:195]
 v_exp_f32 v20,v20
 v_mfma_f32_16x16x32_bf16 v[196:199],a[132:135],v[44:47],v[196:199]
 s_waitcnt vmcnt(4)
 buffer_load_dwordx4 v134,s[20:23],s33 offen offset:1024 nt lds
 v_mfma_f32_16x16x32_bf16 v[200:203],a[136:139],v[44:47],v[200:203]
 v_exp_f32 v21,v21
 v_mfma_f32_16x16x32_bf16 v[204:207],a[140:143],v[44:47],v[204:207]
 v_cvt_pk_bf16_f32 v70,v20,v21
 v_mfma_f32_16x16x32_bf16 a[196:199],a[212:215],v[44:47],a[196:199]
 ds_read_b128 a[100:103],v106 offset:20480
 v_mfma_f32_16x16x32_bf16 v[208:211],a[112:115],v[48:51],v[208:211]
 v_exp_f32 v22,v22
 v_mfma_f32_16x16x32_bf16 v[212:215],a[116:119],v[48:51],v[212:215]
 ds_read_b128 a[88:91],v107 offset:16384
 v_mfma_f32_16x16x32_bf16 v[216:219],a[120:123],v[48:51],v[216:219]
 v_exp_f32 v23,v23
 v_mfma_f32_16x16x32_bf16 v[220:223],a[124:127],v[48:51],v[220:223]
 v_cvt_pk_bf16_f32 v71,v22,v23
 v_mfma_f32_16x16x32_bf16 v[224:227],a[128:131],v[48:51],v[224:227]
 v_exp_f32 v24,v24
 v_mfma_f32_16x16x32_bf16 v[228:231],a[132:135],v[48:51],v[228:231]
 ds_read_b128 a[104:107],v107 offset:20480
 v_mfma_f32_16x16x32_bf16 v[232:235],a[136:139],v[48:51],v[232:235]
 v_exp_f32 v25,v25
 v_mfma_f32_16x16x32_bf16 v[236:239],a[140:143],v[48:51],v[236:239]
 v_cvt_pk_bf16_f32 v72,v24,v25
 s_waitcnt vmcnt(4)
 buffer_load_dwordx4 v133,s[20:23],s33 offen offset:2048 nt lds
 v_mfma_f32_16x16x32_bf16 a[200:203],a[212:215],v[48:51],a[200:203]
 v_mfma_f32_16x16x32_bf16 v[240:243],a[112:115],v[52:55],v[240:243]
 v_exp_f32 v26,v26
 v_mfma_f32_16x16x32_bf16 v[244:247],a[116:119],v[52:55],v[244:247]
 ds_read_b128 a[92:95],v108 offset:16384
 v_mfma_f32_16x16x32_bf16 v[248:251],a[120:123],v[52:55],v[248:251]
 v_exp_f32 v27,v27
 v_mfma_f32_16x16x32_bf16 v[252:255],a[124:127],v[52:55],v[252:255]
 v_cvt_pk_bf16_f32 v73,v26,v27
 v_mfma_f32_16x16x32_bf16 a[144:147],a[128:131],v[52:55],a[144:147]
 v_exp_f32 v28,v28
 v_mfma_f32_16x16x32_bf16 a[148:151],a[132:135],v[52:55],a[148:151]
 ds_read_b128 a[108:111],v108 offset:20480
 v_mfma_f32_16x16x32_bf16 a[152:155],a[136:139],v[52:55],a[152:155]
 v_exp_f32 v29,v29
 v_mfma_f32_16x16x32_bf16 a[156:159],a[140:143],v[52:55],a[156:159]
 v_cvt_pk_bf16_f32 v74,v28,v29
 s_waitcnt vmcnt(4)
 buffer_load_dwordx4 v134,s[20:23],s33 offen offset:3072 nt lds
 v_mfma_f32_16x16x32_bf16 a[204:207],a[212:215],v[52:55],a[204:207]
 v_mfma_f32_16x16x32_bf16 a[160:163],a[112:115],v[56:59],a[160:163]
 v_exp_f32 v30,v30
 v_mfma_f32_16x16x32_bf16 a[164:167],a[116:119],v[56:59],a[164:167]
 v_mfma_f32_16x16x32_bf16 a[168:171],a[120:123],v[56:59],a[168:171]
 v_exp_f32 v31,v31
 v_mfma_f32_16x16x32_bf16 a[172:175],a[124:127],v[56:59],a[172:175]
 v_cvt_pk_bf16_f32 v75,v30,v31
 v_mfma_f32_16x16x32_bf16 a[176:179],a[128:131],v[56:59],a[176:179]
 v_exp_f32 v32,v32
 v_mfma_f32_16x16x32_bf16 a[180:183],a[132:135],v[56:59],a[180:183]
 v_mfma_f32_16x16x32_bf16 a[184:187],a[136:139],v[56:59],a[184:187]
 v_exp_f32 v33,v33
 v_mfma_f32_16x16x32_bf16 a[188:191],a[140:143],v[56:59],a[188:191]
 v_cvt_pk_bf16_f32 v76,v32,v33
 v_mfma_f32_16x16x32_bf16 a[208:211],a[212:215],v[56:59],a[208:211]
 s_waitcnt lgkmcnt(0)
 v_mfma_f32_16x16x32_bf16 v[0:3],a[80:83],a[0:3],v[80:83]
 v_exp_f32 v34,v34
 v_mfma_f32_16x16x32_bf16 v[4:7],a[96:99],a[0:3],v[80:83]
 ds_read_b64_tr_b16 a[112:113],v113 offset:32768
 ds_read_b64_tr_b16 a[114:115],v113 offset:36864
 v_mfma_f32_16x16x32_bf16 v[0:3],a[84:87],a[4:7],v[0:3]
 v_exp_f32 v35,v35
 v_mfma_f32_16x16x32_bf16 v[4:7],a[100:103],a[4:7],v[4:7]
 v_cvt_pk_bf16_f32 v77,v34,v35
 v_mfma_f32_16x16x32_bf16 v[0:3],a[88:91],a[8:11],v[0:3]
 v_exp_f32 v36,v36
 v_mfma_f32_16x16x32_bf16 v[4:7],a[104:107],a[8:11],v[4:7]
 ds_read_b64_tr_b16 a[116:117],v114 offset:32768
 ds_read_b64_tr_b16 a[118:119],v114 offset:36864
 s_add_u32 m0,s34,0x0
 v_mfma_f32_16x16x32_bf16 v[0:3],a[92:95],a[12:15],v[0:3]
 v_exp_f32 v37,v37
 s_xor_b32 s32,s57,0x14000
 v_mfma_f32_16x16x32_bf16 v[4:7],a[108:111],a[12:15],v[4:7]
 v_cvt_pk_bf16_f32 v78,v36,v37
 s_waitcnt vmcnt(4)
 buffer_load_dwordx4 v129,s[16:19],s32 offen offset:0 nt lds
 v_mfma_f32_16x16x32_bf16 v[8:11],a[80:83],a[16:19],v[84:87]
 v_exp_f32 v38,v38
 v_mfma_f32_16x16x32_bf16 v[12:15],a[96:99],a[16:19],v[84:87]
 ds_read_b64_tr_b16 a[120:121],v115 offset:32768
 ds_read_b64_tr_b16 a[122:123],v115 offset:36864
 v_mfma_f32_16x16x32_bf16 v[8:11],a[84:87],a[20:23],v[8:11]
 v_exp_f32 v39,v39
 v_mfma_f32_16x16x32_bf16 v[12:15],a[100:103],a[20:23],v[12:15]
 v_cvt_pk_bf16_f32 v79,v38,v39
 v_mfma_f32_16x16x32_bf16 v[8:11],a[88:91],a[24:27],v[8:11]
 v_exp_f32 v0,v0
 v_mfma_f32_16x16x32_bf16 v[12:15],a[104:107],a[24:27],v[12:15]
 ds_read_b64_tr_b16 a[124:125],v116 offset:32768
 ds_read_b64_tr_b16 a[126:127],v116 offset:36864
 v_mfma_f32_16x16x32_bf16 v[8:11],a[92:95],a[28:31],v[8:11]
 v_exp_f32 v1,v1
 v_mfma_f32_16x16x32_bf16 v[12:15],a[108:111],a[28:31],v[12:15]
 v_cvt_pk_bf16_f32 v40,v0,v1
 s_waitcnt vmcnt(4)
 buffer_load_dwordx4 v130,s[16:19],s32 offen offset:1024 nt lds
 v_mfma_f32_16x16x32_bf16 v[16:19],a[80:83],a[32:35],v[88:91]
 v_exp_f32 v2,v2
 v_mfma_f32_16x16x32_bf16 v[20:23],a[96:99],a[32:35],v[88:91]
 ds_read_b64_tr_b16 a[128:129],v117 offset:32768
 ds_read_b64_tr_b16 a[130:131],v117 offset:36864
 v_mfma_f32_16x16x32_bf16 v[16:19],a[84:87],a[36:39],v[16:19]
 v_exp_f32 v3,v3
 v_mfma_f32_16x16x32_bf16 v[20:23],a[100:103],a[36:39],v[20:23]
 v_cvt_pk_bf16_f32 v41,v2,v3
 v_mfma_f32_16x16x32_bf16 v[16:19],a[88:91],a[40:43],v[16:19]
 v_exp_f32 v4,v4
 v_mfma_f32_16x16x32_bf16 v[20:23],a[104:107],a[40:43],v[20:23]
 ds_read_b64_tr_b16 a[132:133],v118 offset:32768
 ds_read_b64_tr_b16 a[134:135],v118 offset:36864
 v_mfma_f32_16x16x32_bf16 v[16:19],a[92:95],a[44:47],v[16:19]
 v_exp_f32 v5,v5
 v_mfma_f32_16x16x32_bf16 v[20:23],a[108:111],a[44:47],v[20:23]
 v_cvt_pk_bf16_f32 v42,v4,v5
 s_waitcnt vmcnt(4)
 buffer_load_dwordx4 v131,s[16:19],s32 offen offset:2048 nt lds
 v_mfma_f32_16x16x32_bf16 v[24:27],a[80:83],a[48:51],v[92:95]
 v_exp_f32 v6,v6
 v_mfma_f32_16x16x32_bf16 v[28:31],a[96:99],a[48:51],v[92:95]
 ds_read_b64_tr_b16 a[136:137],v119 offset:32768
 ds_read_b64_tr_b16 a[138:139],v119 offset:36864
 v_mfma_f32_16x16x32_bf16 v[24:27],a[84:87],a[52:55],v[24:27]
 v_exp_f32 v7,v7
 v_mfma_f32_16x16x32_bf16 v[28:31],a[100:103],a[52:55],v[28:31]
 v_cvt_pk_bf16_f32 v43,v6,v7
 v_mfma_f32_16x16x32_bf16 v[24:27],a[88:91],a[56:59],v[24:27]
 v_exp_f32 v8,v8
 v_mfma_f32_16x16x32_bf16 v[28:31],a[104:107],a[56:59],v[28:31]
 ds_read_b64_tr_b16 a[140:141],v120 offset:32768
 ds_read_b64_tr_b16 a[142:143],v120 offset:36864
 v_mfma_f32_16x16x32_bf16 v[24:27],a[92:95],a[60:63],v[24:27]
 v_exp_f32 v9,v9
 v_mfma_f32_16x16x32_bf16 v[28:31],a[108:111],a[60:63],v[28:31]
 v_cvt_pk_bf16_f32 v44,v8,v9
 s_waitcnt vmcnt(4)
 buffer_load_dwordx4 v132,s[16:19],s32 offen offset:3072 nt lds
 v_mfma_f32_16x16x32_bf16 v[32:35],a[80:83],a[64:67],v[96:99]
 v_exp_f32 v10,v10
 v_mfma_f32_16x16x32_bf16 v[36:39],a[96:99],a[64:67],v[96:99]
 v_mfma_f32_16x16x32_bf16 v[32:35],a[84:87],a[68:71],v[32:35]
 v_exp_f32 v11,v11
 v_mfma_f32_16x16x32_bf16 v[36:39],a[100:103],a[68:71],v[36:39]
 v_cvt_pk_bf16_f32 v45,v10,v11
 v_mfma_f32_16x16x32_bf16 v[32:35],a[88:91],a[72:75],v[32:35]
 v_exp_f32 v12,v12
 v_mfma_f32_16x16x32_bf16 v[36:39],a[104:107],a[72:75],v[36:39]
 v_mfma_f32_16x16x32_bf16 v[32:35],a[92:95],a[76:79],v[32:35]
 v_exp_f32 v13,v13
 v_mfma_f32_16x16x32_bf16 v[36:39],a[108:111],a[76:79],v[36:39]
 v_cvt_pk_bf16_f32 v46,v12,v13
 s_waitcnt lgkmcnt(0)
 v_mfma_f32_16x16x32_bf16 v[144:147],a[112:115],v[60:63],v[144:147]
 s_barrier
 v_exp_f32 v14,v14
 v_mfma_f32_16x16x32_bf16 v[148:151],a[116:119],v[60:63],v[148:151]
 v_mfma_f32_16x16x32_bf16 v[152:155],a[120:123],v[60:63],v[152:155]
 v_exp_f32 v15,v15
 v_mfma_f32_16x16x32_bf16 v[156:159],a[124:127],v[60:63],v[156:159]
 v_cvt_pk_bf16_f32 v47,v14,v15
 s_add_u32 m0,s34,0x20000
 v_mfma_f32_16x16x32_bf16 v[160:163],a[128:131],v[60:63],v[160:163]
 v_exp_f32 v16,v16
 s_xor_b32 s33,s57,0x14000
 v_mfma_f32_16x16x32_bf16 v[164:167],a[132:135],v[60:63],v[164:167]
 ds_read_b128 a[80:83],v105 offset:32768
 s_waitcnt vmcnt(4)
 buffer_load_dwordx4 v133,s[20:23],s33 offen offset:0 nt lds
 v_mfma_f32_16x16x32_bf16 v[168:171],a[136:139],v[60:63],v[168:171]
 v_exp_f32 v17,v17
 v_mfma_f32_16x16x32_bf16 v[172:175],a[140:143],v[60:63],v[172:175]
 v_cvt_pk_bf16_f32 v48,v16,v17
 v_mfma_f32_16x16x32_bf16 a[192:195],a[212:215],v[60:63],a[192:195]
 ds_read_b128 a[96:99],v105 offset:36864
 v_mfma_f32_16x16x32_bf16 v[176:179],a[112:115],v[64:67],v[176:179]
 v_exp_f32 v18,v18
 v_mfma_f32_16x16x32_bf16 v[180:183],a[116:119],v[64:67],v[180:183]
 ds_read_b128 a[84:87],v106 offset:32768
 v_mfma_f32_16x16x32_bf16 v[184:187],a[120:123],v[64:67],v[184:187]
 v_exp_f32 v19,v19
 v_mfma_f32_16x16x32_bf16 v[188:191],a[124:127],v[64:67],v[188:191]
 v_cvt_pk_bf16_f32 v49,v18,v19
 v_mfma_f32_16x16x32_bf16 v[192:195],a[128:131],v[64:67],v[192:195]
 v_exp_f32 v20,v20
 v_mfma_f32_16x16x32_bf16 v[196:199],a[132:135],v[64:67],v[196:199]
 s_waitcnt vmcnt(4)
 buffer_load_dwordx4 v134,s[20:23],s33 offen offset:1024 nt lds
 v_mfma_f32_16x16x32_bf16 v[200:203],a[136:139],v[64:67],v[200:203]
 v_exp_f32 v21,v21
 v_mfma_f32_16x16x32_bf16 v[204:207],a[140:143],v[64:67],v[204:207]
 v_cvt_pk_bf16_f32 v50,v20,v21
 v_mfma_f32_16x16x32_bf16 a[196:199],a[212:215],v[64:67],a[196:199]
 ds_read_b128 a[100:103],v106 offset:36864
 v_mfma_f32_16x16x32_bf16 v[208:211],a[112:115],v[68:71],v[208:211]
 v_exp_f32 v22,v22
 v_mfma_f32_16x16x32_bf16 v[212:215],a[116:119],v[68:71],v[212:215]
 ds_read_b128 a[88:91],v107 offset:32768
 v_mfma_f32_16x16x32_bf16 v[216:219],a[120:123],v[68:71],v[216:219]
 v_exp_f32 v23,v23
 v_mfma_f32_16x16x32_bf16 v[220:223],a[124:127],v[68:71],v[220:223]
 v_cvt_pk_bf16_f32 v51,v22,v23
 v_mfma_f32_16x16x32_bf16 v[224:227],a[128:131],v[68:71],v[224:227]
 v_exp_f32 v24,v24
 v_mfma_f32_16x16x32_bf16 v[228:231],a[132:135],v[68:71],v[228:231]
 ds_read_b128 a[104:107],v107 offset:36864
 v_mfma_f32_16x16x32_bf16 v[232:235],a[136:139],v[68:71],v[232:235]
 v_exp_f32 v25,v25
 v_mfma_f32_16x16x32_bf16 v[236:239],a[140:143],v[68:71],v[236:239]
 v_cvt_pk_bf16_f32 v52,v24,v25
 s_waitcnt vmcnt(4)
 buffer_load_dwordx4 v133,s[20:23],s33 offen offset:2048 nt lds
 v_mfma_f32_16x16x32_bf16 a[200:203],a[212:215],v[68:71],a[200:203]
 v_mfma_f32_16x16x32_bf16 v[240:243],a[112:115],v[72:75],v[240:243]
 v_exp_f32 v26,v26
 v_mfma_f32_16x16x32_bf16 v[244:247],a[116:119],v[72:75],v[244:247]
 ds_read_b128 a[92:95],v108 offset:32768
 v_mfma_f32_16x16x32_bf16 v[248:251],a[120:123],v[72:75],v[248:251]
 v_exp_f32 v27,v27
 v_mfma_f32_16x16x32_bf16 v[252:255],a[124:127],v[72:75],v[252:255]
 v_cvt_pk_bf16_f32 v53,v26,v27
 v_mfma_f32_16x16x32_bf16 a[144:147],a[128:131],v[72:75],a[144:147]
 v_exp_f32 v28,v28
 v_mfma_f32_16x16x32_bf16 a[148:151],a[132:135],v[72:75],a[148:151]
 ds_read_b128 a[108:111],v108 offset:36864
 v_mfma_f32_16x16x32_bf16 a[152:155],a[136:139],v[72:75],a[152:155]
 v_exp_f32 v29,v29
 v_mfma_f32_16x16x32_bf16 a[156:159],a[140:143],v[72:75],a[156:159]
 v_cvt_pk_bf16_f32 v54,v28,v29
 s_waitcnt vmcnt(4)
 buffer_load_dwordx4 v134,s[20:23],s33 offen offset:3072 nt lds
 v_mfma_f32_16x16x32_bf16 a[204:207],a[212:215],v[72:75],a[204:207]
 v_mfma_f32_16x16x32_bf16 a[160:163],a[112:115],v[76:79],a[160:163]
 v_exp_f32 v30,v30
 v_mfma_f32_16x16x32_bf16 a[164:167],a[116:119],v[76:79],a[164:167]
 v_mfma_f32_16x16x32_bf16 a[168:171],a[120:123],v[76:79],a[168:171]
 v_exp_f32 v31,v31
 v_mfma_f32_16x16x32_bf16 a[172:175],a[124:127],v[76:79],a[172:175]
 v_cvt_pk_bf16_f32 v55,v30,v31
 v_mfma_f32_16x16x32_bf16 a[176:179],a[128:131],v[76:79],a[176:179]
 v_exp_f32 v32,v32
 v_mfma_f32_16x16x32_bf16 a[180:183],a[132:135],v[76:79],a[180:183]
 v_mfma_f32_16x16x32_bf16 a[184:187],a[136:139],v[76:79],a[184:187]
 v_exp_f32 v33,v33
 v_mfma_f32_16x16x32_bf16 a[188:191],a[140:143],v[76:79],a[188:191]
 v_cvt_pk_bf16_f32 v56,v32,v33
 v_mfma_f32_16x16x32_bf16 a[208:211],a[212:215],v[76:79],a[208:211]
 s_waitcnt lgkmcnt(0)
 v_mfma_f32_16x16x32_bf16 v[0:3],a[80:83],a[0:3],v[80:83]
 v_exp_f32 v34,v34
 v_mfma_f32_16x16x32_bf16 v[4:7],a[96:99],a[0:3],v[80:83]
 ds_read_b64_tr_b16 a[112:113],v113 offset:49152
 ds_read_b64_tr_b16 a[114:115],v113 offset:53248
 v_mfma_f32_16x16x32_bf16 v[0:3],a[84:87],a[4:7],v[0:3]
 v_exp_f32 v35,v35
 v_mfma_f32_16x16x32_bf16 v[4:7],a[100:103],a[4:7],v[4:7]
 v_cvt_pk_bf16_f32 v57,v34,v35
 v_mfma_f32_16x16x32_bf16 v[0:3],a[88:91],a[8:11],v[0:3]
 v_exp_f32 v36,v36
 v_mfma_f32_16x16x32_bf16 v[4:7],a[104:107],a[8:11],v[4:7]
 ds_read_b64_tr_b16 a[116:117],v114 offset:49152
 ds_read_b64_tr_b16 a[118:119],v114 offset:53248
 s_add_u32 m0,s34,0x4000
 v_mfma_f32_16x16x32_bf16 v[0:3],a[92:95],a[12:15],v[0:3]
 v_exp_f32 v37,v37
 s_xor_b32 s32,s57,0x16000
 v_mfma_f32_16x16x32_bf16 v[4:7],a[108:111],a[12:15],v[4:7]
 v_cvt_pk_bf16_f32 v58,v36,v37
 s_waitcnt vmcnt(4)
 buffer_load_dwordx4 v129,s[16:19],s32 offen offset:0 nt lds
 v_mfma_f32_16x16x32_bf16 v[8:11],a[80:83],a[16:19],v[84:87]
 v_exp_f32 v38,v38
 v_mfma_f32_16x16x32_bf16 v[12:15],a[96:99],a[16:19],v[84:87]
 ds_read_b64_tr_b16 a[120:121],v115 offset:49152
 ds_read_b64_tr_b16 a[122:123],v115 offset:53248
 v_mfma_f32_16x16x32_bf16 v[8:11],a[84:87],a[20:23],v[8:11]
 v_exp_f32 v39,v39
 v_mfma_f32_16x16x32_bf16 v[12:15],a[100:103],a[20:23],v[12:15]
 v_cvt_pk_bf16_f32 v59,v38,v39
 v_mfma_f32_16x16x32_bf16 v[8:11],a[88:91],a[24:27],v[8:11]
 v_exp_f32 v0,v0
 v_mfma_f32_16x16x32_bf16 v[12:15],a[104:107],a[24:27],v[12:15]
 ds_read_b64_tr_b16 a[124:125],v116 offset:49152
 ds_read_b64_tr_b16 a[126:127],v116 offset:53248
 v_mfma_f32_16x16x32_bf16 v[8:11],a[92:95],a[28:31],v[8:11]
 v_exp_f32 v1,v1
 v_mfma_f32_16x16x32_bf16 v[12:15],a[108:111],a[28:31],v[12:15]
 v_cvt_pk_bf16_f32 v60,v0,v1
 s_waitcnt vmcnt(4)
 buffer_load_dwordx4 v130,s[16:19],s32 offen offset:1024 nt lds
 v_mfma_f32_16x16x32_bf16 v[16:19],a[80:83],a[32:35],v[88:91]
 v_exp_f32 v2,v2
 v_mfma_f32_16x16x32_bf16 v[20:23],a[96:99],a[32:35],v[88:91]
 ds_read_b64_tr_b16 a[128:129],v117 offset:49152
 ds_read_b64_tr_b16 a[130:131],v117 offset:53248
 v_mfma_f32_16x16x32_bf16 v[16:19],a[84:87],a[36:39],v[16:19]
 v_exp_f32 v3,v3
 v_mfma_f32_16x16x32_bf16 v[20:23],a[100:103],a[36:39],v[20:23]
 v_cvt_pk_bf16_f32 v61,v2,v3
 v_mfma_f32_16x16x32_bf16 v[16:19],a[88:91],a[40:43],v[16:19]
 v_exp_f32 v4,v4
 v_mfma_f32_16x16x32_bf16 v[20:23],a[104:107],a[40:43],v[20:23]
 ds_read_b64_tr_b16 a[132:133],v118 offset:49152
 ds_read_b64_tr_b16 a[134:135],v118 offset:53248
 v_mfma_f32_16x16x32_bf16 v[16:19],a[92:95],a[44:47],v[16:19]
 v_exp_f32 v5,v5
 v_mfma_f32_16x16x32_bf16 v[20:23],a[108:111],a[44:47],v[20:23]
 v_cvt_pk_bf16_f32 v62,v4,v5
 s_waitcnt vmcnt(4)
 buffer_load_dwordx4 v131,s[16:19],s32 offen offset:2048 nt lds
 v_mfma_f32_16x16x32_bf16 v[24:27],a[80:83],a[48:51],v[92:95]
 v_exp_f32 v6,v6
 v_mfma_f32_16x16x32_bf16 v[28:31],a[96:99],a[48:51],v[92:95]
 ds_read_b64_tr_b16 a[136:137],v119 offset:49152
 ds_read_b64_tr_b16 a[138:139],v119 offset:53248
 v_mfma_f32_16x16x32_bf16 v[24:27],a[84:87],a[52:55],v[24:27]
 v_exp_f32 v7,v7
 v_mfma_f32_16x16x32_bf16 v[28:31],a[100:103],a[52:55],v[28:31]
 v_cvt_pk_bf16_f32 v63,v6,v7
 v_mfma_f32_16x16x32_bf16 v[24:27],a[88:91],a[56:59],v[24:27]
 v_exp_f32 v8,v8
 v_mfma_f32_16x16x32_bf16 v[28:31],a[104:107],a[56:59],v[28:31]
 ds_read_b64_tr_b16 a[140:141],v120 offset:49152
 ds_read_b64_tr_b16 a[142:143],v120 offset:53248
 v_mfma_f32_16x16x32_bf16 v[24:27],a[92:95],a[60:63],v[24:27]
 v_exp_f32 v9,v9
 v_mfma_f32_16x16x32_bf16 v[28:31],a[108:111],a[60:63],v[28:31]
 v_cvt_pk_bf16_f32 v64,v8,v9
 s_waitcnt vmcnt(4)
 buffer_load_dwordx4 v132,s[16:19],s32 offen offset:3072 nt lds
 v_mfma_f32_16x16x32_bf16 v[32:35],a[80:83],a[64:67],v[96:99]
 v_exp_f32 v10,v10
 v_mfma_f32_16x16x32_bf16 v[36:39],a[96:99],a[64:67],v[96:99]
 v_mfma_f32_16x16x32_bf16 v[32:35],a[84:87],a[68:71],v[32:35]
 v_exp_f32 v11,v11
 v_mfma_f32_16x16x32_bf16 v[36:39],a[100:103],a[68:71],v[36:39]
 v_cvt_pk_bf16_f32 v65,v10,v11
 v_mfma_f32_16x16x32_bf16 v[32:35],a[88:91],a[72:75],v[32:35]
 v_exp_f32 v12,v12
 v_mfma_f32_16x16x32_bf16 v[36:39],a[104:107],a[72:75],v[36:39]
 v_mfma_f32_16x16x32_bf16 v[32:35],a[92:95],a[76:79],v[32:35]
 v_exp_f32 v13,v13
 v_mfma_f32_16x16x32_bf16 v[36:39],a[108:111],a[76:79],v[36:39]
 v_cvt_pk_bf16_f32 v66,v12,v13
 s_waitcnt lgkmcnt(0)
 v_mfma_f32_16x16x32_bf16 v[144:147],a[112:115],v[40:43],v[144:147]
 s_barrier
 v_exp_f32 v14,v14
 v_mfma_f32_16x16x32_bf16 v[148:151],a[116:119],v[40:43],v[148:151]
 v_mfma_f32_16x16x32_bf16 v[152:155],a[120:123],v[40:43],v[152:155]
 v_exp_f32 v15,v15
 v_mfma_f32_16x16x32_bf16 v[156:159],a[124:127],v[40:43],v[156:159]
 v_cvt_pk_bf16_f32 v67,v14,v15
 s_add_u32 m0,s34,0x24000
 v_mfma_f32_16x16x32_bf16 v[160:163],a[128:131],v[40:43],v[160:163]
 v_exp_f32 v16,v16
 s_xor_b32 s33,s57,0x16000
 v_mfma_f32_16x16x32_bf16 v[164:167],a[132:135],v[40:43],v[164:167]
 ds_read_b128 a[80:83],v105 offset:49152
 s_waitcnt vmcnt(4)
 buffer_load_dwordx4 v133,s[20:23],s33 offen offset:0 nt lds
 v_mfma_f32_16x16x32_bf16 v[168:171],a[136:139],v[40:43],v[168:171]
 v_exp_f32 v17,v17
 v_mfma_f32_16x16x32_bf16 v[172:175],a[140:143],v[40:43],v[172:175]
 v_cvt_pk_bf16_f32 v68,v16,v17
 v_mfma_f32_16x16x32_bf16 a[192:195],a[212:215],v[40:43],a[192:195]
 ds_read_b128 a[96:99],v105 offset:53248
 v_mfma_f32_16x16x32_bf16 v[176:179],a[112:115],v[44:47],v[176:179]
 v_exp_f32 v18,v18
 v_mfma_f32_16x16x32_bf16 v[180:183],a[116:119],v[44:47],v[180:183]
 ds_read_b128 a[84:87],v106 offset:49152
 v_mfma_f32_16x16x32_bf16 v[184:187],a[120:123],v[44:47],v[184:187]
 v_exp_f32 v19,v19
 v_mfma_f32_16x16x32_bf16 v[188:191],a[124:127],v[44:47],v[188:191]
 v_cvt_pk_bf16_f32 v69,v18,v19
 v_mfma_f32_16x16x32_bf16 v[192:195],a[128:131],v[44:47],v[192:195]
 v_exp_f32 v20,v20
 v_mfma_f32_16x16x32_bf16 v[196:199],a[132:135],v[44:47],v[196:199]
 v_mfma_f32_16x16x32_bf16 v[200:203],a[136:139],v[44:47],v[200:203]
 v_exp_f32 v21,v21
 v_mfma_f32_16x16x32_bf16 v[204:207],a[140:143],v[44:47],v[204:207]
 v_cvt_pk_bf16_f32 v70,v20,v21
 v_mfma_f32_16x16x32_bf16 a[196:199],a[212:215],v[44:47],a[196:199]
 ds_read_b128 a[100:103],v106 offset:53248
 s_waitcnt vmcnt(4)
 buffer_load_dwordx4 v134,s[20:23],s33 offen offset:1024 nt lds
 v_mfma_f32_16x16x32_bf16 v[208:211],a[112:115],v[48:51],v[208:211]
 v_exp_f32 v22,v22
 v_mfma_f32_16x16x32_bf16 v[212:215],a[116:119],v[48:51],v[212:215]
 ds_read_b128 a[88:91],v107 offset:49152
 v_mfma_f32_16x16x32_bf16 v[216:219],a[120:123],v[48:51],v[216:219]
 v_exp_f32 v23,v23
 v_mfma_f32_16x16x32_bf16 v[220:223],a[124:127],v[48:51],v[220:223]
 v_cvt_pk_bf16_f32 v71,v22,v23
 v_mfma_f32_16x16x32_bf16 v[224:227],a[128:131],v[48:51],v[224:227]
 v_exp_f32 v24,v24
 v_mfma_f32_16x16x32_bf16 v[228:231],a[132:135],v[48:51],v[228:231]
 ds_read_b128 a[104:107],v107 offset:53248
 v_mfma_f32_16x16x32_bf16 v[232:235],a[136:139],v[48:51],v[232:235]
 v_exp_f32 v25,v25
 v_mfma_f32_16x16x32_bf16 v[236:239],a[140:143],v[48:51],v[236:239]
 v_cvt_pk_bf16_f32 v72,v24,v25
 v_mfma_f32_16x16x32_bf16 a[200:203],a[212:215],v[48:51],a[200:203]
 v_mfma_f32_16x16x32_bf16 v[240:243],a[112:115],v[52:55],v[240:243]
 v_exp_f32 v26,v26
 v_mfma_f32_16x16x32_bf16 v[244:247],a[116:119],v[52:55],v[244:247]
 ds_read_b128 a[92:95],v108 offset:49152
 v_mfma_f32_16x16x32_bf16 v[248:251],a[120:123],v[52:55],v[248:251]
 v_exp_f32 v27,v27
 v_mfma_f32_16x16x32_bf16 v[252:255],a[124:127],v[52:55],v[252:255]
 v_cvt_pk_bf16_f32 v73,v26,v27
 v_mfma_f32_16x16x32_bf16 a[144:147],a[128:131],v[52:55],a[144:147]
 v_exp_f32 v28,v28
 v_mfma_f32_16x16x32_bf16 a[148:151],a[132:135],v[52:55],a[148:151]
 ds_read_b128 a[108:111],v108 offset:53248
 s_waitcnt vmcnt(4)
 buffer_load_dwordx4 v133,s[20:23],s33 offen offset:2048 nt lds
 v_mfma_f32_16x16x32_bf16 a[152:155],a[136:139],v[52:55],a[152:155]
 v_exp_f32 v29,v29
 v_mfma_f32_16x16x32_bf16 a[156:159],a[140:143],v[52:55],a[156:159]
 v_cvt_pk_bf16_f32 v74,v28,v29
 v_mfma_f32_16x16x32_bf16 a[204:207],a[212:215],v[52:55],a[204:207]
 v_mfma_f32_16x16x32_bf16 a[160:163],a[112:115],v[56:59],a[160:163]
 v_exp_f32 v30,v30
 v_mfma_f32_16x16x32_bf16 a[164:167],a[116:119],v[56:59],a[164:167]
 v_mfma_f32_16x16x32_bf16 a[168:171],a[120:123],v[56:59],a[168:171]
 v_exp_f32 v31,v31
 v_mfma_f32_16x16x32_bf16 a[172:175],a[124:127],v[56:59],a[172:175]
 v_cvt_pk_bf16_f32 v75,v30,v31
 v_mfma_f32_16x16x32_bf16 a[176:179],a[128:131],v[56:59],a[176:179]
 v_exp_f32 v32,v32
 v_mfma_f32_16x16x32_bf16 a[180:183],a[132:135],v[56:59],a[180:183]
 v_mfma_f32_16x16x32_bf16 a[184:187],a[136:139],v[56:59],a[184:187]
 v_exp_f32 v33,v33
 v_mfma_f32_16x16x32_bf16 a[188:191],a[140:143],v[56:59],a[188:191]
 v_cvt_pk_bf16_f32 v76,v32,v33
 v_mfma_f32_16x16x32_bf16 a[208:211],a[212:215],v[56:59],a[208:211]
 s_waitcnt lgkmcnt(0)
 v_mfma_f32_16x16x32_bf16 v[0:3],a[80:83],a[0:3],v[80:83]
 v_exp_f32 v34,v34
 v_mfma_f32_16x16x32_bf16 v[4:7],a[96:99],a[0:3],v[80:83]
 ds_read_b64_tr_b16 a[112:113],v121 offset:0
 ds_read_b64_tr_b16 a[114:115],v121 offset:4096
 v_mfma_f32_16x16x32_bf16 v[0:3],a[84:87],a[4:7],v[0:3]
 v_exp_f32 v35,v35
 v_mfma_f32_16x16x32_bf16 v[4:7],a[100:103],a[4:7],v[4:7]
 v_cvt_pk_bf16_f32 v77,v34,v35
 v_mfma_f32_16x16x32_bf16 v[0:3],a[88:91],a[8:11],v[0:3]
 v_exp_f32 v36,v36
 v_mfma_f32_16x16x32_bf16 v[4:7],a[104:107],a[8:11],v[4:7]
 ds_read_b64_tr_b16 a[116:117],v122 offset:0
 ds_read_b64_tr_b16 a[118:119],v122 offset:4096
 v_mfma_f32_16x16x32_bf16 v[0:3],a[92:95],a[12:15],v[0:3]
 v_exp_f32 v37,v37
 v_mfma_f32_16x16x32_bf16 v[4:7],a[108:111],a[12:15],v[4:7]
 v_cvt_pk_bf16_f32 v78,v36,v37
 s_waitcnt vmcnt(4)
 buffer_load_dwordx4 v134,s[20:23],s33 offen offset:3072 nt lds
 v_mfma_f32_16x16x32_bf16 v[8:11],a[80:83],a[16:19],v[84:87]
 v_exp_f32 v38,v38
 v_mfma_f32_16x16x32_bf16 v[12:15],a[96:99],a[16:19],v[84:87]
 ds_read_b64_tr_b16 a[120:121],v123 offset:0
 ds_read_b64_tr_b16 a[122:123],v123 offset:4096
 v_mfma_f32_16x16x32_bf16 v[8:11],a[84:87],a[20:23],v[8:11]
 v_exp_f32 v39,v39
 v_mfma_f32_16x16x32_bf16 v[12:15],a[100:103],a[20:23],v[12:15]
 v_cvt_pk_bf16_f32 v79,v38,v39
 v_mfma_f32_16x16x32_bf16 v[8:11],a[88:91],a[24:27],v[8:11]
 v_exp_f32 v0,v0
 v_mfma_f32_16x16x32_bf16 v[12:15],a[104:107],a[24:27],v[12:15]
 ds_read_b64_tr_b16 a[124:125],v124 offset:0
 ds_read_b64_tr_b16 a[126:127],v124 offset:4096
 s_add_u32 m0,s34,0x8000
 v_mfma_f32_16x16x32_bf16 v[8:11],a[92:95],a[28:31],v[8:11]
 v_exp_f32 v1,v1
 s_xor_b32 s32,s57,0x18000
 v_mfma_f32_16x16x32_bf16 v[12:15],a[108:111],a[28:31],v[12:15]
 v_cvt_pk_bf16_f32 v40,v0,v1
 s_waitcnt vmcnt(3)
 buffer_load_dwordx4 v129,s[16:19],s32 offen offset:0 nt lds
 v_mfma_f32_16x16x32_bf16 v[16:19],a[80:83],a[32:35],v[88:91]
 v_exp_f32 v2,v2
 v_mfma_f32_16x16x32_bf16 v[20:23],a[96:99],a[32:35],v[88:91]
 ds_read_b64_tr_b16 a[128:129],v125 offset:0
 ds_read_b64_tr_b16 a[130:131],v125 offset:4096
 v_mfma_f32_16x16x32_bf16 v[16:19],a[84:87],a[36:39],v[16:19]
 v_exp_f32 v3,v3
 v_mfma_f32_16x16x32_bf16 v[20:23],a[100:103],a[36:39],v[20:23]
 v_cvt_pk_bf16_f32 v41,v2,v3
 v_mfma_f32_16x16x32_bf16 v[16:19],a[88:91],a[40:43],v[16:19]
 v_exp_f32 v4,v4
 v_mfma_f32_16x16x32_bf16 v[20:23],a[104:107],a[40:43],v[20:23]
 ds_read_b64_tr_b16 a[132:133],v126 offset:0
 ds_read_b64_tr_b16 a[134:135],v126 offset:4096
 v_mfma_f32_16x16x32_bf16 v[16:19],a[92:95],a[44:47],v[16:19]
 v_exp_f32 v5,v5
 v_mfma_f32_16x16x32_bf16 v[20:23],a[108:111],a[44:47],v[20:23]
 v_cvt_pk_bf16_f32 v42,v4,v5
 s_waitcnt vmcnt(4)
 buffer_load_dwordx4 v130,s[16:19],s32 offen offset:1024 nt lds
 v_mfma_f32_16x16x32_bf16 v[24:27],a[80:83],a[48:51],v[92:95]
 v_exp_f32 v6,v6
 v_mfma_f32_16x16x32_bf16 v[28:31],a[96:99],a[48:51],v[92:95]
 ds_read_b64_tr_b16 a[136:137],v127 offset:0
 ds_read_b64_tr_b16 a[138:139],v127 offset:4096
 v_mfma_f32_16x16x32_bf16 v[24:27],a[84:87],a[52:55],v[24:27]
 v_exp_f32 v7,v7
 v_mfma_f32_16x16x32_bf16 v[28:31],a[100:103],a[52:55],v[28:31]
 v_cvt_pk_bf16_f32 v43,v6,v7
 v_mfma_f32_16x16x32_bf16 v[24:27],a[88:91],a[56:59],v[24:27]
 v_exp_f32 v8,v8
 v_mfma_f32_16x16x32_bf16 v[28:31],a[104:107],a[56:59],v[28:31]
 ds_read_b64_tr_b16 a[140:141],v128 offset:0
 ds_read_b64_tr_b16 a[142:143],v128 offset:4096
 v_mfma_f32_16x16x32_bf16 v[24:27],a[92:95],a[60:63],v[24:27]
 v_exp_f32 v9,v9
 v_mfma_f32_16x16x32_bf16 v[28:31],a[108:111],a[60:63],v[28:31]
 v_cvt_pk_bf16_f32 v44,v8,v9
 s_waitcnt vmcnt(4)
 buffer_load_dwordx4 v131,s[16:19],s32 offen offset:2048 nt lds
 v_mfma_f32_16x16x32_bf16 v[32:35],a[80:83],a[64:67],v[96:99]
 v_exp_f32 v10,v10
 v_mfma_f32_16x16x32_bf16 v[36:39],a[96:99],a[64:67],v[96:99]
 v_mfma_f32_16x16x32_bf16 v[32:35],a[84:87],a[68:71],v[32:35]
 v_exp_f32 v11,v11
 v_mfma_f32_16x16x32_bf16 v[36:39],a[100:103],a[68:71],v[36:39]
 v_cvt_pk_bf16_f32 v45,v10,v11
 v_mfma_f32_16x16x32_bf16 v[32:35],a[88:91],a[72:75],v[32:35]
 v_exp_f32 v12,v12
 v_mfma_f32_16x16x32_bf16 v[36:39],a[104:107],a[72:75],v[36:39]
 v_mfma_f32_16x16x32_bf16 v[32:35],a[92:95],a[76:79],v[32:35]
 v_exp_f32 v13,v13
 v_mfma_f32_16x16x32_bf16 v[36:39],a[108:111],a[76:79],v[36:39]
 v_cvt_pk_bf16_f32 v46,v12,v13
 s_waitcnt lgkmcnt(0)
 v_mfma_f32_16x16x32_bf16 v[144:147],a[112:115],v[60:63],v[144:147]
 s_barrier
 v_exp_f32 v14,v14
 v_mfma_f32_16x16x32_bf16 v[148:151],a[116:119],v[60:63],v[148:151]
 v_mfma_f32_16x16x32_bf16 v[152:155],a[120:123],v[60:63],v[152:155]
 v_exp_f32 v15,v15
 v_mfma_f32_16x16x32_bf16 v[156:159],a[124:127],v[60:63],v[156:159]
 v_cvt_pk_bf16_f32 v47,v14,v15
 v_mfma_f32_16x16x32_bf16 v[160:163],a[128:131],v[60:63],v[160:163]
 v_exp_f32 v16,v16
 v_mfma_f32_16x16x32_bf16 v[164:167],a[132:135],v[60:63],v[164:167]
 ds_read_b128 a[80:83],v109 offset:0
 s_waitcnt vmcnt(4)
 buffer_load_dwordx4 v132,s[16:19],s32 offen offset:3072 nt lds
 v_mfma_f32_16x16x32_bf16 v[168:171],a[136:139],v[60:63],v[168:171]
 v_exp_f32 v17,v17
 v_mfma_f32_16x16x32_bf16 v[172:175],a[140:143],v[60:63],v[172:175]
 v_cvt_pk_bf16_f32 v48,v16,v17
 v_mfma_f32_16x16x32_bf16 a[192:195],a[212:215],v[60:63],a[192:195]
 ds_read_b128 a[96:99],v109 offset:4096
 v_mfma_f32_16x16x32_bf16 v[176:179],a[112:115],v[64:67],v[176:179]
 v_exp_f32 v18,v18
 v_mfma_f32_16x16x32_bf16 v[180:183],a[116:119],v[64:67],v[180:183]
 ds_read_b128 a[84:87],v110 offset:0
 v_mfma_f32_16x16x32_bf16 v[184:187],a[120:123],v[64:67],v[184:187]
 v_exp_f32 v19,v19
 v_mfma_f32_16x16x32_bf16 v[188:191],a[124:127],v[64:67],v[188:191]
 v_cvt_pk_bf16_f32 v49,v18,v19
 s_add_u32 m0,s34,0x14000
 v_mfma_f32_16x16x32_bf16 v[192:195],a[128:131],v[64:67],v[192:195]
 v_exp_f32 v20,v20
 s_xor_b32 s33,s57,0x18000
 v_mfma_f32_16x16x32_bf16 v[196:199],a[132:135],v[64:67],v[196:199]
 s_waitcnt vmcnt(3)
 buffer_load_dwordx4 v133,s[20:23],s33 offen offset:0 nt lds
 v_mfma_f32_16x16x32_bf16 v[200:203],a[136:139],v[64:67],v[200:203]
 v_exp_f32 v21,v21
 v_mfma_f32_16x16x32_bf16 v[204:207],a[140:143],v[64:67],v[204:207]
 v_cvt_pk_bf16_f32 v50,v20,v21
 v_mfma_f32_16x16x32_bf16 a[196:199],a[212:215],v[64:67],a[196:199]
 ds_read_b128 a[100:103],v110 offset:4096
 v_mfma_f32_16x16x32_bf16 v[208:211],a[112:115],v[68:71],v[208:211]
 v_exp_f32 v22,v22
 v_mfma_f32_16x16x32_bf16 v[212:215],a[116:119],v[68:71],v[212:215]
 ds_read_b128 a[88:91],v111 offset:0
 v_mfma_f32_16x16x32_bf16 v[216:219],a[120:123],v[68:71],v[216:219]
 v_exp_f32 v23,v23
 v_mfma_f32_16x16x32_bf16 v[220:223],a[124:127],v[68:71],v[220:223]
 v_cvt_pk_bf16_f32 v51,v22,v23
 v_mfma_f32_16x16x32_bf16 v[224:227],a[128:131],v[68:71],v[224:227]
 v_exp_f32 v24,v24
 v_mfma_f32_16x16x32_bf16 v[228:231],a[132:135],v[68:71],v[228:231]
 ds_read_b128 a[104:107],v111 offset:4096
 v_mfma_f32_16x16x32_bf16 v[232:235],a[136:139],v[68:71],v[232:235]
 v_exp_f32 v25,v25
 v_mfma_f32_16x16x32_bf16 v[236:239],a[140:143],v[68:71],v[236:239]
 v_cvt_pk_bf16_f32 v52,v24,v25
 s_waitcnt vmcnt(4)
 buffer_load_dwordx4 v134,s[20:23],s33 offen offset:1024 nt lds
 v_mfma_f32_16x16x32_bf16 a[200:203],a[212:215],v[68:71],a[200:203]
 v_mfma_f32_16x16x32_bf16 v[240:243],a[112:115],v[72:75],v[240:243]
 v_exp_f32 v26,v26
 v_mfma_f32_16x16x32_bf16 v[244:247],a[116:119],v[72:75],v[244:247]
 ds_read_b128 a[92:95],v112 offset:0
 v_mfma_f32_16x16x32_bf16 v[248:251],a[120:123],v[72:75],v[248:251]
 v_exp_f32 v27,v27
 v_mfma_f32_16x16x32_bf16 v[252:255],a[124:127],v[72:75],v[252:255]
 v_cvt_pk_bf16_f32 v53,v26,v27
 v_mfma_f32_16x16x32_bf16 a[144:147],a[128:131],v[72:75],a[144:147]
 v_exp_f32 v28,v28
 v_mfma_f32_16x16x32_bf16 a[148:151],a[132:135],v[72:75],a[148:151]
 ds_read_b128 a[108:111],v112 offset:4096
 v_mfma_f32_16x16x32_bf16 a[152:155],a[136:139],v[72:75],a[152:155]
 v_exp_f32 v29,v29
 v_mfma_f32_16x16x32_bf16 a[156:159],a[140:143],v[72:75],a[156:159]
 v_cvt_pk_bf16_f32 v54,v28,v29
 s_waitcnt vmcnt(4)
 buffer_load_dwordx4 v133,s[20:23],s33 offen offset:2048 nt lds
 v_mfma_f32_16x16x32_bf16 a[204:207],a[212:215],v[72:75],a[204:207]
 v_mfma_f32_16x16x32_bf16 a[160:163],a[112:115],v[76:79],a[160:163]
 v_exp_f32 v30,v30
 v_mfma_f32_16x16x32_bf16 a[164:167],a[116:119],v[76:79],a[164:167]
 v_mfma_f32_16x16x32_bf16 a[168:171],a[120:123],v[76:79],a[168:171]
 v_exp_f32 v31,v31
 v_mfma_f32_16x16x32_bf16 a[172:175],a[124:127],v[76:79],a[172:175]
 v_cvt_pk_bf16_f32 v55,v30,v31
 v_mfma_f32_16x16x32_bf16 a[176:179],a[128:131],v[76:79],a[176:179]
 v_exp_f32 v32,v32
 v_mfma_f32_16x16x32_bf16 a[180:183],a[132:135],v[76:79],a[180:183]
 v_mfma_f32_16x16x32_bf16 a[184:187],a[136:139],v[76:79],a[184:187]
 v_exp_f32 v33,v33
 v_mfma_f32_16x16x32_bf16 a[188:191],a[140:143],v[76:79],a[188:191]
 v_cvt_pk_bf16_f32 v56,v32,v33
 v_mfma_f32_16x16x32_bf16 a[208:211],a[212:215],v[76:79],a[208:211]
 s_waitcnt lgkmcnt(0)
 v_mfma_f32_16x16x32_bf16 v[0:3],a[80:83],a[0:3],v[80:83]
 v_exp_f32 v34,v34
 v_mfma_f32_16x16x32_bf16 v[4:7],a[96:99],a[0:3],v[80:83]
 ds_read_b64_tr_b16 a[112:113],v113 offset:0
 ds_read_b64_tr_b16 a[114:115],v113 offset:4096
 v_mfma_f32_16x16x32_bf16 v[0:3],a[84:87],a[4:7],v[0:3]
 v_exp_f32 v35,v35
 v_mfma_f32_16x16x32_bf16 v[4:7],a[100:103],a[4:7],v[4:7]
 v_cvt_pk_bf16_f32 v57,v34,v35
 v_mfma_f32_16x16x32_bf16 v[0:3],a[88:91],a[8:11],v[0:3]
 v_exp_f32 v36,v36
 v_mfma_f32_16x16x32_bf16 v[4:7],a[104:107],a[8:11],v[4:7]
 ds_read_b64_tr_b16 a[116:117],v114 offset:0
 ds_read_b64_tr_b16 a[118:119],v114 offset:4096
 v_mfma_f32_16x16x32_bf16 v[0:3],a[92:95],a[12:15],v[0:3]
 v_exp_f32 v37,v37
 v_mfma_f32_16x16x32_bf16 v[4:7],a[108:111],a[12:15],v[4:7]
 v_cvt_pk_bf16_f32 v58,v36,v37
 s_waitcnt vmcnt(4)
 buffer_load_dwordx4 v134,s[20:23],s33 offen offset:3072 nt lds
 v_mfma_f32_16x16x32_bf16 v[8:11],a[80:83],a[16:19],v[84:87]
 v_exp_f32 v38,v38
 v_mfma_f32_16x16x32_bf16 v[12:15],a[96:99],a[16:19],v[84:87]
 ds_read_b64_tr_b16 a[120:121],v115 offset:0
 ds_read_b64_tr_b16 a[122:123],v115 offset:4096
 v_mfma_f32_16x16x32_bf16 v[8:11],a[84:87],a[20:23],v[8:11]
 v_exp_f32 v39,v39
 v_mfma_f32_16x16x32_bf16 v[12:15],a[100:103],a[20:23],v[12:15]
 v_cvt_pk_bf16_f32 v59,v38,v39
 v_mfma_f32_16x16x32_bf16 v[8:11],a[88:91],a[24:27],v[8:11]
 v_exp_f32 v0,v0
 v_mfma_f32_16x16x32_bf16 v[12:15],a[104:107],a[24:27],v[12:15]
 ds_read_b64_tr_b16 a[124:125],v116 offset:0
 ds_read_b64_tr_b16 a[126:127],v116 offset:4096
 v_mfma_f32_16x16x32_bf16 v[8:11],a[92:95],a[28:31],v[8:11]
 v_exp_f32 v1,v1
 v_mfma_f32_16x16x32_bf16 v[12:15],a[108:111],a[28:31],v[12:15]
 v_cvt_pk_bf16_f32 v60,v0,v1
 v_mfma_f32_16x16x32_bf16 v[16:19],a[80:83],a[32:35],v[88:91]
 v_exp_f32 v2,v2
 v_mfma_f32_16x16x32_bf16 v[20:23],a[96:99],a[32:35],v[88:91]
 ds_read_b64_tr_b16 a[128:129],v117 offset:0
 ds_read_b64_tr_b16 a[130:131],v117 offset:4096
 s_add_u32 m0,s34,0xc000
 v_mfma_f32_16x16x32_bf16 v[16:19],a[84:87],a[36:39],v[16:19]
 v_exp_f32 v3,v3
 s_xor_b32 s32,s57,0x1a000
 v_mfma_f32_16x16x32_bf16 v[20:23],a[100:103],a[36:39],v[20:23]
 v_cvt_pk_bf16_f32 v61,v2,v3
 s_waitcnt vmcnt(4)
 buffer_load_dwordx4 v129,s[16:19],s32 offen offset:0 nt lds
 v_mfma_f32_16x16x32_bf16 v[16:19],a[88:91],a[40:43],v[16:19]
 v_exp_f32 v4,v4
 v_mfma_f32_16x16x32_bf16 v[20:23],a[104:107],a[40:43],v[20:23]
 ds_read_b64_tr_b16 a[132:133],v118 offset:0
 ds_read_b64_tr_b16 a[134:135],v118 offset:4096
 v_mfma_f32_16x16x32_bf16 v[16:19],a[92:95],a[44:47],v[16:19]
 v_exp_f32 v5,v5
 v_mfma_f32_16x16x32_bf16 v[20:23],a[108:111],a[44:47],v[20:23]
 v_cvt_pk_bf16_f32 v62,v4,v5
 v_mfma_f32_16x16x32_bf16 v[24:27],a[80:83],a[48:51],v[92:95]
 v_exp_f32 v6,v6
 v_mfma_f32_16x16x32_bf16 v[28:31],a[96:99],a[48:51],v[92:95]
 ds_read_b64_tr_b16 a[136:137],v119 offset:0
 ds_read_b64_tr_b16 a[138:139],v119 offset:4096
 v_mfma_f32_16x16x32_bf16 v[24:27],a[84:87],a[52:55],v[24:27]
 v_exp_f32 v7,v7
 v_mfma_f32_16x16x32_bf16 v[28:31],a[100:103],a[52:55],v[28:31]
 v_cvt_pk_bf16_f32 v63,v6,v7
 v_mfma_f32_16x16x32_bf16 v[24:27],a[88:91],a[56:59],v[24:27]
 v_exp_f32 v8,v8
 v_mfma_f32_16x16x32_bf16 v[28:31],a[104:107],a[56:59],v[28:31]
 ds_read_b64_tr_b16 a[140:141],v120 offset:0
 ds_read_b64_tr_b16 a[142:143],v120 offset:4096
 v_mfma_f32_16x16x32_bf16 v[24:27],a[92:95],a[60:63],v[24:27]
 v_exp_f32 v9,v9
 v_mfma_f32_16x16x32_bf16 v[28:31],a[108:111],a[60:63],v[28:31]
 v_cvt_pk_bf16_f32 v64,v8,v9
 s_waitcnt vmcnt(4)
 buffer_load_dwordx4 v130,s[16:19],s32 offen offset:1024 nt lds
 v_mfma_f32_16x16x32_bf16 v[32:35],a[80:83],a[64:67],v[96:99]
 v_exp_f32 v10,v10
 v_mfma_f32_16x16x32_bf16 v[36:39],a[96:99],a[64:67],v[96:99]
 v_mfma_f32_16x16x32_bf16 v[32:35],a[84:87],a[68:71],v[32:35]
 v_exp_f32 v11,v11
 v_mfma_f32_16x16x32_bf16 v[36:39],a[100:103],a[68:71],v[36:39]
 v_cvt_pk_bf16_f32 v65,v10,v11
 v_mfma_f32_16x16x32_bf16 v[32:35],a[88:91],a[72:75],v[32:35]
 v_exp_f32 v12,v12
 v_mfma_f32_16x16x32_bf16 v[36:39],a[104:107],a[72:75],v[36:39]
 v_mfma_f32_16x16x32_bf16 v[32:35],a[92:95],a[76:79],v[32:35]
 v_exp_f32 v13,v13
 v_mfma_f32_16x16x32_bf16 v[36:39],a[108:111],a[76:79],v[36:39]
 v_cvt_pk_bf16_f32 v66,v12,v13
 s_waitcnt lgkmcnt(0)
 v_mfma_f32_16x16x32_bf16 v[144:147],a[112:115],v[40:43],v[144:147]
 s_barrier
 v_exp_f32 v14,v14
 v_mfma_f32_16x16x32_bf16 v[148:151],a[116:119],v[40:43],v[148:151]
 v_mfma_f32_16x16x32_bf16 v[152:155],a[120:123],v[40:43],v[152:155]
 v_exp_f32 v15,v15
 v_mfma_f32_16x16x32_bf16 v[156:159],a[124:127],v[40:43],v[156:159]
 v_cvt_pk_bf16_f32 v67,v14,v15
 v_mfma_f32_16x16x32_bf16 v[160:163],a[128:131],v[40:43],v[160:163]
 v_exp_f32 v16,v16
 v_mfma_f32_16x16x32_bf16 v[164:167],a[132:135],v[40:43],v[164:167]
 ds_read_b128 a[80:83],v105 offset:0
 s_waitcnt vmcnt(4)
 buffer_load_dwordx4 v131,s[16:19],s32 offen offset:2048 nt lds
 v_mfma_f32_16x16x32_bf16 v[168:171],a[136:139],v[40:43],v[168:171]
 v_exp_f32 v17,v17
 v_mfma_f32_16x16x32_bf16 v[172:175],a[140:143],v[40:43],v[172:175]
 v_cvt_pk_bf16_f32 v68,v16,v17
 v_mfma_f32_16x16x32_bf16 a[192:195],a[212:215],v[40:43],a[192:195]
 ds_read_b128 a[96:99],v105 offset:4096
 v_mfma_f32_16x16x32_bf16 v[176:179],a[112:115],v[44:47],v[176:179]
 v_exp_f32 v18,v18
 v_mfma_f32_16x16x32_bf16 v[180:183],a[116:119],v[44:47],v[180:183]
 ds_read_b128 a[84:87],v106 offset:0
 v_mfma_f32_16x16x32_bf16 v[184:187],a[120:123],v[44:47],v[184:187]
 v_exp_f32 v19,v19
 v_mfma_f32_16x16x32_bf16 v[188:191],a[124:127],v[44:47],v[188:191]
 v_cvt_pk_bf16_f32 v69,v18,v19
 v_mfma_f32_16x16x32_bf16 v[192:195],a[128:131],v[44:47],v[192:195]
 v_exp_f32 v20,v20
 v_mfma_f32_16x16x32_bf16 v[196:199],a[132:135],v[44:47],v[196:199]
 s_waitcnt vmcnt(4)
 buffer_load_dwordx4 v132,s[16:19],s32 offen offset:3072 nt lds
 v_mfma_f32_16x16x32_bf16 v[200:203],a[136:139],v[44:47],v[200:203]
 v_exp_f32 v21,v21
 v_mfma_f32_16x16x32_bf16 v[204:207],a[140:143],v[44:47],v[204:207]
 v_cvt_pk_bf16_f32 v70,v20,v21
 v_mfma_f32_16x16x32_bf16 a[196:199],a[212:215],v[44:47],a[196:199]
 ds_read_b128 a[100:103],v106 offset:4096
 v_mfma_f32_16x16x32_bf16 v[208:211],a[112:115],v[48:51],v[208:211]
 v_exp_f32 v22,v22
 v_mfma_f32_16x16x32_bf16 v[212:215],a[116:119],v[48:51],v[212:215]
 ds_read_b128 a[88:91],v107 offset:0
 v_mfma_f32_16x16x32_bf16 v[216:219],a[120:123],v[48:51],v[216:219]
 v_exp_f32 v23,v23
 v_mfma_f32_16x16x32_bf16 v[220:223],a[124:127],v[48:51],v[220:223]
 v_cvt_pk_bf16_f32 v71,v22,v23
 v_mfma_f32_16x16x32_bf16 v[224:227],a[128:131],v[48:51],v[224:227]
 v_exp_f32 v24,v24
 v_mfma_f32_16x16x32_bf16 v[228:231],a[132:135],v[48:51],v[228:231]
 ds_read_b128 a[104:107],v107 offset:4096
 s_add_u32 m0,s34,0x18000
 v_mfma_f32_16x16x32_bf16 v[232:235],a[136:139],v[48:51],v[232:235]
 v_exp_f32 v25,v25
 s_xor_b32 s33,s57,0x1a000
 v_mfma_f32_16x16x32_bf16 v[236:239],a[140:143],v[48:51],v[236:239]
 v_cvt_pk_bf16_f32 v72,v24,v25
 s_waitcnt vmcnt(4)
 buffer_load_dwordx4 v133,s[20:23],s33 offen offset:0 nt lds
 v_mfma_f32_16x16x32_bf16 a[200:203],a[212:215],v[48:51],a[200:203]
 v_mfma_f32_16x16x32_bf16 v[240:243],a[112:115],v[52:55],v[240:243]
 v_exp_f32 v26,v26
 v_mfma_f32_16x16x32_bf16 v[244:247],a[116:119],v[52:55],v[244:247]
 ds_read_b128 a[92:95],v108 offset:0
 v_mfma_f32_16x16x32_bf16 v[248:251],a[120:123],v[52:55],v[248:251]
 v_exp_f32 v27,v27
 v_mfma_f32_16x16x32_bf16 v[252:255],a[124:127],v[52:55],v[252:255]
 v_cvt_pk_bf16_f32 v73,v26,v27
 v_mfma_f32_16x16x32_bf16 a[144:147],a[128:131],v[52:55],a[144:147]
 v_exp_f32 v28,v28
 v_mfma_f32_16x16x32_bf16 a[148:151],a[132:135],v[52:55],a[148:151]
 ds_read_b128 a[108:111],v108 offset:4096
 v_mfma_f32_16x16x32_bf16 a[152:155],a[136:139],v[52:55],a[152:155]
 v_exp_f32 v29,v29
 v_mfma_f32_16x16x32_bf16 a[156:159],a[140:143],v[52:55],a[156:159]
 v_cvt_pk_bf16_f32 v74,v28,v29
 s_waitcnt vmcnt(4)
 buffer_load_dwordx4 v134,s[20:23],s33 offen offset:1024 nt lds
 v_mfma_f32_16x16x32_bf16 a[204:207],a[212:215],v[52:55],a[204:207]
 v_mfma_f32_16x16x32_bf16 a[160:163],a[112:115],v[56:59],a[160:163]
 v_exp_f32 v30,v30
 v_mfma_f32_16x16x32_bf16 a[164:167],a[116:119],v[56:59],a[164:167]
 v_mfma_f32_16x16x32_bf16 a[168:171],a[120:123],v[56:59],a[168:171]
 v_exp_f32 v31,v31
 v_mfma_f32_16x16x32_bf16 a[172:175],a[124:127],v[56:59],a[172:175]
 v_cvt_pk_bf16_f32 v75,v30,v31
 v_mfma_f32_16x16x32_bf16 a[176:179],a[128:131],v[56:59],a[176:179]
 v_exp_f32 v32,v32
 v_mfma_f32_16x16x32_bf16 a[180:183],a[132:135],v[56:59],a[180:183]
 v_mfma_f32_16x16x32_bf16 a[184:187],a[136:139],v[56:59],a[184:187]
 v_exp_f32 v33,v33
 v_mfma_f32_16x16x32_bf16 a[188:191],a[140:143],v[56:59],a[188:191]
 v_cvt_pk_bf16_f32 v76,v32,v33
 v_mfma_f32_16x16x32_bf16 a[208:211],a[212:215],v[56:59],a[208:211]
 s_waitcnt lgkmcnt(0)
 v_mfma_f32_16x16x32_bf16 v[0:3],a[80:83],a[0:3],v[80:83]
 v_exp_f32 v34,v34
 v_mfma_f32_16x16x32_bf16 v[4:7],a[96:99],a[0:3],v[80:83]
 ds_read_b64_tr_b16 a[112:113],v113 offset:16384
 ds_read_b64_tr_b16 a[114:115],v113 offset:20480
 v_mfma_f32_16x16x32_bf16 v[0:3],a[84:87],a[4:7],v[0:3]
 v_exp_f32 v35,v35
 v_mfma_f32_16x16x32_bf16 v[4:7],a[100:103],a[4:7],v[4:7]
 v_cvt_pk_bf16_f32 v77,v34,v35
 v_mfma_f32_16x16x32_bf16 v[0:3],a[88:91],a[8:11],v[0:3]
 v_exp_f32 v36,v36
 v_mfma_f32_16x16x32_bf16 v[4:7],a[104:107],a[8:11],v[4:7]
 ds_read_b64_tr_b16 a[116:117],v114 offset:16384
 ds_read_b64_tr_b16 a[118:119],v114 offset:20480
 v_mfma_f32_16x16x32_bf16 v[0:3],a[92:95],a[12:15],v[0:3]
 v_exp_f32 v37,v37
 v_mfma_f32_16x16x32_bf16 v[4:7],a[108:111],a[12:15],v[4:7]
 v_cvt_pk_bf16_f32 v78,v36,v37
 s_waitcnt vmcnt(4)
 buffer_load_dwordx4 v133,s[20:23],s33 offen offset:2048 nt lds
 v_mfma_f32_16x16x32_bf16 v[8:11],a[80:83],a[16:19],v[84:87]
 v_exp_f32 v38,v38
 v_mfma_f32_16x16x32_bf16 v[12:15],a[96:99],a[16:19],v[84:87]
 ds_read_b64_tr_b16 a[120:121],v115 offset:16384
 ds_read_b64_tr_b16 a[122:123],v115 offset:20480
 v_mfma_f32_16x16x32_bf16 v[8:11],a[84:87],a[20:23],v[8:11]
 v_exp_f32 v39,v39
 v_mfma_f32_16x16x32_bf16 v[12:15],a[100:103],a[20:23],v[12:15]
 v_cvt_pk_bf16_f32 v79,v38,v39
 v_mfma_f32_16x16x32_bf16 v[8:11],a[88:91],a[24:27],v[8:11]
 v_exp_f32 v0,v0
 v_mfma_f32_16x16x32_bf16 v[12:15],a[104:107],a[24:27],v[12:15]
 ds_read_b64_tr_b16 a[124:125],v116 offset:16384
 ds_read_b64_tr_b16 a[126:127],v116 offset:20480
 v_mfma_f32_16x16x32_bf16 v[8:11],a[92:95],a[28:31],v[8:11]
 v_exp_f32 v1,v1
 v_mfma_f32_16x16x32_bf16 v[12:15],a[108:111],a[28:31],v[12:15]
 v_cvt_pk_bf16_f32 v40,v0,v1
 s_waitcnt vmcnt(4)
 buffer_load_dwordx4 v134,s[20:23],s33 offen offset:3072 nt lds
 v_mfma_f32_16x16x32_bf16 v[16:19],a[80:83],a[32:35],v[88:91]
 v_exp_f32 v2,v2
 v_mfma_f32_16x16x32_bf16 v[20:23],a[96:99],a[32:35],v[88:91]
 ds_read_b64_tr_b16 a[128:129],v117 offset:16384
 ds_read_b64_tr_b16 a[130:131],v117 offset:20480
 v_mfma_f32_16x16x32_bf16 v[16:19],a[84:87],a[36:39],v[16:19]
 v_exp_f32 v3,v3
 v_mfma_f32_16x16x32_bf16 v[20:23],a[100:103],a[36:39],v[20:23]
 v_cvt_pk_bf16_f32 v41,v2,v3
 v_mfma_f32_16x16x32_bf16 v[16:19],a[88:91],a[40:43],v[16:19]
 v_exp_f32 v4,v4
 v_mfma_f32_16x16x32_bf16 v[20:23],a[104:107],a[40:43],v[20:23]
 ds_read_b64_tr_b16 a[132:133],v118 offset:16384
 ds_read_b64_tr_b16 a[134:135],v118 offset:20480
 s_add_u32 m0,s34,0x10000
 v_mfma_f32_16x16x32_bf16 v[16:19],a[92:95],a[44:47],v[16:19]
 v_exp_f32 v5,v5
 s_xor_b32 s32,s57,0x1c000
 v_mfma_f32_16x16x32_bf16 v[20:23],a[108:111],a[44:47],v[20:23]
 v_cvt_pk_bf16_f32 v42,v4,v5
 s_waitcnt vmcnt(4)
 buffer_load_dwordx4 v129,s[16:19],s32 offen offset:0 nt lds
 v_mfma_f32_16x16x32_bf16 v[24:27],a[80:83],a[48:51],v[92:95]
 v_exp_f32 v6,v6
 v_mfma_f32_16x16x32_bf16 v[28:31],a[96:99],a[48:51],v[92:95]
 ds_read_b64_tr_b16 a[136:137],v119 offset:16384
 ds_read_b64_tr_b16 a[138:139],v119 offset:20480
 v_mfma_f32_16x16x32_bf16 v[24:27],a[84:87],a[52:55],v[24:27]
 v_exp_f32 v7,v7
 v_mfma_f32_16x16x32_bf16 v[28:31],a[100:103],a[52:55],v[28:31]
 v_cvt_pk_bf16_f32 v43,v6,v7
 v_mfma_f32_16x16x32_bf16 v[24:27],a[88:91],a[56:59],v[24:27]
 v_exp_f32 v8,v8
 v_mfma_f32_16x16x32_bf16 v[28:31],a[104:107],a[56:59],v[28:31]
 ds_read_b64_tr_b16 a[140:141],v120 offset:16384
 ds_read_b64_tr_b16 a[142:143],v120 offset:20480
 v_mfma_f32_16x16x32_bf16 v[24:27],a[92:95],a[60:63],v[24:27]
 v_exp_f32 v9,v9
 v_mfma_f32_16x16x32_bf16 v[28:31],a[108:111],a[60:63],v[28:31]
 v_cvt_pk_bf16_f32 v44,v8,v9
 s_waitcnt vmcnt(4)
 buffer_load_dwordx4 v130,s[16:19],s32 offen offset:1024 nt lds
 v_mfma_f32_16x16x32_bf16 v[32:35],a[80:83],a[64:67],v[96:99]
 v_exp_f32 v10,v10
 v_mfma_f32_16x16x32_bf16 v[36:39],a[96:99],a[64:67],v[96:99]
 v_mfma_f32_16x16x32_bf16 v[32:35],a[84:87],a[68:71],v[32:35]
 v_exp_f32 v11,v11
 v_mfma_f32_16x16x32_bf16 v[36:39],a[100:103],a[68:71],v[36:39]
 v_cvt_pk_bf16_f32 v45,v10,v11
 v_mfma_f32_16x16x32_bf16 v[32:35],a[88:91],a[72:75],v[32:35]
 v_exp_f32 v12,v12
 v_mfma_f32_16x16x32_bf16 v[36:39],a[104:107],a[72:75],v[36:39]
 v_mfma_f32_16x16x32_bf16 v[32:35],a[92:95],a[76:79],v[32:35]
 v_exp_f32 v13,v13
 v_mfma_f32_16x16x32_bf16 v[36:39],a[108:111],a[76:79],v[36:39]
 v_cvt_pk_bf16_f32 v46,v12,v13
 s_waitcnt lgkmcnt(0)
 v_mfma_f32_16x16x32_bf16 v[144:147],a[112:115],v[60:63],v[144:147]
 s_barrier
 v_exp_f32 v14,v14
 v_mfma_f32_16x16x32_bf16 v[148:151],a[116:119],v[60:63],v[148:151]
 v_mfma_f32_16x16x32_bf16 v[152:155],a[120:123],v[60:63],v[152:155]
 v_exp_f32 v15,v15
 v_mfma_f32_16x16x32_bf16 v[156:159],a[124:127],v[60:63],v[156:159]
 v_cvt_pk_bf16_f32 v47,v14,v15
 v_mfma_f32_16x16x32_bf16 v[160:163],a[128:131],v[60:63],v[160:163]
 v_exp_f32 v16,v16
 v_mfma_f32_16x16x32_bf16 v[164:167],a[132:135],v[60:63],v[164:167]
 ds_read_b128 a[80:83],v105 offset:16384
 s_waitcnt vmcnt(4)
 buffer_load_dwordx4 v131,s[16:19],s32 offen offset:2048 nt lds
 v_mfma_f32_16x16x32_bf16 v[168:171],a[136:139],v[60:63],v[168:171]
 v_exp_f32 v17,v17
 v_mfma_f32_16x16x32_bf16 v[172:175],a[140:143],v[60:63],v[172:175]
 v_cvt_pk_bf16_f32 v48,v16,v17
 v_mfma_f32_16x16x32_bf16 a[192:195],a[212:215],v[60:63],a[192:195]
 ds_read_b128 a[96:99],v105 offset:20480
 v_mfma_f32_16x16x32_bf16 v[176:179],a[112:115],v[64:67],v[176:179]
 v_exp_f32 v18,v18
 v_mfma_f32_16x16x32_bf16 v[180:183],a[116:119],v[64:67],v[180:183]
 ds_read_b128 a[84:87],v106 offset:16384
 v_mfma_f32_16x16x32_bf16 v[184:187],a[120:123],v[64:67],v[184:187]
 v_exp_f32 v19,v19
 v_mfma_f32_16x16x32_bf16 v[188:191],a[124:127],v[64:67],v[188:191]
 v_cvt_pk_bf16_f32 v49,v18,v19
 v_mfma_f32_16x16x32_bf16 v[192:195],a[128:131],v[64:67],v[192:195]
 v_exp_f32 v20,v20
 v_mfma_f32_16x16x32_bf16 v[196:199],a[132:135],v[64:67],v[196:199]
 v_mfma_f32_16x16x32_bf16 v[200:203],a[136:139],v[64:67],v[200:203]
 v_exp_f32 v21,v21
 v_mfma_f32_16x16x32_bf16 v[204:207],a[140:143],v[64:67],v[204:207]
 v_cvt_pk_bf16_f32 v50,v20,v21
 v_mfma_f32_16x16x32_bf16 a[196:199],a[212:215],v[64:67],a[196:199]
 ds_read_b128 a[100:103],v106 offset:20480
 s_waitcnt vmcnt(4)
 buffer_load_dwordx4 v132,s[16:19],s32 offen offset:3072 nt lds
 v_mfma_f32_16x16x32_bf16 v[208:211],a[112:115],v[68:71],v[208:211]
 v_exp_f32 v22,v22
 v_mfma_f32_16x16x32_bf16 v[212:215],a[116:119],v[68:71],v[212:215]
 ds_read_b128 a[88:91],v107 offset:16384
 v_mfma_f32_16x16x32_bf16 v[216:219],a[120:123],v[68:71],v[216:219]
 v_exp_f32 v23,v23
 v_mfma_f32_16x16x32_bf16 v[220:223],a[124:127],v[68:71],v[220:223]
 v_cvt_pk_bf16_f32 v51,v22,v23
 v_mfma_f32_16x16x32_bf16 v[224:227],a[128:131],v[68:71],v[224:227]
 v_exp_f32 v24,v24
 v_mfma_f32_16x16x32_bf16 v[228:231],a[132:135],v[68:71],v[228:231]
 ds_read_b128 a[104:107],v107 offset:20480
 v_mfma_f32_16x16x32_bf16 v[232:235],a[136:139],v[68:71],v[232:235]
 v_exp_f32 v25,v25
 v_mfma_f32_16x16x32_bf16 v[236:239],a[140:143],v[68:71],v[236:239]
 v_cvt_pk_bf16_f32 v52,v24,v25
 v_mfma_f32_16x16x32_bf16 a[200:203],a[212:215],v[68:71],a[200:203]
 v_mfma_f32_16x16x32_bf16 v[240:243],a[112:115],v[72:75],v[240:243]
 v_exp_f32 v26,v26
 v_mfma_f32_16x16x32_bf16 v[244:247],a[116:119],v[72:75],v[244:247]
 ds_read_b128 a[92:95],v108 offset:16384
 v_mfma_f32_16x16x32_bf16 v[248:251],a[120:123],v[72:75],v[248:251]
 v_exp_f32 v27,v27
 v_mfma_f32_16x16x32_bf16 v[252:255],a[124:127],v[72:75],v[252:255]
 v_cvt_pk_bf16_f32 v53,v26,v27
 s_add_u32 m0,s34,0x1c000
 v_mfma_f32_16x16x32_bf16 a[144:147],a[128:131],v[72:75],a[144:147]
 v_exp_f32 v28,v28
 s_xor_b32 s33,s57,0x1c000
 v_mfma_f32_16x16x32_bf16 a[148:151],a[132:135],v[72:75],a[148:151]
 ds_read_b128 a[108:111],v108 offset:20480
 s_waitcnt vmcnt(4)
 buffer_load_dwordx4 v133,s[20:23],s33 offen offset:0 nt lds
 v_mfma_f32_16x16x32_bf16 a[152:155],a[136:139],v[72:75],a[152:155]
 v_exp_f32 v29,v29
 v_mfma_f32_16x16x32_bf16 a[156:159],a[140:143],v[72:75],a[156:159]
 v_cvt_pk_bf16_f32 v54,v28,v29
 v_mfma_f32_16x16x32_bf16 a[204:207],a[212:215],v[72:75],a[204:207]
 v_mfma_f32_16x16x32_bf16 a[160:163],a[112:115],v[76:79],a[160:163]
 v_exp_f32 v30,v30
 v_mfma_f32_16x16x32_bf16 a[164:167],a[116:119],v[76:79],a[164:167]
 v_mfma_f32_16x16x32_bf16 a[168:171],a[120:123],v[76:79],a[168:171]
 v_exp_f32 v31,v31
 v_mfma_f32_16x16x32_bf16 a[172:175],a[124:127],v[76:79],a[172:175]
 v_cvt_pk_bf16_f32 v55,v30,v31
 v_mfma_f32_16x16x32_bf16 a[176:179],a[128:131],v[76:79],a[176:179]
 v_exp_f32 v32,v32
 v_mfma_f32_16x16x32_bf16 a[180:183],a[132:135],v[76:79],a[180:183]
 v_mfma_f32_16x16x32_bf16 a[184:187],a[136:139],v[76:79],a[184:187]
 v_exp_f32 v33,v33
 v_mfma_f32_16x16x32_bf16 a[188:191],a[140:143],v[76:79],a[188:191]
 v_cvt_pk_bf16_f32 v56,v32,v33
 v_mfma_f32_16x16x32_bf16 a[208:211],a[212:215],v[76:79],a[208:211]
 s_waitcnt lgkmcnt(0)
 v_mfma_f32_16x16x32_bf16 v[0:3],a[80:83],a[0:3],v[80:83]
 v_exp_f32 v34,v34
 v_mfma_f32_16x16x32_bf16 v[4:7],a[96:99],a[0:3],v[80:83]
 ds_read_b64_tr_b16 a[112:113],v113 offset:32768
 ds_read_b64_tr_b16 a[114:115],v113 offset:36864
 v_mfma_f32_16x16x32_bf16 v[0:3],a[84:87],a[4:7],v[0:3]
 v_exp_f32 v35,v35
 v_mfma_f32_16x16x32_bf16 v[4:7],a[100:103],a[4:7],v[4:7]
 v_cvt_pk_bf16_f32 v57,v34,v35
 v_mfma_f32_16x16x32_bf16 v[0:3],a[88:91],a[8:11],v[0:3]
 v_exp_f32 v36,v36
 v_mfma_f32_16x16x32_bf16 v[4:7],a[104:107],a[8:11],v[4:7]
 ds_read_b64_tr_b16 a[116:117],v114 offset:32768
 ds_read_b64_tr_b16 a[118:119],v114 offset:36864
 v_mfma_f32_16x16x32_bf16 v[0:3],a[92:95],a[12:15],v[0:3]
 v_exp_f32 v37,v37
 v_mfma_f32_16x16x32_bf16 v[4:7],a[108:111],a[12:15],v[4:7]
 v_cvt_pk_bf16_f32 v58,v36,v37
 s_waitcnt vmcnt(4)
 buffer_load_dwordx4 v134,s[20:23],s33 offen offset:1024 nt lds
 v_mfma_f32_16x16x32_bf16 v[8:11],a[80:83],a[16:19],v[84:87]
 v_exp_f32 v38,v38
 v_mfma_f32_16x16x32_bf16 v[12:15],a[96:99],a[16:19],v[84:87]
 ds_read_b64_tr_b16 a[120:121],v115 offset:32768
 ds_read_b64_tr_b16 a[122:123],v115 offset:36864
 v_mfma_f32_16x16x32_bf16 v[8:11],a[84:87],a[20:23],v[8:11]
 v_exp_f32 v39,v39
 v_mfma_f32_16x16x32_bf16 v[12:15],a[100:103],a[20:23],v[12:15]
 v_cvt_pk_bf16_f32 v59,v38,v39
 v_mfma_f32_16x16x32_bf16 v[8:11],a[88:91],a[24:27],v[8:11]
 v_exp_f32 v0,v0
 v_mfma_f32_16x16x32_bf16 v[12:15],a[104:107],a[24:27],v[12:15]
 ds_read_b64_tr_b16 a[124:125],v116 offset:32768
 ds_read_b64_tr_b16 a[126:127],v116 offset:36864
 v_mfma_f32_16x16x32_bf16 v[8:11],a[92:95],a[28:31],v[8:11]
 v_exp_f32 v1,v1
 v_mfma_f32_16x16x32_bf16 v[12:15],a[108:111],a[28:31],v[12:15]
 v_cvt_pk_bf16_f32 v60,v0,v1
 s_waitcnt vmcnt(4)
 buffer_load_dwordx4 v133,s[20:23],s33 offen offset:2048 nt lds
 v_mfma_f32_16x16x32_bf16 v[16:19],a[80:83],a[32:35],v[88:91]
 v_exp_f32 v2,v2
 v_mfma_f32_16x16x32_bf16 v[20:23],a[96:99],a[32:35],v[88:91]
 ds_read_b64_tr_b16 a[128:129],v117 offset:32768
 ds_read_b64_tr_b16 a[130:131],v117 offset:36864
 v_mfma_f32_16x16x32_bf16 v[16:19],a[84:87],a[36:39],v[16:19]
 v_exp_f32 v3,v3
 v_mfma_f32_16x16x32_bf16 v[20:23],a[100:103],a[36:39],v[20:23]
 v_cvt_pk_bf16_f32 v61,v2,v3
 v_mfma_f32_16x16x32_bf16 v[16:19],a[88:91],a[40:43],v[16:19]
 v_exp_f32 v4,v4
 v_mfma_f32_16x16x32_bf16 v[20:23],a[104:107],a[40:43],v[20:23]
 ds_read_b64_tr_b16 a[132:133],v118 offset:32768
 ds_read_b64_tr_b16 a[134:135],v118 offset:36864
 v_mfma_f32_16x16x32_bf16 v[16:19],a[92:95],a[44:47],v[16:19]
 v_exp_f32 v5,v5
 v_mfma_f32_16x16x32_bf16 v[20:23],a[108:111],a[44:47],v[20:23]
 v_cvt_pk_bf16_f32 v62,v4,v5
 s_waitcnt vmcnt(4)
 buffer_load_dwordx4 v134,s[20:23],s33 offen offset:3072 nt lds
 v_mfma_f32_16x16x32_bf16 v[24:27],a[80:83],a[48:51],v[92:95]
 v_exp_f32 v6,v6
 v_mfma_f32_16x16x32_bf16 v[28:31],a[96:99],a[48:51],v[92:95]
 ds_read_b64_tr_b16 a[136:137],v119 offset:32768
 ds_read_b64_tr_b16 a[138:139],v119 offset:36864
 v_mfma_f32_16x16x32_bf16 v[24:27],a[84:87],a[52:55],v[24:27]
 v_exp_f32 v7,v7
 v_mfma_f32_16x16x32_bf16 v[28:31],a[100:103],a[52:55],v[28:31]
 v_cvt_pk_bf16_f32 v63,v6,v7
 v_mfma_f32_16x16x32_bf16 v[24:27],a[88:91],a[56:59],v[24:27]
 v_exp_f32 v8,v8
 v_mfma_f32_16x16x32_bf16 v[28:31],a[104:107],a[56:59],v[28:31]
 ds_read_b64_tr_b16 a[140:141],v120 offset:32768
 ds_read_b64_tr_b16 a[142:143],v120 offset:36864
 s_add_u32 m0,s34,0x0
 v_mfma_f32_16x16x32_bf16 v[24:27],a[92:95],a[60:63],v[24:27]
 v_exp_f32 v9,v9
 s_xor_b32 s32,s57,0x1e000
 v_mfma_f32_16x16x32_bf16 v[28:31],a[108:111],a[60:63],v[28:31]
 v_cvt_pk_bf16_f32 v64,v8,v9
 s_waitcnt vmcnt(3)
 buffer_load_dwordx4 v129,s[16:19],s32 offen offset:0 nt lds
 v_mfma_f32_16x16x32_bf16 v[32:35],a[80:83],a[64:67],v[96:99]
 v_exp_f32 v10,v10
 v_mfma_f32_16x16x32_bf16 v[36:39],a[96:99],a[64:67],v[96:99]
 v_mfma_f32_16x16x32_bf16 v[32:35],a[84:87],a[68:71],v[32:35]
 v_exp_f32 v11,v11
 v_mfma_f32_16x16x32_bf16 v[36:39],a[100:103],a[68:71],v[36:39]
 v_cvt_pk_bf16_f32 v65,v10,v11
 v_mfma_f32_16x16x32_bf16 v[32:35],a[88:91],a[72:75],v[32:35]
 v_exp_f32 v12,v12
 v_mfma_f32_16x16x32_bf16 v[36:39],a[104:107],a[72:75],v[36:39]
 v_mfma_f32_16x16x32_bf16 v[32:35],a[92:95],a[76:79],v[32:35]
 v_exp_f32 v13,v13
 v_mfma_f32_16x16x32_bf16 v[36:39],a[108:111],a[76:79],v[36:39]
 v_cvt_pk_bf16_f32 v66,v12,v13
 s_waitcnt lgkmcnt(0)
 v_mfma_f32_16x16x32_bf16 v[144:147],a[112:115],v[40:43],v[144:147]
 s_barrier
 v_exp_f32 v14,v14
 v_mfma_f32_16x16x32_bf16 v[148:151],a[116:119],v[40:43],v[148:151]
 v_mfma_f32_16x16x32_bf16 v[152:155],a[120:123],v[40:43],v[152:155]
 v_exp_f32 v15,v15
 v_mfma_f32_16x16x32_bf16 v[156:159],a[124:127],v[40:43],v[156:159]
 v_cvt_pk_bf16_f32 v67,v14,v15
 v_mfma_f32_16x16x32_bf16 v[160:163],a[128:131],v[40:43],v[160:163]
 v_exp_f32 v16,v16
 v_mfma_f32_16x16x32_bf16 v[164:167],a[132:135],v[40:43],v[164:167]
 ds_read_b128 a[80:83],v105 offset:32768
 s_waitcnt vmcnt(4)
 buffer_load_dwordx4 v130,s[16:19],s32 offen offset:1024 nt lds
 v_mfma_f32_16x16x32_bf16 v[168:171],a[136:139],v[40:43],v[168:171]
 v_exp_f32 v17,v17
 v_mfma_f32_16x16x32_bf16 v[172:175],a[140:143],v[40:43],v[172:175]
 v_cvt_pk_bf16_f32 v68,v16,v17
 v_mfma_f32_16x16x32_bf16 a[192:195],a[212:215],v[40:43],a[192:195]
 ds_read_b128 a[96:99],v105 offset:36864
 v_mfma_f32_16x16x32_bf16 v[176:179],a[112:115],v[44:47],v[176:179]
 v_exp_f32 v18,v18
 v_mfma_f32_16x16x32_bf16 v[180:183],a[116:119],v[44:47],v[180:183]
 ds_read_b128 a[84:87],v106 offset:32768
 v_mfma_f32_16x16x32_bf16 v[184:187],a[120:123],v[44:47],v[184:187]
 v_exp_f32 v19,v19
 v_mfma_f32_16x16x32_bf16 v[188:191],a[124:127],v[44:47],v[188:191]
 v_cvt_pk_bf16_f32 v69,v18,v19
 v_mfma_f32_16x16x32_bf16 v[192:195],a[128:131],v[44:47],v[192:195]
 v_exp_f32 v20,v20
 v_mfma_f32_16x16x32_bf16 v[196:199],a[132:135],v[44:47],v[196:199]
 s_waitcnt vmcnt(4)
 buffer_load_dwordx4 v131,s[16:19],s32 offen offset:2048 nt lds
 v_mfma_f32_16x16x32_bf16 v[200:203],a[136:139],v[44:47],v[200:203]
 v_exp_f32 v21,v21
 v_mfma_f32_16x16x32_bf16 v[204:207],a[140:143],v[44:47],v[204:207]
 v_cvt_pk_bf16_f32 v70,v20,v21
 v_mfma_f32_16x16x32_bf16 a[196:199],a[212:215],v[44:47],a[196:199]
 ds_read_b128 a[100:103],v106 offset:36864
 v_mfma_f32_16x16x32_bf16 v[208:211],a[112:115],v[48:51],v[208:211]
 v_exp_f32 v22,v22
 v_mfma_f32_16x16x32_bf16 v[212:215],a[116:119],v[48:51],v[212:215]
 ds_read_b128 a[88:91],v107 offset:32768
 v_mfma_f32_16x16x32_bf16 v[216:219],a[120:123],v[48:51],v[216:219]
 v_exp_f32 v23,v23
 v_mfma_f32_16x16x32_bf16 v[220:223],a[124:127],v[48:51],v[220:223]
 v_cvt_pk_bf16_f32 v71,v22,v23
 v_mfma_f32_16x16x32_bf16 v[224:227],a[128:131],v[48:51],v[224:227]
 v_exp_f32 v24,v24
 v_mfma_f32_16x16x32_bf16 v[228:231],a[132:135],v[48:51],v[228:231]
 ds_read_b128 a[104:107],v107 offset:36864
 v_mfma_f32_16x16x32_bf16 v[232:235],a[136:139],v[48:51],v[232:235]
 v_exp_f32 v25,v25
 v_mfma_f32_16x16x32_bf16 v[236:239],a[140:143],v[48:51],v[236:239]
 v_cvt_pk_bf16_f32 v72,v24,v25
 s_waitcnt vmcnt(4)
 buffer_load_dwordx4 v132,s[16:19],s32 offen offset:3072 nt lds
 v_mfma_f32_16x16x32_bf16 a[200:203],a[212:215],v[48:51],a[200:203]
 v_mfma_f32_16x16x32_bf16 v[240:243],a[112:115],v[52:55],v[240:243]
 v_exp_f32 v26,v26
 v_mfma_f32_16x16x32_bf16 v[244:247],a[116:119],v[52:55],v[244:247]
 ds_read_b128 a[92:95],v108 offset:32768
 v_mfma_f32_16x16x32_bf16 v[248:251],a[120:123],v[52:55],v[248:251]
 v_exp_f32 v27,v27
 v_mfma_f32_16x16x32_bf16 v[252:255],a[124:127],v[52:55],v[252:255]
 v_cvt_pk_bf16_f32 v73,v26,v27
 v_mfma_f32_16x16x32_bf16 a[144:147],a[128:131],v[52:55],a[144:147]
 v_exp_f32 v28,v28
 v_mfma_f32_16x16x32_bf16 a[148:151],a[132:135],v[52:55],a[148:151]
 ds_read_b128 a[108:111],v108 offset:36864
 s_add_u32 m0,s34,0x20000
 v_mfma_f32_16x16x32_bf16 a[152:155],a[136:139],v[52:55],a[152:155]
 v_exp_f32 v29,v29
 s_xor_b32 s33,s57,0x1e000
 v_mfma_f32_16x16x32_bf16 a[156:159],a[140:143],v[52:55],a[156:159]
 v_cvt_pk_bf16_f32 v74,v28,v29
 s_waitcnt vmcnt(3)
 buffer_load_dwordx4 v133,s[20:23],s33 offen offset:0 nt lds
 v_mfma_f32_16x16x32_bf16 a[204:207],a[212:215],v[52:55],a[204:207]
 v_mfma_f32_16x16x32_bf16 a[160:163],a[112:115],v[56:59],a[160:163]
 v_exp_f32 v30,v30
 v_mfma_f32_16x16x32_bf16 a[164:167],a[116:119],v[56:59],a[164:167]
 v_mfma_f32_16x16x32_bf16 a[168:171],a[120:123],v[56:59],a[168:171]
 v_exp_f32 v31,v31
 v_mfma_f32_16x16x32_bf16 a[172:175],a[124:127],v[56:59],a[172:175]
 v_cvt_pk_bf16_f32 v75,v30,v31
 v_mfma_f32_16x16x32_bf16 a[176:179],a[128:131],v[56:59],a[176:179]
 v_exp_f32 v32,v32
 v_mfma_f32_16x16x32_bf16 a[180:183],a[132:135],v[56:59],a[180:183]
 v_mfma_f32_16x16x32_bf16 a[184:187],a[136:139],v[56:59],a[184:187]
 v_exp_f32 v33,v33
 v_mfma_f32_16x16x32_bf16 a[188:191],a[140:143],v[56:59],a[188:191]
 v_cvt_pk_bf16_f32 v76,v32,v33
 v_mfma_f32_16x16x32_bf16 a[208:211],a[212:215],v[56:59],a[208:211]
 s_waitcnt lgkmcnt(0)
 v_mfma_f32_16x16x32_bf16 v[0:3],a[80:83],a[0:3],v[80:83]
 v_exp_f32 v34,v34
 v_mfma_f32_16x16x32_bf16 v[4:7],a[96:99],a[0:3],v[80:83]
 ds_read_b64_tr_b16 a[112:113],v113 offset:49152
 ds_read_b64_tr_b16 a[114:115],v113 offset:53248
 v_mfma_f32_16x16x32_bf16 v[0:3],a[84:87],a[4:7],v[0:3]
 v_exp_f32 v35,v35
 v_mfma_f32_16x16x32_bf16 v[4:7],a[100:103],a[4:7],v[4:7]
 v_cvt_pk_bf16_f32 v77,v34,v35
 v_mfma_f32_16x16x32_bf16 v[0:3],a[88:91],a[8:11],v[0:3]
 v_exp_f32 v36,v36
 v_mfma_f32_16x16x32_bf16 v[4:7],a[104:107],a[8:11],v[4:7]
 ds_read_b64_tr_b16 a[116:117],v114 offset:49152
 ds_read_b64_tr_b16 a[118:119],v114 offset:53248
 v_mfma_f32_16x16x32_bf16 v[0:3],a[92:95],a[12:15],v[0:3]
 v_exp_f32 v37,v37
 v_mfma_f32_16x16x32_bf16 v[4:7],a[108:111],a[12:15],v[4:7]
 v_cvt_pk_bf16_f32 v78,v36,v37
 s_waitcnt vmcnt(4)
 buffer_load_dwordx4 v134,s[20:23],s33 offen offset:1024 nt lds
 v_mfma_f32_16x16x32_bf16 v[8:11],a[80:83],a[16:19],v[84:87]
 v_exp_f32 v38,v38
 v_mfma_f32_16x16x32_bf16 v[12:15],a[96:99],a[16:19],v[84:87]
 ds_read_b64_tr_b16 a[120:121],v115 offset:49152
 ds_read_b64_tr_b16 a[122:123],v115 offset:53248
 v_mfma_f32_16x16x32_bf16 v[8:11],a[84:87],a[20:23],v[8:11]
 v_exp_f32 v39,v39
 v_mfma_f32_16x16x32_bf16 v[12:15],a[100:103],a[20:23],v[12:15]
 v_cvt_pk_bf16_f32 v79,v38,v39
 v_mfma_f32_16x16x32_bf16 v[8:11],a[88:91],a[24:27],v[8:11]
 v_exp_f32 v0,v0
 v_mfma_f32_16x16x32_bf16 v[12:15],a[104:107],a[24:27],v[12:15]
 ds_read_b64_tr_b16 a[124:125],v116 offset:49152
 ds_read_b64_tr_b16 a[126:127],v116 offset:53248
 v_mfma_f32_16x16x32_bf16 v[8:11],a[92:95],a[28:31],v[8:11]
 v_exp_f32 v1,v1
 v_mfma_f32_16x16x32_bf16 v[12:15],a[108:111],a[28:31],v[12:15]
 v_cvt_pk_bf16_f32 v40,v0,v1
 v_mfma_f32_16x16x32_bf16 v[16:19],a[80:83],a[32:35],v[88:91]
 v_exp_f32 v2,v2
 v_mfma_f32_16x16x32_bf16 v[20:23],a[96:99],a[32:35],v[88:91]
 ds_read_b64_tr_b16 a[128:129],v117 offset:49152
 ds_read_b64_tr_b16 a[130:131],v117 offset:53248
 v_mfma_f32_16x16x32_bf16 v[16:19],a[84:87],a[36:39],v[16:19]
 v_exp_f32 v3,v3
 v_mfma_f32_16x16x32_bf16 v[20:23],a[100:103],a[36:39],v[20:23]
 v_cvt_pk_bf16_f32 v41,v2,v3
 s_waitcnt vmcnt(4)
 buffer_load_dwordx4 v133,s[20:23],s33 offen offset:2048 nt lds
 v_mfma_f32_16x16x32_bf16 v[16:19],a[88:91],a[40:43],v[16:19]
 v_exp_f32 v4,v4
 v_mfma_f32_16x16x32_bf16 v[20:23],a[104:107],a[40:43],v[20:23]
 ds_read_b64_tr_b16 a[132:133],v118 offset:49152
 ds_read_b64_tr_b16 a[134:135],v118 offset:53248
 v_mfma_f32_16x16x32_bf16 v[16:19],a[92:95],a[44:47],v[16:19]
 v_exp_f32 v5,v5
 v_mfma_f32_16x16x32_bf16 v[20:23],a[108:111],a[44:47],v[20:23]
 v_cvt_pk_bf16_f32 v42,v4,v5
 v_mfma_f32_16x16x32_bf16 v[24:27],a[80:83],a[48:51],v[92:95]
 v_exp_f32 v6,v6
 v_mfma_f32_16x16x32_bf16 v[28:31],a[96:99],a[48:51],v[92:95]
 ds_read_b64_tr_b16 a[136:137],v119 offset:49152
 ds_read_b64_tr_b16 a[138:139],v119 offset:53248
 v_mfma_f32_16x16x32_bf16 v[24:27],a[84:87],a[52:55],v[24:27]
 v_exp_f32 v7,v7
 v_mfma_f32_16x16x32_bf16 v[28:31],a[100:103],a[52:55],v[28:31]
 v_cvt_pk_bf16_f32 v43,v6,v7
 v_mfma_f32_16x16x32_bf16 v[24:27],a[88:91],a[56:59],v[24:27]
 v_exp_f32 v8,v8
 v_mfma_f32_16x16x32_bf16 v[28:31],a[104:107],a[56:59],v[28:31]
 ds_read_b64_tr_b16 a[140:141],v120 offset:49152
 ds_read_b64_tr_b16 a[142:143],v120 offset:53248
 v_mfma_f32_16x16x32_bf16 v[24:27],a[92:95],a[60:63],v[24:27]
 v_exp_f32 v9,v9
 v_mfma_f32_16x16x32_bf16 v[28:31],a[108:111],a[60:63],v[28:31]
 v_cvt_pk_bf16_f32 v44,v8,v9
 s_waitcnt vmcnt(4)
 buffer_load_dwordx4 v134,s[20:23],s33 offen offset:3072 nt lds
 v_mfma_f32_16x16x32_bf16 v[32:35],a[80:83],a[64:67],v[96:99]
 v_exp_f32 v10,v10
 v_mfma_f32_16x16x32_bf16 v[36:39],a[96:99],a[64:67],v[96:99]
 v_mfma_f32_16x16x32_bf16 v[32:35],a[84:87],a[68:71],v[32:35]
 v_exp_f32 v11,v11
 v_mfma_f32_16x16x32_bf16 v[36:39],a[100:103],a[68:71],v[36:39]
 v_cvt_pk_bf16_f32 v45,v10,v11
 v_mfma_f32_16x16x32_bf16 v[32:35],a[88:91],a[72:75],v[32:35]
 v_exp_f32 v12,v12
 v_mfma_f32_16x16x32_bf16 v[36:39],a[104:107],a[72:75],v[36:39]
 v_mfma_f32_16x16x32_bf16 v[32:35],a[92:95],a[76:79],v[32:35]
 v_exp_f32 v13,v13
 v_mfma_f32_16x16x32_bf16 v[36:39],a[108:111],a[76:79],v[36:39]
 v_cvt_pk_bf16_f32 v46,v12,v13
 s_waitcnt lgkmcnt(0)
 v_mfma_f32_16x16x32_bf16 v[144:147],a[112:115],v[60:63],v[144:147]
 s_barrier
 v_exp_f32 v14,v14
 v_mfma_f32_16x16x32_bf16 v[148:151],a[116:119],v[60:63],v[148:151]
 v_mfma_f32_16x16x32_bf16 v[152:155],a[120:123],v[60:63],v[152:155]
 v_exp_f32 v15,v15
 v_mfma_f32_16x16x32_bf16 v[156:159],a[124:127],v[60:63],v[156:159]
 v_cvt_pk_bf16_f32 v47,v14,v15
 s_add_u32 m0,s34,0x4000
 v_mfma_f32_16x16x32_bf16 v[160:163],a[128:131],v[60:63],v[160:163]
 v_exp_f32 v16,v16
 s_xor_b32 s32,s57,0x20000
 v_mfma_f32_16x16x32_bf16 v[164:167],a[132:135],v[60:63],v[164:167]
 ds_read_b128 a[80:83],v105 offset:49152
 s_waitcnt vmcnt(4)
 buffer_load_dwordx4 v129,s[16:19],s32 offen offset:0 nt lds
 v_mfma_f32_16x16x32_bf16 v[168:171],a[136:139],v[60:63],v[168:171]
 v_exp_f32 v17,v17
 v_mfma_f32_16x16x32_bf16 v[172:175],a[140:143],v[60:63],v[172:175]
 v_cvt_pk_bf16_f32 v48,v16,v17
 v_mfma_f32_16x16x32_bf16 a[192:195],a[212:215],v[60:63],a[192:195]
 ds_read_b128 a[96:99],v105 offset:53248
 v_mfma_f32_16x16x32_bf16 v[176:179],a[112:115],v[64:67],v[176:179]
 v_exp_f32 v18,v18
 v_mfma_f32_16x16x32_bf16 v[180:183],a[116:119],v[64:67],v[180:183]
 ds_read_b128 a[84:87],v106 offset:49152
 v_mfma_f32_16x16x32_bf16 v[184:187],a[120:123],v[64:67],v[184:187]
 v_exp_f32 v19,v19
 v_mfma_f32_16x16x32_bf16 v[188:191],a[124:127],v[64:67],v[188:191]
 v_cvt_pk_bf16_f32 v49,v18,v19
 v_mfma_f32_16x16x32_bf16 v[192:195],a[128:131],v[64:67],v[192:195]
 v_exp_f32 v20,v20
 v_mfma_f32_16x16x32_bf16 v[196:199],a[132:135],v[64:67],v[196:199]
 s_waitcnt vmcnt(4)
 buffer_load_dwordx4 v130,s[16:19],s32 offen offset:1024 nt lds
 v_mfma_f32_16x16x32_bf16 v[200:203],a[136:139],v[64:67],v[200:203]
 v_exp_f32 v21,v21
 v_mfma_f32_16x16x32_bf16 v[204:207],a[140:143],v[64:67],v[204:207]
 v_cvt_pk_bf16_f32 v50,v20,v21
 v_mfma_f32_16x16x32_bf16 a[196:199],a[212:215],v[64:67],a[196:199]
 ds_read_b128 a[100:103],v106 offset:53248
 v_mfma_f32_16x16x32_bf16 v[208:211],a[112:115],v[68:71],v[208:211]
 v_exp_f32 v22,v22
 v_mfma_f32_16x16x32_bf16 v[212:215],a[116:119],v[68:71],v[212:215]
 ds_read_b128 a[88:91],v107 offset:49152
 v_mfma_f32_16x16x32_bf16 v[216:219],a[120:123],v[68:71],v[216:219]
 v_exp_f32 v23,v23
 v_mfma_f32_16x16x32_bf16 v[220:223],a[124:127],v[68:71],v[220:223]
 v_cvt_pk_bf16_f32 v51,v22,v23
 v_mfma_f32_16x16x32_bf16 v[224:227],a[128:131],v[68:71],v[224:227]
 v_exp_f32 v24,v24
 v_mfma_f32_16x16x32_bf16 v[228:231],a[132:135],v[68:71],v[228:231]
 ds_read_b128 a[104:107],v107 offset:53248
 v_mfma_f32_16x16x32_bf16 v[232:235],a[136:139],v[68:71],v[232:235]
 v_exp_f32 v25,v25
 v_mfma_f32_16x16x32_bf16 v[236:239],a[140:143],v[68:71],v[236:239]
 v_cvt_pk_bf16_f32 v52,v24,v25
 s_waitcnt vmcnt(4)
 buffer_load_dwordx4 v131,s[16:19],s32 offen offset:2048 nt lds
 v_mfma_f32_16x16x32_bf16 a[200:203],a[212:215],v[68:71],a[200:203]
 v_mfma_f32_16x16x32_bf16 v[240:243],a[112:115],v[72:75],v[240:243]
 v_exp_f32 v26,v26
 v_mfma_f32_16x16x32_bf16 v[244:247],a[116:119],v[72:75],v[244:247]
 ds_read_b128 a[92:95],v108 offset:49152
 v_mfma_f32_16x16x32_bf16 v[248:251],a[120:123],v[72:75],v[248:251]
 v_exp_f32 v27,v27
 v_mfma_f32_16x16x32_bf16 v[252:255],a[124:127],v[72:75],v[252:255]
 v_cvt_pk_bf16_f32 v53,v26,v27
 v_mfma_f32_16x16x32_bf16 a[144:147],a[128:131],v[72:75],a[144:147]
 v_exp_f32 v28,v28
 v_mfma_f32_16x16x32_bf16 a[148:151],a[132:135],v[72:75],a[148:151]
 ds_read_b128 a[108:111],v108 offset:53248
 v_mfma_f32_16x16x32_bf16 a[152:155],a[136:139],v[72:75],a[152:155]
 v_exp_f32 v29,v29
 v_mfma_f32_16x16x32_bf16 a[156:159],a[140:143],v[72:75],a[156:159]
 v_cvt_pk_bf16_f32 v54,v28,v29
 s_waitcnt vmcnt(4)
 buffer_load_dwordx4 v132,s[16:19],s32 offen offset:3072 nt lds
 v_mfma_f32_16x16x32_bf16 a[204:207],a[212:215],v[72:75],a[204:207]
 v_mfma_f32_16x16x32_bf16 a[160:163],a[112:115],v[76:79],a[160:163]
 v_exp_f32 v30,v30
 v_mfma_f32_16x16x32_bf16 a[164:167],a[116:119],v[76:79],a[164:167]
 v_mfma_f32_16x16x32_bf16 a[168:171],a[120:123],v[76:79],a[168:171]
 v_exp_f32 v31,v31
 v_mfma_f32_16x16x32_bf16 a[172:175],a[124:127],v[76:79],a[172:175]
 v_cvt_pk_bf16_f32 v55,v30,v31
 v_mfma_f32_16x16x32_bf16 a[176:179],a[128:131],v[76:79],a[176:179]
 v_exp_f32 v32,v32
 v_mfma_f32_16x16x32_bf16 a[180:183],a[132:135],v[76:79],a[180:183]
 v_mfma_f32_16x16x32_bf16 a[184:187],a[136:139],v[76:79],a[184:187]
 v_exp_f32 v33,v33
 v_mfma_f32_16x16x32_bf16 a[188:191],a[140:143],v[76:79],a[188:191]
 v_cvt_pk_bf16_f32 v56,v32,v33
 v_mfma_f32_16x16x32_bf16 a[208:211],a[212:215],v[76:79],a[208:211]
 s_waitcnt lgkmcnt(0)
 v_mfma_f32_16x16x32_bf16 v[0:3],a[80:83],a[0:3],v[80:83]
 v_exp_f32 v34,v34
 v_mfma_f32_16x16x32_bf16 v[4:7],a[96:99],a[0:3],v[80:83]
 ds_read_b64_tr_b16 a[112:113],v121 offset:0
 ds_read_b64_tr_b16 a[114:115],v121 offset:4096
 v_mfma_f32_16x16x32_bf16 v[0:3],a[84:87],a[4:7],v[0:3]
 v_exp_f32 v35,v35
 v_mfma_f32_16x16x32_bf16 v[4:7],a[100:103],a[4:7],v[4:7]
 v_cvt_pk_bf16_f32 v57,v34,v35
 v_mfma_f32_16x16x32_bf16 v[0:3],a[88:91],a[8:11],v[0:3]
 v_exp_f32 v36,v36
 v_mfma_f32_16x16x32_bf16 v[4:7],a[104:107],a[8:11],v[4:7]
 ds_read_b64_tr_b16 a[116:117],v122 offset:0
 ds_read_b64_tr_b16 a[118:119],v122 offset:4096
 s_add_u32 m0,s34,0x24000
 v_mfma_f32_16x16x32_bf16 v[0:3],a[92:95],a[12:15],v[0:3]
 v_exp_f32 v37,v37
 s_xor_b32 s33,s57,0x20000
 v_mfma_f32_16x16x32_bf16 v[4:7],a[108:111],a[12:15],v[4:7]
 v_cvt_pk_bf16_f32 v58,v36,v37
 s_waitcnt vmcnt(4)
 buffer_load_dwordx4 v133,s[20:23],s33 offen offset:0 nt lds
 v_mfma_f32_16x16x32_bf16 v[8:11],a[80:83],a[16:19],v[84:87]
 v_exp_f32 v38,v38
 v_mfma_f32_16x16x32_bf16 v[12:15],a[96:99],a[16:19],v[84:87]
 ds_read_b64_tr_b16 a[120:121],v123 offset:0
 ds_read_b64_tr_b16 a[122:123],v123 offset:4096
 v_mfma_f32_16x16x32_bf16 v[8:11],a[84:87],a[20:23],v[8:11]
 v_exp_f32 v39,v39
 v_mfma_f32_16x16x32_bf16 v[12:15],a[100:103],a[20:23],v[12:15]
 v_cvt_pk_bf16_f32 v59,v38,v39
 v_mfma_f32_16x16x32_bf16 v[8:11],a[88:91],a[24:27],v[8:11]
 v_exp_f32 v0,v0
 v_mfma_f32_16x16x32_bf16 v[12:15],a[104:107],a[24:27],v[12:15]
 ds_read_b64_tr_b16 a[124:125],v124 offset:0
 ds_read_b64_tr_b16 a[126:127],v124 offset:4096
 v_mfma_f32_16x16x32_bf16 v[8:11],a[92:95],a[28:31],v[8:11]
 v_exp_f32 v1,v1
 v_mfma_f32_16x16x32_bf16 v[12:15],a[108:111],a[28:31],v[12:15]
 v_cvt_pk_bf16_f32 v60,v0,v1
 s_waitcnt vmcnt(4)
 buffer_load_dwordx4 v134,s[20:23],s33 offen offset:1024 nt lds
 v_mfma_f32_16x16x32_bf16 v[16:19],a[80:83],a[32:35],v[88:91]
 v_exp_f32 v2,v2
 v_mfma_f32_16x16x32_bf16 v[20:23],a[96:99],a[32:35],v[88:91]
 ds_read_b64_tr_b16 a[128:129],v125 offset:0
 ds_read_b64_tr_b16 a[130:131],v125 offset:4096
 v_mfma_f32_16x16x32_bf16 v[16:19],a[84:87],a[36:39],v[16:19]
 v_exp_f32 v3,v3
 v_mfma_f32_16x16x32_bf16 v[20:23],a[100:103],a[36:39],v[20:23]
 v_cvt_pk_bf16_f32 v61,v2,v3
 v_mfma_f32_16x16x32_bf16 v[16:19],a[88:91],a[40:43],v[16:19]
 v_exp_f32 v4,v4
 v_mfma_f32_16x16x32_bf16 v[20:23],a[104:107],a[40:43],v[20:23]
 ds_read_b64_tr_b16 a[132:133],v126 offset:0
 ds_read_b64_tr_b16 a[134:135],v126 offset:4096
 v_mfma_f32_16x16x32_bf16 v[16:19],a[92:95],a[44:47],v[16:19]
 v_exp_f32 v5,v5
 v_mfma_f32_16x16x32_bf16 v[20:23],a[108:111],a[44:47],v[20:23]
 v_cvt_pk_bf16_f32 v62,v4,v5
 s_waitcnt vmcnt(4)
 buffer_load_dwordx4 v133,s[20:23],s33 offen offset:2048 nt lds
 v_mfma_f32_16x16x32_bf16 v[24:27],a[80:83],a[48:51],v[92:95]
 v_exp_f32 v6,v6
 v_mfma_f32_16x16x32_bf16 v[28:31],a[96:99],a[48:51],v[92:95]
 ds_read_b64_tr_b16 a[136:137],v127 offset:0
 ds_read_b64_tr_b16 a[138:139],v127 offset:4096
 v_mfma_f32_16x16x32_bf16 v[24:27],a[84:87],a[52:55],v[24:27]
 v_exp_f32 v7,v7
 v_mfma_f32_16x16x32_bf16 v[28:31],a[100:103],a[52:55],v[28:31]
 v_cvt_pk_bf16_f32 v63,v6,v7
 v_mfma_f32_16x16x32_bf16 v[24:27],a[88:91],a[56:59],v[24:27]
 v_exp_f32 v8,v8
 v_mfma_f32_16x16x32_bf16 v[28:31],a[104:107],a[56:59],v[28:31]
 ds_read_b64_tr_b16 a[140:141],v128 offset:0
 ds_read_b64_tr_b16 a[142:143],v128 offset:4096
 v_mfma_f32_16x16x32_bf16 v[24:27],a[92:95],a[60:63],v[24:27]
 v_exp_f32 v9,v9
 v_mfma_f32_16x16x32_bf16 v[28:31],a[108:111],a[60:63],v[28:31]
 v_cvt_pk_bf16_f32 v64,v8,v9
 s_waitcnt vmcnt(4)
 buffer_load_dwordx4 v134,s[20:23],s33 offen offset:3072 nt lds
 v_mfma_f32_16x16x32_bf16 v[32:35],a[80:83],a[64:67],v[96:99]
 v_exp_f32 v10,v10
 v_mfma_f32_16x16x32_bf16 v[36:39],a[96:99],a[64:67],v[96:99]
 v_mfma_f32_16x16x32_bf16 v[32:35],a[84:87],a[68:71],v[32:35]
 v_exp_f32 v11,v11
 v_mfma_f32_16x16x32_bf16 v[36:39],a[100:103],a[68:71],v[36:39]
 v_cvt_pk_bf16_f32 v65,v10,v11
 v_mfma_f32_16x16x32_bf16 v[32:35],a[88:91],a[72:75],v[32:35]
 v_exp_f32 v12,v12
 v_mfma_f32_16x16x32_bf16 v[36:39],a[104:107],a[72:75],v[36:39]
 v_mfma_f32_16x16x32_bf16 v[32:35],a[92:95],a[76:79],v[32:35]
 v_exp_f32 v13,v13
 v_mfma_f32_16x16x32_bf16 v[36:39],a[108:111],a[76:79],v[36:39]
 v_cvt_pk_bf16_f32 v66,v12,v13
 s_waitcnt lgkmcnt(0)
 v_mfma_f32_16x16x32_bf16 v[144:147],a[112:115],v[40:43],v[144:147]
 s_barrier
 v_exp_f32 v14,v14
 v_mfma_f32_16x16x32_bf16 v[148:151],a[116:119],v[40:43],v[148:151]
 v_mfma_f32_16x16x32_bf16 v[152:155],a[120:123],v[40:43],v[152:155]
 v_exp_f32 v15,v15
 v_mfma_f32_16x16x32_bf16 v[156:159],a[124:127],v[40:43],v[156:159]
 v_cvt_pk_bf16_f32 v67,v14,v15
 s_add_u32 m0,s34,0x8000
 v_mfma_f32_16x16x32_bf16 v[160:163],a[128:131],v[40:43],v[160:163]
 v_exp_f32 v16,v16
 s_xor_b32 s32,s57,0x22000
 v_mfma_f32_16x16x32_bf16 v[164:167],a[132:135],v[40:43],v[164:167]
 ds_read_b128 a[80:83],v109 offset:0
 s_waitcnt vmcnt(4)
 buffer_load_dwordx4 v129,s[16:19],s32 offen offset:0 nt lds
 v_mfma_f32_16x16x32_bf16 v[168:171],a[136:139],v[40:43],v[168:171]
 v_exp_f32 v17,v17
 v_mfma_f32_16x16x32_bf16 v[172:175],a[140:143],v[40:43],v[172:175]
 v_cvt_pk_bf16_f32 v68,v16,v17
 v_mfma_f32_16x16x32_bf16 a[192:195],a[212:215],v[40:43],a[192:195]
 ds_read_b128 a[96:99],v109 offset:4096
 v_mfma_f32_16x16x32_bf16 v[176:179],a[112:115],v[44:47],v[176:179]
 v_exp_f32 v18,v18
 v_mfma_f32_16x16x32_bf16 v[180:183],a[116:119],v[44:47],v[180:183]
 ds_read_b128 a[84:87],v110 offset:0
 v_mfma_f32_16x16x32_bf16 v[184:187],a[120:123],v[44:47],v[184:187]
 v_exp_f32 v19,v19
 v_mfma_f32_16x16x32_bf16 v[188:191],a[124:127],v[44:47],v[188:191]
 v_cvt_pk_bf16_f32 v69,v18,v19
 v_mfma_f32_16x16x32_bf16 v[192:195],a[128:131],v[44:47],v[192:195]
 v_exp_f32 v20,v20
 v_mfma_f32_16x16x32_bf16 v[196:199],a[132:135],v[44:47],v[196:199]
 v_mfma_f32_16x16x32_bf16 v[200:203],a[136:139],v[44:47],v[200:203]
 v_exp_f32 v21,v21
 v_mfma_f32_16x16x32_bf16 v[204:207],a[140:143],v[44:47],v[204:207]
 v_cvt_pk_bf16_f32 v70,v20,v21
 v_mfma_f32_16x16x32_bf16 a[196:199],a[212:215],v[44:47],a[196:199]
 ds_read_b128 a[100:103],v110 offset:4096
 s_waitcnt vmcnt(4)
 buffer_load_dwordx4 v130,s[16:19],s32 offen offset:1024 nt lds
 v_mfma_f32_16x16x32_bf16 v[208:211],a[112:115],v[48:51],v[208:211]
 v_exp_f32 v22,v22
 v_mfma_f32_16x16x32_bf16 v[212:215],a[116:119],v[48:51],v[212:215]
 ds_read_b128 a[88:91],v111 offset:0
 v_mfma_f32_16x16x32_bf16 v[216:219],a[120:123],v[48:51],v[216:219]
 v_exp_f32 v23,v23
 v_mfma_f32_16x16x32_bf16 v[220:223],a[124:127],v[48:51],v[220:223]
 v_cvt_pk_bf16_f32 v71,v22,v23
 v_mfma_f32_16x16x32_bf16 v[224:227],a[128:131],v[48:51],v[224:227]
 v_exp_f32 v24,v24
 v_mfma_f32_16x16x32_bf16 v[228:231],a[132:135],v[48:51],v[228:231]
 ds_read_b128 a[104:107],v111 offset:4096
 v_mfma_f32_16x16x32_bf16 v[232:235],a[136:139],v[48:51],v[232:235]
 v_exp_f32 v25,v25
 v_mfma_f32_16x16x32_bf16 v[236:239],a[140:143],v[48:51],v[236:239]
 v_cvt_pk_bf16_f32 v72,v24,v25
 v_mfma_f32_16x16x32_bf16 a[200:203],a[212:215],v[48:51],a[200:203]
 v_mfma_f32_16x16x32_bf16 v[240:243],a[112:115],v[52:55],v[240:243]
 v_exp_f32 v26,v26
 v_mfma_f32_16x16x32_bf16 v[244:247],a[116:119],v[52:55],v[244:247]
 ds_read_b128 a[92:95],v112 offset:0
 v_mfma_f32_16x16x32_bf16 v[248:251],a[120:123],v[52:55],v[248:251]
 v_exp_f32 v27,v27
 v_mfma_f32_16x16x32_bf16 v[252:255],a[124:127],v[52:55],v[252:255]
 v_cvt_pk_bf16_f32 v73,v26,v27
 v_mfma_f32_16x16x32_bf16 a[144:147],a[128:131],v[52:55],a[144:147]
 v_exp_f32 v28,v28
 v_mfma_f32_16x16x32_bf16 a[148:151],a[132:135],v[52:55],a[148:151]
 ds_read_b128 a[108:111],v112 offset:4096
 s_waitcnt vmcnt(4)
 buffer_load_dwordx4 v131,s[16:19],s32 offen offset:2048 nt lds
 v_mfma_f32_16x16x32_bf16 a[152:155],a[136:139],v[52:55],a[152:155]
 v_exp_f32 v29,v29
 v_mfma_f32_16x16x32_bf16 a[156:159],a[140:143],v[52:55],a[156:159]
 v_cvt_pk_bf16_f32 v74,v28,v29
 v_mfma_f32_16x16x32_bf16 a[204:207],a[212:215],v[52:55],a[204:207]
 v_mfma_f32_16x16x32_bf16 a[160:163],a[112:115],v[56:59],a[160:163]
 v_exp_f32 v30,v30
 v_mfma_f32_16x16x32_bf16 a[164:167],a[116:119],v[56:59],a[164:167]
 v_mfma_f32_16x16x32_bf16 a[168:171],a[120:123],v[56:59],a[168:171]
 v_exp_f32 v31,v31
 v_mfma_f32_16x16x32_bf16 a[172:175],a[124:127],v[56:59],a[172:175]
 v_cvt_pk_bf16_f32 v75,v30,v31
 v_mfma_f32_16x16x32_bf16 a[176:179],a[128:131],v[56:59],a[176:179]
 v_exp_f32 v32,v32
 v_mfma_f32_16x16x32_bf16 a[180:183],a[132:135],v[56:59],a[180:183]
 v_mfma_f32_16x16x32_bf16 a[184:187],a[136:139],v[56:59],a[184:187]
 v_exp_f32 v33,v33
 v_mfma_f32_16x16x32_bf16 a[188:191],a[140:143],v[56:59],a[188:191]
 v_cvt_pk_bf16_f32 v76,v32,v33
 v_mfma_f32_16x16x32_bf16 a[208:211],a[212:215],v[56:59],a[208:211]
 s_waitcnt lgkmcnt(0)
 v_mfma_f32_16x16x32_bf16 v[0:3],a[80:83],a[0:3],v[80:83]
 v_exp_f32 v34,v34
 v_mfma_f32_16x16x32_bf16 v[4:7],a[96:99],a[0:3],v[80:83]
 ds_read_b64_tr_b16 a[112:113],v113 offset:0
 ds_read_b64_tr_b16 a[114:115],v113 offset:4096
 v_mfma_f32_16x16x32_bf16 v[0:3],a[84:87],a[4:7],v[0:3]
 v_exp_f32 v35,v35
 v_mfma_f32_16x16x32_bf16 v[4:7],a[100:103],a[4:7],v[4:7]
 v_cvt_pk_bf16_f32 v77,v34,v35
 v_mfma_f32_16x16x32_bf16 v[0:3],a[88:91],a[8:11],v[0:3]
 v_exp_f32 v36,v36
 v_mfma_f32_16x16x32_bf16 v[4:7],a[104:107],a[8:11],v[4:7]
 ds_read_b64_tr_b16 a[116:117],v114 offset:0
 ds_read_b64_tr_b16 a[118:119],v114 offset:4096
 v_mfma_f32_16x16x32_bf16 v[0:3],a[92:95],a[12:15],v[0:3]
 v_exp_f32 v37,v37
 v_mfma_f32_16x16x32_bf16 v[4:7],a[108:111],a[12:15],v[4:7]
 v_cvt_pk_bf16_f32 v78,v36,v37
 s_waitcnt vmcnt(4)
 buffer_load_dwordx4 v132,s[16:19],s32 offen offset:3072 nt lds
 v_mfma_f32_16x16x32_bf16 v[8:11],a[80:83],a[16:19],v[84:87]
 v_exp_f32 v38,v38
 v_mfma_f32_16x16x32_bf16 v[12:15],a[96:99],a[16:19],v[84:87]
 ds_read_b64_tr_b16 a[120:121],v115 offset:0
 ds_read_b64_tr_b16 a[122:123],v115 offset:4096
 v_mfma_f32_16x16x32_bf16 v[8:11],a[84:87],a[20:23],v[8:11]
 v_exp_f32 v39,v39
 v_mfma_f32_16x16x32_bf16 v[12:15],a[100:103],a[20:23],v[12:15]
 v_cvt_pk_bf16_f32 v79,v38,v39
 v_mfma_f32_16x16x32_bf16 v[8:11],a[88:91],a[24:27],v[8:11]
 v_exp_f32 v0,v0
 v_mfma_f32_16x16x32_bf16 v[12:15],a[104:107],a[24:27],v[12:15]
 ds_read_b64_tr_b16 a[124:125],v116 offset:0
 ds_read_b64_tr_b16 a[126:127],v116 offset:4096
 s_add_u32 m0,s34,0x14000
 v_mfma_f32_16x16x32_bf16 v[8:11],a[92:95],a[28:31],v[8:11]
 v_exp_f32 v1,v1
 s_xor_b32 s33,s57,0x22000
 v_mfma_f32_16x16x32_bf16 v[12:15],a[108:111],a[28:31],v[12:15]
 v_cvt_pk_bf16_f32 v40,v0,v1
 s_waitcnt vmcnt(4)
 buffer_load_dwordx4 v133,s[20:23],s33 offen offset:0 nt lds
 v_mfma_f32_16x16x32_bf16 v[16:19],a[80:83],a[32:35],v[88:91]
 v_exp_f32 v2,v2
 v_mfma_f32_16x16x32_bf16 v[20:23],a[96:99],a[32:35],v[88:91]
 ds_read_b64_tr_b16 a[128:129],v117 offset:0
 ds_read_b64_tr_b16 a[130:131],v117 offset:4096
 v_mfma_f32_16x16x32_bf16 v[16:19],a[84:87],a[36:39],v[16:19]
 v_exp_f32 v3,v3
 v_mfma_f32_16x16x32_bf16 v[20:23],a[100:103],a[36:39],v[20:23]
 v_cvt_pk_bf16_f32 v41,v2,v3
 v_mfma_f32_16x16x32_bf16 v[16:19],a[88:91],a[40:43],v[16:19]
 v_exp_f32 v4,v4
 v_mfma_f32_16x16x32_bf16 v[20:23],a[104:107],a[40:43],v[20:23]
 ds_read_b64_tr_b16 a[132:133],v118 offset:0
 ds_read_b64_tr_b16 a[134:135],v118 offset:4096
 v_mfma_f32_16x16x32_bf16 v[16:19],a[92:95],a[44:47],v[16:19]
 v_exp_f32 v5,v5
 v_mfma_f32_16x16x32_bf16 v[20:23],a[108:111],a[44:47],v[20:23]
 v_cvt_pk_bf16_f32 v42,v4,v5
 s_waitcnt vmcnt(4)
 buffer_load_dwordx4 v134,s[20:23],s33 offen offset:1024 nt lds
 v_mfma_f32_16x16x32_bf16 v[24:27],a[80:83],a[48:51],v[92:95]
 v_exp_f32 v6,v6
 v_mfma_f32_16x16x32_bf16 v[28:31],a[96:99],a[48:51],v[92:95]
 ds_read_b64_tr_b16 a[136:137],v119 offset:0
 ds_read_b64_tr_b16 a[138:139],v119 offset:4096
 v_mfma_f32_16x16x32_bf16 v[24:27],a[84:87],a[52:55],v[24:27]
 v_exp_f32 v7,v7
 v_mfma_f32_16x16x32_bf16 v[28:31],a[100:103],a[52:55],v[28:31]
 v_cvt_pk_bf16_f32 v43,v6,v7
 v_mfma_f32_16x16x32_bf16 v[24:27],a[88:91],a[56:59],v[24:27]
 v_exp_f32 v8,v8
 v_mfma_f32_16x16x32_bf16 v[28:31],a[104:107],a[56:59],v[28:31]
 ds_read_b64_tr_b16 a[140:141],v120 offset:0
 ds_read_b64_tr_b16 a[142:143],v120 offset:4096
 v_mfma_f32_16x16x32_bf16 v[24:27],a[92:95],a[60:63],v[24:27]
 v_exp_f32 v9,v9
 v_mfma_f32_16x16x32_bf16 v[28:31],a[108:111],a[60:63],v[28:31]
 v_cvt_pk_bf16_f32 v44,v8,v9
 s_waitcnt vmcnt(4)
 buffer_load_dwordx4 v133,s[20:23],s33 offen offset:2048 nt lds
 v_mfma_f32_16x16x32_bf16 v[32:35],a[80:83],a[64:67],v[96:99]
 v_exp_f32 v10,v10
 v_mfma_f32_16x16x32_bf16 v[36:39],a[96:99],a[64:67],v[96:99]
 v_mfma_f32_16x16x32_bf16 v[32:35],a[84:87],a[68:71],v[32:35]
 v_exp_f32 v11,v11
 v_mfma_f32_16x16x32_bf16 v[36:39],a[100:103],a[68:71],v[36:39]
 v_cvt_pk_bf16_f32 v45,v10,v11
 v_mfma_f32_16x16x32_bf16 v[32:35],a[88:91],a[72:75],v[32:35]
 v_exp_f32 v12,v12
 v_mfma_f32_16x16x32_bf16 v[36:39],a[104:107],a[72:75],v[36:39]
 v_mfma_f32_16x16x32_bf16 v[32:35],a[92:95],a[76:79],v[32:35]
 v_exp_f32 v13,v13
 v_mfma_f32_16x16x32_bf16 v[36:39],a[108:111],a[76:79],v[36:39]
 v_cvt_pk_bf16_f32 v46,v12,v13
 s_waitcnt lgkmcnt(0)
 v_mfma_f32_16x16x32_bf16 v[144:147],a[112:115],v[60:63],v[144:147]
 s_barrier
 v_exp_f32 v14,v14
 v_mfma_f32_16x16x32_bf16 v[148:151],a[116:119],v[60:63],v[148:151]
 v_mfma_f32_16x16x32_bf16 v[152:155],a[120:123],v[60:63],v[152:155]
 v_exp_f32 v15,v15
 v_mfma_f32_16x16x32_bf16 v[156:159],a[124:127],v[60:63],v[156:159]
 v_cvt_pk_bf16_f32 v47,v14,v15
 v_mfma_f32_16x16x32_bf16 v[160:163],a[128:131],v[60:63],v[160:163]
 v_exp_f32 v16,v16
 v_mfma_f32_16x16x32_bf16 v[164:167],a[132:135],v[60:63],v[164:167]
 ds_read_b128 a[80:83],v105 offset:0
 s_waitcnt vmcnt(4)
 buffer_load_dwordx4 v134,s[20:23],s33 offen offset:3072 nt lds
 v_mfma_f32_16x16x32_bf16 v[168:171],a[136:139],v[60:63],v[168:171]
 v_exp_f32 v17,v17
 v_mfma_f32_16x16x32_bf16 v[172:175],a[140:143],v[60:63],v[172:175]
 v_cvt_pk_bf16_f32 v48,v16,v17
 v_mfma_f32_16x16x32_bf16 a[192:195],a[212:215],v[60:63],a[192:195]
 ds_read_b128 a[96:99],v105 offset:4096
 v_mfma_f32_16x16x32_bf16 v[176:179],a[112:115],v[64:67],v[176:179]
 v_exp_f32 v18,v18
 v_mfma_f32_16x16x32_bf16 v[180:183],a[116:119],v[64:67],v[180:183]
 ds_read_b128 a[84:87],v106 offset:0
 v_mfma_f32_16x16x32_bf16 v[184:187],a[120:123],v[64:67],v[184:187]
 v_exp_f32 v19,v19
 v_mfma_f32_16x16x32_bf16 v[188:191],a[124:127],v[64:67],v[188:191]
 v_cvt_pk_bf16_f32 v49,v18,v19
 s_add_u32 m0,s34,0xc000
 v_mfma_f32_16x16x32_bf16 v[192:195],a[128:131],v[64:67],v[192:195]
 v_exp_f32 v20,v20
 s_xor_b32 s32,s57,0x24000
 v_mfma_f32_16x16x32_bf16 v[196:199],a[132:135],v[64:67],v[196:199]
 s_waitcnt vmcnt(3)
 buffer_load_dwordx4 v129,s[16:19],s32 offen offset:0 nt lds
 v_mfma_f32_16x16x32_bf16 v[200:203],a[136:139],v[64:67],v[200:203]
 v_exp_f32 v21,v21
 v_mfma_f32_16x16x32_bf16 v[204:207],a[140:143],v[64:67],v[204:207]
 v_cvt_pk_bf16_f32 v50,v20,v21
 v_mfma_f32_16x16x32_bf16 a[196:199],a[212:215],v[64:67],a[196:199]
 ds_read_b128 a[100:103],v106 offset:4096
 v_mfma_f32_16x16x32_bf16 v[208:211],a[112:115],v[68:71],v[208:211]
 v_exp_f32 v22,v22
 v_mfma_f32_16x16x32_bf16 v[212:215],a[116:119],v[68:71],v[212:215]
 ds_read_b128 a[88:91],v107 offset:0
 v_mfma_f32_16x16x32_bf16 v[216:219],a[120:123],v[68:71],v[216:219]
 v_exp_f32 v23,v23
 v_mfma_f32_16x16x32_bf16 v[220:223],a[124:127],v[68:71],v[220:223]
 v_cvt_pk_bf16_f32 v51,v22,v23
 v_mfma_f32_16x16x32_bf16 v[224:227],a[128:131],v[68:71],v[224:227]
 v_exp_f32 v24,v24
 v_mfma_f32_16x16x32_bf16 v[228:231],a[132:135],v[68:71],v[228:231]
 ds_read_b128 a[104:107],v107 offset:4096
 v_mfma_f32_16x16x32_bf16 v[232:235],a[136:139],v[68:71],v[232:235]
 v_exp_f32 v25,v25
 v_mfma_f32_16x16x32_bf16 v[236:239],a[140:143],v[68:71],v[236:239]
 v_cvt_pk_bf16_f32 v52,v24,v25
 s_waitcnt vmcnt(4)
 buffer_load_dwordx4 v130,s[16:19],s32 offen offset:1024 nt lds
 v_mfma_f32_16x16x32_bf16 a[200:203],a[212:215],v[68:71],a[200:203]
 v_mfma_f32_16x16x32_bf16 v[240:243],a[112:115],v[72:75],v[240:243]
 v_exp_f32 v26,v26
 v_mfma_f32_16x16x32_bf16 v[244:247],a[116:119],v[72:75],v[244:247]
 ds_read_b128 a[92:95],v108 offset:0
 v_mfma_f32_16x16x32_bf16 v[248:251],a[120:123],v[72:75],v[248:251]
 v_exp_f32 v27,v27
 v_mfma_f32_16x16x32_bf16 v[252:255],a[124:127],v[72:75],v[252:255]
 v_cvt_pk_bf16_f32 v53,v26,v27
 v_mfma_f32_16x16x32_bf16 a[144:147],a[128:131],v[72:75],a[144:147]
 v_exp_f32 v28,v28
 v_mfma_f32_16x16x32_bf16 a[148:151],a[132:135],v[72:75],a[148:151]
 ds_read_b128 a[108:111],v108 offset:4096
 v_mfma_f32_16x16x32_bf16 a[152:155],a[136:139],v[72:75],a[152:155]
 v_exp_f32 v29,v29
 v_mfma_f32_16x16x32_bf16 a[156:159],a[140:143],v[72:75],a[156:159]
 v_cvt_pk_bf16_f32 v54,v28,v29
 s_waitcnt vmcnt(4)
 buffer_load_dwordx4 v131,s[16:19],s32 offen offset:2048 nt lds
 v_mfma_f32_16x16x32_bf16 a[204:207],a[212:215],v[72:75],a[204:207]
 v_mfma_f32_16x16x32_bf16 a[160:163],a[112:115],v[76:79],a[160:163]
 v_exp_f32 v30,v30
 v_mfma_f32_16x16x32_bf16 a[164:167],a[116:119],v[76:79],a[164:167]
 v_mfma_f32_16x16x32_bf16 a[168:171],a[120:123],v[76:79],a[168:171]
 v_exp_f32 v31,v31
 v_mfma_f32_16x16x32_bf16 a[172:175],a[124:127],v[76:79],a[172:175]
 v_cvt_pk_bf16_f32 v55,v30,v31
 v_mfma_f32_16x16x32_bf16 a[176:179],a[128:131],v[76:79],a[176:179]
 v_exp_f32 v32,v32
 v_mfma_f32_16x16x32_bf16 a[180:183],a[132:135],v[76:79],a[180:183]
 v_mfma_f32_16x16x32_bf16 a[184:187],a[136:139],v[76:79],a[184:187]
 v_exp_f32 v33,v33
 v_mfma_f32_16x16x32_bf16 a[188:191],a[140:143],v[76:79],a[188:191]
 v_cvt_pk_bf16_f32 v56,v32,v33
 v_mfma_f32_16x16x32_bf16 a[208:211],a[212:215],v[76:79],a[208:211]
 s_waitcnt lgkmcnt(0)
 v_mfma_f32_16x16x32_bf16 v[0:3],a[80:83],a[0:3],v[80:83]
 v_exp_f32 v34,v34
 v_mfma_f32_16x16x32_bf16 v[4:7],a[96:99],a[0:3],v[80:83]
 ds_read_b64_tr_b16 a[112:113],v113 offset:16384
 ds_read_b64_tr_b16 a[114:115],v113 offset:20480
 v_mfma_f32_16x16x32_bf16 v[0:3],a[84:87],a[4:7],v[0:3]
 v_exp_f32 v35,v35
 v_mfma_f32_16x16x32_bf16 v[4:7],a[100:103],a[4:7],v[4:7]
 v_cvt_pk_bf16_f32 v57,v34,v35
 v_mfma_f32_16x16x32_bf16 v[0:3],a[88:91],a[8:11],v[0:3]
 v_exp_f32 v36,v36
 v_mfma_f32_16x16x32_bf16 v[4:7],a[104:107],a[8:11],v[4:7]
 ds_read_b64_tr_b16 a[116:117],v114 offset:16384
 ds_read_b64_tr_b16 a[118:119],v114 offset:20480
 v_mfma_f32_16x16x32_bf16 v[0:3],a[92:95],a[12:15],v[0:3]
 v_exp_f32 v37,v37
 v_mfma_f32_16x16x32_bf16 v[4:7],a[108:111],a[12:15],v[4:7]
 v_cvt_pk_bf16_f32 v58,v36,v37
 s_waitcnt vmcnt(4)
 buffer_load_dwordx4 v132,s[16:19],s32 offen offset:3072 nt lds
 v_mfma_f32_16x16x32_bf16 v[8:11],a[80:83],a[16:19],v[84:87]
 v_exp_f32 v38,v38
 v_mfma_f32_16x16x32_bf16 v[12:15],a[96:99],a[16:19],v[84:87]
 ds_read_b64_tr_b16 a[120:121],v115 offset:16384
 ds_read_b64_tr_b16 a[122:123],v115 offset:20480
 v_mfma_f32_16x16x32_bf16 v[8:11],a[84:87],a[20:23],v[8:11]
 v_exp_f32 v39,v39
 v_mfma_f32_16x16x32_bf16 v[12:15],a[100:103],a[20:23],v[12:15]
 v_cvt_pk_bf16_f32 v59,v38,v39
 v_mfma_f32_16x16x32_bf16 v[8:11],a[88:91],a[24:27],v[8:11]
 v_exp_f32 v0,v0
 v_mfma_f32_16x16x32_bf16 v[12:15],a[104:107],a[24:27],v[12:15]
 ds_read_b64_tr_b16 a[124:125],v116 offset:16384
 ds_read_b64_tr_b16 a[126:127],v116 offset:20480
 v_mfma_f32_16x16x32_bf16 v[8:11],a[92:95],a[28:31],v[8:11]
 v_exp_f32 v1,v1
 v_mfma_f32_16x16x32_bf16 v[12:15],a[108:111],a[28:31],v[12:15]
 v_cvt_pk_bf16_f32 v60,v0,v1
 v_mfma_f32_16x16x32_bf16 v[16:19],a[80:83],a[32:35],v[88:91]
 v_exp_f32 v2,v2
 v_mfma_f32_16x16x32_bf16 v[20:23],a[96:99],a[32:35],v[88:91]
 ds_read_b64_tr_b16 a[128:129],v117 offset:16384
 ds_read_b64_tr_b16 a[130:131],v117 offset:20480
 s_add_u32 m0,s34,0x18000
 v_mfma_f32_16x16x32_bf16 v[16:19],a[84:87],a[36:39],v[16:19]
 v_exp_f32 v3,v3
 s_xor_b32 s33,s57,0x24000
 v_mfma_f32_16x16x32_bf16 v[20:23],a[100:103],a[36:39],v[20:23]
 v_cvt_pk_bf16_f32 v61,v2,v3
 s_waitcnt vmcnt(3)
 buffer_load_dwordx4 v133,s[20:23],s33 offen offset:0 nt lds
 v_mfma_f32_16x16x32_bf16 v[16:19],a[88:91],a[40:43],v[16:19]
 v_exp_f32 v4,v4
 v_mfma_f32_16x16x32_bf16 v[20:23],a[104:107],a[40:43],v[20:23]
 ds_read_b64_tr_b16 a[132:133],v118 offset:16384
 ds_read_b64_tr_b16 a[134:135],v118 offset:20480
 v_mfma_f32_16x16x32_bf16 v[16:19],a[92:95],a[44:47],v[16:19]
 v_exp_f32 v5,v5
 v_mfma_f32_16x16x32_bf16 v[20:23],a[108:111],a[44:47],v[20:23]
 v_cvt_pk_bf16_f32 v62,v4,v5
 v_mfma_f32_16x16x32_bf16 v[24:27],a[80:83],a[48:51],v[92:95]
 v_exp_f32 v6,v6
 v_mfma_f32_16x16x32_bf16 v[28:31],a[96:99],a[48:51],v[92:95]
 ds_read_b64_tr_b16 a[136:137],v119 offset:16384
 ds_read_b64_tr_b16 a[138:139],v119 offset:20480
 v_mfma_f32_16x16x32_bf16 v[24:27],a[84:87],a[52:55],v[24:27]
 v_exp_f32 v7,v7
 v_mfma_f32_16x16x32_bf16 v[28:31],a[100:103],a[52:55],v[28:31]
 v_cvt_pk_bf16_f32 v63,v6,v7
 v_mfma_f32_16x16x32_bf16 v[24:27],a[88:91],a[56:59],v[24:27]
 v_exp_f32 v8,v8
 v_mfma_f32_16x16x32_bf16 v[28:31],a[104:107],a[56:59],v[28:31]
 ds_read_b64_tr_b16 a[140:141],v120 offset:16384
 ds_read_b64_tr_b16 a[142:143],v120 offset:20480
 v_mfma_f32_16x16x32_bf16 v[24:27],a[92:95],a[60:63],v[24:27]
 v_exp_f32 v9,v9
 v_mfma_f32_16x16x32_bf16 v[28:31],a[108:111],a[60:63],v[28:31]
 v_cvt_pk_bf16_f32 v64,v8,v9
 s_waitcnt vmcnt(4)
 buffer_load_dwordx4 v134,s[20:23],s33 offen offset:1024 nt lds
 v_mfma_f32_16x16x32_bf16 v[32:35],a[80:83],a[64:67],v[96:99]
 v_exp_f32 v10,v10
 v_mfma_f32_16x16x32_bf16 v[36:39],a[96:99],a[64:67],v[96:99]
 v_mfma_f32_16x16x32_bf16 v[32:35],a[84:87],a[68:71],v[32:35]
 v_exp_f32 v11,v11
 v_mfma_f32_16x16x32_bf16 v[36:39],a[100:103],a[68:71],v[36:39]
 v_cvt_pk_bf16_f32 v65,v10,v11
 v_mfma_f32_16x16x32_bf16 v[32:35],a[88:91],a[72:75],v[32:35]
 v_exp_f32 v12,v12
 v_mfma_f32_16x16x32_bf16 v[36:39],a[104:107],a[72:75],v[36:39]
 v_mfma_f32_16x16x32_bf16 v[32:35],a[92:95],a[76:79],v[32:35]
 v_exp_f32 v13,v13
 v_mfma_f32_16x16x32_bf16 v[36:39],a[108:111],a[76:79],v[36:39]
 v_cvt_pk_bf16_f32 v66,v12,v13
 s_waitcnt lgkmcnt(0)
 v_mfma_f32_16x16x32_bf16 v[144:147],a[112:115],v[40:43],v[144:147]
 s_barrier
 v_exp_f32 v14,v14
 v_mfma_f32_16x16x32_bf16 v[148:151],a[116:119],v[40:43],v[148:151]
 v_mfma_f32_16x16x32_bf16 v[152:155],a[120:123],v[40:43],v[152:155]
 v_exp_f32 v15,v15
 v_mfma_f32_16x16x32_bf16 v[156:159],a[124:127],v[40:43],v[156:159]
 v_cvt_pk_bf16_f32 v67,v14,v15
 v_mfma_f32_16x16x32_bf16 v[160:163],a[128:131],v[40:43],v[160:163]
 v_exp_f32 v16,v16
 v_mfma_f32_16x16x32_bf16 v[164:167],a[132:135],v[40:43],v[164:167]
 ds_read_b128 a[80:83],v105 offset:16384
 s_waitcnt vmcnt(4)
 buffer_load_dwordx4 v133,s[20:23],s33 offen offset:2048 nt lds
 v_mfma_f32_16x16x32_bf16 v[168:171],a[136:139],v[40:43],v[168:171]
 v_exp_f32 v17,v17
 v_mfma_f32_16x16x32_bf16 v[172:175],a[140:143],v[40:43],v[172:175]
 v_cvt_pk_bf16_f32 v68,v16,v17
 v_mfma_f32_16x16x32_bf16 a[192:195],a[212:215],v[40:43],a[192:195]
 ds_read_b128 a[96:99],v105 offset:20480
 v_mfma_f32_16x16x32_bf16 v[176:179],a[112:115],v[44:47],v[176:179]
 v_exp_f32 v18,v18
 v_mfma_f32_16x16x32_bf16 v[180:183],a[116:119],v[44:47],v[180:183]
 ds_read_b128 a[84:87],v106 offset:16384
 v_mfma_f32_16x16x32_bf16 v[184:187],a[120:123],v[44:47],v[184:187]
 v_exp_f32 v19,v19
 v_mfma_f32_16x16x32_bf16 v[188:191],a[124:127],v[44:47],v[188:191]
 v_cvt_pk_bf16_f32 v69,v18,v19
 v_mfma_f32_16x16x32_bf16 v[192:195],a[128:131],v[44:47],v[192:195]
 v_exp_f32 v20,v20
 v_mfma_f32_16x16x32_bf16 v[196:199],a[132:135],v[44:47],v[196:199]
 s_waitcnt vmcnt(4)
 buffer_load_dwordx4 v134,s[20:23],s33 offen offset:3072 nt lds
 v_mfma_f32_16x16x32_bf16 v[200:203],a[136:139],v[44:47],v[200:203]
 v_exp_f32 v21,v21
 v_mfma_f32_16x16x32_bf16 v[204:207],a[140:143],v[44:47],v[204:207]
 v_cvt_pk_bf16_f32 v70,v20,v21
 v_mfma_f32_16x16x32_bf16 a[196:199],a[212:215],v[44:47],a[196:199]
 ds_read_b128 a[100:103],v106 offset:20480
 v_mfma_f32_16x16x32_bf16 v[208:211],a[112:115],v[48:51],v[208:211]
 v_exp_f32 v22,v22
 v_mfma_f32_16x16x32_bf16 v[212:215],a[116:119],v[48:51],v[212:215]
 ds_read_b128 a[88:91],v107 offset:16384
 v_mfma_f32_16x16x32_bf16 v[216:219],a[120:123],v[48:51],v[216:219]
 v_exp_f32 v23,v23
 v_mfma_f32_16x16x32_bf16 v[220:223],a[124:127],v[48:51],v[220:223]
 v_cvt_pk_bf16_f32 v71,v22,v23
 v_mfma_f32_16x16x32_bf16 v[224:227],a[128:131],v[48:51],v[224:227]
 v_exp_f32 v24,v24
 v_mfma_f32_16x16x32_bf16 v[228:231],a[132:135],v[48:51],v[228:231]
 ds_read_b128 a[104:107],v107 offset:20480
 s_add_u32 m0,s34,0x10000
 v_mfma_f32_16x16x32_bf16 v[232:235],a[136:139],v[48:51],v[232:235]
 v_exp_f32 v25,v25
 s_xor_b32 s32,s57,0x26000
 v_mfma_f32_16x16x32_bf16 v[236:239],a[140:143],v[48:51],v[236:239]
 v_cvt_pk_bf16_f32 v72,v24,v25
 s_waitcnt vmcnt(4)
 buffer_load_dwordx4 v129,s[16:19],s32 offen offset:0 nt lds
 v_mfma_f32_16x16x32_bf16 a[200:203],a[212:215],v[48:51],a[200:203]
 v_mfma_f32_16x16x32_bf16 v[240:243],a[112:115],v[52:55],v[240:243]
 v_exp_f32 v26,v26
 v_mfma_f32_16x16x32_bf16 v[244:247],a[116:119],v[52:55],v[244:247]
 ds_read_b128 a[92:95],v108 offset:16384
 v_mfma_f32_16x16x32_bf16 v[248:251],a[120:123],v[52:55],v[248:251]
 v_exp_f32 v27,v27
 v_mfma_f32_16x16x32_bf16 v[252:255],a[124:127],v[52:55],v[252:255]
 v_cvt_pk_bf16_f32 v73,v26,v27
 v_mfma_f32_16x16x32_bf16 a[144:147],a[128:131],v[52:55],a[144:147]
 v_exp_f32 v28,v28
 v_mfma_f32_16x16x32_bf16 a[148:151],a[132:135],v[52:55],a[148:151]
 ds_read_b128 a[108:111],v108 offset:20480
 v_mfma_f32_16x16x32_bf16 a[152:155],a[136:139],v[52:55],a[152:155]
 v_exp_f32 v29,v29
 v_mfma_f32_16x16x32_bf16 a[156:159],a[140:143],v[52:55],a[156:159]
 v_cvt_pk_bf16_f32 v74,v28,v29
 s_waitcnt vmcnt(4)
 buffer_load_dwordx4 v130,s[16:19],s32 offen offset:1024 nt lds
 v_mfma_f32_16x16x32_bf16 a[204:207],a[212:215],v[52:55],a[204:207]
 v_mfma_f32_16x16x32_bf16 a[160:163],a[112:115],v[56:59],a[160:163]
 v_exp_f32 v30,v30
 v_mfma_f32_16x16x32_bf16 a[164:167],a[116:119],v[56:59],a[164:167]
 v_mfma_f32_16x16x32_bf16 a[168:171],a[120:123],v[56:59],a[168:171]
 v_exp_f32 v31,v31
 v_mfma_f32_16x16x32_bf16 a[172:175],a[124:127],v[56:59],a[172:175]
 v_cvt_pk_bf16_f32 v75,v30,v31
 v_mfma_f32_16x16x32_bf16 a[176:179],a[128:131],v[56:59],a[176:179]
 v_exp_f32 v32,v32
 v_mfma_f32_16x16x32_bf16 a[180:183],a[132:135],v[56:59],a[180:183]
 v_mfma_f32_16x16x32_bf16 a[184:187],a[136:139],v[56:59],a[184:187]
 v_exp_f32 v33,v33
 v_mfma_f32_16x16x32_bf16 a[188:191],a[140:143],v[56:59],a[188:191]
 v_cvt_pk_bf16_f32 v76,v32,v33
 v_mfma_f32_16x16x32_bf16 a[208:211],a[212:215],v[56:59],a[208:211]
 s_waitcnt lgkmcnt(0)
 v_mfma_f32_16x16x32_bf16 v[0:3],a[80:83],a[0:3],v[80:83]
 v_exp_f32 v34,v34
 v_mfma_f32_16x16x32_bf16 v[4:7],a[96:99],a[0:3],v[80:83]
 ds_read_b64_tr_b16 a[112:113],v113 offset:32768
 ds_read_b64_tr_b16 a[114:115],v113 offset:36864
 v_mfma_f32_16x16x32_bf16 v[0:3],a[84:87],a[4:7],v[0:3]
 v_exp_f32 v35,v35
 v_mfma_f32_16x16x32_bf16 v[4:7],a[100:103],a[4:7],v[4:7]
 v_cvt_pk_bf16_f32 v77,v34,v35
 v_mfma_f32_16x16x32_bf16 v[0:3],a[88:91],a[8:11],v[0:3]
 v_exp_f32 v36,v36
 v_mfma_f32_16x16x32_bf16 v[4:7],a[104:107],a[8:11],v[4:7]
 ds_read_b64_tr_b16 a[116:117],v114 offset:32768
 ds_read_b64_tr_b16 a[118:119],v114 offset:36864
 v_mfma_f32_16x16x32_bf16 v[0:3],a[92:95],a[12:15],v[0:3]
 v_exp_f32 v37,v37
 v_mfma_f32_16x16x32_bf16 v[4:7],a[108:111],a[12:15],v[4:7]
 v_cvt_pk_bf16_f32 v78,v36,v37
 s_waitcnt vmcnt(4)
 buffer_load_dwordx4 v131,s[16:19],s32 offen offset:2048 nt lds
 v_mfma_f32_16x16x32_bf16 v[8:11],a[80:83],a[16:19],v[84:87]
 v_exp_f32 v38,v38
 v_mfma_f32_16x16x32_bf16 v[12:15],a[96:99],a[16:19],v[84:87]
 ds_read_b64_tr_b16 a[120:121],v115 offset:32768
 ds_read_b64_tr_b16 a[122:123],v115 offset:36864
 v_mfma_f32_16x16x32_bf16 v[8:11],a[84:87],a[20:23],v[8:11]
 v_exp_f32 v39,v39
 v_mfma_f32_16x16x32_bf16 v[12:15],a[100:103],a[20:23],v[12:15]
 v_cvt_pk_bf16_f32 v79,v38,v39
 v_mfma_f32_16x16x32_bf16 v[8:11],a[88:91],a[24:27],v[8:11]
 v_exp_f32 v0,v0
 v_mfma_f32_16x16x32_bf16 v[12:15],a[104:107],a[24:27],v[12:15]
 ds_read_b64_tr_b16 a[124:125],v116 offset:32768
 ds_read_b64_tr_b16 a[126:127],v116 offset:36864
 v_mfma_f32_16x16x32_bf16 v[8:11],a[92:95],a[28:31],v[8:11]
 v_exp_f32 v1,v1
 v_mfma_f32_16x16x32_bf16 v[12:15],a[108:111],a[28:31],v[12:15]
 v_cvt_pk_bf16_f32 v40,v0,v1
 s_waitcnt vmcnt(4)
 buffer_load_dwordx4 v132,s[16:19],s32 offen offset:3072 nt lds
 v_mfma_f32_16x16x32_bf16 v[16:19],a[80:83],a[32:35],v[88:91]
 v_exp_f32 v2,v2
 v_mfma_f32_16x16x32_bf16 v[20:23],a[96:99],a[32:35],v[88:91]
 ds_read_b64_tr_b16 a[128:129],v117 offset:32768
 ds_read_b64_tr_b16 a[130:131],v117 offset:36864
 v_mfma_f32_16x16x32_bf16 v[16:19],a[84:87],a[36:39],v[16:19]
 v_exp_f32 v3,v3
 v_mfma_f32_16x16x32_bf16 v[20:23],a[100:103],a[36:39],v[20:23]
 v_cvt_pk_bf16_f32 v41,v2,v3
 v_mfma_f32_16x16x32_bf16 v[16:19],a[88:91],a[40:43],v[16:19]
 v_exp_f32 v4,v4
 v_mfma_f32_16x16x32_bf16 v[20:23],a[104:107],a[40:43],v[20:23]
 ds_read_b64_tr_b16 a[132:133],v118 offset:32768
 ds_read_b64_tr_b16 a[134:135],v118 offset:36864
 s_add_u32 m0,s34,0x1c000
 v_mfma_f32_16x16x32_bf16 v[16:19],a[92:95],a[44:47],v[16:19]
 v_exp_f32 v5,v5
 s_xor_b32 s33,s57,0x26000
 v_mfma_f32_16x16x32_bf16 v[20:23],a[108:111],a[44:47],v[20:23]
 v_cvt_pk_bf16_f32 v42,v4,v5
 s_waitcnt vmcnt(4)
 buffer_load_dwordx4 v133,s[20:23],s33 offen offset:0 nt lds
 v_mfma_f32_16x16x32_bf16 v[24:27],a[80:83],a[48:51],v[92:95]
 v_exp_f32 v6,v6
 v_mfma_f32_16x16x32_bf16 v[28:31],a[96:99],a[48:51],v[92:95]
 ds_read_b64_tr_b16 a[136:137],v119 offset:32768
 ds_read_b64_tr_b16 a[138:139],v119 offset:36864
 v_mfma_f32_16x16x32_bf16 v[24:27],a[84:87],a[52:55],v[24:27]
 v_exp_f32 v7,v7
 v_mfma_f32_16x16x32_bf16 v[28:31],a[100:103],a[52:55],v[28:31]
 v_cvt_pk_bf16_f32 v43,v6,v7
 v_mfma_f32_16x16x32_bf16 v[24:27],a[88:91],a[56:59],v[24:27]
 v_exp_f32 v8,v8
 v_mfma_f32_16x16x32_bf16 v[28:31],a[104:107],a[56:59],v[28:31]
 ds_read_b64_tr_b16 a[140:141],v120 offset:32768
 ds_read_b64_tr_b16 a[142:143],v120 offset:36864
 v_mfma_f32_16x16x32_bf16 v[24:27],a[92:95],a[60:63],v[24:27]
 v_exp_f32 v9,v9
 v_mfma_f32_16x16x32_bf16 v[28:31],a[108:111],a[60:63],v[28:31]
 v_cvt_pk_bf16_f32 v44,v8,v9
 s_waitcnt vmcnt(4)
 buffer_load_dwordx4 v134,s[20:23],s33 offen offset:1024 nt lds
 v_mfma_f32_16x16x32_bf16 v[32:35],a[80:83],a[64:67],v[96:99]
 v_exp_f32 v10,v10
 v_mfma_f32_16x16x32_bf16 v[36:39],a[96:99],a[64:67],v[96:99]
 v_mfma_f32_16x16x32_bf16 v[32:35],a[84:87],a[68:71],v[32:35]
 v_exp_f32 v11,v11
 v_mfma_f32_16x16x32_bf16 v[36:39],a[100:103],a[68:71],v[36:39]
 v_cvt_pk_bf16_f32 v45,v10,v11
 v_mfma_f32_16x16x32_bf16 v[32:35],a[88:91],a[72:75],v[32:35]
 v_exp_f32 v12,v12
 v_mfma_f32_16x16x32_bf16 v[36:39],a[104:107],a[72:75],v[36:39]
 v_mfma_f32_16x16x32_bf16 v[32:35],a[92:95],a[76:79],v[32:35]
 v_exp_f32 v13,v13
 v_mfma_f32_16x16x32_bf16 v[36:39],a[108:111],a[76:79],v[36:39]
 v_cvt_pk_bf16_f32 v46,v12,v13
 s_waitcnt lgkmcnt(0)
 v_mfma_f32_16x16x32_bf16 v[144:147],a[112:115],v[60:63],v[144:147]
 s_barrier
 v_exp_f32 v14,v14
 v_mfma_f32_16x16x32_bf16 v[148:151],a[116:119],v[60:63],v[148:151]
 v_mfma_f32_16x16x32_bf16 v[152:155],a[120:123],v[60:63],v[152:155]
 v_exp_f32 v15,v15
 v_mfma_f32_16x16x32_bf16 v[156:159],a[124:127],v[60:63],v[156:159]
 v_cvt_pk_bf16_f32 v47,v14,v15
 v_mfma_f32_16x16x32_bf16 v[160:163],a[128:131],v[60:63],v[160:163]
 v_exp_f32 v16,v16
 v_mfma_f32_16x16x32_bf16 v[164:167],a[132:135],v[60:63],v[164:167]
 ds_read_b128 a[80:83],v105 offset:32768
 s_waitcnt vmcnt(4)
 buffer_load_dwordx4 v133,s[20:23],s33 offen offset:2048 nt lds
 v_mfma_f32_16x16x32_bf16 v[168:171],a[136:139],v[60:63],v[168:171]
 v_exp_f32 v17,v17
 v_mfma_f32_16x16x32_bf16 v[172:175],a[140:143],v[60:63],v[172:175]
 v_cvt_pk_bf16_f32 v48,v16,v17
 v_mfma_f32_16x16x32_bf16 a[192:195],a[212:215],v[60:63],a[192:195]
 ds_read_b128 a[96:99],v105 offset:36864
 v_mfma_f32_16x16x32_bf16 v[176:179],a[112:115],v[64:67],v[176:179]
 v_exp_f32 v18,v18
 v_mfma_f32_16x16x32_bf16 v[180:183],a[116:119],v[64:67],v[180:183]
 ds_read_b128 a[84:87],v106 offset:32768
 v_mfma_f32_16x16x32_bf16 v[184:187],a[120:123],v[64:67],v[184:187]
 v_exp_f32 v19,v19
 v_mfma_f32_16x16x32_bf16 v[188:191],a[124:127],v[64:67],v[188:191]
 v_cvt_pk_bf16_f32 v49,v18,v19
 v_mfma_f32_16x16x32_bf16 v[192:195],a[128:131],v[64:67],v[192:195]
 v_exp_f32 v20,v20
 v_mfma_f32_16x16x32_bf16 v[196:199],a[132:135],v[64:67],v[196:199]
 v_mfma_f32_16x16x32_bf16 v[200:203],a[136:139],v[64:67],v[200:203]
 v_exp_f32 v21,v21
 v_mfma_f32_16x16x32_bf16 v[204:207],a[140:143],v[64:67],v[204:207]
 v_cvt_pk_bf16_f32 v50,v20,v21
 v_mfma_f32_16x16x32_bf16 a[196:199],a[212:215],v[64:67],a[196:199]
 ds_read_b128 a[100:103],v106 offset:36864
 s_waitcnt vmcnt(4)
 buffer_load_dwordx4 v134,s[20:23],s33 offen offset:3072 nt lds
 v_mfma_f32_16x16x32_bf16 v[208:211],a[112:115],v[68:71],v[208:211]
 v_exp_f32 v22,v22
 v_mfma_f32_16x16x32_bf16 v[212:215],a[116:119],v[68:71],v[212:215]
 ds_read_b128 a[88:91],v107 offset:32768
 v_mfma_f32_16x16x32_bf16 v[216:219],a[120:123],v[68:71],v[216:219]
 v_exp_f32 v23,v23
 v_mfma_f32_16x16x32_bf16 v[220:223],a[124:127],v[68:71],v[220:223]
 v_cvt_pk_bf16_f32 v51,v22,v23
 v_mfma_f32_16x16x32_bf16 v[224:227],a[128:131],v[68:71],v[224:227]
 v_exp_f32 v24,v24
 v_mfma_f32_16x16x32_bf16 v[228:231],a[132:135],v[68:71],v[228:231]
 ds_read_b128 a[104:107],v107 offset:36864
 v_mfma_f32_16x16x32_bf16 v[232:235],a[136:139],v[68:71],v[232:235]
 v_exp_f32 v25,v25
 v_mfma_f32_16x16x32_bf16 v[236:239],a[140:143],v[68:71],v[236:239]
 v_cvt_pk_bf16_f32 v52,v24,v25
 v_mfma_f32_16x16x32_bf16 a[200:203],a[212:215],v[68:71],a[200:203]
 v_mfma_f32_16x16x32_bf16 v[240:243],a[112:115],v[72:75],v[240:243]
 v_exp_f32 v26,v26
 v_mfma_f32_16x16x32_bf16 v[244:247],a[116:119],v[72:75],v[244:247]
 ds_read_b128 a[92:95],v108 offset:32768
 v_mfma_f32_16x16x32_bf16 v[248:251],a[120:123],v[72:75],v[248:251]
 v_exp_f32 v27,v27
 v_mfma_f32_16x16x32_bf16 v[252:255],a[124:127],v[72:75],v[252:255]
 v_cvt_pk_bf16_f32 v53,v26,v27
 s_add_u32 m0,s34,0x0
 v_mfma_f32_16x16x32_bf16 a[144:147],a[128:131],v[72:75],a[144:147]
 v_exp_f32 v28,v28
 s_xor_b32 s32,s57,0x28000
 v_mfma_f32_16x16x32_bf16 a[148:151],a[132:135],v[72:75],a[148:151]
 ds_read_b128 a[108:111],v108 offset:36864
 s_waitcnt vmcnt(4)
 buffer_load_dwordx4 v129,s[16:19],s32 offen offset:0 nt lds
 v_mfma_f32_16x16x32_bf16 a[152:155],a[136:139],v[72:75],a[152:155]
 v_exp_f32 v29,v29
 v_mfma_f32_16x16x32_bf16 a[156:159],a[140:143],v[72:75],a[156:159]
 v_cvt_pk_bf16_f32 v54,v28,v29
 v_mfma_f32_16x16x32_bf16 a[204:207],a[212:215],v[72:75],a[204:207]
 v_mfma_f32_16x16x32_bf16 a[160:163],a[112:115],v[76:79],a[160:163]
 v_exp_f32 v30,v30
 v_mfma_f32_16x16x32_bf16 a[164:167],a[116:119],v[76:79],a[164:167]
 v_mfma_f32_16x16x32_bf16 a[168:171],a[120:123],v[76:79],a[168:171]
 v_exp_f32 v31,v31
 v_mfma_f32_16x16x32_bf16 a[172:175],a[124:127],v[76:79],a[172:175]
 v_cvt_pk_bf16_f32 v55,v30,v31
 v_mfma_f32_16x16x32_bf16 a[176:179],a[128:131],v[76:79],a[176:179]
 v_exp_f32 v32,v32
 v_mfma_f32_16x16x32_bf16 a[180:183],a[132:135],v[76:79],a[180:183]
 v_mfma_f32_16x16x32_bf16 a[184:187],a[136:139],v[76:79],a[184:187]
 v_exp_f32 v33,v33
 v_mfma_f32_16x16x32_bf16 a[188:191],a[140:143],v[76:79],a[188:191]
 v_cvt_pk_bf16_f32 v56,v32,v33
 v_mfma_f32_16x16x32_bf16 a[208:211],a[212:215],v[76:79],a[208:211]
 s_waitcnt lgkmcnt(0)
 v_mfma_f32_16x16x32_bf16 v[0:3],a[80:83],a[0:3],v[80:83]
 v_exp_f32 v34,v34
 v_mfma_f32_16x16x32_bf16 v[4:7],a[96:99],a[0:3],v[80:83]
 ds_read_b64_tr_b16 a[112:113],v113 offset:49152
 ds_read_b64_tr_b16 a[114:115],v113 offset:53248
 v_mfma_f32_16x16x32_bf16 v[0:3],a[84:87],a[4:7],v[0:3]
 v_exp_f32 v35,v35
 v_mfma_f32_16x16x32_bf16 v[4:7],a[100:103],a[4:7],v[4:7]
 v_cvt_pk_bf16_f32 v57,v34,v35
 v_mfma_f32_16x16x32_bf16 v[0:3],a[88:91],a[8:11],v[0:3]
 v_exp_f32 v36,v36
 v_mfma_f32_16x16x32_bf16 v[4:7],a[104:107],a[8:11],v[4:7]
 ds_read_b64_tr_b16 a[116:117],v114 offset:49152
 ds_read_b64_tr_b16 a[118:119],v114 offset:53248
 v_mfma_f32_16x16x32_bf16 v[0:3],a[92:95],a[12:15],v[0:3]
 v_exp_f32 v37,v37
 v_mfma_f32_16x16x32_bf16 v[4:7],a[108:111],a[12:15],v[4:7]
 v_cvt_pk_bf16_f32 v58,v36,v37
 s_waitcnt vmcnt(4)
 buffer_load_dwordx4 v130,s[16:19],s32 offen offset:1024 nt lds
 v_mfma_f32_16x16x32_bf16 v[8:11],a[80:83],a[16:19],v[84:87]
 v_exp_f32 v38,v38
 v_mfma_f32_16x16x32_bf16 v[12:15],a[96:99],a[16:19],v[84:87]
 ds_read_b64_tr_b16 a[120:121],v115 offset:49152
 ds_read_b64_tr_b16 a[122:123],v115 offset:53248
 v_mfma_f32_16x16x32_bf16 v[8:11],a[84:87],a[20:23],v[8:11]
 v_exp_f32 v39,v39
 v_mfma_f32_16x16x32_bf16 v[12:15],a[100:103],a[20:23],v[12:15]
 v_cvt_pk_bf16_f32 v59,v38,v39
 v_mfma_f32_16x16x32_bf16 v[8:11],a[88:91],a[24:27],v[8:11]
 v_exp_f32 v0,v0
 v_mfma_f32_16x16x32_bf16 v[12:15],a[104:107],a[24:27],v[12:15]
 ds_read_b64_tr_b16 a[124:125],v116 offset:49152
 ds_read_b64_tr_b16 a[126:127],v116 offset:53248
 v_mfma_f32_16x16x32_bf16 v[8:11],a[92:95],a[28:31],v[8:11]
 v_exp_f32 v1,v1
 v_mfma_f32_16x16x32_bf16 v[12:15],a[108:111],a[28:31],v[12:15]
 v_cvt_pk_bf16_f32 v60,v0,v1
 s_waitcnt vmcnt(4)
 buffer_load_dwordx4 v131,s[16:19],s32 offen offset:2048 nt lds
 v_mfma_f32_16x16x32_bf16 v[16:19],a[80:83],a[32:35],v[88:91]
 v_exp_f32 v2,v2
 v_mfma_f32_16x16x32_bf16 v[20:23],a[96:99],a[32:35],v[88:91]
 ds_read_b64_tr_b16 a[128:129],v117 offset:49152
 ds_read_b64_tr_b16 a[130:131],v117 offset:53248
 v_mfma_f32_16x16x32_bf16 v[16:19],a[84:87],a[36:39],v[16:19]
 v_exp_f32 v3,v3
 v_mfma_f32_16x16x32_bf16 v[20:23],a[100:103],a[36:39],v[20:23]
 v_cvt_pk_bf16_f32 v61,v2,v3
 v_mfma_f32_16x16x32_bf16 v[16:19],a[88:91],a[40:43],v[16:19]
 v_exp_f32 v4,v4
 v_mfma_f32_16x16x32_bf16 v[20:23],a[104:107],a[40:43],v[20:23]
 ds_read_b64_tr_b16 a[132:133],v118 offset:49152
 ds_read_b64_tr_b16 a[134:135],v118 offset:53248
 v_mfma_f32_16x16x32_bf16 v[16:19],a[92:95],a[44:47],v[16:19]
 v_exp_f32 v5,v5
 v_mfma_f32_16x16x32_bf16 v[20:23],a[108:111],a[44:47],v[20:23]
 v_cvt_pk_bf16_f32 v62,v4,v5
 s_waitcnt vmcnt(4)
 buffer_load_dwordx4 v132,s[16:19],s32 offen offset:3072 nt lds
 v_mfma_f32_16x16x32_bf16 v[24:27],a[80:83],a[48:51],v[92:95]
 v_exp_f32 v6,v6
 v_mfma_f32_16x16x32_bf16 v[28:31],a[96:99],a[48:51],v[92:95]
 ds_read_b64_tr_b16 a[136:137],v119 offset:49152
 ds_read_b64_tr_b16 a[138:139],v119 offset:53248
 v_mfma_f32_16x16x32_bf16 v[24:27],a[84:87],a[52:55],v[24:27]
 v_exp_f32 v7,v7
 v_mfma_f32_16x16x32_bf16 v[28:31],a[100:103],a[52:55],v[28:31]
 v_cvt_pk_bf16_f32 v63,v6,v7
 v_mfma_f32_16x16x32_bf16 v[24:27],a[88:91],a[56:59],v[24:27]
 v_exp_f32 v8,v8
 v_mfma_f32_16x16x32_bf16 v[28:31],a[104:107],a[56:59],v[28:31]
 ds_read_b64_tr_b16 a[140:141],v120 offset:49152
 ds_read_b64_tr_b16 a[142:143],v120 offset:53248
 s_add_u32 m0,s34,0x20000
 v_mfma_f32_16x16x32_bf16 v[24:27],a[92:95],a[60:63],v[24:27]
 v_exp_f32 v9,v9
 s_xor_b32 s33,s57,0x28000
 v_mfma_f32_16x16x32_bf16 v[28:31],a[108:111],a[60:63],v[28:31]
 v_cvt_pk_bf16_f32 v64,v8,v9
 s_waitcnt vmcnt(4)
 buffer_load_dwordx4 v133,s[20:23],s33 offen offset:0 nt lds
 v_mfma_f32_16x16x32_bf16 v[32:35],a[80:83],a[64:67],v[96:99]
 v_exp_f32 v10,v10
 v_mfma_f32_16x16x32_bf16 v[36:39],a[96:99],a[64:67],v[96:99]
 v_mfma_f32_16x16x32_bf16 v[32:35],a[84:87],a[68:71],v[32:35]
 v_exp_f32 v11,v11
 v_mfma_f32_16x16x32_bf16 v[36:39],a[100:103],a[68:71],v[36:39]
 v_cvt_pk_bf16_f32 v65,v10,v11
 v_mfma_f32_16x16x32_bf16 v[32:35],a[88:91],a[72:75],v[32:35]
 v_exp_f32 v12,v12
 v_mfma_f32_16x16x32_bf16 v[36:39],a[104:107],a[72:75],v[36:39]
 v_mfma_f32_16x16x32_bf16 v[32:35],a[92:95],a[76:79],v[32:35]
 v_exp_f32 v13,v13
 v_mfma_f32_16x16x32_bf16 v[36:39],a[108:111],a[76:79],v[36:39]
 v_cvt_pk_bf16_f32 v66,v12,v13
 s_waitcnt lgkmcnt(0)
 v_mfma_f32_16x16x32_bf16 v[144:147],a[112:115],v[40:43],v[144:147]
 s_barrier
 v_exp_f32 v14,v14
 v_mfma_f32_16x16x32_bf16 v[148:151],a[116:119],v[40:43],v[148:151]
 v_mfma_f32_16x16x32_bf16 v[152:155],a[120:123],v[40:43],v[152:155]
 v_exp_f32 v15,v15
 v_mfma_f32_16x16x32_bf16 v[156:159],a[124:127],v[40:43],v[156:159]
 v_cvt_pk_bf16_f32 v67,v14,v15
 v_mfma_f32_16x16x32_bf16 v[160:163],a[128:131],v[40:43],v[160:163]
 v_exp_f32 v16,v16
 v_mfma_f32_16x16x32_bf16 v[164:167],a[132:135],v[40:43],v[164:167]
 ds_read_b128 a[80:83],v105 offset:49152
 s_waitcnt vmcnt(4)
 buffer_load_dwordx4 v134,s[20:23],s33 offen offset:1024 nt lds
 v_mfma_f32_16x16x32_bf16 v[168:171],a[136:139],v[40:43],v[168:171]
 v_exp_f32 v17,v17
 v_mfma_f32_16x16x32_bf16 v[172:175],a[140:143],v[40:43],v[172:175]
 v_cvt_pk_bf16_f32 v68,v16,v17
 v_mfma_f32_16x16x32_bf16 a[192:195],a[212:215],v[40:43],a[192:195]
 ds_read_b128 a[96:99],v105 offset:53248
 v_mfma_f32_16x16x32_bf16 v[176:179],a[112:115],v[44:47],v[176:179]
 v_exp_f32 v18,v18
 v_mfma_f32_16x16x32_bf16 v[180:183],a[116:119],v[44:47],v[180:183]
 ds_read_b128 a[84:87],v106 offset:49152
 v_mfma_f32_16x16x32_bf16 v[184:187],a[120:123],v[44:47],v[184:187]
 v_exp_f32 v19,v19
 v_mfma_f32_16x16x32_bf16 v[188:191],a[124:127],v[44:47],v[188:191]
 v_cvt_pk_bf16_f32 v69,v18,v19
 v_mfma_f32_16x16x32_bf16 v[192:195],a[128:131],v[44:47],v[192:195]
 v_exp_f32 v20,v20
 v_mfma_f32_16x16x32_bf16 v[196:199],a[132:135],v[44:47],v[196:199]
 s_waitcnt vmcnt(4)
 buffer_load_dwordx4 v133,s[20:23],s33 offen offset:2048 nt lds
 v_mfma_f32_16x16x32_bf16 v[200:203],a[136:139],v[44:47],v[200:203]
 v_exp_f32 v21,v21
 v_mfma_f32_16x16x32_bf16 v[204:207],a[140:143],v[44:47],v[204:207]
 v_cvt_pk_bf16_f32 v70,v20,v21
 v_mfma_f32_16x16x32_bf16 a[196:199],a[212:215],v[44:47],a[196:199]
 ds_read_b128 a[100:103],v106 offset:53248
 v_mfma_f32_16x16x32_bf16 v[208:211],a[112:115],v[48:51],v[208:211]
 v_exp_f32 v22,v22
 v_mfma_f32_16x16x32_bf16 v[212:215],a[116:119],v[48:51],v[212:215]
 ds_read_b128 a[88:91],v107 offset:49152
 v_mfma_f32_16x16x32_bf16 v[216:219],a[120:123],v[48:51],v[216:219]
 v_exp_f32 v23,v23
 v_mfma_f32_16x16x32_bf16 v[220:223],a[124:127],v[48:51],v[220:223]
 v_cvt_pk_bf16_f32 v71,v22,v23
 v_mfma_f32_16x16x32_bf16 v[224:227],a[128:131],v[48:51],v[224:227]
 v_exp_f32 v24,v24
 v_mfma_f32_16x16x32_bf16 v[228:231],a[132:135],v[48:51],v[228:231]
 ds_read_b128 a[104:107],v107 offset:53248
 v_mfma_f32_16x16x32_bf16 v[232:235],a[136:139],v[48:51],v[232:235]
 v_exp_f32 v25,v25
 v_mfma_f32_16x16x32_bf16 v[236:239],a[140:143],v[48:51],v[236:239]
 v_cvt_pk_bf16_f32 v72,v24,v25
 s_waitcnt vmcnt(4)
 buffer_load_dwordx4 v134,s[20:23],s33 offen offset:3072 nt lds
 v_mfma_f32_16x16x32_bf16 a[200:203],a[212:215],v[48:51],a[200:203]
 v_mfma_f32_16x16x32_bf16 v[240:243],a[112:115],v[52:55],v[240:243]
 v_exp_f32 v26,v26
 v_mfma_f32_16x16x32_bf16 v[244:247],a[116:119],v[52:55],v[244:247]
 ds_read_b128 a[92:95],v108 offset:49152
 v_mfma_f32_16x16x32_bf16 v[248:251],a[120:123],v[52:55],v[248:251]
 v_exp_f32 v27,v27
 v_mfma_f32_16x16x32_bf16 v[252:255],a[124:127],v[52:55],v[252:255]
 v_cvt_pk_bf16_f32 v73,v26,v27
 v_mfma_f32_16x16x32_bf16 a[144:147],a[128:131],v[52:55],a[144:147]
 v_exp_f32 v28,v28
 v_mfma_f32_16x16x32_bf16 a[148:151],a[132:135],v[52:55],a[148:151]
 ds_read_b128 a[108:111],v108 offset:53248
 s_add_u32 m0,s34,0x4000
 v_mfma_f32_16x16x32_bf16 a[152:155],a[136:139],v[52:55],a[152:155]
 v_exp_f32 v29,v29
 s_xor_b32 s32,s57,0x2a000
 v_mfma_f32_16x16x32_bf16 a[156:159],a[140:143],v[52:55],a[156:159]
 v_cvt_pk_bf16_f32 v74,v28,v29
 s_waitcnt vmcnt(3)
 buffer_load_dwordx4 v129,s[16:19],s32 offen offset:0 nt lds
 v_mfma_f32_16x16x32_bf16 a[204:207],a[212:215],v[52:55],a[204:207]
 v_mfma_f32_16x16x32_bf16 a[160:163],a[112:115],v[56:59],a[160:163]
 v_exp_f32 v30,v30
 v_mfma_f32_16x16x32_bf16 a[164:167],a[116:119],v[56:59],a[164:167]
 v_mfma_f32_16x16x32_bf16 a[168:171],a[120:123],v[56:59],a[168:171]
 v_exp_f32 v31,v31
 v_mfma_f32_16x16x32_bf16 a[172:175],a[124:127],v[56:59],a[172:175]
 v_cvt_pk_bf16_f32 v75,v30,v31
 v_mfma_f32_16x16x32_bf16 a[176:179],a[128:131],v[56:59],a[176:179]
 v_exp_f32 v32,v32
 v_mfma_f32_16x16x32_bf16 a[180:183],a[132:135],v[56:59],a[180:183]
 v_mfma_f32_16x16x32_bf16 a[184:187],a[136:139],v[56:59],a[184:187]
 v_exp_f32 v33,v33
 v_mfma_f32_16x16x32_bf16 a[188:191],a[140:143],v[56:59],a[188:191]
 v_cvt_pk_bf16_f32 v76,v32,v33
 v_mfma_f32_16x16x32_bf16 a[208:211],a[212:215],v[56:59],a[208:211]
 s_waitcnt lgkmcnt(0)
 v_mfma_f32_16x16x32_bf16 v[0:3],a[80:83],a[0:3],v[80:83]
 v_exp_f32 v34,v34
 v_mfma_f32_16x16x32_bf16 v[4:7],a[96:99],a[0:3],v[80:83]
 ds_read_b64_tr_b16 a[112:113],v121 offset:0
 ds_read_b64_tr_b16 a[114:115],v121 offset:4096
 v_mfma_f32_16x16x32_bf16 v[0:3],a[84:87],a[4:7],v[0:3]
 v_exp_f32 v35,v35
 v_mfma_f32_16x16x32_bf16 v[4:7],a[100:103],a[4:7],v[4:7]
 v_cvt_pk_bf16_f32 v77,v34,v35
 v_mfma_f32_16x16x32_bf16 v[0:3],a[88:91],a[8:11],v[0:3]
 v_exp_f32 v36,v36
 v_mfma_f32_16x16x32_bf16 v[4:7],a[104:107],a[8:11],v[4:7]
 ds_read_b64_tr_b16 a[116:117],v122 offset:0
 ds_read_b64_tr_b16 a[118:119],v122 offset:4096
 v_mfma_f32_16x16x32_bf16 v[0:3],a[92:95],a[12:15],v[0:3]
 v_exp_f32 v37,v37
 v_mfma_f32_16x16x32_bf16 v[4:7],a[108:111],a[12:15],v[4:7]
 v_cvt_pk_bf16_f32 v78,v36,v37
 s_waitcnt vmcnt(4)
 buffer_load_dwordx4 v130,s[16:19],s32 offen offset:1024 nt lds
 v_mfma_f32_16x16x32_bf16 v[8:11],a[80:83],a[16:19],v[84:87]
 v_exp_f32 v38,v38
 v_mfma_f32_16x16x32_bf16 v[12:15],a[96:99],a[16:19],v[84:87]
 ds_read_b64_tr_b16 a[120:121],v123 offset:0
 ds_read_b64_tr_b16 a[122:123],v123 offset:4096
 v_mfma_f32_16x16x32_bf16 v[8:11],a[84:87],a[20:23],v[8:11]
 v_exp_f32 v39,v39
 v_mfma_f32_16x16x32_bf16 v[12:15],a[100:103],a[20:23],v[12:15]
 v_cvt_pk_bf16_f32 v79,v38,v39
 v_mfma_f32_16x16x32_bf16 v[8:11],a[88:91],a[24:27],v[8:11]
 v_exp_f32 v0,v0
 v_mfma_f32_16x16x32_bf16 v[12:15],a[104:107],a[24:27],v[12:15]
 ds_read_b64_tr_b16 a[124:125],v124 offset:0
 ds_read_b64_tr_b16 a[126:127],v124 offset:4096
 v_mfma_f32_16x16x32_bf16 v[8:11],a[92:95],a[28:31],v[8:11]
 v_exp_f32 v1,v1
 v_mfma_f32_16x16x32_bf16 v[12:15],a[108:111],a[28:31],v[12:15]
 v_cvt_pk_bf16_f32 v40,v0,v1
 v_mfma_f32_16x16x32_bf16 v[16:19],a[80:83],a[32:35],v[88:91]
 v_exp_f32 v2,v2
 v_mfma_f32_16x16x32_bf16 v[20:23],a[96:99],a[32:35],v[88:91]
 ds_read_b64_tr_b16 a[128:129],v125 offset:0
 ds_read_b64_tr_b16 a[130:131],v125 offset:4096
 v_mfma_f32_16x16x32_bf16 v[16:19],a[84:87],a[36:39],v[16:19]
 v_exp_f32 v3,v3
 v_mfma_f32_16x16x32_bf16 v[20:23],a[100:103],a[36:39],v[20:23]
 v_cvt_pk_bf16_f32 v41,v2,v3
 s_waitcnt vmcnt(4)
 buffer_load_dwordx4 v131,s[16:19],s32 offen offset:2048 nt lds
 v_mfma_f32_16x16x32_bf16 v[16:19],a[88:91],a[40:43],v[16:19]
 v_exp_f32 v4,v4
 v_mfma_f32_16x16x32_bf16 v[20:23],a[104:107],a[40:43],v[20:23]
 ds_read_b64_tr_b16 a[132:133],v126 offset:0
 ds_read_b64_tr_b16 a[134:135],v126 offset:4096
 v_mfma_f32_16x16x32_bf16 v[16:19],a[92:95],a[44:47],v[16:19]
 v_exp_f32 v5,v5
 v_mfma_f32_16x16x32_bf16 v[20:23],a[108:111],a[44:47],v[20:23]
 v_cvt_pk_bf16_f32 v42,v4,v5
 v_mfma_f32_16x16x32_bf16 v[24:27],a[80:83],a[48:51],v[92:95]
 v_exp_f32 v6,v6
 v_mfma_f32_16x16x32_bf16 v[28:31],a[96:99],a[48:51],v[92:95]
 ds_read_b64_tr_b16 a[136:137],v127 offset:0
 ds_read_b64_tr_b16 a[138:139],v127 offset:4096
 v_mfma_f32_16x16x32_bf16 v[24:27],a[84:87],a[52:55],v[24:27]
 v_exp_f32 v7,v7
 v_mfma_f32_16x16x32_bf16 v[28:31],a[100:103],a[52:55],v[28:31]
 v_cvt_pk_bf16_f32 v43,v6,v7
 v_mfma_f32_16x16x32_bf16 v[24:27],a[88:91],a[56:59],v[24:27]
 v_exp_f32 v8,v8
 v_mfma_f32_16x16x32_bf16 v[28:31],a[104:107],a[56:59],v[28:31]
 ds_read_b64_tr_b16 a[140:141],v128 offset:0
 ds_read_b64_tr_b16 a[142:143],v128 offset:4096
 v_mfma_f32_16x16x32_bf16 v[24:27],a[92:95],a[60:63],v[24:27]
 v_exp_f32 v9,v9
 v_mfma_f32_16x16x32_bf16 v[28:31],a[108:111],a[60:63],v[28:31]
 v_cvt_pk_bf16_f32 v44,v8,v9
 s_waitcnt vmcnt(4)
 buffer_load_dwordx4 v132,s[16:19],s32 offen offset:3072 nt lds
 v_mfma_f32_16x16x32_bf16 v[32:35],a[80:83],a[64:67],v[96:99]
 v_exp_f32 v10,v10
 v_mfma_f32_16x16x32_bf16 v[36:39],a[96:99],a[64:67],v[96:99]
 v_mfma_f32_16x16x32_bf16 v[32:35],a[84:87],a[68:71],v[32:35]
 v_exp_f32 v11,v11
 v_mfma_f32_16x16x32_bf16 v[36:39],a[100:103],a[68:71],v[36:39]
 v_cvt_pk_bf16_f32 v45,v10,v11
 v_mfma_f32_16x16x32_bf16 v[32:35],a[88:91],a[72:75],v[32:35]
 v_exp_f32 v12,v12
 v_mfma_f32_16x16x32_bf16 v[36:39],a[104:107],a[72:75],v[36:39]
 v_mfma_f32_16x16x32_bf16 v[32:35],a[92:95],a[76:79],v[32:35]
 v_exp_f32 v13,v13
 v_mfma_f32_16x16x32_bf16 v[36:39],a[108:111],a[76:79],v[36:39]
 v_cvt_pk_bf16_f32 v46,v12,v13
 s_waitcnt lgkmcnt(0)
 v_mfma_f32_16x16x32_bf16 v[144:147],a[112:115],v[60:63],v[144:147]
 s_barrier
 v_exp_f32 v14,v14
 v_mfma_f32_16x16x32_bf16 v[148:151],a[116:119],v[60:63],v[148:151]
 v_mfma_f32_16x16x32_bf16 v[152:155],a[120:123],v[60:63],v[152:155]
 v_exp_f32 v15,v15
 v_mfma_f32_16x16x32_bf16 v[156:159],a[124:127],v[60:63],v[156:159]
 v_cvt_pk_bf16_f32 v47,v14,v15
 s_add_u32 m0,s34,0x24000
 v_mfma_f32_16x16x32_bf16 v[160:163],a[128:131],v[60:63],v[160:163]
 v_exp_f32 v16,v16
 s_xor_b32 s33,s57,0x2a000
 v_mfma_f32_16x16x32_bf16 v[164:167],a[132:135],v[60:63],v[164:167]
 ds_read_b128 a[80:83],v109 offset:0
 s_waitcnt vmcnt(3)
 buffer_load_dwordx4 v133,s[20:23],s33 offen offset:0 nt lds
 v_mfma_f32_16x16x32_bf16 v[168:171],a[136:139],v[60:63],v[168:171]
 v_exp_f32 v17,v17
 v_mfma_f32_16x16x32_bf16 v[172:175],a[140:143],v[60:63],v[172:175]
 v_cvt_pk_bf16_f32 v48,v16,v17
 v_mfma_f32_16x16x32_bf16 a[192:195],a[212:215],v[60:63],a[192:195]
 ds_read_b128 a[96:99],v109 offset:4096
 v_mfma_f32_16x16x32_bf16 v[176:179],a[112:115],v[64:67],v[176:179]
 v_exp_f32 v18,v18
 v_mfma_f32_16x16x32_bf16 v[180:183],a[116:119],v[64:67],v[180:183]
 ds_read_b128 a[84:87],v110 offset:0
 v_mfma_f32_16x16x32_bf16 v[184:187],a[120:123],v[64:67],v[184:187]
 v_exp_f32 v19,v19
 v_mfma_f32_16x16x32_bf16 v[188:191],a[124:127],v[64:67],v[188:191]
 v_cvt_pk_bf16_f32 v49,v18,v19
 v_mfma_f32_16x16x32_bf16 v[192:195],a[128:131],v[64:67],v[192:195]
 v_exp_f32 v20,v20
 v_mfma_f32_16x16x32_bf16 v[196:199],a[132:135],v[64:67],v[196:199]
 s_waitcnt vmcnt(4)
 buffer_load_dwordx4 v134,s[20:23],s33 offen offset:1024 nt lds
 v_mfma_f32_16x16x32_bf16 v[200:203],a[136:139],v[64:67],v[200:203]
 v_exp_f32 v21,v21
 v_mfma_f32_16x16x32_bf16 v[204:207],a[140:143],v[64:67],v[204:207]
 v_cvt_pk_bf16_f32 v50,v20,v21
 v_mfma_f32_16x16x32_bf16 a[196:199],a[212:215],v[64:67],a[196:199]
 ds_read_b128 a[100:103],v110 offset:4096
 v_mfma_f32_16x16x32_bf16 v[208:211],a[112:115],v[68:71],v[208:211]
 v_exp_f32 v22,v22
 v_mfma_f32_16x16x32_bf16 v[212:215],a[116:119],v[68:71],v[212:215]
 ds_read_b128 a[88:91],v111 offset:0
 v_mfma_f32_16x16x32_bf16 v[216:219],a[120:123],v[68:71],v[216:219]
 v_exp_f32 v23,v23
 v_mfma_f32_16x16x32_bf16 v[220:223],a[124:127],v[68:71],v[220:223]
 v_cvt_pk_bf16_f32 v51,v22,v23
 v_mfma_f32_16x16x32_bf16 v[224:227],a[128:131],v[68:71],v[224:227]
 v_exp_f32 v24,v24
 v_mfma_f32_16x16x32_bf16 v[228:231],a[132:135],v[68:71],v[228:231]
 ds_read_b128 a[104:107],v111 offset:4096
 v_mfma_f32_16x16x32_bf16 v[232:235],a[136:139],v[68:71],v[232:235]
 v_exp_f32 v25,v25
 v_mfma_f32_16x16x32_bf16 v[236:239],a[140:143],v[68:71],v[236:239]
 v_cvt_pk_bf16_f32 v52,v24,v25
 s_waitcnt vmcnt(4)
 buffer_load_dwordx4 v133,s[20:23],s33 offen offset:2048 nt lds
 v_mfma_f32_16x16x32_bf16 a[200:203],a[212:215],v[68:71],a[200:203]
 v_mfma_f32_16x16x32_bf16 v[240:243],a[112:115],v[72:75],v[240:243]
 v_exp_f32 v26,v26
 v_mfma_f32_16x16x32_bf16 v[244:247],a[116:119],v[72:75],v[244:247]
 ds_read_b128 a[92:95],v112 offset:0
 v_mfma_f32_16x16x32_bf16 v[248:251],a[120:123],v[72:75],v[248:251]
 v_exp_f32 v27,v27
 v_mfma_f32_16x16x32_bf16 v[252:255],a[124:127],v[72:75],v[252:255]
 v_cvt_pk_bf16_f32 v53,v26,v27
 v_mfma_f32_16x16x32_bf16 a[144:147],a[128:131],v[72:75],a[144:147]
 v_exp_f32 v28,v28
 v_mfma_f32_16x16x32_bf16 a[148:151],a[132:135],v[72:75],a[148:151]
 ds_read_b128 a[108:111],v112 offset:4096
 v_mfma_f32_16x16x32_bf16 a[152:155],a[136:139],v[72:75],a[152:155]
 v_exp_f32 v29,v29
 v_mfma_f32_16x16x32_bf16 a[156:159],a[140:143],v[72:75],a[156:159]
 v_cvt_pk_bf16_f32 v54,v28,v29
 s_waitcnt vmcnt(4)
 buffer_load_dwordx4 v134,s[20:23],s33 offen offset:3072 nt lds
 v_mfma_f32_16x16x32_bf16 a[204:207],a[212:215],v[72:75],a[204:207]
 v_mfma_f32_16x16x32_bf16 a[160:163],a[112:115],v[76:79],a[160:163]
 v_exp_f32 v30,v30
 v_mfma_f32_16x16x32_bf16 a[164:167],a[116:119],v[76:79],a[164:167]
 v_mfma_f32_16x16x32_bf16 a[168:171],a[120:123],v[76:79],a[168:171]
 v_exp_f32 v31,v31
 v_mfma_f32_16x16x32_bf16 a[172:175],a[124:127],v[76:79],a[172:175]
 v_cvt_pk_bf16_f32 v55,v30,v31
 v_mfma_f32_16x16x32_bf16 a[176:179],a[128:131],v[76:79],a[176:179]
 v_exp_f32 v32,v32
 v_mfma_f32_16x16x32_bf16 a[180:183],a[132:135],v[76:79],a[180:183]
 v_mfma_f32_16x16x32_bf16 a[184:187],a[136:139],v[76:79],a[184:187]
 v_exp_f32 v33,v33
 v_mfma_f32_16x16x32_bf16 a[188:191],a[140:143],v[76:79],a[188:191]
 v_cvt_pk_bf16_f32 v56,v32,v33
 v_mfma_f32_16x16x32_bf16 a[208:211],a[212:215],v[76:79],a[208:211]
 s_waitcnt lgkmcnt(0)
 v_mfma_f32_16x16x32_bf16 v[0:3],a[80:83],a[0:3],v[80:83]
 v_exp_f32 v34,v34
 v_mfma_f32_16x16x32_bf16 v[4:7],a[96:99],a[0:3],v[80:83]
 ds_read_b64_tr_b16 a[112:113],v113 offset:0
 ds_read_b64_tr_b16 a[114:115],v113 offset:4096
 v_mfma_f32_16x16x32_bf16 v[0:3],a[84:87],a[4:7],v[0:3]
 v_exp_f32 v35,v35
 v_mfma_f32_16x16x32_bf16 v[4:7],a[100:103],a[4:7],v[4:7]
 v_cvt_pk_bf16_f32 v57,v34,v35
 v_mfma_f32_16x16x32_bf16 v[0:3],a[88:91],a[8:11],v[0:3]
 v_exp_f32 v36,v36
 v_mfma_f32_16x16x32_bf16 v[4:7],a[104:107],a[8:11],v[4:7]
 ds_read_b64_tr_b16 a[116:117],v114 offset:0
 ds_read_b64_tr_b16 a[118:119],v114 offset:4096
 s_add_u32 m0,s34,0x8000
 v_mfma_f32_16x16x32_bf16 v[0:3],a[92:95],a[12:15],v[0:3]
 v_exp_f32 v37,v37
 s_xor_b32 s32,s57,0x2c000
 v_mfma_f32_16x16x32_bf16 v[4:7],a[108:111],a[12:15],v[4:7]
 v_cvt_pk_bf16_f32 v58,v36,v37
 s_waitcnt vmcnt(4)
 buffer_load_dwordx4 v129,s[16:19],s32 offen offset:0 nt lds
 v_mfma_f32_16x16x32_bf16 v[8:11],a[80:83],a[16:19],v[84:87]
 v_exp_f32 v38,v38
 v_mfma_f32_16x16x32_bf16 v[12:15],a[96:99],a[16:19],v[84:87]
 ds_read_b64_tr_b16 a[120:121],v115 offset:0
 ds_read_b64_tr_b16 a[122:123],v115 offset:4096
 v_mfma_f32_16x16x32_bf16 v[8:11],a[84:87],a[20:23],v[8:11]
 v_exp_f32 v39,v39
 v_mfma_f32_16x16x32_bf16 v[12:15],a[100:103],a[20:23],v[12:15]
 v_cvt_pk_bf16_f32 v59,v38,v39
 v_mfma_f32_16x16x32_bf16 v[8:11],a[88:91],a[24:27],v[8:11]
 v_exp_f32 v0,v0
 v_mfma_f32_16x16x32_bf16 v[12:15],a[104:107],a[24:27],v[12:15]
 ds_read_b64_tr_b16 a[124:125],v116 offset:0
 ds_read_b64_tr_b16 a[126:127],v116 offset:4096
 v_mfma_f32_16x16x32_bf16 v[8:11],a[92:95],a[28:31],v[8:11]
 v_exp_f32 v1,v1
 v_mfma_f32_16x16x32_bf16 v[12:15],a[108:111],a[28:31],v[12:15]
 v_cvt_pk_bf16_f32 v60,v0,v1
 s_waitcnt vmcnt(4)
 buffer_load_dwordx4 v130,s[16:19],s32 offen offset:1024 nt lds
 v_mfma_f32_16x16x32_bf16 v[16:19],a[80:83],a[32:35],v[88:91]
 v_exp_f32 v2,v2
 v_mfma_f32_16x16x32_bf16 v[20:23],a[96:99],a[32:35],v[88:91]
 ds_read_b64_tr_b16 a[128:129],v117 offset:0
 ds_read_b64_tr_b16 a[130:131],v117 offset:4096
 v_mfma_f32_16x16x32_bf16 v[16:19],a[84:87],a[36:39],v[16:19]
 v_exp_f32 v3,v3
 v_mfma_f32_16x16x32_bf16 v[20:23],a[100:103],a[36:39],v[20:23]
 v_cvt_pk_bf16_f32 v61,v2,v3
 v_mfma_f32_16x16x32_bf16 v[16:19],a[88:91],a[40:43],v[16:19]
 v_exp_f32 v4,v4
 v_mfma_f32_16x16x32_bf16 v[20:23],a[104:107],a[40:43],v[20:23]
 ds_read_b64_tr_b16 a[132:133],v118 offset:0
 ds_read_b64_tr_b16 a[134:135],v118 offset:4096
 v_mfma_f32_16x16x32_bf16 v[16:19],a[92:95],a[44:47],v[16:19]
 v_exp_f32 v5,v5
 v_mfma_f32_16x16x32_bf16 v[20:23],a[108:111],a[44:47],v[20:23]
 v_cvt_pk_bf16_f32 v62,v4,v5
 s_waitcnt vmcnt(4)
 buffer_load_dwordx4 v131,s[16:19],s32 offen offset:2048 nt lds
 v_mfma_f32_16x16x32_bf16 v[24:27],a[80:83],a[48:51],v[92:95]
 v_exp_f32 v6,v6
 v_mfma_f32_16x16x32_bf16 v[28:31],a[96:99],a[48:51],v[92:95]
 ds_read_b64_tr_b16 a[136:137],v119 offset:0
 ds_read_b64_tr_b16 a[138:139],v119 offset:4096
 v_mfma_f32_16x16x32_bf16 v[24:27],a[84:87],a[52:55],v[24:27]
 v_exp_f32 v7,v7
 v_mfma_f32_16x16x32_bf16 v[28:31],a[100:103],a[52:55],v[28:31]
 v_cvt_pk_bf16_f32 v63,v6,v7
 v_mfma_f32_16x16x32_bf16 v[24:27],a[88:91],a[56:59],v[24:27]
 v_exp_f32 v8,v8
 v_mfma_f32_16x16x32_bf16 v[28:31],a[104:107],a[56:59],v[28:31]
 ds_read_b64_tr_b16 a[140:141],v120 offset:0
 ds_read_b64_tr_b16 a[142:143],v120 offset:4096
 v_mfma_f32_16x16x32_bf16 v[24:27],a[92:95],a[60:63],v[24:27]
 v_exp_f32 v9,v9
 v_mfma_f32_16x16x32_bf16 v[28:31],a[108:111],a[60:63],v[28:31]
 v_cvt_pk_bf16_f32 v64,v8,v9
 s_waitcnt vmcnt(4)
 buffer_load_dwordx4 v132,s[16:19],s32 offen offset:3072 nt lds
 v_mfma_f32_16x16x32_bf16 v[32:35],a[80:83],a[64:67],v[96:99]
 v_exp_f32 v10,v10
 v_mfma_f32_16x16x32_bf16 v[36:39],a[96:99],a[64:67],v[96:99]
 v_mfma_f32_16x16x32_bf16 v[32:35],a[84:87],a[68:71],v[32:35]
 v_exp_f32 v11,v11
 v_mfma_f32_16x16x32_bf16 v[36:39],a[100:103],a[68:71],v[36:39]
 v_cvt_pk_bf16_f32 v65,v10,v11
 v_mfma_f32_16x16x32_bf16 v[32:35],a[88:91],a[72:75],v[32:35]
 v_exp_f32 v12,v12
 v_mfma_f32_16x16x32_bf16 v[36:39],a[104:107],a[72:75],v[36:39]
 v_mfma_f32_16x16x32_bf16 v[32:35],a[92:95],a[76:79],v[32:35]
 v_exp_f32 v13,v13
 v_mfma_f32_16x16x32_bf16 v[36:39],a[108:111],a[76:79],v[36:39]
 v_cvt_pk_bf16_f32 v66,v12,v13
 s_waitcnt lgkmcnt(0)
 v_mfma_f32_16x16x32_bf16 v[144:147],a[112:115],v[40:43],v[144:147]
 s_barrier
 v_exp_f32 v14,v14
 v_mfma_f32_16x16x32_bf16 v[148:151],a[116:119],v[40:43],v[148:151]
 v_mfma_f32_16x16x32_bf16 v[152:155],a[120:123],v[40:43],v[152:155]
 v_exp_f32 v15,v15
 v_mfma_f32_16x16x32_bf16 v[156:159],a[124:127],v[40:43],v[156:159]
 v_cvt_pk_bf16_f32 v67,v14,v15
 s_add_u32 m0,s34,0x14000
 v_mfma_f32_16x16x32_bf16 v[160:163],a[128:131],v[40:43],v[160:163]
 v_exp_f32 v16,v16
 s_xor_b32 s33,s57,0x2c000
 v_mfma_f32_16x16x32_bf16 v[164:167],a[132:135],v[40:43],v[164:167]
 ds_read_b128 a[80:83],v105 offset:0
 s_waitcnt vmcnt(4)
 buffer_load_dwordx4 v133,s[20:23],s33 offen offset:0 nt lds
 v_mfma_f32_16x16x32_bf16 v[168:171],a[136:139],v[40:43],v[168:171]
 v_exp_f32 v17,v17
 v_mfma_f32_16x16x32_bf16 v[172:175],a[140:143],v[40:43],v[172:175]
 v_cvt_pk_bf16_f32 v68,v16,v17
 v_mfma_f32_16x16x32_bf16 a[192:195],a[212:215],v[40:43],a[192:195]
 ds_read_b128 a[96:99],v105 offset:4096
 v_mfma_f32_16x16x32_bf16 v[176:179],a[112:115],v[44:47],v[176:179]
 v_exp_f32 v18,v18
 v_mfma_f32_16x16x32_bf16 v[180:183],a[116:119],v[44:47],v[180:183]
 ds_read_b128 a[84:87],v106 offset:0
 v_mfma_f32_16x16x32_bf16 v[184:187],a[120:123],v[44:47],v[184:187]
 v_exp_f32 v19,v19
 v_mfma_f32_16x16x32_bf16 v[188:191],a[124:127],v[44:47],v[188:191]
 v_cvt_pk_bf16_f32 v69,v18,v19
 v_mfma_f32_16x16x32_bf16 v[192:195],a[128:131],v[44:47],v[192:195]
 v_exp_f32 v20,v20
 v_mfma_f32_16x16x32_bf16 v[196:199],a[132:135],v[44:47],v[196:199]
 v_mfma_f32_16x16x32_bf16 v[200:203],a[136:139],v[44:47],v[200:203]
 v_exp_f32 v21,v21
 v_mfma_f32_16x16x32_bf16 v[204:207],a[140:143],v[44:47],v[204:207]
 v_cvt_pk_bf16_f32 v70,v20,v21
 v_mfma_f32_16x16x32_bf16 a[196:199],a[212:215],v[44:47],a[196:199]
 ds_read_b128 a[100:103],v106 offset:4096
 s_waitcnt vmcnt(4)
 buffer_load_dwordx4 v134,s[20:23],s33 offen offset:1024 nt lds
 v_mfma_f32_16x16x32_bf16 v[208:211],a[112:115],v[48:51],v[208:211]
 v_exp_f32 v22,v22
 v_mfma_f32_16x16x32_bf16 v[212:215],a[116:119],v[48:51],v[212:215]
 ds_read_b128 a[88:91],v107 offset:0
 v_mfma_f32_16x16x32_bf16 v[216:219],a[120:123],v[48:51],v[216:219]
 v_exp_f32 v23,v23
 v_mfma_f32_16x16x32_bf16 v[220:223],a[124:127],v[48:51],v[220:223]
 v_cvt_pk_bf16_f32 v71,v22,v23
 v_mfma_f32_16x16x32_bf16 v[224:227],a[128:131],v[48:51],v[224:227]
 v_exp_f32 v24,v24
 v_mfma_f32_16x16x32_bf16 v[228:231],a[132:135],v[48:51],v[228:231]
 ds_read_b128 a[104:107],v107 offset:4096
 v_mfma_f32_16x16x32_bf16 v[232:235],a[136:139],v[48:51],v[232:235]
 v_exp_f32 v25,v25
 v_mfma_f32_16x16x32_bf16 v[236:239],a[140:143],v[48:51],v[236:239]
 v_cvt_pk_bf16_f32 v72,v24,v25
 v_mfma_f32_16x16x32_bf16 a[200:203],a[212:215],v[48:51],a[200:203]
 v_mfma_f32_16x16x32_bf16 v[240:243],a[112:115],v[52:55],v[240:243]
 v_exp_f32 v26,v26
 v_mfma_f32_16x16x32_bf16 v[244:247],a[116:119],v[52:55],v[244:247]
 ds_read_b128 a[92:95],v108 offset:0
 v_mfma_f32_16x16x32_bf16 v[248:251],a[120:123],v[52:55],v[248:251]
 v_exp_f32 v27,v27
 v_mfma_f32_16x16x32_bf16 v[252:255],a[124:127],v[52:55],v[252:255]
 v_cvt_pk_bf16_f32 v73,v26,v27
 v_mfma_f32_16x16x32_bf16 a[144:147],a[128:131],v[52:55],a[144:147]
 v_exp_f32 v28,v28
 v_mfma_f32_16x16x32_bf16 a[148:151],a[132:135],v[52:55],a[148:151]
 ds_read_b128 a[108:111],v108 offset:4096
 s_waitcnt vmcnt(4)
 buffer_load_dwordx4 v133,s[20:23],s33 offen offset:2048 nt lds
 v_mfma_f32_16x16x32_bf16 a[152:155],a[136:139],v[52:55],a[152:155]
 v_exp_f32 v29,v29
 v_mfma_f32_16x16x32_bf16 a[156:159],a[140:143],v[52:55],a[156:159]
 v_cvt_pk_bf16_f32 v74,v28,v29
 v_mfma_f32_16x16x32_bf16 a[204:207],a[212:215],v[52:55],a[204:207]
 v_mfma_f32_16x16x32_bf16 a[160:163],a[112:115],v[56:59],a[160:163]
 v_exp_f32 v30,v30
 v_mfma_f32_16x16x32_bf16 a[164:167],a[116:119],v[56:59],a[164:167]
 v_mfma_f32_16x16x32_bf16 a[168:171],a[120:123],v[56:59],a[168:171]
 v_exp_f32 v31,v31
 v_mfma_f32_16x16x32_bf16 a[172:175],a[124:127],v[56:59],a[172:175]
 v_cvt_pk_bf16_f32 v75,v30,v31
 v_mfma_f32_16x16x32_bf16 a[176:179],a[128:131],v[56:59],a[176:179]
 v_exp_f32 v32,v32
 v_mfma_f32_16x16x32_bf16 a[180:183],a[132:135],v[56:59],a[180:183]
 v_mfma_f32_16x16x32_bf16 a[184:187],a[136:139],v[56:59],a[184:187]
 v_exp_f32 v33,v33
 v_mfma_f32_16x16x32_bf16 a[188:191],a[140:143],v[56:59],a[188:191]
 v_cvt_pk_bf16_f32 v76,v32,v33
 v_mfma_f32_16x16x32_bf16 a[208:211],a[212:215],v[56:59],a[208:211]
 s_waitcnt lgkmcnt(0)
 v_mfma_f32_16x16x32_bf16 v[0:3],a[80:83],a[0:3],v[80:83]
 v_exp_f32 v34,v34
 v_mfma_f32_16x16x32_bf16 v[4:7],a[96:99],a[0:3],v[80:83]
 ds_read_b64_tr_b16 a[112:113],v113 offset:16384
 ds_read_b64_tr_b16 a[114:115],v113 offset:20480
 v_mfma_f32_16x16x32_bf16 v[0:3],a[84:87],a[4:7],v[0:3]
 v_exp_f32 v35,v35
 v_mfma_f32_16x16x32_bf16 v[4:7],a[100:103],a[4:7],v[4:7]
 v_cvt_pk_bf16_f32 v77,v34,v35
 v_mfma_f32_16x16x32_bf16 v[0:3],a[88:91],a[8:11],v[0:3]
 v_exp_f32 v36,v36
 v_mfma_f32_16x16x32_bf16 v[4:7],a[104:107],a[8:11],v[4:7]
 ds_read_b64_tr_b16 a[116:117],v114 offset:16384
 ds_read_b64_tr_b16 a[118:119],v114 offset:20480
 v_mfma_f32_16x16x32_bf16 v[0:3],a[92:95],a[12:15],v[0:3]
 v_exp_f32 v37,v37
 v_mfma_f32_16x16x32_bf16 v[4:7],a[108:111],a[12:15],v[4:7]
 v_cvt_pk_bf16_f32 v78,v36,v37
 s_waitcnt vmcnt(4)
 buffer_load_dwordx4 v134,s[20:23],s33 offen offset:3072 nt lds
 v_mfma_f32_16x16x32_bf16 v[8:11],a[80:83],a[16:19],v[84:87]
 v_exp_f32 v38,v38
 v_mfma_f32_16x16x32_bf16 v[12:15],a[96:99],a[16:19],v[84:87]
 ds_read_b64_tr_b16 a[120:121],v115 offset:16384
 ds_read_b64_tr_b16 a[122:123],v115 offset:20480
 v_mfma_f32_16x16x32_bf16 v[8:11],a[84:87],a[20:23],v[8:11]
 v_exp_f32 v39,v39
 v_mfma_f32_16x16x32_bf16 v[12:15],a[100:103],a[20:23],v[12:15]
 v_cvt_pk_bf16_f32 v79,v38,v39
 v_mfma_f32_16x16x32_bf16 v[8:11],a[88:91],a[24:27],v[8:11]
 v_exp_f32 v0,v0
 v_mfma_f32_16x16x32_bf16 v[12:15],a[104:107],a[24:27],v[12:15]
 ds_read_b64_tr_b16 a[124:125],v116 offset:16384
 ds_read_b64_tr_b16 a[126:127],v116 offset:20480
 s_add_u32 m0,s34,0xc000
 v_mfma_f32_16x16x32_bf16 v[8:11],a[92:95],a[28:31],v[8:11]
 v_exp_f32 v1,v1
 s_xor_b32 s32,s57,0x2e000
 v_mfma_f32_16x16x32_bf16 v[12:15],a[108:111],a[28:31],v[12:15]
 v_cvt_pk_bf16_f32 v40,v0,v1
 s_waitcnt vmcnt(4)
 buffer_load_dwordx4 v129,s[16:19],s32 offen offset:0 nt lds
 v_mfma_f32_16x16x32_bf16 v[16:19],a[80:83],a[32:35],v[88:91]
 v_exp_f32 v2,v2
 v_mfma_f32_16x16x32_bf16 v[20:23],a[96:99],a[32:35],v[88:91]
 ds_read_b64_tr_b16 a[128:129],v117 offset:16384
 ds_read_b64_tr_b16 a[130:131],v117 offset:20480
 v_mfma_f32_16x16x32_bf16 v[16:19],a[84:87],a[36:39],v[16:19]
 v_exp_f32 v3,v3
 v_mfma_f32_16x16x32_bf16 v[20:23],a[100:103],a[36:39],v[20:23]
 v_cvt_pk_bf16_f32 v41,v2,v3
 v_mfma_f32_16x16x32_bf16 v[16:19],a[88:91],a[40:43],v[16:19]
 v_exp_f32 v4,v4
 v_mfma_f32_16x16x32_bf16 v[20:23],a[104:107],a[40:43],v[20:23]
 ds_read_b64_tr_b16 a[132:133],v118 offset:16384
 ds_read_b64_tr_b16 a[134:135],v118 offset:20480
 v_mfma_f32_16x16x32_bf16 v[16:19],a[92:95],a[44:47],v[16:19]
 v_exp_f32 v5,v5
 v_mfma_f32_16x16x32_bf16 v[20:23],a[108:111],a[44:47],v[20:23]
 v_cvt_pk_bf16_f32 v42,v4,v5
 s_waitcnt vmcnt(4)
 buffer_load_dwordx4 v130,s[16:19],s32 offen offset:1024 nt lds
 v_mfma_f32_16x16x32_bf16 v[24:27],a[80:83],a[48:51],v[92:95]
 v_exp_f32 v6,v6
 v_mfma_f32_16x16x32_bf16 v[28:31],a[96:99],a[48:51],v[92:95]
 ds_read_b64_tr_b16 a[136:137],v119 offset:16384
 ds_read_b64_tr_b16 a[138:139],v119 offset:20480
 v_mfma_f32_16x16x32_bf16 v[24:27],a[84:87],a[52:55],v[24:27]
 v_exp_f32 v7,v7
 v_mfma_f32_16x16x32_bf16 v[28:31],a[100:103],a[52:55],v[28:31]
 v_cvt_pk_bf16_f32 v43,v6,v7
 v_mfma_f32_16x16x32_bf16 v[24:27],a[88:91],a[56:59],v[24:27]
 v_exp_f32 v8,v8
 v_mfma_f32_16x16x32_bf16 v[28:31],a[104:107],a[56:59],v[28:31]
 ds_read_b64_tr_b16 a[140:141],v120 offset:16384
 ds_read_b64_tr_b16 a[142:143],v120 offset:20480
 v_mfma_f32_16x16x32_bf16 v[24:27],a[92:95],a[60:63],v[24:27]
 v_exp_f32 v9,v9
 v_mfma_f32_16x16x32_bf16 v[28:31],a[108:111],a[60:63],v[28:31]
 v_cvt_pk_bf16_f32 v44,v8,v9
 s_waitcnt vmcnt(4)
 buffer_load_dwordx4 v131,s[16:19],s32 offen offset:2048 nt lds
 v_mfma_f32_16x16x32_bf16 v[32:35],a[80:83],a[64:67],v[96:99]
 v_exp_f32 v10,v10
 v_mfma_f32_16x16x32_bf16 v[36:39],a[96:99],a[64:67],v[96:99]
 v_mfma_f32_16x16x32_bf16 v[32:35],a[84:87],a[68:71],v[32:35]
 v_exp_f32 v11,v11
 v_mfma_f32_16x16x32_bf16 v[36:39],a[100:103],a[68:71],v[36:39]
 v_cvt_pk_bf16_f32 v45,v10,v11
 v_mfma_f32_16x16x32_bf16 v[32:35],a[88:91],a[72:75],v[32:35]
 v_exp_f32 v12,v12
 v_mfma_f32_16x16x32_bf16 v[36:39],a[104:107],a[72:75],v[36:39]
 v_mfma_f32_16x16x32_bf16 v[32:35],a[92:95],a[76:79],v[32:35]
 v_exp_f32 v13,v13
 v_mfma_f32_16x16x32_bf16 v[36:39],a[108:111],a[76:79],v[36:39]
 v_cvt_pk_bf16_f32 v46,v12,v13
 s_waitcnt lgkmcnt(0)
 v_mfma_f32_16x16x32_bf16 v[144:147],a[112:115],v[60:63],v[144:147]
 s_barrier
 v_exp_f32 v14,v14
 v_mfma_f32_16x16x32_bf16 v[148:151],a[116:119],v[60:63],v[148:151]
 v_mfma_f32_16x16x32_bf16 v[152:155],a[120:123],v[60:63],v[152:155]
 v_exp_f32 v15,v15
 v_mfma_f32_16x16x32_bf16 v[156:159],a[124:127],v[60:63],v[156:159]
 v_cvt_pk_bf16_f32 v47,v14,v15
 v_mfma_f32_16x16x32_bf16 v[160:163],a[128:131],v[60:63],v[160:163]
 v_exp_f32 v16,v16
 v_mfma_f32_16x16x32_bf16 v[164:167],a[132:135],v[60:63],v[164:167]
 ds_read_b128 a[80:83],v105 offset:16384
 s_waitcnt vmcnt(4)
 buffer_load_dwordx4 v132,s[16:19],s32 offen offset:3072 nt lds
 v_mfma_f32_16x16x32_bf16 v[168:171],a[136:139],v[60:63],v[168:171]
 v_exp_f32 v17,v17
 v_mfma_f32_16x16x32_bf16 v[172:175],a[140:143],v[60:63],v[172:175]
 v_cvt_pk_bf16_f32 v48,v16,v17
 v_mfma_f32_16x16x32_bf16 a[192:195],a[212:215],v[60:63],a[192:195]
 ds_read_b128 a[96:99],v105 offset:20480
 v_mfma_f32_16x16x32_bf16 v[176:179],a[112:115],v[64:67],v[176:179]
 v_exp_f32 v18,v18
 v_mfma_f32_16x16x32_bf16 v[180:183],a[116:119],v[64:67],v[180:183]
 ds_read_b128 a[84:87],v106 offset:16384
 v_mfma_f32_16x16x32_bf16 v[184:187],a[120:123],v[64:67],v[184:187]
 v_exp_f32 v19,v19
 v_mfma_f32_16x16x32_bf16 v[188:191],a[124:127],v[64:67],v[188:191]
 v_cvt_pk_bf16_f32 v49,v18,v19
 s_add_u32 m0,s34,0x18000
 v_mfma_f32_16x16x32_bf16 v[192:195],a[128:131],v[64:67],v[192:195]
 v_exp_f32 v20,v20
 s_xor_b32 s33,s57,0x2e000
 v_mfma_f32_16x16x32_bf16 v[196:199],a[132:135],v[64:67],v[196:199]
 s_waitcnt vmcnt(4)
 buffer_load_dwordx4 v133,s[20:23],s33 offen offset:0 nt lds
 v_mfma_f32_16x16x32_bf16 v[200:203],a[136:139],v[64:67],v[200:203]
 v_exp_f32 v21,v21
 v_mfma_f32_16x16x32_bf16 v[204:207],a[140:143],v[64:67],v[204:207]
 v_cvt_pk_bf16_f32 v50,v20,v21
 v_mfma_f32_16x16x32_bf16 a[196:199],a[212:215],v[64:67],a[196:199]
 ds_read_b128 a[100:103],v106 offset:20480
 v_mfma_f32_16x16x32_bf16 v[208:211],a[112:115],v[68:71],v[208:211]
 v_exp_f32 v22,v22
 v_mfma_f32_16x16x32_bf16 v[212:215],a[116:119],v[68:71],v[212:215]
 ds_read_b128 a[88:91],v107 offset:16384
 v_mfma_f32_16x16x32_bf16 v[216:219],a[120:123],v[68:71],v[216:219]
 v_exp_f32 v23,v23
 v_mfma_f32_16x16x32_bf16 v[220:223],a[124:127],v[68:71],v[220:223]
 v_cvt_pk_bf16_f32 v51,v22,v23
 v_mfma_f32_16x16x32_bf16 v[224:227],a[128:131],v[68:71],v[224:227]
 v_exp_f32 v24,v24
 v_mfma_f32_16x16x32_bf16 v[228:231],a[132:135],v[68:71],v[228:231]
 ds_read_b128 a[104:107],v107 offset:20480
 v_mfma_f32_16x16x32_bf16 v[232:235],a[136:139],v[68:71],v[232:235]
 v_exp_f32 v25,v25
 v_mfma_f32_16x16x32_bf16 v[236:239],a[140:143],v[68:71],v[236:239]
 v_cvt_pk_bf16_f32 v52,v24,v25
 s_waitcnt vmcnt(4)
 buffer_load_dwordx4 v134,s[20:23],s33 offen offset:1024 nt lds
 v_mfma_f32_16x16x32_bf16 a[200:203],a[212:215],v[68:71],a[200:203]
 v_mfma_f32_16x16x32_bf16 v[240:243],a[112:115],v[72:75],v[240:243]
 v_exp_f32 v26,v26
 v_mfma_f32_16x16x32_bf16 v[244:247],a[116:119],v[72:75],v[244:247]
 ds_read_b128 a[92:95],v108 offset:16384
 v_mfma_f32_16x16x32_bf16 v[248:251],a[120:123],v[72:75],v[248:251]
 v_exp_f32 v27,v27
 v_mfma_f32_16x16x32_bf16 v[252:255],a[124:127],v[72:75],v[252:255]
 v_cvt_pk_bf16_f32 v53,v26,v27
 v_mfma_f32_16x16x32_bf16 a[144:147],a[128:131],v[72:75],a[144:147]
 v_exp_f32 v28,v28
 v_mfma_f32_16x16x32_bf16 a[148:151],a[132:135],v[72:75],a[148:151]
 ds_read_b128 a[108:111],v108 offset:20480
 v_mfma_f32_16x16x32_bf16 a[152:155],a[136:139],v[72:75],a[152:155]
 v_exp_f32 v29,v29
 v_mfma_f32_16x16x32_bf16 a[156:159],a[140:143],v[72:75],a[156:159]
 v_cvt_pk_bf16_f32 v54,v28,v29
 s_waitcnt vmcnt(4)
 buffer_load_dwordx4 v133,s[20:23],s33 offen offset:2048 nt lds
 v_mfma_f32_16x16x32_bf16 a[204:207],a[212:215],v[72:75],a[204:207]
 v_mfma_f32_16x16x32_bf16 a[160:163],a[112:115],v[76:79],a[160:163]
 v_exp_f32 v30,v30
 v_mfma_f32_16x16x32_bf16 a[164:167],a[116:119],v[76:79],a[164:167]
 v_mfma_f32_16x16x32_bf16 a[168:171],a[120:123],v[76:79],a[168:171]
 v_exp_f32 v31,v31
 v_mfma_f32_16x16x32_bf16 a[172:175],a[124:127],v[76:79],a[172:175]
 v_cvt_pk_bf16_f32 v55,v30,v31
 v_mfma_f32_16x16x32_bf16 a[176:179],a[128:131],v[76:79],a[176:179]
 v_exp_f32 v32,v32
 v_mfma_f32_16x16x32_bf16 a[180:183],a[132:135],v[76:79],a[180:183]
 v_mfma_f32_16x16x32_bf16 a[184:187],a[136:139],v[76:79],a[184:187]
 v_exp_f32 v33,v33
 v_mfma_f32_16x16x32_bf16 a[188:191],a[140:143],v[76:79],a[188:191]
 v_cvt_pk_bf16_f32 v56,v32,v33
 v_mfma_f32_16x16x32_bf16 a[208:211],a[212:215],v[76:79],a[208:211]
 s_waitcnt lgkmcnt(0)
 v_mfma_f32_16x16x32_bf16 v[0:3],a[80:83],a[0:3],v[80:83]
 v_exp_f32 v34,v34
 v_mfma_f32_16x16x32_bf16 v[4:7],a[96:99],a[0:3],v[80:83]
 ds_read_b64_tr_b16 a[112:113],v113 offset:32768
 ds_read_b64_tr_b16 a[114:115],v113 offset:36864
 v_mfma_f32_16x16x32_bf16 v[0:3],a[84:87],a[4:7],v[0:3]
 v_exp_f32 v35,v35
 v_mfma_f32_16x16x32_bf16 v[4:7],a[100:103],a[4:7],v[4:7]
 v_cvt_pk_bf16_f32 v57,v34,v35
 v_mfma_f32_16x16x32_bf16 v[0:3],a[88:91],a[8:11],v[0:3]
 v_exp_f32 v36,v36
 v_mfma_f32_16x16x32_bf16 v[4:7],a[104:107],a[8:11],v[4:7]
 ds_read_b64_tr_b16 a[116:117],v114 offset:32768
 ds_read_b64_tr_b16 a[118:119],v114 offset:36864
 v_mfma_f32_16x16x32_bf16 v[0:3],a[92:95],a[12:15],v[0:3]
 v_exp_f32 v37,v37
 v_mfma_f32_16x16x32_bf16 v[4:7],a[108:111],a[12:15],v[4:7]
 v_cvt_pk_bf16_f32 v58,v36,v37
 s_waitcnt vmcnt(4)
 buffer_load_dwordx4 v134,s[20:23],s33 offen offset:3072 nt lds
 v_mfma_f32_16x16x32_bf16 v[8:11],a[80:83],a[16:19],v[84:87]
 v_exp_f32 v38,v38
 v_mfma_f32_16x16x32_bf16 v[12:15],a[96:99],a[16:19],v[84:87]
 ds_read_b64_tr_b16 a[120:121],v115 offset:32768
 ds_read_b64_tr_b16 a[122:123],v115 offset:36864
 v_mfma_f32_16x16x32_bf16 v[8:11],a[84:87],a[20:23],v[8:11]
 v_exp_f32 v39,v39
 v_mfma_f32_16x16x32_bf16 v[12:15],a[100:103],a[20:23],v[12:15]
 v_cvt_pk_bf16_f32 v59,v38,v39
 v_mfma_f32_16x16x32_bf16 v[8:11],a[88:91],a[24:27],v[8:11]
 v_exp_f32 v0,v0
 v_mfma_f32_16x16x32_bf16 v[12:15],a[104:107],a[24:27],v[12:15]
 ds_read_b64_tr_b16 a[124:125],v116 offset:32768
 ds_read_b64_tr_b16 a[126:127],v116 offset:36864
 v_mfma_f32_16x16x32_bf16 v[8:11],a[92:95],a[28:31],v[8:11]
 v_exp_f32 v1,v1
 v_mfma_f32_16x16x32_bf16 v[12:15],a[108:111],a[28:31],v[12:15]
 v_cvt_pk_bf16_f32 v60,v0,v1
 v_mfma_f32_16x16x32_bf16 v[16:19],a[80:83],a[32:35],v[88:91]
 v_exp_f32 v2,v2
 v_mfma_f32_16x16x32_bf16 v[20:23],a[96:99],a[32:35],v[88:91]
 ds_read_b64_tr_b16 a[128:129],v117 offset:32768
 ds_read_b64_tr_b16 a[130:131],v117 offset:36864
 s_add_u32 m0,s34,0x10000
 v_mfma_f32_16x16x32_bf16 v[16:19],a[84:87],a[36:39],v[16:19]
 v_exp_f32 v3,v3
 s_xor_b32 s32,s57,0x30000
 v_mfma_f32_16x16x32_bf16 v[20:23],a[100:103],a[36:39],v[20:23]
 v_cvt_pk_bf16_f32 v61,v2,v3
 s_waitcnt vmcnt(3)
 buffer_load_dwordx4 v129,s[16:19],s32 offen offset:0 nt lds
 v_mfma_f32_16x16x32_bf16 v[16:19],a[88:91],a[40:43],v[16:19]
 v_exp_f32 v4,v4
 v_mfma_f32_16x16x32_bf16 v[20:23],a[104:107],a[40:43],v[20:23]
 ds_read_b64_tr_b16 a[132:133],v118 offset:32768
 ds_read_b64_tr_b16 a[134:135],v118 offset:36864
 v_mfma_f32_16x16x32_bf16 v[16:19],a[92:95],a[44:47],v[16:19]
 v_exp_f32 v5,v5
 v_mfma_f32_16x16x32_bf16 v[20:23],a[108:111],a[44:47],v[20:23]
 v_cvt_pk_bf16_f32 v62,v4,v5
 v_mfma_f32_16x16x32_bf16 v[24:27],a[80:83],a[48:51],v[92:95]
 v_exp_f32 v6,v6
 v_mfma_f32_16x16x32_bf16 v[28:31],a[96:99],a[48:51],v[92:95]
 ds_read_b64_tr_b16 a[136:137],v119 offset:32768
 ds_read_b64_tr_b16 a[138:139],v119 offset:36864
 v_mfma_f32_16x16x32_bf16 v[24:27],a[84:87],a[52:55],v[24:27]
 v_exp_f32 v7,v7
 v_mfma_f32_16x16x32_bf16 v[28:31],a[100:103],a[52:55],v[28:31]
 v_cvt_pk_bf16_f32 v63,v6,v7
 v_mfma_f32_16x16x32_bf16 v[24:27],a[88:91],a[56:59],v[24:27]
 v_exp_f32 v8,v8
 v_mfma_f32_16x16x32_bf16 v[28:31],a[104:107],a[56:59],v[28:31]
 ds_read_b64_tr_b16 a[140:141],v120 offset:32768
 ds_read_b64_tr_b16 a[142:143],v120 offset:36864
 v_mfma_f32_16x16x32_bf16 v[24:27],a[92:95],a[60:63],v[24:27]
 v_exp_f32 v9,v9
 v_mfma_f32_16x16x32_bf16 v[28:31],a[108:111],a[60:63],v[28:31]
 v_cvt_pk_bf16_f32 v64,v8,v9
 s_waitcnt vmcnt(4)
 buffer_load_dwordx4 v130,s[16:19],s32 offen offset:1024 nt lds
 v_mfma_f32_16x16x32_bf16 v[32:35],a[80:83],a[64:67],v[96:99]
 v_exp_f32 v10,v10
 v_mfma_f32_16x16x32_bf16 v[36:39],a[96:99],a[64:67],v[96:99]
 v_mfma_f32_16x16x32_bf16 v[32:35],a[84:87],a[68:71],v[32:35]
 v_exp_f32 v11,v11
 v_mfma_f32_16x16x32_bf16 v[36:39],a[100:103],a[68:71],v[36:39]
 v_cvt_pk_bf16_f32 v65,v10,v11
 v_mfma_f32_16x16x32_bf16 v[32:35],a[88:91],a[72:75],v[32:35]
 v_exp_f32 v12,v12
 v_mfma_f32_16x16x32_bf16 v[36:39],a[104:107],a[72:75],v[36:39]
 v_mfma_f32_16x16x32_bf16 v[32:35],a[92:95],a[76:79],v[32:35]
 v_exp_f32 v13,v13
 v_mfma_f32_16x16x32_bf16 v[36:39],a[108:111],a[76:79],v[36:39]
 v_cvt_pk_bf16_f32 v66,v12,v13
 s_waitcnt lgkmcnt(0)
 v_mfma_f32_16x16x32_bf16 v[144:147],a[112:115],v[40:43],v[144:147]
 s_barrier
 v_exp_f32 v14,v14
 v_mfma_f32_16x16x32_bf16 v[148:151],a[116:119],v[40:43],v[148:151]
 v_mfma_f32_16x16x32_bf16 v[152:155],a[120:123],v[40:43],v[152:155]
 v_exp_f32 v15,v15
 v_mfma_f32_16x16x32_bf16 v[156:159],a[124:127],v[40:43],v[156:159]
 v_cvt_pk_bf16_f32 v67,v14,v15
 v_mfma_f32_16x16x32_bf16 v[160:163],a[128:131],v[40:43],v[160:163]
 v_exp_f32 v16,v16
 v_mfma_f32_16x16x32_bf16 v[164:167],a[132:135],v[40:43],v[164:167]
 ds_read_b128 a[80:83],v105 offset:32768
 s_waitcnt vmcnt(4)
 buffer_load_dwordx4 v131,s[16:19],s32 offen offset:2048 nt lds
 v_mfma_f32_16x16x32_bf16 v[168:171],a[136:139],v[40:43],v[168:171]
 v_exp_f32 v17,v17
 v_mfma_f32_16x16x32_bf16 v[172:175],a[140:143],v[40:43],v[172:175]
 v_cvt_pk_bf16_f32 v68,v16,v17
 v_mfma_f32_16x16x32_bf16 a[192:195],a[212:215],v[40:43],a[192:195]
 ds_read_b128 a[96:99],v105 offset:36864
 v_mfma_f32_16x16x32_bf16 v[176:179],a[112:115],v[44:47],v[176:179]
 v_exp_f32 v18,v18
 v_mfma_f32_16x16x32_bf16 v[180:183],a[116:119],v[44:47],v[180:183]
 ds_read_b128 a[84:87],v106 offset:32768
 v_mfma_f32_16x16x32_bf16 v[184:187],a[120:123],v[44:47],v[184:187]
 v_exp_f32 v19,v19
 v_mfma_f32_16x16x32_bf16 v[188:191],a[124:127],v[44:47],v[188:191]
 v_cvt_pk_bf16_f32 v69,v18,v19
 v_mfma_f32_16x16x32_bf16 v[192:195],a[128:131],v[44:47],v[192:195]
 v_exp_f32 v20,v20
 v_mfma_f32_16x16x32_bf16 v[196:199],a[132:135],v[44:47],v[196:199]
 s_waitcnt vmcnt(4)
 buffer_load_dwordx4 v132,s[16:19],s32 offen offset:3072 nt lds
 v_mfma_f32_16x16x32_bf16 v[200:203],a[136:139],v[44:47],v[200:203]
 v_exp_f32 v21,v21
 v_mfma_f32_16x16x32_bf16 v[204:207],a[140:143],v[44:47],v[204:207]
 v_cvt_pk_bf16_f32 v70,v20,v21
 v_mfma_f32_16x16x32_bf16 a[196:199],a[212:215],v[44:47],a[196:199]
 ds_read_b128 a[100:103],v106 offset:36864
 v_mfma_f32_16x16x32_bf16 v[208:211],a[112:115],v[48:51],v[208:211]
 v_exp_f32 v22,v22
 v_mfma_f32_16x16x32_bf16 v[212:215],a[116:119],v[48:51],v[212:215]
 ds_read_b128 a[88:91],v107 offset:32768
 v_mfma_f32_16x16x32_bf16 v[216:219],a[120:123],v[48:51],v[216:219]
 v_exp_f32 v23,v23
 v_mfma_f32_16x16x32_bf16 v[220:223],a[124:127],v[48:51],v[220:223]
 v_cvt_pk_bf16_f32 v71,v22,v23
 v_mfma_f32_16x16x32_bf16 v[224:227],a[128:131],v[48:51],v[224:227]
 v_exp_f32 v24,v24
 v_mfma_f32_16x16x32_bf16 v[228:231],a[132:135],v[48:51],v[228:231]
 ds_read_b128 a[104:107],v107 offset:36864
 s_add_u32 m0,s34,0x1c000
 v_mfma_f32_16x16x32_bf16 v[232:235],a[136:139],v[48:51],v[232:235]
 v_exp_f32 v25,v25
 s_xor_b32 s33,s57,0x30000
 v_mfma_f32_16x16x32_bf16 v[236:239],a[140:143],v[48:51],v[236:239]
 v_cvt_pk_bf16_f32 v72,v24,v25
 s_waitcnt vmcnt(3)
 buffer_load_dwordx4 v133,s[20:23],s33 offen offset:0 nt lds
 v_mfma_f32_16x16x32_bf16 a[200:203],a[212:215],v[48:51],a[200:203]
 v_mfma_f32_16x16x32_bf16 v[240:243],a[112:115],v[52:55],v[240:243]
 v_exp_f32 v26,v26
 v_mfma_f32_16x16x32_bf16 v[244:247],a[116:119],v[52:55],v[244:247]
 ds_read_b128 a[92:95],v108 offset:32768
 v_mfma_f32_16x16x32_bf16 v[248:251],a[120:123],v[52:55],v[248:251]
 v_exp_f32 v27,v27
 v_mfma_f32_16x16x32_bf16 v[252:255],a[124:127],v[52:55],v[252:255]
 v_cvt_pk_bf16_f32 v73,v26,v27
 v_mfma_f32_16x16x32_bf16 a[144:147],a[128:131],v[52:55],a[144:147]
 v_exp_f32 v28,v28
 v_mfma_f32_16x16x32_bf16 a[148:151],a[132:135],v[52:55],a[148:151]
 ds_read_b128 a[108:111],v108 offset:36864
 v_mfma_f32_16x16x32_bf16 a[152:155],a[136:139],v[52:55],a[152:155]
 v_exp_f32 v29,v29
 v_mfma_f32_16x16x32_bf16 a[156:159],a[140:143],v[52:55],a[156:159]
 v_cvt_pk_bf16_f32 v74,v28,v29
 s_waitcnt vmcnt(4)
 buffer_load_dwordx4 v134,s[20:23],s33 offen offset:1024 nt lds
 v_mfma_f32_16x16x32_bf16 a[204:207],a[212:215],v[52:55],a[204:207]
 v_mfma_f32_16x16x32_bf16 a[160:163],a[112:115],v[56:59],a[160:163]
 v_exp_f32 v30,v30
 v_mfma_f32_16x16x32_bf16 a[164:167],a[116:119],v[56:59],a[164:167]
 v_mfma_f32_16x16x32_bf16 a[168:171],a[120:123],v[56:59],a[168:171]
 v_exp_f32 v31,v31
 v_mfma_f32_16x16x32_bf16 a[172:175],a[124:127],v[56:59],a[172:175]
 v_cvt_pk_bf16_f32 v75,v30,v31
 v_mfma_f32_16x16x32_bf16 a[176:179],a[128:131],v[56:59],a[176:179]
 v_exp_f32 v32,v32
 v_mfma_f32_16x16x32_bf16 a[180:183],a[132:135],v[56:59],a[180:183]
 v_mfma_f32_16x16x32_bf16 a[184:187],a[136:139],v[56:59],a[184:187]
 v_exp_f32 v33,v33
 v_mfma_f32_16x16x32_bf16 a[188:191],a[140:143],v[56:59],a[188:191]
 v_cvt_pk_bf16_f32 v76,v32,v33
 v_mfma_f32_16x16x32_bf16 a[208:211],a[212:215],v[56:59],a[208:211]
 s_waitcnt lgkmcnt(0)
 v_mfma_f32_16x16x32_bf16 v[0:3],a[80:83],a[0:3],v[80:83]
 v_exp_f32 v34,v34
 v_mfma_f32_16x16x32_bf16 v[4:7],a[96:99],a[0:3],v[80:83]
 ds_read_b64_tr_b16 a[112:113],v113 offset:49152
 ds_read_b64_tr_b16 a[114:115],v113 offset:53248
 v_mfma_f32_16x16x32_bf16 v[0:3],a[84:87],a[4:7],v[0:3]
 v_exp_f32 v35,v35
 v_mfma_f32_16x16x32_bf16 v[4:7],a[100:103],a[4:7],v[4:7]
 v_cvt_pk_bf16_f32 v77,v34,v35
 v_mfma_f32_16x16x32_bf16 v[0:3],a[88:91],a[8:11],v[0:3]
 v_exp_f32 v36,v36
 v_mfma_f32_16x16x32_bf16 v[4:7],a[104:107],a[8:11],v[4:7]
 ds_read_b64_tr_b16 a[116:117],v114 offset:49152
 ds_read_b64_tr_b16 a[118:119],v114 offset:53248
 v_mfma_f32_16x16x32_bf16 v[0:3],a[92:95],a[12:15],v[0:3]
 v_exp_f32 v37,v37
 v_mfma_f32_16x16x32_bf16 v[4:7],a[108:111],a[12:15],v[4:7]
 v_cvt_pk_bf16_f32 v78,v36,v37
 s_waitcnt vmcnt(4)
 buffer_load_dwordx4 v133,s[20:23],s33 offen offset:2048 nt lds
 v_mfma_f32_16x16x32_bf16 v[8:11],a[80:83],a[16:19],v[84:87]
 v_exp_f32 v38,v38
 v_mfma_f32_16x16x32_bf16 v[12:15],a[96:99],a[16:19],v[84:87]
 ds_read_b64_tr_b16 a[120:121],v115 offset:49152
 ds_read_b64_tr_b16 a[122:123],v115 offset:53248
 v_mfma_f32_16x16x32_bf16 v[8:11],a[84:87],a[20:23],v[8:11]
 v_exp_f32 v39,v39
 v_mfma_f32_16x16x32_bf16 v[12:15],a[100:103],a[20:23],v[12:15]
 v_cvt_pk_bf16_f32 v79,v38,v39
 v_mfma_f32_16x16x32_bf16 v[8:11],a[88:91],a[24:27],v[8:11]
 v_exp_f32 v0,v0
 v_mfma_f32_16x16x32_bf16 v[12:15],a[104:107],a[24:27],v[12:15]
 ds_read_b64_tr_b16 a[124:125],v116 offset:49152
 ds_read_b64_tr_b16 a[126:127],v116 offset:53248
 v_mfma_f32_16x16x32_bf16 v[8:11],a[92:95],a[28:31],v[8:11]
 v_exp_f32 v1,v1
 v_mfma_f32_16x16x32_bf16 v[12:15],a[108:111],a[28:31],v[12:15]
 v_cvt_pk_bf16_f32 v40,v0,v1
 s_waitcnt vmcnt(4)
 buffer_load_dwordx4 v134,s[20:23],s33 offen offset:3072 nt lds
 v_mfma_f32_16x16x32_bf16 v[16:19],a[80:83],a[32:35],v[88:91]
 v_exp_f32 v2,v2
 v_mfma_f32_16x16x32_bf16 v[20:23],a[96:99],a[32:35],v[88:91]
 ds_read_b64_tr_b16 a[128:129],v117 offset:49152
 ds_read_b64_tr_b16 a[130:131],v117 offset:53248
 v_mfma_f32_16x16x32_bf16 v[16:19],a[84:87],a[36:39],v[16:19]
 v_exp_f32 v3,v3
 v_mfma_f32_16x16x32_bf16 v[20:23],a[100:103],a[36:39],v[20:23]
 v_cvt_pk_bf16_f32 v41,v2,v3
 v_mfma_f32_16x16x32_bf16 v[16:19],a[88:91],a[40:43],v[16:19]
 v_exp_f32 v4,v4
 v_mfma_f32_16x16x32_bf16 v[20:23],a[104:107],a[40:43],v[20:23]
 ds_read_b64_tr_b16 a[132:133],v118 offset:49152
 ds_read_b64_tr_b16 a[134:135],v118 offset:53248
 s_add_u32 m0,s34,0x0
 v_mfma_f32_16x16x32_bf16 v[16:19],a[92:95],a[44:47],v[16:19]
 v_exp_f32 v5,v5
 s_xor_b32 s32,s57,0x32000
 v_mfma_f32_16x16x32_bf16 v[20:23],a[108:111],a[44:47],v[20:23]
 v_cvt_pk_bf16_f32 v42,v4,v5
 s_waitcnt vmcnt(4)
 buffer_load_dwordx4 v129,s[16:19],s32 offen offset:0 nt lds
 v_mfma_f32_16x16x32_bf16 v[24:27],a[80:83],a[48:51],v[92:95]
 v_exp_f32 v6,v6
 v_mfma_f32_16x16x32_bf16 v[28:31],a[96:99],a[48:51],v[92:95]
 ds_read_b64_tr_b16 a[136:137],v119 offset:49152
 ds_read_b64_tr_b16 a[138:139],v119 offset:53248
 v_mfma_f32_16x16x32_bf16 v[24:27],a[84:87],a[52:55],v[24:27]
 v_exp_f32 v7,v7
 v_mfma_f32_16x16x32_bf16 v[28:31],a[100:103],a[52:55],v[28:31]
 v_cvt_pk_bf16_f32 v43,v6,v7
 v_mfma_f32_16x16x32_bf16 v[24:27],a[88:91],a[56:59],v[24:27]
 v_exp_f32 v8,v8
 v_mfma_f32_16x16x32_bf16 v[28:31],a[104:107],a[56:59],v[28:31]
 ds_read_b64_tr_b16 a[140:141],v120 offset:49152
 ds_read_b64_tr_b16 a[142:143],v120 offset:53248
 v_mfma_f32_16x16x32_bf16 v[24:27],a[92:95],a[60:63],v[24:27]
 v_exp_f32 v9,v9
 v_mfma_f32_16x16x32_bf16 v[28:31],a[108:111],a[60:63],v[28:31]
 v_cvt_pk_bf16_f32 v44,v8,v9
 s_waitcnt vmcnt(4)
 buffer_load_dwordx4 v130,s[16:19],s32 offen offset:1024 nt lds
 v_mfma_f32_16x16x32_bf16 v[32:35],a[80:83],a[64:67],v[96:99]
 v_exp_f32 v10,v10
 v_mfma_f32_16x16x32_bf16 v[36:39],a[96:99],a[64:67],v[96:99]
 v_mfma_f32_16x16x32_bf16 v[32:35],a[84:87],a[68:71],v[32:35]
 v_exp_f32 v11,v11
 v_mfma_f32_16x16x32_bf16 v[36:39],a[100:103],a[68:71],v[36:39]
 v_cvt_pk_bf16_f32 v45,v10,v11
 v_mfma_f32_16x16x32_bf16 v[32:35],a[88:91],a[72:75],v[32:35]
 v_exp_f32 v12,v12
 v_mfma_f32_16x16x32_bf16 v[36:39],a[104:107],a[72:75],v[36:39]
 v_mfma_f32_16x16x32_bf16 v[32:35],a[92:95],a[76:79],v[32:35]
 v_exp_f32 v13,v13
 v_mfma_f32_16x16x32_bf16 v[36:39],a[108:111],a[76:79],v[36:39]
 v_cvt_pk_bf16_f32 v46,v12,v13
 s_waitcnt lgkmcnt(0)
 v_mfma_f32_16x16x32_bf16 v[144:147],a[112:115],v[60:63],v[144:147]
 s_barrier
 v_exp_f32 v14,v14
 v_mfma_f32_16x16x32_bf16 v[148:151],a[116:119],v[60:63],v[148:151]
 v_mfma_f32_16x16x32_bf16 v[152:155],a[120:123],v[60:63],v[152:155]
 v_exp_f32 v15,v15
 v_mfma_f32_16x16x32_bf16 v[156:159],a[124:127],v[60:63],v[156:159]
 v_cvt_pk_bf16_f32 v47,v14,v15
 v_mfma_f32_16x16x32_bf16 v[160:163],a[128:131],v[60:63],v[160:163]
 v_exp_f32 v16,v16
 v_mfma_f32_16x16x32_bf16 v[164:167],a[132:135],v[60:63],v[164:167]
 ds_read_b128 a[80:83],v105 offset:49152
 s_waitcnt vmcnt(4)
 buffer_load_dwordx4 v131,s[16:19],s32 offen offset:2048 nt lds
 v_mfma_f32_16x16x32_bf16 v[168:171],a[136:139],v[60:63],v[168:171]
 v_exp_f32 v17,v17
 v_mfma_f32_16x16x32_bf16 v[172:175],a[140:143],v[60:63],v[172:175]
 v_cvt_pk_bf16_f32 v48,v16,v17
 v_mfma_f32_16x16x32_bf16 a[192:195],a[212:215],v[60:63],a[192:195]
 ds_read_b128 a[96:99],v105 offset:53248
 v_mfma_f32_16x16x32_bf16 v[176:179],a[112:115],v[64:67],v[176:179]
 v_exp_f32 v18,v18
 v_mfma_f32_16x16x32_bf16 v[180:183],a[116:119],v[64:67],v[180:183]
 ds_read_b128 a[84:87],v106 offset:49152
 v_mfma_f32_16x16x32_bf16 v[184:187],a[120:123],v[64:67],v[184:187]
 v_exp_f32 v19,v19
 v_mfma_f32_16x16x32_bf16 v[188:191],a[124:127],v[64:67],v[188:191]
 v_cvt_pk_bf16_f32 v49,v18,v19
 v_mfma_f32_16x16x32_bf16 v[192:195],a[128:131],v[64:67],v[192:195]
 v_exp_f32 v20,v20
 v_mfma_f32_16x16x32_bf16 v[196:199],a[132:135],v[64:67],v[196:199]
 v_mfma_f32_16x16x32_bf16 v[200:203],a[136:139],v[64:67],v[200:203]
 v_exp_f32 v21,v21
 v_mfma_f32_16x16x32_bf16 v[204:207],a[140:143],v[64:67],v[204:207]
 v_cvt_pk_bf16_f32 v50,v20,v21
 v_mfma_f32_16x16x32_bf16 a[196:199],a[212:215],v[64:67],a[196:199]
 ds_read_b128 a[100:103],v106 offset:53248
 s_waitcnt vmcnt(4)
 buffer_load_dwordx4 v132,s[16:19],s32 offen offset:3072 nt lds
 v_mfma_f32_16x16x32_bf16 v[208:211],a[112:115],v[68:71],v[208:211]
 v_exp_f32 v22,v22
 v_mfma_f32_16x16x32_bf16 v[212:215],a[116:119],v[68:71],v[212:215]
 ds_read_b128 a[88:91],v107 offset:49152
 v_mfma_f32_16x16x32_bf16 v[216:219],a[120:123],v[68:71],v[216:219]
 v_exp_f32 v23,v23
 v_mfma_f32_16x16x32_bf16 v[220:223],a[124:127],v[68:71],v[220:223]
 v_cvt_pk_bf16_f32 v51,v22,v23
 v_mfma_f32_16x16x32_bf16 v[224:227],a[128:131],v[68:71],v[224:227]
 v_exp_f32 v24,v24
 v_mfma_f32_16x16x32_bf16 v[228:231],a[132:135],v[68:71],v[228:231]
 ds_read_b128 a[104:107],v107 offset:53248
 v_mfma_f32_16x16x32_bf16 v[232:235],a[136:139],v[68:71],v[232:235]
 v_exp_f32 v25,v25
 v_mfma_f32_16x16x32_bf16 v[236:239],a[140:143],v[68:71],v[236:239]
 v_cvt_pk_bf16_f32 v52,v24,v25
 v_mfma_f32_16x16x32_bf16 a[200:203],a[212:215],v[68:71],a[200:203]
 v_mfma_f32_16x16x32_bf16 v[240:243],a[112:115],v[72:75],v[240:243]
 v_exp_f32 v26,v26
 v_mfma_f32_16x16x32_bf16 v[244:247],a[116:119],v[72:75],v[244:247]
 ds_read_b128 a[92:95],v108 offset:49152
 v_mfma_f32_16x16x32_bf16 v[248:251],a[120:123],v[72:75],v[248:251]
 v_exp_f32 v27,v27
 v_mfma_f32_16x16x32_bf16 v[252:255],a[124:127],v[72:75],v[252:255]
 v_cvt_pk_bf16_f32 v53,v26,v27
 s_add_u32 m0,s34,0x20000
 v_mfma_f32_16x16x32_bf16 a[144:147],a[128:131],v[72:75],a[144:147]
 v_exp_f32 v28,v28
 s_xor_b32 s33,s57,0x32000
 v_mfma_f32_16x16x32_bf16 a[148:151],a[132:135],v[72:75],a[148:151]
 ds_read_b128 a[108:111],v108 offset:53248
 s_waitcnt vmcnt(4)
 buffer_load_dwordx4 v133,s[20:23],s33 offen offset:0 nt lds
 v_mfma_f32_16x16x32_bf16 a[152:155],a[136:139],v[72:75],a[152:155]
 v_exp_f32 v29,v29
 v_mfma_f32_16x16x32_bf16 a[156:159],a[140:143],v[72:75],a[156:159]
 v_cvt_pk_bf16_f32 v54,v28,v29
 v_mfma_f32_16x16x32_bf16 a[204:207],a[212:215],v[72:75],a[204:207]
 v_mfma_f32_16x16x32_bf16 a[160:163],a[112:115],v[76:79],a[160:163]
 v_exp_f32 v30,v30
 v_mfma_f32_16x16x32_bf16 a[164:167],a[116:119],v[76:79],a[164:167]
 v_mfma_f32_16x16x32_bf16 a[168:171],a[120:123],v[76:79],a[168:171]
 v_exp_f32 v31,v31
 v_mfma_f32_16x16x32_bf16 a[172:175],a[124:127],v[76:79],a[172:175]
 v_cvt_pk_bf16_f32 v55,v30,v31
 v_mfma_f32_16x16x32_bf16 a[176:179],a[128:131],v[76:79],a[176:179]
 v_exp_f32 v32,v32
 v_mfma_f32_16x16x32_bf16 a[180:183],a[132:135],v[76:79],a[180:183]
 v_mfma_f32_16x16x32_bf16 a[184:187],a[136:139],v[76:79],a[184:187]
 v_exp_f32 v33,v33
 v_mfma_f32_16x16x32_bf16 a[188:191],a[140:143],v[76:79],a[188:191]
 v_cvt_pk_bf16_f32 v56,v32,v33
 v_mfma_f32_16x16x32_bf16 a[208:211],a[212:215],v[76:79],a[208:211]
 s_waitcnt lgkmcnt(0)
 v_mfma_f32_16x16x32_bf16 v[0:3],a[80:83],a[0:3],v[80:83]
 v_exp_f32 v34,v34
 v_mfma_f32_16x16x32_bf16 v[4:7],a[96:99],a[0:3],v[80:83]
 ds_read_b64_tr_b16 a[112:113],v121 offset:0
 ds_read_b64_tr_b16 a[114:115],v121 offset:4096
 v_mfma_f32_16x16x32_bf16 v[0:3],a[84:87],a[4:7],v[0:3]
 v_exp_f32 v35,v35
 v_mfma_f32_16x16x32_bf16 v[4:7],a[100:103],a[4:7],v[4:7]
 v_cvt_pk_bf16_f32 v57,v34,v35
 v_mfma_f32_16x16x32_bf16 v[0:3],a[88:91],a[8:11],v[0:3]
 v_exp_f32 v36,v36
 v_mfma_f32_16x16x32_bf16 v[4:7],a[104:107],a[8:11],v[4:7]
 ds_read_b64_tr_b16 a[116:117],v122 offset:0
 ds_read_b64_tr_b16 a[118:119],v122 offset:4096
 v_mfma_f32_16x16x32_bf16 v[0:3],a[92:95],a[12:15],v[0:3]
 v_exp_f32 v37,v37
 v_mfma_f32_16x16x32_bf16 v[4:7],a[108:111],a[12:15],v[4:7]
 v_cvt_pk_bf16_f32 v58,v36,v37
 s_waitcnt vmcnt(4)
 buffer_load_dwordx4 v134,s[20:23],s33 offen offset:1024 nt lds
 v_mfma_f32_16x16x32_bf16 v[8:11],a[80:83],a[16:19],v[84:87]
 v_exp_f32 v38,v38
 v_mfma_f32_16x16x32_bf16 v[12:15],a[96:99],a[16:19],v[84:87]
 ds_read_b64_tr_b16 a[120:121],v123 offset:0
 ds_read_b64_tr_b16 a[122:123],v123 offset:4096
 v_mfma_f32_16x16x32_bf16 v[8:11],a[84:87],a[20:23],v[8:11]
 v_exp_f32 v39,v39
 v_mfma_f32_16x16x32_bf16 v[12:15],a[100:103],a[20:23],v[12:15]
 v_cvt_pk_bf16_f32 v59,v38,v39
 v_mfma_f32_16x16x32_bf16 v[8:11],a[88:91],a[24:27],v[8:11]
 v_exp_f32 v0,v0
 v_mfma_f32_16x16x32_bf16 v[12:15],a[104:107],a[24:27],v[12:15]
 ds_read_b64_tr_b16 a[124:125],v124 offset:0
 ds_read_b64_tr_b16 a[126:127],v124 offset:4096
 v_mfma_f32_16x16x32_bf16 v[8:11],a[92:95],a[28:31],v[8:11]
 v_exp_f32 v1,v1
 v_mfma_f32_16x16x32_bf16 v[12:15],a[108:111],a[28:31],v[12:15]
 v_cvt_pk_bf16_f32 v60,v0,v1
 s_waitcnt vmcnt(4)
 buffer_load_dwordx4 v133,s[20:23],s33 offen offset:2048 nt lds
 v_mfma_f32_16x16x32_bf16 v[16:19],a[80:83],a[32:35],v[88:91]
 v_exp_f32 v2,v2
 v_mfma_f32_16x16x32_bf16 v[20:23],a[96:99],a[32:35],v[88:91]
 ds_read_b64_tr_b16 a[128:129],v125 offset:0
 ds_read_b64_tr_b16 a[130:131],v125 offset:4096
 v_mfma_f32_16x16x32_bf16 v[16:19],a[84:87],a[36:39],v[16:19]
 v_exp_f32 v3,v3
 v_mfma_f32_16x16x32_bf16 v[20:23],a[100:103],a[36:39],v[20:23]
 v_cvt_pk_bf16_f32 v61,v2,v3
 v_mfma_f32_16x16x32_bf16 v[16:19],a[88:91],a[40:43],v[16:19]
 v_exp_f32 v4,v4
 v_mfma_f32_16x16x32_bf16 v[20:23],a[104:107],a[40:43],v[20:23]
 ds_read_b64_tr_b16 a[132:133],v126 offset:0
 ds_read_b64_tr_b16 a[134:135],v126 offset:4096
 v_mfma_f32_16x16x32_bf16 v[16:19],a[92:95],a[44:47],v[16:19]
 v_exp_f32 v5,v5
 v_mfma_f32_16x16x32_bf16 v[20:23],a[108:111],a[44:47],v[20:23]
 v_cvt_pk_bf16_f32 v62,v4,v5
 s_waitcnt vmcnt(4)
 buffer_load_dwordx4 v134,s[20:23],s33 offen offset:3072 nt lds
 v_mfma_f32_16x16x32_bf16 v[24:27],a[80:83],a[48:51],v[92:95]
 v_exp_f32 v6,v6
 v_mfma_f32_16x16x32_bf16 v[28:31],a[96:99],a[48:51],v[92:95]
 ds_read_b64_tr_b16 a[136:137],v127 offset:0
 ds_read_b64_tr_b16 a[138:139],v127 offset:4096
 v_mfma_f32_16x16x32_bf16 v[24:27],a[84:87],a[52:55],v[24:27]
 v_exp_f32 v7,v7
 v_mfma_f32_16x16x32_bf16 v[28:31],a[100:103],a[52:55],v[28:31]
 v_cvt_pk_bf16_f32 v63,v6,v7
 v_mfma_f32_16x16x32_bf16 v[24:27],a[88:91],a[56:59],v[24:27]
 v_exp_f32 v8,v8
 v_mfma_f32_16x16x32_bf16 v[28:31],a[104:107],a[56:59],v[28:31]
 ds_read_b64_tr_b16 a[140:141],v128 offset:0
 ds_read_b64_tr_b16 a[142:143],v128 offset:4096
 s_add_u32 m0,s34,0x4000
 v_mfma_f32_16x16x32_bf16 v[24:27],a[92:95],a[60:63],v[24:27]
 v_exp_f32 v9,v9
 s_xor_b32 s32,s57,0x34000
 v_mfma_f32_16x16x32_bf16 v[28:31],a[108:111],a[60:63],v[28:31]
 v_cvt_pk_bf16_f32 v64,v8,v9
 s_waitcnt vmcnt(4)
 buffer_load_dwordx4 v129,s[16:19],s32 offen offset:0 nt lds
 v_mfma_f32_16x16x32_bf16 v[32:35],a[80:83],a[64:67],v[96:99]
 v_exp_f32 v10,v10
 v_mfma_f32_16x16x32_bf16 v[36:39],a[96:99],a[64:67],v[96:99]
 v_mfma_f32_16x16x32_bf16 v[32:35],a[84:87],a[68:71],v[32:35]
 v_exp_f32 v11,v11
 v_mfma_f32_16x16x32_bf16 v[36:39],a[100:103],a[68:71],v[36:39]
 v_cvt_pk_bf16_f32 v65,v10,v11
 v_mfma_f32_16x16x32_bf16 v[32:35],a[88:91],a[72:75],v[32:35]
 v_exp_f32 v12,v12
 v_mfma_f32_16x16x32_bf16 v[36:39],a[104:107],a[72:75],v[36:39]
 v_mfma_f32_16x16x32_bf16 v[32:35],a[92:95],a[76:79],v[32:35]
 v_exp_f32 v13,v13
 v_mfma_f32_16x16x32_bf16 v[36:39],a[108:111],a[76:79],v[36:39]
 v_cvt_pk_bf16_f32 v66,v12,v13
 s_waitcnt lgkmcnt(0)
 v_mfma_f32_16x16x32_bf16 v[144:147],a[112:115],v[40:43],v[144:147]
 s_barrier
 v_exp_f32 v14,v14
 v_mfma_f32_16x16x32_bf16 v[148:151],a[116:119],v[40:43],v[148:151]
 v_mfma_f32_16x16x32_bf16 v[152:155],a[120:123],v[40:43],v[152:155]
 v_exp_f32 v15,v15
 v_mfma_f32_16x16x32_bf16 v[156:159],a[124:127],v[40:43],v[156:159]
 v_cvt_pk_bf16_f32 v67,v14,v15
 v_mfma_f32_16x16x32_bf16 v[160:163],a[128:131],v[40:43],v[160:163]
 v_exp_f32 v16,v16
 v_mfma_f32_16x16x32_bf16 v[164:167],a[132:135],v[40:43],v[164:167]
 ds_read_b128 a[80:83],v109 offset:0
 s_waitcnt vmcnt(4)
 buffer_load_dwordx4 v130,s[16:19],s32 offen offset:1024 nt lds
 v_mfma_f32_16x16x32_bf16 v[168:171],a[136:139],v[40:43],v[168:171]
 v_exp_f32 v17,v17
 v_mfma_f32_16x16x32_bf16 v[172:175],a[140:143],v[40:43],v[172:175]
 v_cvt_pk_bf16_f32 v68,v16,v17
 v_mfma_f32_16x16x32_bf16 a[192:195],a[212:215],v[40:43],a[192:195]
 ds_read_b128 a[96:99],v109 offset:4096
 v_mfma_f32_16x16x32_bf16 v[176:179],a[112:115],v[44:47],v[176:179]
 v_exp_f32 v18,v18
 v_mfma_f32_16x16x32_bf16 v[180:183],a[116:119],v[44:47],v[180:183]
 ds_read_b128 a[84:87],v110 offset:0
 v_mfma_f32_16x16x32_bf16 v[184:187],a[120:123],v[44:47],v[184:187]
 v_exp_f32 v19,v19
 v_mfma_f32_16x16x32_bf16 v[188:191],a[124:127],v[44:47],v[188:191]
 v_cvt_pk_bf16_f32 v69,v18,v19
 v_mfma_f32_16x16x32_bf16 v[192:195],a[128:131],v[44:47],v[192:195]
 v_exp_f32 v20,v20
 v_mfma_f32_16x16x32_bf16 v[196:199],a[132:135],v[44:47],v[196:199]
 s_waitcnt vmcnt(4)
 buffer_load_dwordx4 v131,s[16:19],s32 offen offset:2048 nt lds
 v_mfma_f32_16x16x32_bf16 v[200:203],a[136:139],v[44:47],v[200:203]
 v_exp_f32 v21,v21
 v_mfma_f32_16x16x32_bf16 v[204:207],a[140:143],v[44:47],v[204:207]
 v_cvt_pk_bf16_f32 v70,v20,v21
 v_mfma_f32_16x16x32_bf16 a[196:199],a[212:215],v[44:47],a[196:199]
 ds_read_b128 a[100:103],v110 offset:4096
 v_mfma_f32_16x16x32_bf16 v[208:211],a[112:115],v[48:51],v[208:211]
 v_exp_f32 v22,v22
 v_mfma_f32_16x16x32_bf16 v[212:215],a[116:119],v[48:51],v[212:215]
 ds_read_b128 a[88:91],v111 offset:0
 v_mfma_f32_16x16x32_bf16 v[216:219],a[120:123],v[48:51],v[216:219]
 v_exp_f32 v23,v23
 v_mfma_f32_16x16x32_bf16 v[220:223],a[124:127],v[48:51],v[220:223]
 v_cvt_pk_bf16_f32 v71,v22,v23
 v_mfma_f32_16x16x32_bf16 v[224:227],a[128:131],v[48:51],v[224:227]
 v_exp_f32 v24,v24
 v_mfma_f32_16x16x32_bf16 v[228:231],a[132:135],v[48:51],v[228:231]
 ds_read_b128 a[104:107],v111 offset:4096
 v_mfma_f32_16x16x32_bf16 v[232:235],a[136:139],v[48:51],v[232:235]
 v_exp_f32 v25,v25
 v_mfma_f32_16x16x32_bf16 v[236:239],a[140:143],v[48:51],v[236:239]
 v_cvt_pk_bf16_f32 v72,v24,v25
 s_waitcnt vmcnt(4)
 buffer_load_dwordx4 v132,s[16:19],s32 offen offset:3072 nt lds
 v_mfma_f32_16x16x32_bf16 a[200:203],a[212:215],v[48:51],a[200:203]
 v_mfma_f32_16x16x32_bf16 v[240:243],a[112:115],v[52:55],v[240:243]
 v_exp_f32 v26,v26
 v_mfma_f32_16x16x32_bf16 v[244:247],a[116:119],v[52:55],v[244:247]
 ds_read_b128 a[92:95],v112 offset:0
 v_mfma_f32_16x16x32_bf16 v[248:251],a[120:123],v[52:55],v[248:251]
 v_exp_f32 v27,v27
 v_mfma_f32_16x16x32_bf16 v[252:255],a[124:127],v[52:55],v[252:255]
 v_cvt_pk_bf16_f32 v73,v26,v27
 v_mfma_f32_16x16x32_bf16 a[144:147],a[128:131],v[52:55],a[144:147]
 v_exp_f32 v28,v28
 v_mfma_f32_16x16x32_bf16 a[148:151],a[132:135],v[52:55],a[148:151]
 ds_read_b128 a[108:111],v112 offset:4096
 s_add_u32 m0,s34,0x24000
 v_mfma_f32_16x16x32_bf16 a[152:155],a[136:139],v[52:55],a[152:155]
 v_exp_f32 v29,v29
 s_xor_b32 s33,s57,0x34000
 v_mfma_f32_16x16x32_bf16 a[156:159],a[140:143],v[52:55],a[156:159]
 v_cvt_pk_bf16_f32 v74,v28,v29
 s_waitcnt vmcnt(4)
 buffer_load_dwordx4 v133,s[20:23],s33 offen offset:0 nt lds
 v_mfma_f32_16x16x32_bf16 a[204:207],a[212:215],v[52:55],a[204:207]
 v_mfma_f32_16x16x32_bf16 a[160:163],a[112:115],v[56:59],a[160:163]
 v_exp_f32 v30,v30
 v_mfma_f32_16x16x32_bf16 a[164:167],a[116:119],v[56:59],a[164:167]
 v_mfma_f32_16x16x32_bf16 a[168:171],a[120:123],v[56:59],a[168:171]
 v_exp_f32 v31,v31
 v_mfma_f32_16x16x32_bf16 a[172:175],a[124:127],v[56:59],a[172:175]
 v_cvt_pk_bf16_f32 v75,v30,v31
 v_mfma_f32_16x16x32_bf16 a[176:179],a[128:131],v[56:59],a[176:179]
 v_exp_f32 v32,v32
 v_mfma_f32_16x16x32_bf16 a[180:183],a[132:135],v[56:59],a[180:183]
 v_mfma_f32_16x16x32_bf16 a[184:187],a[136:139],v[56:59],a[184:187]
 v_exp_f32 v33,v33
 v_mfma_f32_16x16x32_bf16 a[188:191],a[140:143],v[56:59],a[188:191]
 v_cvt_pk_bf16_f32 v76,v32,v33
 v_mfma_f32_16x16x32_bf16 a[208:211],a[212:215],v[56:59],a[208:211]
 s_waitcnt lgkmcnt(0)
 v_mfma_f32_16x16x32_bf16 v[0:3],a[80:83],a[0:3],v[80:83]
 v_exp_f32 v34,v34
 v_mfma_f32_16x16x32_bf16 v[4:7],a[96:99],a[0:3],v[80:83]
 ds_read_b64_tr_b16 a[112:113],v113 offset:0
 ds_read_b64_tr_b16 a[114:115],v113 offset:4096
 v_mfma_f32_16x16x32_bf16 v[0:3],a[84:87],a[4:7],v[0:3]
 v_exp_f32 v35,v35
 v_mfma_f32_16x16x32_bf16 v[4:7],a[100:103],a[4:7],v[4:7]
 v_cvt_pk_bf16_f32 v77,v34,v35
 v_mfma_f32_16x16x32_bf16 v[0:3],a[88:91],a[8:11],v[0:3]
 v_exp_f32 v36,v36
 v_mfma_f32_16x16x32_bf16 v[4:7],a[104:107],a[8:11],v[4:7]
 ds_read_b64_tr_b16 a[116:117],v114 offset:0
 ds_read_b64_tr_b16 a[118:119],v114 offset:4096
 v_mfma_f32_16x16x32_bf16 v[0:3],a[92:95],a[12:15],v[0:3]
 v_exp_f32 v37,v37
 v_mfma_f32_16x16x32_bf16 v[4:7],a[108:111],a[12:15],v[4:7]
 v_cvt_pk_bf16_f32 v78,v36,v37
 s_waitcnt vmcnt(4)
 buffer_load_dwordx4 v134,s[20:23],s33 offen offset:1024 nt lds
 v_mfma_f32_16x16x32_bf16 v[8:11],a[80:83],a[16:19],v[84:87]
 v_exp_f32 v38,v38
 v_mfma_f32_16x16x32_bf16 v[12:15],a[96:99],a[16:19],v[84:87]
 ds_read_b64_tr_b16 a[120:121],v115 offset:0
 ds_read_b64_tr_b16 a[122:123],v115 offset:4096
 v_mfma_f32_16x16x32_bf16 v[8:11],a[84:87],a[20:23],v[8:11]
 v_exp_f32 v39,v39
 v_mfma_f32_16x16x32_bf16 v[12:15],a[100:103],a[20:23],v[12:15]
 v_cvt_pk_bf16_f32 v79,v38,v39
 v_mfma_f32_16x16x32_bf16 v[8:11],a[88:91],a[24:27],v[8:11]
 v_exp_f32 v0,v0
 v_mfma_f32_16x16x32_bf16 v[12:15],a[104:107],a[24:27],v[12:15]
 ds_read_b64_tr_b16 a[124:125],v116 offset:0
 ds_read_b64_tr_b16 a[126:127],v116 offset:4096
 v_mfma_f32_16x16x32_bf16 v[8:11],a[92:95],a[28:31],v[8:11]
 v_exp_f32 v1,v1
 v_mfma_f32_16x16x32_bf16 v[12:15],a[108:111],a[28:31],v[12:15]
 v_cvt_pk_bf16_f32 v40,v0,v1
 v_mfma_f32_16x16x32_bf16 v[16:19],a[80:83],a[32:35],v[88:91]
 v_exp_f32 v2,v2
 v_mfma_f32_16x16x32_bf16 v[20:23],a[96:99],a[32:35],v[88:91]
 ds_read_b64_tr_b16 a[128:129],v117 offset:0
 ds_read_b64_tr_b16 a[130:131],v117 offset:4096
 v_mfma_f32_16x16x32_bf16 v[16:19],a[84:87],a[36:39],v[16:19]
 v_exp_f32 v3,v3
 v_mfma_f32_16x16x32_bf16 v[20:23],a[100:103],a[36:39],v[20:23]
 v_cvt_pk_bf16_f32 v41,v2,v3
 s_waitcnt vmcnt(4)
 buffer_load_dwordx4 v133,s[20:23],s33 offen offset:2048 nt lds
 v_mfma_f32_16x16x32_bf16 v[16:19],a[88:91],a[40:43],v[16:19]
 v_exp_f32 v4,v4
 v_mfma_f32_16x16x32_bf16 v[20:23],a[104:107],a[40:43],v[20:23]
 ds_read_b64_tr_b16 a[132:133],v118 offset:0
 ds_read_b64_tr_b16 a[134:135],v118 offset:4096
 v_mfma_f32_16x16x32_bf16 v[16:19],a[92:95],a[44:47],v[16:19]
 v_exp_f32 v5,v5
 v_mfma_f32_16x16x32_bf16 v[20:23],a[108:111],a[44:47],v[20:23]
 v_cvt_pk_bf16_f32 v42,v4,v5
 v_mfma_f32_16x16x32_bf16 v[24:27],a[80:83],a[48:51],v[92:95]
 v_exp_f32 v6,v6
 v_mfma_f32_16x16x32_bf16 v[28:31],a[96:99],a[48:51],v[92:95]
 ds_read_b64_tr_b16 a[136:137],v119 offset:0
 ds_read_b64_tr_b16 a[138:139],v119 offset:4096
 v_mfma_f32_16x16x32_bf16 v[24:27],a[84:87],a[52:55],v[24:27]
 v_exp_f32 v7,v7
 v_mfma_f32_16x16x32_bf16 v[28:31],a[100:103],a[52:55],v[28:31]
 v_cvt_pk_bf16_f32 v43,v6,v7
 v_mfma_f32_16x16x32_bf16 v[24:27],a[88:91],a[56:59],v[24:27]
 v_exp_f32 v8,v8
 v_mfma_f32_16x16x32_bf16 v[28:31],a[104:107],a[56:59],v[28:31]
 ds_read_b64_tr_b16 a[140:141],v120 offset:0
 ds_read_b64_tr_b16 a[142:143],v120 offset:4096
 v_mfma_f32_16x16x32_bf16 v[24:27],a[92:95],a[60:63],v[24:27]
 v_exp_f32 v9,v9
 v_mfma_f32_16x16x32_bf16 v[28:31],a[108:111],a[60:63],v[28:31]
 v_cvt_pk_bf16_f32 v44,v8,v9
 s_waitcnt vmcnt(4)
 buffer_load_dwordx4 v134,s[20:23],s33 offen offset:3072 nt lds
 v_mfma_f32_16x16x32_bf16 v[32:35],a[80:83],a[64:67],v[96:99]
 v_exp_f32 v10,v10
 v_mfma_f32_16x16x32_bf16 v[36:39],a[96:99],a[64:67],v[96:99]
 v_mfma_f32_16x16x32_bf16 v[32:35],a[84:87],a[68:71],v[32:35]
 v_exp_f32 v11,v11
 v_mfma_f32_16x16x32_bf16 v[36:39],a[100:103],a[68:71],v[36:39]
 v_cvt_pk_bf16_f32 v45,v10,v11
 v_mfma_f32_16x16x32_bf16 v[32:35],a[88:91],a[72:75],v[32:35]
 v_exp_f32 v12,v12
 v_mfma_f32_16x16x32_bf16 v[36:39],a[104:107],a[72:75],v[36:39]
 v_mfma_f32_16x16x32_bf16 v[32:35],a[92:95],a[76:79],v[32:35]
 v_exp_f32 v13,v13
 v_mfma_f32_16x16x32_bf16 v[36:39],a[108:111],a[76:79],v[36:39]
 v_cvt_pk_bf16_f32 v46,v12,v13
 s_waitcnt lgkmcnt(0)
 v_mfma_f32_16x16x32_bf16 v[144:147],a[112:115],v[60:63],v[144:147]
 s_barrier
 v_exp_f32 v14,v14
 v_mfma_f32_16x16x32_bf16 v[148:151],a[116:119],v[60:63],v[148:151]
 v_mfma_f32_16x16x32_bf16 v[152:155],a[120:123],v[60:63],v[152:155]
 v_exp_f32 v15,v15
 v_mfma_f32_16x16x32_bf16 v[156:159],a[124:127],v[60:63],v[156:159]
 v_cvt_pk_bf16_f32 v47,v14,v15
 s_add_u32 m0,s34,0x8000
 v_mfma_f32_16x16x32_bf16 v[160:163],a[128:131],v[60:63],v[160:163]
 v_exp_f32 v16,v16
 s_xor_b32 s32,s57,0x36000
 v_mfma_f32_16x16x32_bf16 v[164:167],a[132:135],v[60:63],v[164:167]
 ds_read_b128 a[80:83],v105 offset:0
 s_waitcnt vmcnt(3)
 buffer_load_dwordx4 v129,s[16:19],s32 offen offset:0 nt lds
 v_mfma_f32_16x16x32_bf16 v[168:171],a[136:139],v[60:63],v[168:171]
 v_exp_f32 v17,v17
 v_mfma_f32_16x16x32_bf16 v[172:175],a[140:143],v[60:63],v[172:175]
 v_cvt_pk_bf16_f32 v48,v16,v17
 v_mfma_f32_16x16x32_bf16 a[192:195],a[212:215],v[60:63],a[192:195]
 ds_read_b128 a[96:99],v105 offset:4096
 v_mfma_f32_16x16x32_bf16 v[176:179],a[112:115],v[64:67],v[176:179]
 v_exp_f32 v18,v18
 v_mfma_f32_16x16x32_bf16 v[180:183],a[116:119],v[64:67],v[180:183]
 ds_read_b128 a[84:87],v106 offset:0
 v_mfma_f32_16x16x32_bf16 v[184:187],a[120:123],v[64:67],v[184:187]
 v_exp_f32 v19,v19
 v_mfma_f32_16x16x32_bf16 v[188:191],a[124:127],v[64:67],v[188:191]
 v_cvt_pk_bf16_f32 v49,v18,v19
 v_mfma_f32_16x16x32_bf16 v[192:195],a[128:131],v[64:67],v[192:195]
 v_exp_f32 v20,v20
 v_mfma_f32_16x16x32_bf16 v[196:199],a[132:135],v[64:67],v[196:199]
 s_waitcnt vmcnt(4)
 buffer_load_dwordx4 v130,s[16:19],s32 offen offset:1024 nt lds
 v_mfma_f32_16x16x32_bf16 v[200:203],a[136:139],v[64:67],v[200:203]
 v_exp_f32 v21,v21
 v_mfma_f32_16x16x32_bf16 v[204:207],a[140:143],v[64:67],v[204:207]
 v_cvt_pk_bf16_f32 v50,v20,v21
 v_mfma_f32_16x16x32_bf16 a[196:199],a[212:215],v[64:67],a[196:199]
 ds_read_b128 a[100:103],v106 offset:4096
 v_mfma_f32_16x16x32_bf16 v[208:211],a[112:115],v[68:71],v[208:211]
 v_exp_f32 v22,v22
 v_mfma_f32_16x16x32_bf16 v[212:215],a[116:119],v[68:71],v[212:215]
 ds_read_b128 a[88:91],v107 offset:0
 v_mfma_f32_16x16x32_bf16 v[216:219],a[120:123],v[68:71],v[216:219]
 v_exp_f32 v23,v23
 v_mfma_f32_16x16x32_bf16 v[220:223],a[124:127],v[68:71],v[220:223]
 v_cvt_pk_bf16_f32 v51,v22,v23
 v_mfma_f32_16x16x32_bf16 v[224:227],a[128:131],v[68:71],v[224:227]
 v_exp_f32 v24,v24
 v_mfma_f32_16x16x32_bf16 v[228:231],a[132:135],v[68:71],v[228:231]
 ds_read_b128 a[104:107],v107 offset:4096
 v_mfma_f32_16x16x32_bf16 v[232:235],a[136:139],v[68:71],v[232:235]
 v_exp_f32 v25,v25
 v_mfma_f32_16x16x32_bf16 v[236:239],a[140:143],v[68:71],v[236:239]
 v_cvt_pk_bf16_f32 v52,v24,v25
 s_waitcnt vmcnt(4)
 buffer_load_dwordx4 v131,s[16:19],s32 offen offset:2048 nt lds
 v_mfma_f32_16x16x32_bf16 a[200:203],a[212:215],v[68:71],a[200:203]
 v_mfma_f32_16x16x32_bf16 v[240:243],a[112:115],v[72:75],v[240:243]
 v_exp_f32 v26,v26
 v_mfma_f32_16x16x32_bf16 v[244:247],a[116:119],v[72:75],v[244:247]
 ds_read_b128 a[92:95],v108 offset:0
 v_mfma_f32_16x16x32_bf16 v[248:251],a[120:123],v[72:75],v[248:251]
 v_exp_f32 v27,v27
 v_mfma_f32_16x16x32_bf16 v[252:255],a[124:127],v[72:75],v[252:255]
 v_cvt_pk_bf16_f32 v53,v26,v27
 v_mfma_f32_16x16x32_bf16 a[144:147],a[128:131],v[72:75],a[144:147]
 v_exp_f32 v28,v28
 v_mfma_f32_16x16x32_bf16 a[148:151],a[132:135],v[72:75],a[148:151]
 ds_read_b128 a[108:111],v108 offset:4096
 v_mfma_f32_16x16x32_bf16 a[152:155],a[136:139],v[72:75],a[152:155]
 v_exp_f32 v29,v29
 v_mfma_f32_16x16x32_bf16 a[156:159],a[140:143],v[72:75],a[156:159]
 v_cvt_pk_bf16_f32 v54,v28,v29
 s_waitcnt vmcnt(4)
 buffer_load_dwordx4 v132,s[16:19],s32 offen offset:3072 nt lds
 v_mfma_f32_16x16x32_bf16 a[204:207],a[212:215],v[72:75],a[204:207]
 v_mfma_f32_16x16x32_bf16 a[160:163],a[112:115],v[76:79],a[160:163]
 v_exp_f32 v30,v30
 v_mfma_f32_16x16x32_bf16 a[164:167],a[116:119],v[76:79],a[164:167]
 v_mfma_f32_16x16x32_bf16 a[168:171],a[120:123],v[76:79],a[168:171]
 v_exp_f32 v31,v31
 v_mfma_f32_16x16x32_bf16 a[172:175],a[124:127],v[76:79],a[172:175]
 v_cvt_pk_bf16_f32 v55,v30,v31
 v_mfma_f32_16x16x32_bf16 a[176:179],a[128:131],v[76:79],a[176:179]
 v_exp_f32 v32,v32
 v_mfma_f32_16x16x32_bf16 a[180:183],a[132:135],v[76:79],a[180:183]
 v_mfma_f32_16x16x32_bf16 a[184:187],a[136:139],v[76:79],a[184:187]
 v_exp_f32 v33,v33
 v_mfma_f32_16x16x32_bf16 a[188:191],a[140:143],v[76:79],a[188:191]
 v_cvt_pk_bf16_f32 v56,v32,v33
 v_mfma_f32_16x16x32_bf16 a[208:211],a[212:215],v[76:79],a[208:211]
 s_waitcnt lgkmcnt(0)
 v_mfma_f32_16x16x32_bf16 v[0:3],a[80:83],a[0:3],v[80:83]
 v_exp_f32 v34,v34
 v_mfma_f32_16x16x32_bf16 v[4:7],a[96:99],a[0:3],v[80:83]
 ds_read_b64_tr_b16 a[112:113],v113 offset:16384
 ds_read_b64_tr_b16 a[114:115],v113 offset:20480
 v_mfma_f32_16x16x32_bf16 v[0:3],a[84:87],a[4:7],v[0:3]
 v_exp_f32 v35,v35
 v_mfma_f32_16x16x32_bf16 v[4:7],a[100:103],a[4:7],v[4:7]
 v_cvt_pk_bf16_f32 v57,v34,v35
 v_mfma_f32_16x16x32_bf16 v[0:3],a[88:91],a[8:11],v[0:3]
 v_exp_f32 v36,v36
 v_mfma_f32_16x16x32_bf16 v[4:7],a[104:107],a[8:11],v[4:7]
 ds_read_b64_tr_b16 a[116:117],v114 offset:16384
 ds_read_b64_tr_b16 a[118:119],v114 offset:20480
 s_add_u32 m0,s34,0x14000
 v_mfma_f32_16x16x32_bf16 v[0:3],a[92:95],a[12:15],v[0:3]
 v_exp_f32 v37,v37
 s_xor_b32 s33,s57,0x36000
 v_mfma_f32_16x16x32_bf16 v[4:7],a[108:111],a[12:15],v[4:7]
 v_cvt_pk_bf16_f32 v58,v36,v37
 s_waitcnt vmcnt(3)
 buffer_load_dwordx4 v133,s[20:23],s33 offen offset:0 nt lds
 v_mfma_f32_16x16x32_bf16 v[8:11],a[80:83],a[16:19],v[84:87]
 v_exp_f32 v38,v38
 v_mfma_f32_16x16x32_bf16 v[12:15],a[96:99],a[16:19],v[84:87]
 ds_read_b64_tr_b16 a[120:121],v115 offset:16384
 ds_read_b64_tr_b16 a[122:123],v115 offset:20480
 v_mfma_f32_16x16x32_bf16 v[8:11],a[84:87],a[20:23],v[8:11]
 v_exp_f32 v39,v39
 v_mfma_f32_16x16x32_bf16 v[12:15],a[100:103],a[20:23],v[12:15]
 v_cvt_pk_bf16_f32 v59,v38,v39
 v_mfma_f32_16x16x32_bf16 v[8:11],a[88:91],a[24:27],v[8:11]
 v_exp_f32 v0,v0
 v_mfma_f32_16x16x32_bf16 v[12:15],a[104:107],a[24:27],v[12:15]
 ds_read_b64_tr_b16 a[124:125],v116 offset:16384
 ds_read_b64_tr_b16 a[126:127],v116 offset:20480
 v_mfma_f32_16x16x32_bf16 v[8:11],a[92:95],a[28:31],v[8:11]
 v_exp_f32 v1,v1
 v_mfma_f32_16x16x32_bf16 v[12:15],a[108:111],a[28:31],v[12:15]
 v_cvt_pk_bf16_f32 v60,v0,v1
 s_waitcnt vmcnt(4)
 buffer_load_dwordx4 v134,s[20:23],s33 offen offset:1024 nt lds
 v_mfma_f32_16x16x32_bf16 v[16:19],a[80:83],a[32:35],v[88:91]
 v_exp_f32 v2,v2
 v_mfma_f32_16x16x32_bf16 v[20:23],a[96:99],a[32:35],v[88:91]
 ds_read_b64_tr_b16 a[128:129],v117 offset:16384
 ds_read_b64_tr_b16 a[130:131],v117 offset:20480
 v_mfma_f32_16x16x32_bf16 v[16:19],a[84:87],a[36:39],v[16:19]
 v_exp_f32 v3,v3
 v_mfma_f32_16x16x32_bf16 v[20:23],a[100:103],a[36:39],v[20:23]
 v_cvt_pk_bf16_f32 v61,v2,v3
 v_mfma_f32_16x16x32_bf16 v[16:19],a[88:91],a[40:43],v[16:19]
 v_exp_f32 v4,v4
 v_mfma_f32_16x16x32_bf16 v[20:23],a[104:107],a[40:43],v[20:23]
 ds_read_b64_tr_b16 a[132:133],v118 offset:16384
 ds_read_b64_tr_b16 a[134:135],v118 offset:20480
 v_mfma_f32_16x16x32_bf16 v[16:19],a[92:95],a[44:47],v[16:19]
 v_exp_f32 v5,v5
 v_mfma_f32_16x16x32_bf16 v[20:23],a[108:111],a[44:47],v[20:23]
 v_cvt_pk_bf16_f32 v62,v4,v5
 s_waitcnt vmcnt(4)
 buffer_load_dwordx4 v133,s[20:23],s33 offen offset:2048 nt lds
 v_mfma_f32_16x16x32_bf16 v[24:27],a[80:83],a[48:51],v[92:95]
 v_exp_f32 v6,v6
 v_mfma_f32_16x16x32_bf16 v[28:31],a[96:99],a[48:51],v[92:95]
 ds_read_b64_tr_b16 a[136:137],v119 offset:16384
 ds_read_b64_tr_b16 a[138:139],v119 offset:20480
 v_mfma_f32_16x16x32_bf16 v[24:27],a[84:87],a[52:55],v[24:27]
 v_exp_f32 v7,v7
 v_mfma_f32_16x16x32_bf16 v[28:31],a[100:103],a[52:55],v[28:31]
 v_cvt_pk_bf16_f32 v63,v6,v7
 v_mfma_f32_16x16x32_bf16 v[24:27],a[88:91],a[56:59],v[24:27]
 v_exp_f32 v8,v8
 v_mfma_f32_16x16x32_bf16 v[28:31],a[104:107],a[56:59],v[28:31]
 ds_read_b64_tr_b16 a[140:141],v120 offset:16384
 ds_read_b64_tr_b16 a[142:143],v120 offset:20480
 v_mfma_f32_16x16x32_bf16 v[24:27],a[92:95],a[60:63],v[24:27]
 v_exp_f32 v9,v9
 v_mfma_f32_16x16x32_bf16 v[28:31],a[108:111],a[60:63],v[28:31]
 v_cvt_pk_bf16_f32 v64,v8,v9
 s_waitcnt vmcnt(4)
 buffer_load_dwordx4 v134,s[20:23],s33 offen offset:3072 nt lds
 v_mfma_f32_16x16x32_bf16 v[32:35],a[80:83],a[64:67],v[96:99]
 v_exp_f32 v10,v10
 v_mfma_f32_16x16x32_bf16 v[36:39],a[96:99],a[64:67],v[96:99]
 v_mfma_f32_16x16x32_bf16 v[32:35],a[84:87],a[68:71],v[32:35]
 v_exp_f32 v11,v11
 v_mfma_f32_16x16x32_bf16 v[36:39],a[100:103],a[68:71],v[36:39]
 v_cvt_pk_bf16_f32 v65,v10,v11
 v_mfma_f32_16x16x32_bf16 v[32:35],a[88:91],a[72:75],v[32:35]
 v_exp_f32 v12,v12
 v_mfma_f32_16x16x32_bf16 v[36:39],a[104:107],a[72:75],v[36:39]
 v_mfma_f32_16x16x32_bf16 v[32:35],a[92:95],a[76:79],v[32:35]
 v_exp_f32 v13,v13
 v_mfma_f32_16x16x32_bf16 v[36:39],a[108:111],a[76:79],v[36:39]
 v_cvt_pk_bf16_f32 v66,v12,v13
 s_waitcnt lgkmcnt(0)
 v_mfma_f32_16x16x32_bf16 v[144:147],a[112:115],v[40:43],v[144:147]
 s_barrier
 v_exp_f32 v14,v14
 v_mfma_f32_16x16x32_bf16 v[148:151],a[116:119],v[40:43],v[148:151]
 v_mfma_f32_16x16x32_bf16 v[152:155],a[120:123],v[40:43],v[152:155]
 v_exp_f32 v15,v15
 v_mfma_f32_16x16x32_bf16 v[156:159],a[124:127],v[40:43],v[156:159]
 v_cvt_pk_bf16_f32 v67,v14,v15
 s_add_u32 m0,s34,0xc000
 v_mfma_f32_16x16x32_bf16 v[160:163],a[128:131],v[40:43],v[160:163]
 v_exp_f32 v16,v16
 s_xor_b32 s32,s57,0x38000
 v_mfma_f32_16x16x32_bf16 v[164:167],a[132:135],v[40:43],v[164:167]
 ds_read_b128 a[80:83],v105 offset:16384
 s_waitcnt vmcnt(4)
 buffer_load_dwordx4 v129,s[16:19],s32 offen offset:0 nt lds
 v_mfma_f32_16x16x32_bf16 v[168:171],a[136:139],v[40:43],v[168:171]
 v_exp_f32 v17,v17
 v_mfma_f32_16x16x32_bf16 v[172:175],a[140:143],v[40:43],v[172:175]
 v_cvt_pk_bf16_f32 v68,v16,v17
 v_mfma_f32_16x16x32_bf16 a[192:195],a[212:215],v[40:43],a[192:195]
 ds_read_b128 a[96:99],v105 offset:20480
 v_mfma_f32_16x16x32_bf16 v[176:179],a[112:115],v[44:47],v[176:179]
 v_exp_f32 v18,v18
 v_mfma_f32_16x16x32_bf16 v[180:183],a[116:119],v[44:47],v[180:183]
 ds_read_b128 a[84:87],v106 offset:16384
 v_mfma_f32_16x16x32_bf16 v[184:187],a[120:123],v[44:47],v[184:187]
 v_exp_f32 v19,v19
 v_mfma_f32_16x16x32_bf16 v[188:191],a[124:127],v[44:47],v[188:191]
 v_cvt_pk_bf16_f32 v69,v18,v19
 v_mfma_f32_16x16x32_bf16 v[192:195],a[128:131],v[44:47],v[192:195]
 v_exp_f32 v20,v20
 v_mfma_f32_16x16x32_bf16 v[196:199],a[132:135],v[44:47],v[196:199]
 v_mfma_f32_16x16x32_bf16 v[200:203],a[136:139],v[44:47],v[200:203]
 v_exp_f32 v21,v21
 v_mfma_f32_16x16x32_bf16 v[204:207],a[140:143],v[44:47],v[204:207]
 v_cvt_pk_bf16_f32 v70,v20,v21
 v_mfma_f32_16x16x32_bf16 a[196:199],a[212:215],v[44:47],a[196:199]
 ds_read_b128 a[100:103],v106 offset:20480
 s_waitcnt vmcnt(4)
 buffer_load_dwordx4 v130,s[16:19],s32 offen offset:1024 nt lds
 v_mfma_f32_16x16x32_bf16 v[208:211],a[112:115],v[48:51],v[208:211]
 v_exp_f32 v22,v22
 v_mfma_f32_16x16x32_bf16 v[212:215],a[116:119],v[48:51],v[212:215]
 ds_read_b128 a[88:91],v107 offset:16384
 v_mfma_f32_16x16x32_bf16 v[216:219],a[120:123],v[48:51],v[216:219]
 v_exp_f32 v23,v23
 v_mfma_f32_16x16x32_bf16 v[220:223],a[124:127],v[48:51],v[220:223]
 v_cvt_pk_bf16_f32 v71,v22,v23
 v_mfma_f32_16x16x32_bf16 v[224:227],a[128:131],v[48:51],v[224:227]
 v_exp_f32 v24,v24
 v_mfma_f32_16x16x32_bf16 v[228:231],a[132:135],v[48:51],v[228:231]
 ds_read_b128 a[104:107],v107 offset:20480
 v_mfma_f32_16x16x32_bf16 v[232:235],a[136:139],v[48:51],v[232:235]
 v_exp_f32 v25,v25
 v_mfma_f32_16x16x32_bf16 v[236:239],a[140:143],v[48:51],v[236:239]
 v_cvt_pk_bf16_f32 v72,v24,v25
 v_mfma_f32_16x16x32_bf16 a[200:203],a[212:215],v[48:51],a[200:203]
 v_mfma_f32_16x16x32_bf16 v[240:243],a[112:115],v[52:55],v[240:243]
 v_exp_f32 v26,v26
 v_mfma_f32_16x16x32_bf16 v[244:247],a[116:119],v[52:55],v[244:247]
 ds_read_b128 a[92:95],v108 offset:16384
 v_mfma_f32_16x16x32_bf16 v[248:251],a[120:123],v[52:55],v[248:251]
 v_exp_f32 v27,v27
 v_mfma_f32_16x16x32_bf16 v[252:255],a[124:127],v[52:55],v[252:255]
 v_cvt_pk_bf16_f32 v73,v26,v27
 v_mfma_f32_16x16x32_bf16 a[144:147],a[128:131],v[52:55],a[144:147]
 v_exp_f32 v28,v28
 v_mfma_f32_16x16x32_bf16 a[148:151],a[132:135],v[52:55],a[148:151]
 ds_read_b128 a[108:111],v108 offset:20480
 s_waitcnt vmcnt(4)
 buffer_load_dwordx4 v131,s[16:19],s32 offen offset:2048 nt lds
 v_mfma_f32_16x16x32_bf16 a[152:155],a[136:139],v[52:55],a[152:155]
 v_exp_f32 v29,v29
 v_mfma_f32_16x16x32_bf16 a[156:159],a[140:143],v[52:55],a[156:159]
 v_cvt_pk_bf16_f32 v74,v28,v29
 v_mfma_f32_16x16x32_bf16 a[204:207],a[212:215],v[52:55],a[204:207]
 v_mfma_f32_16x16x32_bf16 a[160:163],a[112:115],v[56:59],a[160:163]
 v_exp_f32 v30,v30
 v_mfma_f32_16x16x32_bf16 a[164:167],a[116:119],v[56:59],a[164:167]
 v_mfma_f32_16x16x32_bf16 a[168:171],a[120:123],v[56:59],a[168:171]
 v_exp_f32 v31,v31
 v_mfma_f32_16x16x32_bf16 a[172:175],a[124:127],v[56:59],a[172:175]
 v_cvt_pk_bf16_f32 v75,v30,v31
 v_mfma_f32_16x16x32_bf16 a[176:179],a[128:131],v[56:59],a[176:179]
 v_exp_f32 v32,v32
 v_mfma_f32_16x16x32_bf16 a[180:183],a[132:135],v[56:59],a[180:183]
 v_mfma_f32_16x16x32_bf16 a[184:187],a[136:139],v[56:59],a[184:187]
 v_exp_f32 v33,v33
 v_mfma_f32_16x16x32_bf16 a[188:191],a[140:143],v[56:59],a[188:191]
 v_cvt_pk_bf16_f32 v76,v32,v33
 v_mfma_f32_16x16x32_bf16 a[208:211],a[212:215],v[56:59],a[208:211]
 s_waitcnt lgkmcnt(0)
 v_mfma_f32_16x16x32_bf16 v[0:3],a[80:83],a[0:3],v[80:83]
 v_exp_f32 v34,v34
 v_mfma_f32_16x16x32_bf16 v[4:7],a[96:99],a[0:3],v[80:83]
 ds_read_b64_tr_b16 a[112:113],v113 offset:32768
 ds_read_b64_tr_b16 a[114:115],v113 offset:36864
 v_mfma_f32_16x16x32_bf16 v[0:3],a[84:87],a[4:7],v[0:3]
 v_exp_f32 v35,v35
 v_mfma_f32_16x16x32_bf16 v[4:7],a[100:103],a[4:7],v[4:7]
 v_cvt_pk_bf16_f32 v77,v34,v35
 v_mfma_f32_16x16x32_bf16 v[0:3],a[88:91],a[8:11],v[0:3]
 v_exp_f32 v36,v36
 v_mfma_f32_16x16x32_bf16 v[4:7],a[104:107],a[8:11],v[4:7]
 ds_read_b64_tr_b16 a[116:117],v114 offset:32768
 ds_read_b64_tr_b16 a[118:119],v114 offset:36864
 v_mfma_f32_16x16x32_bf16 v[0:3],a[92:95],a[12:15],v[0:3]
 v_exp_f32 v37,v37
 v_mfma_f32_16x16x32_bf16 v[4:7],a[108:111],a[12:15],v[4:7]
 v_cvt_pk_bf16_f32 v78,v36,v37
 s_waitcnt vmcnt(4)
 buffer_load_dwordx4 v132,s[16:19],s32 offen offset:3072 nt lds
 v_mfma_f32_16x16x32_bf16 v[8:11],a[80:83],a[16:19],v[84:87]
 v_exp_f32 v38,v38
 v_mfma_f32_16x16x32_bf16 v[12:15],a[96:99],a[16:19],v[84:87]
 ds_read_b64_tr_b16 a[120:121],v115 offset:32768
 ds_read_b64_tr_b16 a[122:123],v115 offset:36864
 v_mfma_f32_16x16x32_bf16 v[8:11],a[84:87],a[20:23],v[8:11]
 v_exp_f32 v39,v39
 v_mfma_f32_16x16x32_bf16 v[12:15],a[100:103],a[20:23],v[12:15]
 v_cvt_pk_bf16_f32 v79,v38,v39
 v_mfma_f32_16x16x32_bf16 v[8:11],a[88:91],a[24:27],v[8:11]
 v_exp_f32 v0,v0
 v_mfma_f32_16x16x32_bf16 v[12:15],a[104:107],a[24:27],v[12:15]
 ds_read_b64_tr_b16 a[124:125],v116 offset:32768
 ds_read_b64_tr_b16 a[126:127],v116 offset:36864
 s_add_u32 m0,s34,0x18000
 v_mfma_f32_16x16x32_bf16 v[8:11],a[92:95],a[28:31],v[8:11]
 v_exp_f32 v1,v1
 s_xor_b32 s33,s57,0x38000
 v_mfma_f32_16x16x32_bf16 v[12:15],a[108:111],a[28:31],v[12:15]
 v_cvt_pk_bf16_f32 v40,v0,v1
 s_waitcnt vmcnt(4)
 buffer_load_dwordx4 v133,s[20:23],s33 offen offset:0 nt lds
 v_mfma_f32_16x16x32_bf16 v[16:19],a[80:83],a[32:35],v[88:91]
 v_exp_f32 v2,v2
 v_mfma_f32_16x16x32_bf16 v[20:23],a[96:99],a[32:35],v[88:91]
 ds_read_b64_tr_b16 a[128:129],v117 offset:32768
 ds_read_b64_tr_b16 a[130:131],v117 offset:36864
 v_mfma_f32_16x16x32_bf16 v[16:19],a[84:87],a[36:39],v[16:19]
 v_exp_f32 v3,v3
 v_mfma_f32_16x16x32_bf16 v[20:23],a[100:103],a[36:39],v[20:23]
 v_cvt_pk_bf16_f32 v41,v2,v3
 v_mfma_f32_16x16x32_bf16 v[16:19],a[88:91],a[40:43],v[16:19]
 v_exp_f32 v4,v4
 v_mfma_f32_16x16x32_bf16 v[20:23],a[104:107],a[40:43],v[20:23]
 ds_read_b64_tr_b16 a[132:133],v118 offset:32768
 ds_read_b64_tr_b16 a[134:135],v118 offset:36864
 v_mfma_f32_16x16x32_bf16 v[16:19],a[92:95],a[44:47],v[16:19]
 v_exp_f32 v5,v5
 v_mfma_f32_16x16x32_bf16 v[20:23],a[108:111],a[44:47],v[20:23]
 v_cvt_pk_bf16_f32 v42,v4,v5
 s_waitcnt vmcnt(4)
 buffer_load_dwordx4 v134,s[20:23],s33 offen offset:1024 nt lds
 v_mfma_f32_16x16x32_bf16 v[24:27],a[80:83],a[48:51],v[92:95]
 v_exp_f32 v6,v6
 v_mfma_f32_16x16x32_bf16 v[28:31],a[96:99],a[48:51],v[92:95]
 ds_read_b64_tr_b16 a[136:137],v119 offset:32768
 ds_read_b64_tr_b16 a[138:139],v119 offset:36864
 v_mfma_f32_16x16x32_bf16 v[24:27],a[84:87],a[52:55],v[24:27]
 v_exp_f32 v7,v7
 v_mfma_f32_16x16x32_bf16 v[28:31],a[100:103],a[52:55],v[28:31]
 v_cvt_pk_bf16_f32 v43,v6,v7
 v_mfma_f32_16x16x32_bf16 v[24:27],a[88:91],a[56:59],v[24:27]
 v_exp_f32 v8,v8
 v_mfma_f32_16x16x32_bf16 v[28:31],a[104:107],a[56:59],v[28:31]
 ds_read_b64_tr_b16 a[140:141],v120 offset:32768
 ds_read_b64_tr_b16 a[142:143],v120 offset:36864
 v_mfma_f32_16x16x32_bf16 v[24:27],a[92:95],a[60:63],v[24:27]
 v_exp_f32 v9,v9
 v_mfma_f32_16x16x32_bf16 v[28:31],a[108:111],a[60:63],v[28:31]
 v_cvt_pk_bf16_f32 v44,v8,v9
 s_waitcnt vmcnt(4)
 buffer_load_dwordx4 v133,s[20:23],s33 offen offset:2048 nt lds
 v_mfma_f32_16x16x32_bf16 v[32:35],a[80:83],a[64:67],v[96:99]
 v_exp_f32 v10,v10
 v_mfma_f32_16x16x32_bf16 v[36:39],a[96:99],a[64:67],v[96:99]
 v_mfma_f32_16x16x32_bf16 v[32:35],a[84:87],a[68:71],v[32:35]
 v_exp_f32 v11,v11
 v_mfma_f32_16x16x32_bf16 v[36:39],a[100:103],a[68:71],v[36:39]
 v_cvt_pk_bf16_f32 v45,v10,v11
 v_mfma_f32_16x16x32_bf16 v[32:35],a[88:91],a[72:75],v[32:35]
 v_exp_f32 v12,v12
 v_mfma_f32_16x16x32_bf16 v[36:39],a[104:107],a[72:75],v[36:39]
 v_mfma_f32_16x16x32_bf16 v[32:35],a[92:95],a[76:79],v[32:35]
 v_exp_f32 v13,v13
 v_mfma_f32_16x16x32_bf16 v[36:39],a[108:111],a[76:79],v[36:39]
 v_cvt_pk_bf16_f32 v46,v12,v13
 s_waitcnt lgkmcnt(0)
 v_mfma_f32_16x16x32_bf16 v[144:147],a[112:115],v[60:63],v[144:147]
 s_barrier
 v_exp_f32 v14,v14
 v_mfma_f32_16x16x32_bf16 v[148:151],a[116:119],v[60:63],v[148:151]
 v_mfma_f32_16x16x32_bf16 v[152:155],a[120:123],v[60:63],v[152:155]
 v_exp_f32 v15,v15
 v_mfma_f32_16x16x32_bf16 v[156:159],a[124:127],v[60:63],v[156:159]
 v_cvt_pk_bf16_f32 v47,v14,v15
 v_mfma_f32_16x16x32_bf16 v[160:163],a[128:131],v[60:63],v[160:163]
 v_exp_f32 v16,v16
 v_mfma_f32_16x16x32_bf16 v[164:167],a[132:135],v[60:63],v[164:167]
 ds_read_b128 a[80:83],v105 offset:32768
 s_waitcnt vmcnt(4)
 buffer_load_dwordx4 v134,s[20:23],s33 offen offset:3072 nt lds
 v_mfma_f32_16x16x32_bf16 v[168:171],a[136:139],v[60:63],v[168:171]
 v_exp_f32 v17,v17
 v_mfma_f32_16x16x32_bf16 v[172:175],a[140:143],v[60:63],v[172:175]
 v_cvt_pk_bf16_f32 v48,v16,v17
 v_mfma_f32_16x16x32_bf16 a[192:195],a[212:215],v[60:63],a[192:195]
 ds_read_b128 a[96:99],v105 offset:36864
 v_mfma_f32_16x16x32_bf16 v[176:179],a[112:115],v[64:67],v[176:179]
 v_exp_f32 v18,v18
 v_mfma_f32_16x16x32_bf16 v[180:183],a[116:119],v[64:67],v[180:183]
 ds_read_b128 a[84:87],v106 offset:32768
 v_mfma_f32_16x16x32_bf16 v[184:187],a[120:123],v[64:67],v[184:187]
 v_exp_f32 v19,v19
 v_mfma_f32_16x16x32_bf16 v[188:191],a[124:127],v[64:67],v[188:191]
 v_cvt_pk_bf16_f32 v49,v18,v19
 s_add_u32 m0,s34,0x10000
 v_mfma_f32_16x16x32_bf16 v[192:195],a[128:131],v[64:67],v[192:195]
 v_exp_f32 v20,v20
 s_xor_b32 s32,s57,0x3a000
 v_mfma_f32_16x16x32_bf16 v[196:199],a[132:135],v[64:67],v[196:199]
 s_waitcnt vmcnt(4)
 buffer_load_dwordx4 v129,s[16:19],s32 offen offset:0 nt lds
 v_mfma_f32_16x16x32_bf16 v[200:203],a[136:139],v[64:67],v[200:203]
 v_exp_f32 v21,v21
 v_mfma_f32_16x16x32_bf16 v[204:207],a[140:143],v[64:67],v[204:207]
 v_cvt_pk_bf16_f32 v50,v20,v21
 v_mfma_f32_16x16x32_bf16 a[196:199],a[212:215],v[64:67],a[196:199]
 ds_read_b128 a[100:103],v106 offset:36864
 v_mfma_f32_16x16x32_bf16 v[208:211],a[112:115],v[68:71],v[208:211]
 v_exp_f32 v22,v22
 v_mfma_f32_16x16x32_bf16 v[212:215],a[116:119],v[68:71],v[212:215]
 ds_read_b128 a[88:91],v107 offset:32768
 v_mfma_f32_16x16x32_bf16 v[216:219],a[120:123],v[68:71],v[216:219]
 v_exp_f32 v23,v23
 v_mfma_f32_16x16x32_bf16 v[220:223],a[124:127],v[68:71],v[220:223]
 v_cvt_pk_bf16_f32 v51,v22,v23
 v_mfma_f32_16x16x32_bf16 v[224:227],a[128:131],v[68:71],v[224:227]
 v_exp_f32 v24,v24
 v_mfma_f32_16x16x32_bf16 v[228:231],a[132:135],v[68:71],v[228:231]
 ds_read_b128 a[104:107],v107 offset:36864
 v_mfma_f32_16x16x32_bf16 v[232:235],a[136:139],v[68:71],v[232:235]
 v_exp_f32 v25,v25
 v_mfma_f32_16x16x32_bf16 v[236:239],a[140:143],v[68:71],v[236:239]
 v_cvt_pk_bf16_f32 v52,v24,v25
 s_waitcnt vmcnt(4)
 buffer_load_dwordx4 v130,s[16:19],s32 offen offset:1024 nt lds
 v_mfma_f32_16x16x32_bf16 a[200:203],a[212:215],v[68:71],a[200:203]
 v_mfma_f32_16x16x32_bf16 v[240:243],a[112:115],v[72:75],v[240:243]
 v_exp_f32 v26,v26
 v_mfma_f32_16x16x32_bf16 v[244:247],a[116:119],v[72:75],v[244:247]
 ds_read_b128 a[92:95],v108 offset:32768
 v_mfma_f32_16x16x32_bf16 v[248:251],a[120:123],v[72:75],v[248:251]
 v_exp_f32 v27,v27
 v_mfma_f32_16x16x32_bf16 v[252:255],a[124:127],v[72:75],v[252:255]
 v_cvt_pk_bf16_f32 v53,v26,v27
 v_mfma_f32_16x16x32_bf16 a[144:147],a[128:131],v[72:75],a[144:147]
 v_exp_f32 v28,v28
 v_mfma_f32_16x16x32_bf16 a[148:151],a[132:135],v[72:75],a[148:151]
 ds_read_b128 a[108:111],v108 offset:36864
 v_mfma_f32_16x16x32_bf16 a[152:155],a[136:139],v[72:75],a[152:155]
 v_exp_f32 v29,v29
 v_mfma_f32_16x16x32_bf16 a[156:159],a[140:143],v[72:75],a[156:159]
 v_cvt_pk_bf16_f32 v54,v28,v29
 s_waitcnt vmcnt(4)
 buffer_load_dwordx4 v131,s[16:19],s32 offen offset:2048 nt lds
 v_mfma_f32_16x16x32_bf16 a[204:207],a[212:215],v[72:75],a[204:207]
 v_mfma_f32_16x16x32_bf16 a[160:163],a[112:115],v[76:79],a[160:163]
 v_exp_f32 v30,v30
 v_mfma_f32_16x16x32_bf16 a[164:167],a[116:119],v[76:79],a[164:167]
 v_mfma_f32_16x16x32_bf16 a[168:171],a[120:123],v[76:79],a[168:171]
 v_exp_f32 v31,v31
 v_mfma_f32_16x16x32_bf16 a[172:175],a[124:127],v[76:79],a[172:175]
 v_cvt_pk_bf16_f32 v55,v30,v31
 v_mfma_f32_16x16x32_bf16 a[176:179],a[128:131],v[76:79],a[176:179]
 v_exp_f32 v32,v32
 v_mfma_f32_16x16x32_bf16 a[180:183],a[132:135],v[76:79],a[180:183]
 v_mfma_f32_16x16x32_bf16 a[184:187],a[136:139],v[76:79],a[184:187]
 v_exp_f32 v33,v33
 v_mfma_f32_16x16x32_bf16 a[188:191],a[140:143],v[76:79],a[188:191]
 v_cvt_pk_bf16_f32 v56,v32,v33
 v_mfma_f32_16x16x32_bf16 a[208:211],a[212:215],v[76:79],a[208:211]
 s_waitcnt lgkmcnt(0)
 v_mfma_f32_16x16x32_bf16 v[0:3],a[80:83],a[0:3],v[80:83]
 v_exp_f32 v34,v34
 v_mfma_f32_16x16x32_bf16 v[4:7],a[96:99],a[0:3],v[80:83]
 ds_read_b64_tr_b16 a[112:113],v113 offset:49152
 ds_read_b64_tr_b16 a[114:115],v113 offset:53248
 v_mfma_f32_16x16x32_bf16 v[0:3],a[84:87],a[4:7],v[0:3]
 v_exp_f32 v35,v35
 v_mfma_f32_16x16x32_bf16 v[4:7],a[100:103],a[4:7],v[4:7]
 v_cvt_pk_bf16_f32 v57,v34,v35
 v_mfma_f32_16x16x32_bf16 v[0:3],a[88:91],a[8:11],v[0:3]
 v_exp_f32 v36,v36
 v_mfma_f32_16x16x32_bf16 v[4:7],a[104:107],a[8:11],v[4:7]
 ds_read_b64_tr_b16 a[116:117],v114 offset:49152
 ds_read_b64_tr_b16 a[118:119],v114 offset:53248
 v_mfma_f32_16x16x32_bf16 v[0:3],a[92:95],a[12:15],v[0:3]
 v_exp_f32 v37,v37
 v_mfma_f32_16x16x32_bf16 v[4:7],a[108:111],a[12:15],v[4:7]
 v_cvt_pk_bf16_f32 v58,v36,v37
 s_waitcnt vmcnt(4)
 buffer_load_dwordx4 v132,s[16:19],s32 offen offset:3072 nt lds
 v_mfma_f32_16x16x32_bf16 v[8:11],a[80:83],a[16:19],v[84:87]
 v_exp_f32 v38,v38
 v_mfma_f32_16x16x32_bf16 v[12:15],a[96:99],a[16:19],v[84:87]
 ds_read_b64_tr_b16 a[120:121],v115 offset:49152
 ds_read_b64_tr_b16 a[122:123],v115 offset:53248
 v_mfma_f32_16x16x32_bf16 v[8:11],a[84:87],a[20:23],v[8:11]
 v_exp_f32 v39,v39
 v_mfma_f32_16x16x32_bf16 v[12:15],a[100:103],a[20:23],v[12:15]
 v_cvt_pk_bf16_f32 v59,v38,v39
 v_mfma_f32_16x16x32_bf16 v[8:11],a[88:91],a[24:27],v[8:11]
 v_exp_f32 v0,v0
 v_mfma_f32_16x16x32_bf16 v[12:15],a[104:107],a[24:27],v[12:15]
 ds_read_b64_tr_b16 a[124:125],v116 offset:49152
 ds_read_b64_tr_b16 a[126:127],v116 offset:53248
 v_mfma_f32_16x16x32_bf16 v[8:11],a[92:95],a[28:31],v[8:11]
 v_exp_f32 v1,v1
 v_mfma_f32_16x16x32_bf16 v[12:15],a[108:111],a[28:31],v[12:15]
 v_cvt_pk_bf16_f32 v60,v0,v1
 v_mfma_f32_16x16x32_bf16 v[16:19],a[80:83],a[32:35],v[88:91]
 v_exp_f32 v2,v2
 v_mfma_f32_16x16x32_bf16 v[20:23],a[96:99],a[32:35],v[88:91]
 ds_read_b64_tr_b16 a[128:129],v117 offset:49152
 ds_read_b64_tr_b16 a[130:131],v117 offset:53248
 s_add_u32 m0,s34,0x1c000
 v_mfma_f32_16x16x32_bf16 v[16:19],a[84:87],a[36:39],v[16:19]
 v_exp_f32 v3,v3
 s_xor_b32 s33,s57,0x3a000
 v_mfma_f32_16x16x32_bf16 v[20:23],a[100:103],a[36:39],v[20:23]
 v_cvt_pk_bf16_f32 v61,v2,v3
 s_waitcnt vmcnt(4)
 buffer_load_dwordx4 v133,s[20:23],s33 offen offset:0 nt lds
 v_mfma_f32_16x16x32_bf16 v[16:19],a[88:91],a[40:43],v[16:19]
 v_exp_f32 v4,v4
 v_mfma_f32_16x16x32_bf16 v[20:23],a[104:107],a[40:43],v[20:23]
 ds_read_b64_tr_b16 a[132:133],v118 offset:49152
 ds_read_b64_tr_b16 a[134:135],v118 offset:53248
 v_mfma_f32_16x16x32_bf16 v[16:19],a[92:95],a[44:47],v[16:19]
 v_exp_f32 v5,v5
 v_mfma_f32_16x16x32_bf16 v[20:23],a[108:111],a[44:47],v[20:23]
 v_cvt_pk_bf16_f32 v62,v4,v5
 v_mfma_f32_16x16x32_bf16 v[24:27],a[80:83],a[48:51],v[92:95]
 v_exp_f32 v6,v6
 v_mfma_f32_16x16x32_bf16 v[28:31],a[96:99],a[48:51],v[92:95]
 ds_read_b64_tr_b16 a[136:137],v119 offset:49152
 ds_read_b64_tr_b16 a[138:139],v119 offset:53248
 v_mfma_f32_16x16x32_bf16 v[24:27],a[84:87],a[52:55],v[24:27]
 v_exp_f32 v7,v7
 v_mfma_f32_16x16x32_bf16 v[28:31],a[100:103],a[52:55],v[28:31]
 v_cvt_pk_bf16_f32 v63,v6,v7
 v_mfma_f32_16x16x32_bf16 v[24:27],a[88:91],a[56:59],v[24:27]
 v_exp_f32 v8,v8
 v_mfma_f32_16x16x32_bf16 v[28:31],a[104:107],a[56:59],v[28:31]
 ds_read_b64_tr_b16 a[140:141],v120 offset:49152
 ds_read_b64_tr_b16 a[142:143],v120 offset:53248
 v_mfma_f32_16x16x32_bf16 v[24:27],a[92:95],a[60:63],v[24:27]
 v_exp_f32 v9,v9
 v_mfma_f32_16x16x32_bf16 v[28:31],a[108:111],a[60:63],v[28:31]
 v_cvt_pk_bf16_f32 v64,v8,v9
 s_waitcnt vmcnt(4)
 buffer_load_dwordx4 v134,s[20:23],s33 offen offset:1024 nt lds
 v_mfma_f32_16x16x32_bf16 v[32:35],a[80:83],a[64:67],v[96:99]
 v_exp_f32 v10,v10
 v_mfma_f32_16x16x32_bf16 v[36:39],a[96:99],a[64:67],v[96:99]
 v_mfma_f32_16x16x32_bf16 v[32:35],a[84:87],a[68:71],v[32:35]
 v_exp_f32 v11,v11
 v_mfma_f32_16x16x32_bf16 v[36:39],a[100:103],a[68:71],v[36:39]
 v_cvt_pk_bf16_f32 v65,v10,v11
 v_mfma_f32_16x16x32_bf16 v[32:35],a[88:91],a[72:75],v[32:35]
 v_exp_f32 v12,v12
 v_mfma_f32_16x16x32_bf16 v[36:39],a[104:107],a[72:75],v[36:39]
 v_mfma_f32_16x16x32_bf16 v[32:35],a[92:95],a[76:79],v[32:35]
 v_exp_f32 v13,v13
 v_mfma_f32_16x16x32_bf16 v[36:39],a[108:111],a[76:79],v[36:39]
 v_cvt_pk_bf16_f32 v66,v12,v13
 s_waitcnt lgkmcnt(0)
 v_mfma_f32_16x16x32_bf16 v[144:147],a[112:115],v[40:43],v[144:147]
 s_barrier
 v_exp_f32 v14,v14
 v_mfma_f32_16x16x32_bf16 v[148:151],a[116:119],v[40:43],v[148:151]
 v_mfma_f32_16x16x32_bf16 v[152:155],a[120:123],v[40:43],v[152:155]
 v_exp_f32 v15,v15
 v_mfma_f32_16x16x32_bf16 v[156:159],a[124:127],v[40:43],v[156:159]
 v_cvt_pk_bf16_f32 v67,v14,v15
 v_mfma_f32_16x16x32_bf16 v[160:163],a[128:131],v[40:43],v[160:163]
 v_exp_f32 v16,v16
 v_mfma_f32_16x16x32_bf16 v[164:167],a[132:135],v[40:43],v[164:167]
 ds_read_b128 a[80:83],v105 offset:49152
 s_waitcnt vmcnt(4)
 buffer_load_dwordx4 v133,s[20:23],s33 offen offset:2048 nt lds
 v_mfma_f32_16x16x32_bf16 v[168:171],a[136:139],v[40:43],v[168:171]
 v_exp_f32 v17,v17
 v_mfma_f32_16x16x32_bf16 v[172:175],a[140:143],v[40:43],v[172:175]
 v_cvt_pk_bf16_f32 v68,v16,v17
 v_mfma_f32_16x16x32_bf16 a[192:195],a[212:215],v[40:43],a[192:195]
 ds_read_b128 a[96:99],v105 offset:53248
 v_mfma_f32_16x16x32_bf16 v[176:179],a[112:115],v[44:47],v[176:179]
 v_exp_f32 v18,v18
 v_mfma_f32_16x16x32_bf16 v[180:183],a[116:119],v[44:47],v[180:183]
 ds_read_b128 a[84:87],v106 offset:49152
 v_mfma_f32_16x16x32_bf16 v[184:187],a[120:123],v[44:47],v[184:187]
 v_exp_f32 v19,v19
 v_mfma_f32_16x16x32_bf16 v[188:191],a[124:127],v[44:47],v[188:191]
 v_cvt_pk_bf16_f32 v69,v18,v19
 v_mfma_f32_16x16x32_bf16 v[192:195],a[128:131],v[44:47],v[192:195]
 v_exp_f32 v20,v20
 v_mfma_f32_16x16x32_bf16 v[196:199],a[132:135],v[44:47],v[196:199]
 s_waitcnt vmcnt(4)
 buffer_load_dwordx4 v134,s[20:23],s33 offen offset:3072 nt lds
 v_mfma_f32_16x16x32_bf16 v[200:203],a[136:139],v[44:47],v[200:203]
 v_exp_f32 v21,v21
 v_mfma_f32_16x16x32_bf16 v[204:207],a[140:143],v[44:47],v[204:207]
 v_cvt_pk_bf16_f32 v70,v20,v21
 v_mfma_f32_16x16x32_bf16 a[196:199],a[212:215],v[44:47],a[196:199]
 ds_read_b128 a[100:103],v106 offset:53248
 v_mfma_f32_16x16x32_bf16 v[208:211],a[112:115],v[48:51],v[208:211]
 v_exp_f32 v22,v22
 v_mfma_f32_16x16x32_bf16 v[212:215],a[116:119],v[48:51],v[212:215]
 ds_read_b128 a[88:91],v107 offset:49152
 v_mfma_f32_16x16x32_bf16 v[216:219],a[120:123],v[48:51],v[216:219]
 v_exp_f32 v23,v23
 v_mfma_f32_16x16x32_bf16 v[220:223],a[124:127],v[48:51],v[220:223]
 v_cvt_pk_bf16_f32 v71,v22,v23
 v_mfma_f32_16x16x32_bf16 v[224:227],a[128:131],v[48:51],v[224:227]
 v_exp_f32 v24,v24
 v_mfma_f32_16x16x32_bf16 v[228:231],a[132:135],v[48:51],v[228:231]
 ds_read_b128 a[104:107],v107 offset:53248
 s_add_u32 m0,s34,0x0
 v_mfma_f32_16x16x32_bf16 v[232:235],a[136:139],v[48:51],v[232:235]
 v_exp_f32 v25,v25
 s_xor_b32 s32,s57,0x3c000
 v_mfma_f32_16x16x32_bf16 v[236:239],a[140:143],v[48:51],v[236:239]
 v_cvt_pk_bf16_f32 v72,v24,v25
 s_waitcnt vmcnt(3)
 buffer_load_dwordx4 v129,s[16:19],s32 offen offset:0 nt lds
 v_mfma_f32_16x16x32_bf16 a[200:203],a[212:215],v[48:51],a[200:203]
 v_mfma_f32_16x16x32_bf16 v[240:243],a[112:115],v[52:55],v[240:243]
 v_exp_f32 v26,v26
 v_mfma_f32_16x16x32_bf16 v[244:247],a[116:119],v[52:55],v[244:247]
 ds_read_b128 a[92:95],v108 offset:49152
 v_mfma_f32_16x16x32_bf16 v[248:251],a[120:123],v[52:55],v[248:251]
 v_exp_f32 v27,v27
 v_mfma_f32_16x16x32_bf16 v[252:255],a[124:127],v[52:55],v[252:255]
 v_cvt_pk_bf16_f32 v73,v26,v27
 v_mfma_f32_16x16x32_bf16 a[144:147],a[128:131],v[52:55],a[144:147]
 v_exp_f32 v28,v28
 v_mfma_f32_16x16x32_bf16 a[148:151],a[132:135],v[52:55],a[148:151]
 ds_read_b128 a[108:111],v108 offset:53248
 v_mfma_f32_16x16x32_bf16 a[152:155],a[136:139],v[52:55],a[152:155]
 v_exp_f32 v29,v29
 v_mfma_f32_16x16x32_bf16 a[156:159],a[140:143],v[52:55],a[156:159]
 v_cvt_pk_bf16_f32 v74,v28,v29
 s_waitcnt vmcnt(4)
 buffer_load_dwordx4 v130,s[16:19],s32 offen offset:1024 nt lds
 v_mfma_f32_16x16x32_bf16 a[204:207],a[212:215],v[52:55],a[204:207]
 v_mfma_f32_16x16x32_bf16 a[160:163],a[112:115],v[56:59],a[160:163]
 v_exp_f32 v30,v30
 v_mfma_f32_16x16x32_bf16 a[164:167],a[116:119],v[56:59],a[164:167]
 v_mfma_f32_16x16x32_bf16 a[168:171],a[120:123],v[56:59],a[168:171]
 v_exp_f32 v31,v31
 v_mfma_f32_16x16x32_bf16 a[172:175],a[124:127],v[56:59],a[172:175]
 v_cvt_pk_bf16_f32 v75,v30,v31
 v_mfma_f32_16x16x32_bf16 a[176:179],a[128:131],v[56:59],a[176:179]
 v_exp_f32 v32,v32
 v_mfma_f32_16x16x32_bf16 a[180:183],a[132:135],v[56:59],a[180:183]
 v_mfma_f32_16x16x32_bf16 a[184:187],a[136:139],v[56:59],a[184:187]
 v_exp_f32 v33,v33
 v_mfma_f32_16x16x32_bf16 a[188:191],a[140:143],v[56:59],a[188:191]
 v_cvt_pk_bf16_f32 v76,v32,v33
 v_mfma_f32_16x16x32_bf16 a[208:211],a[212:215],v[56:59],a[208:211]
 s_waitcnt lgkmcnt(0)
 v_mfma_f32_16x16x32_bf16 v[0:3],a[80:83],a[0:3],v[80:83]
 v_exp_f32 v34,v34
 v_mfma_f32_16x16x32_bf16 v[4:7],a[96:99],a[0:3],v[80:83]
 ds_read_b64_tr_b16 a[112:113],v121 offset:0
 ds_read_b64_tr_b16 a[114:115],v121 offset:4096
 v_mfma_f32_16x16x32_bf16 v[0:3],a[84:87],a[4:7],v[0:3]
 v_exp_f32 v35,v35
 v_mfma_f32_16x16x32_bf16 v[4:7],a[100:103],a[4:7],v[4:7]
 v_cvt_pk_bf16_f32 v77,v34,v35
 v_mfma_f32_16x16x32_bf16 v[0:3],a[88:91],a[8:11],v[0:3]
 v_exp_f32 v36,v36
 v_mfma_f32_16x16x32_bf16 v[4:7],a[104:107],a[8:11],v[4:7]
 ds_read_b64_tr_b16 a[116:117],v122 offset:0
 ds_read_b64_tr_b16 a[118:119],v122 offset:4096
 v_mfma_f32_16x16x32_bf16 v[0:3],a[92:95],a[12:15],v[0:3]
 v_exp_f32 v37,v37
 v_mfma_f32_16x16x32_bf16 v[4:7],a[108:111],a[12:15],v[4:7]
 v_cvt_pk_bf16_f32 v78,v36,v37
 s_waitcnt vmcnt(4)
 buffer_load_dwordx4 v131,s[16:19],s32 offen offset:2048 nt lds
 v_mfma_f32_16x16x32_bf16 v[8:11],a[80:83],a[16:19],v[84:87]
 v_exp_f32 v38,v38
 v_mfma_f32_16x16x32_bf16 v[12:15],a[96:99],a[16:19],v[84:87]
 ds_read_b64_tr_b16 a[120:121],v123 offset:0
 ds_read_b64_tr_b16 a[122:123],v123 offset:4096
 v_mfma_f32_16x16x32_bf16 v[8:11],a[84:87],a[20:23],v[8:11]
 v_exp_f32 v39,v39
 v_mfma_f32_16x16x32_bf16 v[12:15],a[100:103],a[20:23],v[12:15]
 v_cvt_pk_bf16_f32 v79,v38,v39
 v_mfma_f32_16x16x32_bf16 v[8:11],a[88:91],a[24:27],v[8:11]
 v_exp_f32 v0,v0
 v_mfma_f32_16x16x32_bf16 v[12:15],a[104:107],a[24:27],v[12:15]
 ds_read_b64_tr_b16 a[124:125],v124 offset:0
 ds_read_b64_tr_b16 a[126:127],v124 offset:4096
 v_mfma_f32_16x16x32_bf16 v[8:11],a[92:95],a[28:31],v[8:11]
 v_exp_f32 v1,v1
 v_mfma_f32_16x16x32_bf16 v[12:15],a[108:111],a[28:31],v[12:15]
 v_cvt_pk_bf16_f32 v40,v0,v1
 s_waitcnt vmcnt(4)
 buffer_load_dwordx4 v132,s[16:19],s32 offen offset:3072 nt lds
 v_mfma_f32_16x16x32_bf16 v[16:19],a[80:83],a[32:35],v[88:91]
 v_exp_f32 v2,v2
 v_mfma_f32_16x16x32_bf16 v[20:23],a[96:99],a[32:35],v[88:91]
 ds_read_b64_tr_b16 a[128:129],v125 offset:0
 ds_read_b64_tr_b16 a[130:131],v125 offset:4096
 v_mfma_f32_16x16x32_bf16 v[16:19],a[84:87],a[36:39],v[16:19]
 v_exp_f32 v3,v3
 v_mfma_f32_16x16x32_bf16 v[20:23],a[100:103],a[36:39],v[20:23]
 v_cvt_pk_bf16_f32 v41,v2,v3
 v_mfma_f32_16x16x32_bf16 v[16:19],a[88:91],a[40:43],v[16:19]
 v_exp_f32 v4,v4
 v_mfma_f32_16x16x32_bf16 v[20:23],a[104:107],a[40:43],v[20:23]
 ds_read_b64_tr_b16 a[132:133],v126 offset:0
 ds_read_b64_tr_b16 a[134:135],v126 offset:4096
 s_add_u32 m0,s34,0x20000
 v_mfma_f32_16x16x32_bf16 v[16:19],a[92:95],a[44:47],v[16:19]
 v_exp_f32 v5,v5
 s_xor_b32 s33,s57,0x3c000
 v_mfma_f32_16x16x32_bf16 v[20:23],a[108:111],a[44:47],v[20:23]
 v_cvt_pk_bf16_f32 v42,v4,v5
 s_waitcnt vmcnt(3)
 buffer_load_dwordx4 v133,s[20:23],s33 offen offset:0 nt lds
 v_mfma_f32_16x16x32_bf16 v[24:27],a[80:83],a[48:51],v[92:95]
 v_exp_f32 v6,v6
 v_mfma_f32_16x16x32_bf16 v[28:31],a[96:99],a[48:51],v[92:95]
 ds_read_b64_tr_b16 a[136:137],v127 offset:0
 ds_read_b64_tr_b16 a[138:139],v127 offset:4096
 v_mfma_f32_16x16x32_bf16 v[24:27],a[84:87],a[52:55],v[24:27]
 v_exp_f32 v7,v7
 v_mfma_f32_16x16x32_bf16 v[28:31],a[100:103],a[52:55],v[28:31]
 v_cvt_pk_bf16_f32 v43,v6,v7
 v_mfma_f32_16x16x32_bf16 v[24:27],a[88:91],a[56:59],v[24:27]
 v_exp_f32 v8,v8
 v_mfma_f32_16x16x32_bf16 v[28:31],a[104:107],a[56:59],v[28:31]
 ds_read_b64_tr_b16 a[140:141],v128 offset:0
 ds_read_b64_tr_b16 a[142:143],v128 offset:4096
 v_mfma_f32_16x16x32_bf16 v[24:27],a[92:95],a[60:63],v[24:27]
 v_exp_f32 v9,v9
 v_mfma_f32_16x16x32_bf16 v[28:31],a[108:111],a[60:63],v[28:31]
 v_cvt_pk_bf16_f32 v44,v8,v9
 s_waitcnt vmcnt(4)
 buffer_load_dwordx4 v134,s[20:23],s33 offen offset:1024 nt lds
 v_mfma_f32_16x16x32_bf16 v[32:35],a[80:83],a[64:67],v[96:99]
 v_exp_f32 v10,v10
 v_mfma_f32_16x16x32_bf16 v[36:39],a[96:99],a[64:67],v[96:99]
 v_mfma_f32_16x16x32_bf16 v[32:35],a[84:87],a[68:71],v[32:35]
 v_exp_f32 v11,v11
 v_mfma_f32_16x16x32_bf16 v[36:39],a[100:103],a[68:71],v[36:39]
 v_cvt_pk_bf16_f32 v45,v10,v11
 v_mfma_f32_16x16x32_bf16 v[32:35],a[88:91],a[72:75],v[32:35]
 v_exp_f32 v12,v12
 v_mfma_f32_16x16x32_bf16 v[36:39],a[104:107],a[72:75],v[36:39]
 v_mfma_f32_16x16x32_bf16 v[32:35],a[92:95],a[76:79],v[32:35]
 v_exp_f32 v13,v13
 v_mfma_f32_16x16x32_bf16 v[36:39],a[108:111],a[76:79],v[36:39]
 v_cvt_pk_bf16_f32 v46,v12,v13
 s_waitcnt lgkmcnt(0)
 v_mfma_f32_16x16x32_bf16 v[144:147],a[112:115],v[60:63],v[144:147]
 s_barrier
 v_exp_f32 v14,v14
 v_mfma_f32_16x16x32_bf16 v[148:151],a[116:119],v[60:63],v[148:151]
 v_mfma_f32_16x16x32_bf16 v[152:155],a[120:123],v[60:63],v[152:155]
 v_exp_f32 v15,v15
 v_mfma_f32_16x16x32_bf16 v[156:159],a[124:127],v[60:63],v[156:159]
 v_cvt_pk_bf16_f32 v47,v14,v15
 v_mfma_f32_16x16x32_bf16 v[160:163],a[128:131],v[60:63],v[160:163]
 v_exp_f32 v16,v16
 v_mfma_f32_16x16x32_bf16 v[164:167],a[132:135],v[60:63],v[164:167]
 ds_read_b128 a[80:83],v109 offset:0
 s_waitcnt vmcnt(4)
 buffer_load_dwordx4 v133,s[20:23],s33 offen offset:2048 nt lds
 v_mfma_f32_16x16x32_bf16 v[168:171],a[136:139],v[60:63],v[168:171]
 v_exp_f32 v17,v17
 v_mfma_f32_16x16x32_bf16 v[172:175],a[140:143],v[60:63],v[172:175]
 v_cvt_pk_bf16_f32 v48,v16,v17
 v_mfma_f32_16x16x32_bf16 a[192:195],a[212:215],v[60:63],a[192:195]
 ds_read_b128 a[96:99],v109 offset:4096
 v_mfma_f32_16x16x32_bf16 v[176:179],a[112:115],v[64:67],v[176:179]
 v_exp_f32 v18,v18
 v_mfma_f32_16x16x32_bf16 v[180:183],a[116:119],v[64:67],v[180:183]
 ds_read_b128 a[84:87],v110 offset:0
 v_mfma_f32_16x16x32_bf16 v[184:187],a[120:123],v[64:67],v[184:187]
 v_exp_f32 v19,v19
 v_mfma_f32_16x16x32_bf16 v[188:191],a[124:127],v[64:67],v[188:191]
 v_cvt_pk_bf16_f32 v49,v18,v19
 v_mfma_f32_16x16x32_bf16 v[192:195],a[128:131],v[64:67],v[192:195]
 v_exp_f32 v20,v20
 v_mfma_f32_16x16x32_bf16 v[196:199],a[132:135],v[64:67],v[196:199]
 v_mfma_f32_16x16x32_bf16 v[200:203],a[136:139],v[64:67],v[200:203]
 v_exp_f32 v21,v21
 v_mfma_f32_16x16x32_bf16 v[204:207],a[140:143],v[64:67],v[204:207]
 v_cvt_pk_bf16_f32 v50,v20,v21
 v_mfma_f32_16x16x32_bf16 a[196:199],a[212:215],v[64:67],a[196:199]
 ds_read_b128 a[100:103],v110 offset:4096
 s_waitcnt vmcnt(4)
 buffer_load_dwordx4 v134,s[20:23],s33 offen offset:3072 nt lds
 v_mfma_f32_16x16x32_bf16 v[208:211],a[112:115],v[68:71],v[208:211]
 v_exp_f32 v22,v22
 v_mfma_f32_16x16x32_bf16 v[212:215],a[116:119],v[68:71],v[212:215]
 ds_read_b128 a[88:91],v111 offset:0
 v_mfma_f32_16x16x32_bf16 v[216:219],a[120:123],v[68:71],v[216:219]
 v_exp_f32 v23,v23
 v_mfma_f32_16x16x32_bf16 v[220:223],a[124:127],v[68:71],v[220:223]
 v_cvt_pk_bf16_f32 v51,v22,v23
 v_mfma_f32_16x16x32_bf16 v[224:227],a[128:131],v[68:71],v[224:227]
 v_exp_f32 v24,v24
 v_mfma_f32_16x16x32_bf16 v[228:231],a[132:135],v[68:71],v[228:231]
 ds_read_b128 a[104:107],v111 offset:4096
 v_mfma_f32_16x16x32_bf16 v[232:235],a[136:139],v[68:71],v[232:235]
 v_exp_f32 v25,v25
 v_mfma_f32_16x16x32_bf16 v[236:239],a[140:143],v[68:71],v[236:239]
 v_cvt_pk_bf16_f32 v52,v24,v25
 v_mfma_f32_16x16x32_bf16 a[200:203],a[212:215],v[68:71],a[200:203]
 v_mfma_f32_16x16x32_bf16 v[240:243],a[112:115],v[72:75],v[240:243]
 v_exp_f32 v26,v26
 v_mfma_f32_16x16x32_bf16 v[244:247],a[116:119],v[72:75],v[244:247]
 ds_read_b128 a[92:95],v112 offset:0
 v_mfma_f32_16x16x32_bf16 v[248:251],a[120:123],v[72:75],v[248:251]
 v_exp_f32 v27,v27
 v_mfma_f32_16x16x32_bf16 v[252:255],a[124:127],v[72:75],v[252:255]
 v_cvt_pk_bf16_f32 v53,v26,v27
 s_add_u32 m0,s34,0x4000
 v_mfma_f32_16x16x32_bf16 a[144:147],a[128:131],v[72:75],a[144:147]
 v_exp_f32 v28,v28
 s_xor_b32 s32,s57,0x3e000
 v_mfma_f32_16x16x32_bf16 a[148:151],a[132:135],v[72:75],a[148:151]
 ds_read_b128 a[108:111],v112 offset:4096
 s_waitcnt vmcnt(4)
 buffer_load_dwordx4 v129,s[16:19],s32 offen offset:0 nt lds
 v_mfma_f32_16x16x32_bf16 a[152:155],a[136:139],v[72:75],a[152:155]
 v_exp_f32 v29,v29
 v_mfma_f32_16x16x32_bf16 a[156:159],a[140:143],v[72:75],a[156:159]
 v_cvt_pk_bf16_f32 v54,v28,v29
 v_mfma_f32_16x16x32_bf16 a[204:207],a[212:215],v[72:75],a[204:207]
 v_mfma_f32_16x16x32_bf16 a[160:163],a[112:115],v[76:79],a[160:163]
 v_exp_f32 v30,v30
 v_mfma_f32_16x16x32_bf16 a[164:167],a[116:119],v[76:79],a[164:167]
 v_mfma_f32_16x16x32_bf16 a[168:171],a[120:123],v[76:79],a[168:171]
 v_exp_f32 v31,v31
 v_mfma_f32_16x16x32_bf16 a[172:175],a[124:127],v[76:79],a[172:175]
 v_cvt_pk_bf16_f32 v55,v30,v31
 v_mfma_f32_16x16x32_bf16 a[176:179],a[128:131],v[76:79],a[176:179]
 v_exp_f32 v32,v32
 v_mfma_f32_16x16x32_bf16 a[180:183],a[132:135],v[76:79],a[180:183]
 v_mfma_f32_16x16x32_bf16 a[184:187],a[136:139],v[76:79],a[184:187]
 v_exp_f32 v33,v33
 v_mfma_f32_16x16x32_bf16 a[188:191],a[140:143],v[76:79],a[188:191]
 v_cvt_pk_bf16_f32 v56,v32,v33
 v_mfma_f32_16x16x32_bf16 a[208:211],a[212:215],v[76:79],a[208:211]
 s_waitcnt lgkmcnt(0)
 v_mfma_f32_16x16x32_bf16 v[0:3],a[80:83],a[0:3],v[80:83]
 v_exp_f32 v34,v34
 v_mfma_f32_16x16x32_bf16 v[4:7],a[96:99],a[0:3],v[80:83]
 ds_read_b64_tr_b16 a[112:113],v113 offset:0
 ds_read_b64_tr_b16 a[114:115],v113 offset:4096
 v_mfma_f32_16x16x32_bf16 v[0:3],a[84:87],a[4:7],v[0:3]
 v_exp_f32 v35,v35
 v_mfma_f32_16x16x32_bf16 v[4:7],a[100:103],a[4:7],v[4:7]
 v_cvt_pk_bf16_f32 v57,v34,v35
 v_mfma_f32_16x16x32_bf16 v[0:3],a[88:91],a[8:11],v[0:3]
 v_exp_f32 v36,v36
 v_mfma_f32_16x16x32_bf16 v[4:7],a[104:107],a[8:11],v[4:7]
 ds_read_b64_tr_b16 a[116:117],v114 offset:0
 ds_read_b64_tr_b16 a[118:119],v114 offset:4096
 v_mfma_f32_16x16x32_bf16 v[0:3],a[92:95],a[12:15],v[0:3]
 v_exp_f32 v37,v37
 v_mfma_f32_16x16x32_bf16 v[4:7],a[108:111],a[12:15],v[4:7]
 v_cvt_pk_bf16_f32 v58,v36,v37
 s_waitcnt vmcnt(4)
 buffer_load_dwordx4 v130,s[16:19],s32 offen offset:1024 nt lds
 v_mfma_f32_16x16x32_bf16 v[8:11],a[80:83],a[16:19],v[84:87]
 v_exp_f32 v38,v38
 v_mfma_f32_16x16x32_bf16 v[12:15],a[96:99],a[16:19],v[84:87]
 ds_read_b64_tr_b16 a[120:121],v115 offset:0
 ds_read_b64_tr_b16 a[122:123],v115 offset:4096
 v_mfma_f32_16x16x32_bf16 v[8:11],a[84:87],a[20:23],v[8:11]
 v_exp_f32 v39,v39
 v_mfma_f32_16x16x32_bf16 v[12:15],a[100:103],a[20:23],v[12:15]
 v_cvt_pk_bf16_f32 v59,v38,v39
 v_mfma_f32_16x16x32_bf16 v[8:11],a[88:91],a[24:27],v[8:11]
 v_exp_f32 v0,v0
 v_mfma_f32_16x16x32_bf16 v[12:15],a[104:107],a[24:27],v[12:15]
 ds_read_b64_tr_b16 a[124:125],v116 offset:0
 ds_read_b64_tr_b16 a[126:127],v116 offset:4096
 v_mfma_f32_16x16x32_bf16 v[8:11],a[92:95],a[28:31],v[8:11]
 v_exp_f32 v1,v1
 v_mfma_f32_16x16x32_bf16 v[12:15],a[108:111],a[28:31],v[12:15]
 v_cvt_pk_bf16_f32 v60,v0,v1
 s_waitcnt vmcnt(4)
 buffer_load_dwordx4 v131,s[16:19],s32 offen offset:2048 nt lds
 v_mfma_f32_16x16x32_bf16 v[16:19],a[80:83],a[32:35],v[88:91]
 v_exp_f32 v2,v2
 v_mfma_f32_16x16x32_bf16 v[20:23],a[96:99],a[32:35],v[88:91]
 ds_read_b64_tr_b16 a[128:129],v117 offset:0
 ds_read_b64_tr_b16 a[130:131],v117 offset:4096
 v_mfma_f32_16x16x32_bf16 v[16:19],a[84:87],a[36:39],v[16:19]
 v_exp_f32 v3,v3
 v_mfma_f32_16x16x32_bf16 v[20:23],a[100:103],a[36:39],v[20:23]
 v_cvt_pk_bf16_f32 v61,v2,v3
 v_mfma_f32_16x16x32_bf16 v[16:19],a[88:91],a[40:43],v[16:19]
 v_exp_f32 v4,v4
 v_mfma_f32_16x16x32_bf16 v[20:23],a[104:107],a[40:43],v[20:23]
 ds_read_b64_tr_b16 a[132:133],v118 offset:0
 ds_read_b64_tr_b16 a[134:135],v118 offset:4096
 v_mfma_f32_16x16x32_bf16 v[16:19],a[92:95],a[44:47],v[16:19]
 v_exp_f32 v5,v5
 v_mfma_f32_16x16x32_bf16 v[20:23],a[108:111],a[44:47],v[20:23]
 v_cvt_pk_bf16_f32 v62,v4,v5
 s_waitcnt vmcnt(4)
 buffer_load_dwordx4 v132,s[16:19],s32 offen offset:3072 nt lds
 v_mfma_f32_16x16x32_bf16 v[24:27],a[80:83],a[48:51],v[92:95]
 v_exp_f32 v6,v6
 v_mfma_f32_16x16x32_bf16 v[28:31],a[96:99],a[48:51],v[92:95]
 ds_read_b64_tr_b16 a[136:137],v119 offset:0
 ds_read_b64_tr_b16 a[138:139],v119 offset:4096
 v_mfma_f32_16x16x32_bf16 v[24:27],a[84:87],a[52:55],v[24:27]
 v_exp_f32 v7,v7
 v_mfma_f32_16x16x32_bf16 v[28:31],a[100:103],a[52:55],v[28:31]
 v_cvt_pk_bf16_f32 v63,v6,v7
 v_mfma_f32_16x16x32_bf16 v[24:27],a[88:91],a[56:59],v[24:27]
 v_exp_f32 v8,v8
 v_mfma_f32_16x16x32_bf16 v[28:31],a[104:107],a[56:59],v[28:31]
 ds_read_b64_tr_b16 a[140:141],v120 offset:0
 ds_read_b64_tr_b16 a[142:143],v120 offset:4096
 s_add_u32 m0,s34,0x24000
 v_mfma_f32_16x16x32_bf16 v[24:27],a[92:95],a[60:63],v[24:27]
 v_exp_f32 v9,v9
 s_xor_b32 s33,s57,0x3e000
 v_mfma_f32_16x16x32_bf16 v[28:31],a[108:111],a[60:63],v[28:31]
 v_cvt_pk_bf16_f32 v64,v8,v9
 s_waitcnt vmcnt(4)
 buffer_load_dwordx4 v133,s[20:23],s33 offen offset:0 nt lds
 v_mfma_f32_16x16x32_bf16 v[32:35],a[80:83],a[64:67],v[96:99]
 v_exp_f32 v10,v10
 v_mfma_f32_16x16x32_bf16 v[36:39],a[96:99],a[64:67],v[96:99]
 v_lshrrev_b32 v122,8,v133
 v_and_b32 v121,0x70,v133
 v_mfma_f32_16x16x32_bf16 v[32:35],a[84:87],a[68:71],v[32:35]
 v_exp_f32 v11,v11
 v_lshl_add_u32 v121,v122,10,v121
 v_bfe_u32 v122,v133,7,1
 v_mfma_f32_16x16x32_bf16 v[36:39],a[100:103],a[68:71],v[36:39]
 v_cvt_pk_bf16_f32 v65,v10,v11
 v_mul_u32_u24 v122,0x20200,v122
 v_add_u32 v121,v121,v122
 v_mfma_f32_16x16x32_bf16 v[32:35],a[88:91],a[72:75],v[32:35]
 v_exp_f32 v12,v12
 v_xor_b32 v122,0x20200,v121
 v_add_u32 v123,6144,v121
 v_mfma_f32_16x16x32_bf16 v[36:39],a[104:107],a[72:75],v[36:39]
 v_add_u32 v124,9216,v122
 v_add_u32 v122,3072,v122
 v_mfma_f32_16x16x32_bf16 v[32:35],a[92:95],a[76:79],v[32:35]
 v_exp_f32 v13,v13
 v_xor_b32 v125,0x20000,v121
 v_xor_b32 v126,0x20000,v122
 v_mfma_f32_16x16x32_bf16 v[36:39],a[108:111],a[76:79],v[36:39]
 v_cvt_pk_bf16_f32 v66,v12,v13
 v_xor_b32 v127,0x20000,v123
 v_xor_b32 v128,0x20000,v124
 s_waitcnt lgkmcnt(0)
 v_mfma_f32_16x16x32_bf16 v[144:147],a[112:115],v[40:43],v[144:147]
 s_barrier
 v_exp_f32 v14,v14
 v_mfma_f32_16x16x32_bf16 v[148:151],a[116:119],v[40:43],v[148:151]
 v_mfma_f32_16x16x32_bf16 v[152:155],a[120:123],v[40:43],v[152:155]
 v_exp_f32 v15,v15
 v_mfma_f32_16x16x32_bf16 v[156:159],a[124:127],v[40:43],v[156:159]
 v_cvt_pk_bf16_f32 v67,v14,v15
 v_mfma_f32_16x16x32_bf16 v[160:163],a[128:131],v[40:43],v[160:163]
 v_exp_f32 v16,v16
 v_mfma_f32_16x16x32_bf16 v[164:167],a[132:135],v[40:43],v[164:167]
 ds_read_b128 a[80:83],v105 offset:0
 s_waitcnt vmcnt(4)
 buffer_load_dwordx4 v134,s[20:23],s33 offen offset:1024 nt lds
 v_mfma_f32_16x16x32_bf16 v[168:171],a[136:139],v[40:43],v[168:171]
 v_exp_f32 v17,v17
 v_mfma_f32_16x16x32_bf16 v[172:175],a[140:143],v[40:43],v[172:175]
 v_cvt_pk_bf16_f32 v68,v16,v17
 v_mfma_f32_16x16x32_bf16 a[192:195],a[212:215],v[40:43],a[192:195]
 ds_read_b128 a[96:99],v105 offset:4096
 v_mfma_f32_16x16x32_bf16 v[176:179],a[112:115],v[44:47],v[176:179]
 v_exp_f32 v18,v18
 v_mfma_f32_16x16x32_bf16 v[180:183],a[116:119],v[44:47],v[180:183]
 ds_read_b128 a[84:87],v106 offset:0
 v_mfma_f32_16x16x32_bf16 v[184:187],a[120:123],v[44:47],v[184:187]
 v_exp_f32 v19,v19
 v_mfma_f32_16x16x32_bf16 v[188:191],a[124:127],v[44:47],v[188:191]
 v_cvt_pk_bf16_f32 v69,v18,v19
 v_mfma_f32_16x16x32_bf16 v[192:195],a[128:131],v[44:47],v[192:195]
 v_exp_f32 v20,v20
 v_mfma_f32_16x16x32_bf16 v[196:199],a[132:135],v[44:47],v[196:199]
 v_mfma_f32_16x16x32_bf16 v[200:203],a[136:139],v[44:47],v[200:203]
 v_exp_f32 v21,v21
 v_mfma_f32_16x16x32_bf16 v[204:207],a[140:143],v[44:47],v[204:207]
 v_cvt_pk_bf16_f32 v70,v20,v21
 v_mfma_f32_16x16x32_bf16 a[196:199],a[212:215],v[44:47],a[196:199]
 ds_read_b128 a[100:103],v106 offset:4096
 s_waitcnt vmcnt(4)
 buffer_load_dwordx4 v133,s[20:23],s33 offen offset:2048 nt lds
 v_mfma_f32_16x16x32_bf16 v[208:211],a[112:115],v[48:51],v[208:211]
 v_exp_f32 v22,v22
 v_mfma_f32_16x16x32_bf16 v[212:215],a[116:119],v[48:51],v[212:215]
 ds_read_b128 a[88:91],v107 offset:0
 v_mfma_f32_16x16x32_bf16 v[216:219],a[120:123],v[48:51],v[216:219]
 v_exp_f32 v23,v23
 v_mfma_f32_16x16x32_bf16 v[220:223],a[124:127],v[48:51],v[220:223]
 v_cvt_pk_bf16_f32 v71,v22,v23
 v_mfma_f32_16x16x32_bf16 v[224:227],a[128:131],v[48:51],v[224:227]
 v_exp_f32 v24,v24
 v_mfma_f32_16x16x32_bf16 v[228:231],a[132:135],v[48:51],v[228:231]
 ds_read_b128 a[104:107],v107 offset:4096
 v_mfma_f32_16x16x32_bf16 v[232:235],a[136:139],v[48:51],v[232:235]
 v_exp_f32 v25,v25
 v_mfma_f32_16x16x32_bf16 v[236:239],a[140:143],v[48:51],v[236:239]
 v_cvt_pk_bf16_f32 v72,v24,v25
 v_mfma_f32_16x16x32_bf16 a[200:203],a[212:215],v[48:51],a[200:203]
 v_mfma_f32_16x16x32_bf16 v[240:243],a[112:115],v[52:55],v[240:243]
 v_exp_f32 v26,v26
 v_mfma_f32_16x16x32_bf16 v[244:247],a[116:119],v[52:55],v[244:247]
 ds_read_b128 a[92:95],v108 offset:0
 v_mfma_f32_16x16x32_bf16 v[248:251],a[120:123],v[52:55],v[248:251]
 v_exp_f32 v27,v27
 v_mfma_f32_16x16x32_bf16 v[252:255],a[124:127],v[52:55],v[252:255]
 v_cvt_pk_bf16_f32 v73,v26,v27
 v_mfma_f32_16x16x32_bf16 a[144:147],a[128:131],v[52:55],a[144:147]
 v_exp_f32 v28,v28
 v_mfma_f32_16x16x32_bf16 a[148:151],a[132:135],v[52:55],a[148:151]
 ds_read_b128 a[108:111],v108 offset:4096
 s_waitcnt vmcnt(4)
 buffer_load_dwordx4 v134,s[20:23],s33 offen offset:3072 nt lds
 v_mfma_f32_16x16x32_bf16 a[152:155],a[136:139],v[52:55],a[152:155]
 v_exp_f32 v29,v29
 v_mfma_f32_16x16x32_bf16 a[156:159],a[140:143],v[52:55],a[156:159]
 v_cvt_pk_bf16_f32 v74,v28,v29
 v_mfma_f32_16x16x32_bf16 a[204:207],a[212:215],v[52:55],a[204:207]
 v_mfma_f32_16x16x32_bf16 a[160:163],a[112:115],v[56:59],a[160:163]
 v_exp_f32 v30,v30
 v_mfma_f32_16x16x32_bf16 a[164:167],a[116:119],v[56:59],a[164:167]
 v_mfma_f32_16x16x32_bf16 a[168:171],a[120:123],v[56:59],a[168:171]
 v_exp_f32 v31,v31
 v_mfma_f32_16x16x32_bf16 a[172:175],a[124:127],v[56:59],a[172:175]
 v_cvt_pk_bf16_f32 v75,v30,v31
 v_mfma_f32_16x16x32_bf16 a[176:179],a[128:131],v[56:59],a[176:179]
 v_exp_f32 v32,v32
 v_mfma_f32_16x16x32_bf16 a[180:183],a[132:135],v[56:59],a[180:183]
 v_mfma_f32_16x16x32_bf16 a[184:187],a[136:139],v[56:59],a[184:187]
 v_exp_f32 v33,v33
 v_mfma_f32_16x16x32_bf16 a[188:191],a[140:143],v[56:59],a[188:191]
 v_cvt_pk_bf16_f32 v76,v32,v33
 v_mfma_f32_16x16x32_bf16 a[208:211],a[212:215],v[56:59],a[208:211]
 s_waitcnt lgkmcnt(0)
 v_mfma_f32_16x16x32_bf16 v[0:3],a[80:83],a[0:3],v[80:83]
 v_exp_f32 v34,v34
 v_mfma_f32_16x16x32_bf16 v[4:7],a[96:99],a[0:3],v[80:83]
 ds_read_b64_tr_b16 a[112:113],v113 offset:16384
 ds_read_b64_tr_b16 a[114:115],v113 offset:20480
 v_mfma_f32_16x16x32_bf16 v[0:3],a[84:87],a[4:7],v[0:3]
 v_exp_f32 v35,v35
 v_mfma_f32_16x16x32_bf16 v[4:7],a[100:103],a[4:7],v[4:7]
 v_cvt_pk_bf16_f32 v77,v34,v35
 v_mfma_f32_16x16x32_bf16 v[0:3],a[88:91],a[8:11],v[0:3]
 v_exp_f32 v36,v36
 v_mfma_f32_16x16x32_bf16 v[4:7],a[104:107],a[8:11],v[4:7]
 ds_read_b64_tr_b16 a[116:117],v114 offset:16384
 ds_read_b64_tr_b16 a[118:119],v114 offset:20480
 v_mfma_f32_16x16x32_bf16 v[0:3],a[92:95],a[12:15],v[0:3]
 v_exp_f32 v37,v37
 v_mfma_f32_16x16x32_bf16 v[4:7],a[108:111],a[12:15],v[4:7]
 v_cvt_pk_bf16_f32 v78,v36,v37
 v_mfma_f32_16x16x32_bf16 v[8:11],a[80:83],a[16:19],v[84:87]
 v_exp_f32 v38,v38
 v_mfma_f32_16x16x32_bf16 v[12:15],a[96:99],a[16:19],v[84:87]
 ds_read_b64_tr_b16 a[120:121],v115 offset:16384
 ds_read_b64_tr_b16 a[122:123],v115 offset:20480
 v_mfma_f32_16x16x32_bf16 v[8:11],a[84:87],a[20:23],v[8:11]
 v_exp_f32 v39,v39
 v_mfma_f32_16x16x32_bf16 v[12:15],a[100:103],a[20:23],v[12:15]
 v_cvt_pk_bf16_f32 v79,v38,v39
 v_mfma_f32_16x16x32_bf16 v[8:11],a[88:91],a[24:27],v[8:11]
 v_exp_f32 v0,v0
 v_mfma_f32_16x16x32_bf16 v[12:15],a[104:107],a[24:27],v[12:15]
 ds_read_b64_tr_b16 a[124:125],v116 offset:16384
 ds_read_b64_tr_b16 a[126:127],v116 offset:20480
 v_mfma_f32_16x16x32_bf16 v[8:11],a[92:95],a[28:31],v[8:11]
 v_exp_f32 v1,v1
 v_mfma_f32_16x16x32_bf16 v[12:15],a[108:111],a[28:31],v[12:15]
 v_cvt_pk_bf16_f32 v40,v0,v1
 v_mfma_f32_16x16x32_bf16 v[16:19],a[80:83],a[32:35],v[88:91]
 v_exp_f32 v2,v2
 v_mfma_f32_16x16x32_bf16 v[20:23],a[96:99],a[32:35],v[88:91]
 ds_read_b64_tr_b16 a[128:129],v117 offset:16384
 ds_read_b64_tr_b16 a[130:131],v117 offset:20480
 v_mfma_f32_16x16x32_bf16 v[16:19],a[84:87],a[36:39],v[16:19]
 v_exp_f32 v3,v3
 v_mfma_f32_16x16x32_bf16 v[20:23],a[100:103],a[36:39],v[20:23]
 v_cvt_pk_bf16_f32 v41,v2,v3
 v_mfma_f32_16x16x32_bf16 v[16:19],a[88:91],a[40:43],v[16:19]
 v_exp_f32 v4,v4
 v_mfma_f32_16x16x32_bf16 v[20:23],a[104:107],a[40:43],v[20:23]
 ds_read_b64_tr_b16 a[132:133],v118 offset:16384
 ds_read_b64_tr_b16 a[134:135],v118 offset:20480
 v_mfma_f32_16x16x32_bf16 v[16:19],a[92:95],a[44:47],v[16:19]
 v_exp_f32 v5,v5
 v_mfma_f32_16x16x32_bf16 v[20:23],a[108:111],a[44:47],v[20:23]
 v_cvt_pk_bf16_f32 v42,v4,v5
 v_mfma_f32_16x16x32_bf16 v[24:27],a[80:83],a[48:51],v[92:95]
 v_exp_f32 v6,v6
 v_mfma_f32_16x16x32_bf16 v[28:31],a[96:99],a[48:51],v[92:95]
 ds_read_b64_tr_b16 a[136:137],v119 offset:16384
 ds_read_b64_tr_b16 a[138:139],v119 offset:20480
 v_mfma_f32_16x16x32_bf16 v[24:27],a[84:87],a[52:55],v[24:27]
 v_exp_f32 v7,v7
 v_mfma_f32_16x16x32_bf16 v[28:31],a[100:103],a[52:55],v[28:31]
 v_cvt_pk_bf16_f32 v43,v6,v7
 v_mfma_f32_16x16x32_bf16 v[24:27],a[88:91],a[56:59],v[24:27]
 v_exp_f32 v8,v8
 v_mfma_f32_16x16x32_bf16 v[28:31],a[104:107],a[56:59],v[28:31]
 ds_read_b64_tr_b16 a[140:141],v120 offset:16384
 ds_read_b64_tr_b16 a[142:143],v120 offset:20480
 v_mfma_f32_16x16x32_bf16 v[24:27],a[92:95],a[60:63],v[24:27]
 v_exp_f32 v9,v9
 v_mfma_f32_16x16x32_bf16 v[28:31],a[108:111],a[60:63],v[28:31]
 v_cvt_pk_bf16_f32 v44,v8,v9
 v_mfma_f32_16x16x32_bf16 v[32:35],a[80:83],a[64:67],v[96:99]
 v_exp_f32 v10,v10
 v_mfma_f32_16x16x32_bf16 v[36:39],a[96:99],a[64:67],v[96:99]
 v_mfma_f32_16x16x32_bf16 v[32:35],a[84:87],a[68:71],v[32:35]
 v_exp_f32 v11,v11
 v_mfma_f32_16x16x32_bf16 v[36:39],a[100:103],a[68:71],v[36:39]
 v_cvt_pk_bf16_f32 v45,v10,v11
 v_mfma_f32_16x16x32_bf16 v[32:35],a[88:91],a[72:75],v[32:35]
 v_exp_f32 v12,v12
 v_mfma_f32_16x16x32_bf16 v[36:39],a[104:107],a[72:75],v[36:39]
 v_mfma_f32_16x16x32_bf16 v[32:35],a[92:95],a[76:79],v[32:35]
 v_exp_f32 v13,v13
 v_mfma_f32_16x16x32_bf16 v[36:39],a[108:111],a[76:79],v[36:39]
 v_cvt_pk_bf16_f32 v46,v12,v13
 s_waitcnt lgkmcnt(0)
 v_mfma_f32_16x16x32_bf16 v[144:147],a[112:115],v[60:63],v[144:147]
 s_waitcnt vmcnt(4)
 s_barrier
 v_exp_f32 v14,v14
 v_mfma_f32_16x16x32_bf16 v[148:151],a[116:119],v[60:63],v[148:151]
 v_mfma_f32_16x16x32_bf16 v[152:155],a[120:123],v[60:63],v[152:155]
 v_exp_f32 v15,v15
 v_mfma_f32_16x16x32_bf16 v[156:159],a[124:127],v[60:63],v[156:159]
 v_cvt_pk_bf16_f32 v47,v14,v15
 v_mfma_f32_16x16x32_bf16 v[160:163],a[128:131],v[60:63],v[160:163]
 v_exp_f32 v16,v16
 s_lshl_b32 s58,s84,3
 v_mfma_f32_16x16x32_bf16 v[164:167],a[132:135],v[60:63],v[164:167]
 ds_read_b128 a[80:83],v105 offset:16384
 buffer_load_dword v136,off,s[76:79],s58 offset:128 sc1
 v_mfma_f32_16x16x32_bf16 v[168:171],a[136:139],v[60:63],v[168:171]
 v_exp_f32 v17,v17
 s_lshl_b32 s59,s34,2
 s_add_u32 s59,s59,s44
 s_add_u32 m0,s34,0x18000
 v_mfma_f32_16x16x32_bf16 v[172:175],a[140:143],v[60:63],v[172:175]
 v_cvt_pk_bf16_f32 v48,v16,v17
 s_add_u32 s59,s59,0x0
 v_mfma_f32_16x16x32_bf16 a[192:195],a[212:215],v[60:63],a[192:195]
 ds_read_b128 a[96:99],v105 offset:20480
 s_waitcnt vmcnt(4)
 buffer_load_dwordx4 v121,s[24:27],s59 offen offset:0  lds
 v_mfma_f32_16x16x32_bf16 v[176:179],a[112:115],v[64:67],v[176:179]
 v_exp_f32 v18,v18
 v_mfma_f32_16x16x32_bf16 v[180:183],a[116:119],v[64:67],v[180:183]
 ds_read_b128 a[84:87],v106 offset:16384
 v_mfma_f32_16x16x32_bf16 v[184:187],a[120:123],v[64:67],v[184:187]
 v_exp_f32 v19,v19
 v_mfma_f32_16x16x32_bf16 v[188:191],a[124:127],v[64:67],v[188:191]
 v_cvt_pk_bf16_f32 v49,v18,v19
 v_mfma_f32_16x16x32_bf16 v[192:195],a[128:131],v[64:67],v[192:195]
 v_exp_f32 v20,v20
 v_mfma_f32_16x16x32_bf16 v[196:199],a[132:135],v[64:67],v[196:199]
 s_waitcnt vmcnt(4)
 buffer_load_dwordx4 v122,s[24:27],s59 offen offset:1024  lds
 v_mfma_f32_16x16x32_bf16 v[200:203],a[136:139],v[64:67],v[200:203]
 v_exp_f32 v21,v21
 v_mfma_f32_16x16x32_bf16 v[204:207],a[140:143],v[64:67],v[204:207]
 v_cvt_pk_bf16_f32 v50,v20,v21
 v_mfma_f32_16x16x32_bf16 a[196:199],a[212:215],v[64:67],a[196:199]
 ds_read_b128 a[100:103],v106 offset:20480
 s_waitcnt vmcnt(4)
 buffer_load_dwordx4 v123,s[24:27],s59 offen offset:2048  lds
 v_mfma_f32_16x16x32_bf16 v[208:211],a[112:115],v[68:71],v[208:211]
 v_exp_f32 v22,v22
 v_mfma_f32_16x16x32_bf16 v[212:215],a[116:119],v[68:71],v[212:215]
 ds_read_b128 a[88:91],v107 offset:16384
 v_mfma_f32_16x16x32_bf16 v[216:219],a[120:123],v[68:71],v[216:219]
 v_exp_f32 v23,v23
 v_mfma_f32_16x16x32_bf16 v[220:223],a[124:127],v[68:71],v[220:223]
 v_cvt_pk_bf16_f32 v51,v22,v23
 v_mfma_f32_16x16x32_bf16 v[224:227],a[128:131],v[68:71],v[224:227]
 v_exp_f32 v24,v24
 v_mfma_f32_16x16x32_bf16 v[228:231],a[132:135],v[68:71],v[228:231]
 ds_read_b128 a[104:107],v107 offset:20480
 s_waitcnt vmcnt(4)
 buffer_load_dwordx4 v124,s[24:27],s59 offen offset:3072  lds
 v_mfma_f32_16x16x32_bf16 v[232:235],a[136:139],v[68:71],v[232:235]
 v_exp_f32 v25,v25
 s_lshl_b32 s59,s34,2
 s_add_u32 s59,s59,s44
 s_add_u32 m0,s34,0x0
 v_mfma_f32_16x16x32_bf16 v[236:239],a[140:143],v[68:71],v[236:239]
 v_cvt_pk_bf16_f32 v52,v24,v25
 s_add_u32 s59,s59,0x10000
 v_mfma_f32_16x16x32_bf16 a[200:203],a[212:215],v[68:71],a[200:203]
 s_waitcnt vmcnt(4)
 buffer_load_dwordx4 v121,s[24:27],s59 offen offset:0  lds
 v_mfma_f32_16x16x32_bf16 v[240:243],a[112:115],v[72:75],v[240:243]
 v_exp_f32 v26,v26
 v_mfma_f32_16x16x32_bf16 v[244:247],a[116:119],v[72:75],v[244:247]
 ds_read_b128 a[92:95],v108 offset:16384
 v_mfma_f32_16x16x32_bf16 v[248:251],a[120:123],v[72:75],v[248:251]
 v_exp_f32 v27,v27
 v_mfma_f32_16x16x32_bf16 v[252:255],a[124:127],v[72:75],v[252:255]
 v_cvt_pk_bf16_f32 v53,v26,v27
 v_mfma_f32_16x16x32_bf16 a[144:147],a[128:131],v[72:75],a[144:147]
 v_exp_f32 v28,v28
 v_mfma_f32_16x16x32_bf16 a[148:151],a[132:135],v[72:75],a[148:151]
 ds_read_b128 a[108:111],v108 offset:20480
 s_waitcnt vmcnt(4)
 buffer_load_dwordx4 v122,s[24:27],s59 offen offset:1024  lds
 v_mfma_f32_16x16x32_bf16 a[152:155],a[136:139],v[72:75],a[152:155]
 v_exp_f32 v29,v29
 v_mfma_f32_16x16x32_bf16 a[156:159],a[140:143],v[72:75],a[156:159]
 v_cvt_pk_bf16_f32 v54,v28,v29
 v_mfma_f32_16x16x32_bf16 a[204:207],a[212:215],v[72:75],a[204:207]
 s_waitcnt vmcnt(4)
 buffer_load_dwordx4 v123,s[24:27],s59 offen offset:2048  lds
 v_mfma_f32_16x16x32_bf16 a[160:163],a[112:115],v[76:79],a[160:163]
 v_exp_f32 v30,v30
 v_mfma_f32_16x16x32_bf16 a[164:167],a[116:119],v[76:79],a[164:167]
 v_mfma_f32_16x16x32_bf16 a[168:171],a[120:123],v[76:79],a[168:171]
 v_exp_f32 v31,v31
 v_mfma_f32_16x16x32_bf16 a[172:175],a[124:127],v[76:79],a[172:175]
 v_cvt_pk_bf16_f32 v55,v30,v31
 v_mfma_f32_16x16x32_bf16 a[176:179],a[128:131],v[76:79],a[176:179]
 v_exp_f32 v32,v32
 v_mfma_f32_16x16x32_bf16 a[180:183],a[132:135],v[76:79],a[180:183]
 s_waitcnt vmcnt(4)
 buffer_load_dwordx4 v124,s[24:27],s59 offen offset:3072  lds
 v_mfma_f32_16x16x32_bf16 a[184:187],a[136:139],v[76:79],a[184:187]
 v_exp_f32 v33,v33
 v_mfma_f32_16x16x32_bf16 a[188:191],a[140:143],v[76:79],a[188:191]
 v_cvt_pk_bf16_f32 v56,v32,v33
 v_mfma_f32_16x16x32_bf16 a[208:211],a[212:215],v[76:79],a[208:211]
 s_waitcnt lgkmcnt(0)
 v_mfma_f32_16x16x32_bf16 v[0:3],a[80:83],a[0:3],v[80:83]
 v_exp_f32 v34,v34
 v_mfma_f32_16x16x32_bf16 v[4:7],a[96:99],a[0:3],v[80:83]
 ds_read_b64_tr_b16 a[112:113],v113 offset:32768
 ds_read_b64_tr_b16 a[114:115],v113 offset:36864
 v_mfma_f32_16x16x32_bf16 v[0:3],a[84:87],a[4:7],v[0:3]
 v_exp_f32 v35,v35
 v_mfma_f32_16x16x32_bf16 v[4:7],a[100:103],a[4:7],v[4:7]
 v_cvt_pk_bf16_f32 v57,v34,v35
 s_lshl_b32 s59,s34,2
 v_mfma_f32_16x16x32_bf16 v[0:3],a[88:91],a[8:11],v[0:3]
 v_exp_f32 v36,v36
 s_add_u32 s59,s59,s44
 v_mfma_f32_16x16x32_bf16 v[4:7],a[104:107],a[8:11],v[4:7]
 ds_read_b64_tr_b16 a[116:117],v114 offset:32768
 ds_read_b64_tr_b16 a[118:119],v114 offset:36864
 s_add_u32 m0,s34,0x1c000
 v_mfma_f32_16x16x32_bf16 v[0:3],a[92:95],a[12:15],v[0:3]
 v_exp_f32 v37,v37
 s_add_u32 s59,s59,0x0
 v_mfma_f32_16x16x32_bf16 v[4:7],a[108:111],a[12:15],v[4:7]
 v_cvt_pk_bf16_f32 v58,v36,v37
 s_waitcnt vmcnt(4)
 buffer_load_dwordx4 v125,s[24:27],s59 offen offset:0  lds
 v_mfma_f32_16x16x32_bf16 v[8:11],a[80:83],a[16:19],v[84:87]
 v_exp_f32 v38,v38
 v_mfma_f32_16x16x32_bf16 v[12:15],a[96:99],a[16:19],v[84:87]
 ds_read_b64_tr_b16 a[120:121],v115 offset:32768
 ds_read_b64_tr_b16 a[122:123],v115 offset:36864
 v_mfma_f32_16x16x32_bf16 v[8:11],a[84:87],a[20:23],v[8:11]
 v_exp_f32 v39,v39
 v_mfma_f32_16x16x32_bf16 v[12:15],a[100:103],a[20:23],v[12:15]
 v_cvt_pk_bf16_f32 v59,v38,v39
 v_mfma_f32_16x16x32_bf16 v[8:11],a[88:91],a[24:27],v[8:11]
 v_exp_f32 v0,v0
 v_mfma_f32_16x16x32_bf16 v[12:15],a[104:107],a[24:27],v[12:15]
 ds_read_b64_tr_b16 a[124:125],v116 offset:32768
 ds_read_b64_tr_b16 a[126:127],v116 offset:36864
 v_mfma_f32_16x16x32_bf16 v[8:11],a[92:95],a[28:31],v[8:11]
 v_exp_f32 v1,v1
 v_mfma_f32_16x16x32_bf16 v[12:15],a[108:111],a[28:31],v[12:15]
 v_cvt_pk_bf16_f32 v60,v0,v1
 s_waitcnt vmcnt(4)
 buffer_load_dwordx4 v126,s[24:27],s59 offen offset:1024  lds
 v_mfma_f32_16x16x32_bf16 v[16:19],a[80:83],a[32:35],v[88:91]
 v_exp_f32 v2,v2
 v_mfma_f32_16x16x32_bf16 v[20:23],a[96:99],a[32:35],v[88:91]
 ds_read_b64_tr_b16 a[128:129],v117 offset:32768
 ds_read_b64_tr_b16 a[130:131],v117 offset:36864
 v_mfma_f32_16x16x32_bf16 v[16:19],a[84:87],a[36:39],v[16:19]
 v_exp_f32 v3,v3
 v_mfma_f32_16x16x32_bf16 v[20:23],a[100:103],a[36:39],v[20:23]
 v_cvt_pk_bf16_f32 v61,v2,v3
 v_mfma_f32_16x16x32_bf16 v[16:19],a[88:91],a[40:43],v[16:19]
 v_exp_f32 v4,v4
 v_mfma_f32_16x16x32_bf16 v[20:23],a[104:107],a[40:43],v[20:23]
 ds_read_b64_tr_b16 a[132:133],v118 offset:32768
 ds_read_b64_tr_b16 a[134:135],v118 offset:36864
 v_mfma_f32_16x16x32_bf16 v[16:19],a[92:95],a[44:47],v[16:19]
 v_exp_f32 v5,v5
 v_mfma_f32_16x16x32_bf16 v[20:23],a[108:111],a[44:47],v[20:23]
 v_cvt_pk_bf16_f32 v62,v4,v5
 s_waitcnt vmcnt(4)
 buffer_load_dwordx4 v127,s[24:27],s59 offen offset:2048  lds
 v_mfma_f32_16x16x32_bf16 v[24:27],a[80:83],a[48:51],v[92:95]
 v_exp_f32 v6,v6
 v_mfma_f32_16x16x32_bf16 v[28:31],a[96:99],a[48:51],v[92:95]
 ds_read_b64_tr_b16 a[136:137],v119 offset:32768
 ds_read_b64_tr_b16 a[138:139],v119 offset:36864
 v_mfma_f32_16x16x32_bf16 v[24:27],a[84:87],a[52:55],v[24:27]
 v_exp_f32 v7,v7
 v_mfma_f32_16x16x32_bf16 v[28:31],a[100:103],a[52:55],v[28:31]
 v_cvt_pk_bf16_f32 v63,v6,v7
 v_mfma_f32_16x16x32_bf16 v[24:27],a[88:91],a[56:59],v[24:27]
 v_exp_f32 v8,v8
 v_mfma_f32_16x16x32_bf16 v[28:31],a[104:107],a[56:59],v[28:31]
 ds_read_b64_tr_b16 a[140:141],v120 offset:32768
 ds_read_b64_tr_b16 a[142:143],v120 offset:36864
 v_mfma_f32_16x16x32_bf16 v[24:27],a[92:95],a[60:63],v[24:27]
 v_exp_f32 v9,v9
 v_mfma_f32_16x16x32_bf16 v[28:31],a[108:111],a[60:63],v[28:31]
 v_cvt_pk_bf16_f32 v64,v8,v9
 s_waitcnt vmcnt(4)
 buffer_load_dwordx4 v128,s[24:27],s59 offen offset:3072  lds
 v_mfma_f32_16x16x32_bf16 v[32:35],a[80:83],a[64:67],v[96:99]
 v_exp_f32 v10,v10
 v_mfma_f32_16x16x32_bf16 v[36:39],a[96:99],a[64:67],v[96:99]
 v_mfma_f32_16x16x32_bf16 v[32:35],a[84:87],a[68:71],v[32:35]
 v_exp_f32 v11,v11
 v_mfma_f32_16x16x32_bf16 v[36:39],a[100:103],a[68:71],v[36:39]
 v_cvt_pk_bf16_f32 v65,v10,v11
 v_mfma_f32_16x16x32_bf16 v[32:35],a[88:91],a[72:75],v[32:35]
 v_exp_f32 v12,v12
 v_mfma_f32_16x16x32_bf16 v[36:39],a[104:107],a[72:75],v[36:39]
 v_mfma_f32_16x16x32_bf16 v[32:35],a[92:95],a[76:79],v[32:35]
 v_exp_f32 v13,v13
 v_mfma_f32_16x16x32_bf16 v[36:39],a[108:111],a[76:79],v[36:39]
 v_cvt_pk_bf16_f32 v66,v12,v13
 s_waitcnt lgkmcnt(0)
 v_mfma_f32_16x16x32_bf16 v[144:147],a[112:115],v[40:43],v[144:147]
 s_barrier
 v_exp_f32 v14,v14
 v_mfma_f32_16x16x32_bf16 v[148:151],a[116:119],v[40:43],v[148:151]
 v_mfma_f32_16x16x32_bf16 v[152:155],a[120:123],v[40:43],v[152:155]
 v_exp_f32 v15,v15
 v_mfma_f32_16x16x32_bf16 v[156:159],a[124:127],v[40:43],v[156:159]
 v_cvt_pk_bf16_f32 v67,v14,v15
 s_lshl_b32 s59,s34,2
 v_mfma_f32_16x16x32_bf16 v[160:163],a[128:131],v[40:43],v[160:163]
 v_exp_f32 v16,v16
 s_add_u32 s59,s59,s44
 v_mfma_f32_16x16x32_bf16 v[164:167],a[132:135],v[40:43],v[164:167]
 ds_read_b64_tr_b16 a[80:81],v113 offset:49152
 ds_read_b64_tr_b16 a[82:83],v113 offset:53248
 s_add_u32 m0,s34,0x20000
 v_mfma_f32_16x16x32_bf16 v[168:171],a[136:139],v[40:43],v[168:171]
 v_exp_f32 v17,v17
 s_add_u32 s59,s59,0x10000
 v_mfma_f32_16x16x32_bf16 v[172:175],a[140:143],v[40:43],v[172:175]
 v_cvt_pk_bf16_f32 v68,v16,v17
 s_waitcnt vmcnt(4)
 buffer_load_dwordx4 v125,s[24:27],s59 offen offset:0  lds
 v_mfma_f32_16x16x32_bf16 a[192:195],a[212:215],v[40:43],a[192:195]
 ds_read_b64_tr_b16 a[84:85],v114 offset:49152
 v_mfma_f32_16x16x32_bf16 v[176:179],a[112:115],v[44:47],v[176:179]
 v_exp_f32 v18,v18
 v_mfma_f32_16x16x32_bf16 v[180:183],a[116:119],v[44:47],v[180:183]
 ds_read_b64_tr_b16 a[86:87],v114 offset:53248
 ds_read_b64_tr_b16 a[88:89],v115 offset:49152
 v_mfma_f32_16x16x32_bf16 v[184:187],a[120:123],v[44:47],v[184:187]
 v_exp_f32 v19,v19
 v_mfma_f32_16x16x32_bf16 v[188:191],a[124:127],v[44:47],v[188:191]
 v_cvt_pk_bf16_f32 v69,v18,v19
 v_mfma_f32_16x16x32_bf16 v[192:195],a[128:131],v[44:47],v[192:195]
 v_exp_f32 v20,v20
 v_mfma_f32_16x16x32_bf16 v[196:199],a[132:135],v[44:47],v[196:199]
 ds_read_b64_tr_b16 a[90:91],v115 offset:53248
 s_waitcnt vmcnt(4)
 buffer_load_dwordx4 v126,s[24:27],s59 offen offset:1024  lds
 v_mfma_f32_16x16x32_bf16 v[200:203],a[136:139],v[44:47],v[200:203]
 v_exp_f32 v21,v21
 v_mfma_f32_16x16x32_bf16 v[204:207],a[140:143],v[44:47],v[204:207]
 v_cvt_pk_bf16_f32 v70,v20,v21
 v_mfma_f32_16x16x32_bf16 a[196:199],a[212:215],v[44:47],a[196:199]
 ds_read_b64_tr_b16 a[92:93],v116 offset:49152
 ds_read_b64_tr_b16 a[94:95],v116 offset:53248
 v_mfma_f32_16x16x32_bf16 v[208:211],a[112:115],v[48:51],v[208:211]
 v_exp_f32 v22,v22
 v_mfma_f32_16x16x32_bf16 v[212:215],a[116:119],v[48:51],v[212:215]
 ds_read_b64_tr_b16 a[96:97],v117 offset:49152
 v_mfma_f32_16x16x32_bf16 v[216:219],a[120:123],v[48:51],v[216:219]
 v_exp_f32 v23,v23
 v_mfma_f32_16x16x32_bf16 v[220:223],a[124:127],v[48:51],v[220:223]
 v_cvt_pk_bf16_f32 v71,v22,v23
 v_mfma_f32_16x16x32_bf16 v[224:227],a[128:131],v[48:51],v[224:227]
 v_exp_f32 v24,v24
 v_mfma_f32_16x16x32_bf16 v[228:231],a[132:135],v[48:51],v[228:231]
 ds_read_b64_tr_b16 a[98:99],v117 offset:53248
 ds_read_b64_tr_b16 a[100:101],v118 offset:49152
 v_mfma_f32_16x16x32_bf16 v[232:235],a[136:139],v[48:51],v[232:235]
 v_exp_f32 v25,v25
 v_mfma_f32_16x16x32_bf16 v[236:239],a[140:143],v[48:51],v[236:239]
 v_cvt_pk_bf16_f32 v72,v24,v25
 s_waitcnt vmcnt(4)
 buffer_load_dwordx4 v127,s[24:27],s59 offen offset:2048  lds
 v_mfma_f32_16x16x32_bf16 a[200:203],a[212:215],v[48:51],a[200:203]
 ds_read_b64_tr_b16 a[102:103],v118 offset:53248
 v_mfma_f32_16x16x32_bf16 v[240:243],a[112:115],v[52:55],v[240:243]
 v_exp_f32 v26,v26
 v_mfma_f32_16x16x32_bf16 v[244:247],a[116:119],v[52:55],v[244:247]
 ds_read_b64_tr_b16 a[104:105],v119 offset:49152
 ds_read_b64_tr_b16 a[106:107],v119 offset:53248
 v_mfma_f32_16x16x32_bf16 v[248:251],a[120:123],v[52:55],v[248:251]
 v_exp_f32 v27,v27
 v_mfma_f32_16x16x32_bf16 v[252:255],a[124:127],v[52:55],v[252:255]
 v_cvt_pk_bf16_f32 v73,v26,v27
 v_mfma_f32_16x16x32_bf16 a[144:147],a[128:131],v[52:55],a[144:147]
 v_exp_f32 v28,v28
 v_mfma_f32_16x16x32_bf16 a[148:151],a[132:135],v[52:55],a[148:151]
 ds_read_b64_tr_b16 a[108:109],v120 offset:49152
 v_mfma_f32_16x16x32_bf16 a[152:155],a[136:139],v[52:55],a[152:155]
 v_exp_f32 v29,v29
 v_mfma_f32_16x16x32_bf16 a[156:159],a[140:143],v[52:55],a[156:159]
 v_cvt_pk_bf16_f32 v74,v28,v29
 s_waitcnt vmcnt(4)
 buffer_load_dwordx4 v128,s[24:27],s59 offen offset:3072  lds
 v_mfma_f32_16x16x32_bf16 a[204:207],a[212:215],v[52:55],a[204:207]
 ds_read_b64_tr_b16 a[110:111],v120 offset:53248
 v_mfma_f32_16x16x32_bf16 a[160:163],a[112:115],v[56:59],a[160:163]
 v_exp_f32 v30,v30
 v_mfma_f32_16x16x32_bf16 a[164:167],a[116:119],v[56:59],a[164:167]
 v_mfma_f32_16x16x32_bf16 a[168:171],a[120:123],v[56:59],a[168:171]
 v_exp_f32 v31,v31
 v_mfma_f32_16x16x32_bf16 a[172:175],a[124:127],v[56:59],a[172:175]
 v_cvt_pk_bf16_f32 v75,v30,v31
 v_mfma_f32_16x16x32_bf16 a[176:179],a[128:131],v[56:59],a[176:179]
 v_exp_f32 v32,v32
 v_mfma_f32_16x16x32_bf16 a[180:183],a[132:135],v[56:59],a[180:183]
 v_mfma_f32_16x16x32_bf16 a[184:187],a[136:139],v[56:59],a[184:187]
 v_exp_f32 v33,v33
 v_mfma_f32_16x16x32_bf16 a[188:191],a[140:143],v[56:59],a[188:191]
 v_cvt_pk_bf16_f32 v76,v32,v33
 v_mfma_f32_16x16x32_bf16 a[208:211],a[212:215],v[56:59],a[208:211]
 s_waitcnt lgkmcnt(0)
 v_mfma_f32_16x16x32_bf16 v[144:147],a[80:83],v[60:63],v[144:147]
 s_barrier
 v_exp_f32 v34,v34
 v_mfma_f32_16x16x32_bf16 v[148:151],a[84:87],v[60:63],v[148:151]
 v_mfma_f32_16x16x32_bf16 v[152:155],a[88:91],v[60:63],v[152:155]
 v_exp_f32 v35,v35
 v_mfma_f32_16x16x32_bf16 v[156:159],a[92:95],v[60:63],v[156:159]
 v_cvt_pk_bf16_f32 v77,v34,v35
 v_mfma_f32_16x16x32_bf16 v[160:163],a[96:99],v[60:63],v[160:163]
 v_exp_f32 v36,v36
 v_mfma_f32_16x16x32_bf16 v[164:167],a[100:103],v[60:63],v[164:167]
 v_mfma_f32_16x16x32_bf16 v[168:171],a[104:107],v[60:63],v[168:171]
 v_exp_f32 v37,v37
 v_mfma_f32_16x16x32_bf16 v[172:175],a[108:111],v[60:63],v[172:175]
 v_cvt_pk_bf16_f32 v78,v36,v37
 v_mfma_f32_16x16x32_bf16 a[192:195],a[212:215],v[60:63],a[192:195]
 v_exp_f32 v38,v38
 v_mfma_f32_16x16x32_bf16 v[176:179],a[80:83],v[64:67],v[176:179]
 v_mfma_f32_16x16x32_bf16 v[180:183],a[84:87],v[64:67],v[180:183]
 v_exp_f32 v39,v39
 v_mfma_f32_16x16x32_bf16 v[184:187],a[88:91],v[64:67],v[184:187]
 v_cvt_pk_bf16_f32 v79,v38,v39
 v_mfma_f32_16x16x32_bf16 v[188:191],a[92:95],v[64:67],v[188:191]
 s_mul_i32 s3,s4,20480
 s_add_u32 s3,s3,0x4000
 v_mfma_f32_16x16x32_bf16 v[192:195],a[96:99],v[64:67],v[192:195]
 v_add_u32 v97,s3,v135
 s_xor_b32 s3,s4,2
 v_mfma_f32_16x16x32_bf16 v[196:199],a[100:103],v[64:67],v[196:199]
 s_mul_i32 s3,s3,20480
 s_add_u32 s3,s3,0x4000
 v_mfma_f32_16x16x32_bf16 v[200:203],a[104:107],v[64:67],v[200:203]
 v_add_u32 v98,s3,v135
 v_accvgpr_read_b32 v100,a192
 v_mfma_f32_16x16x32_bf16 v[204:207],a[108:111],v[64:67],v[204:207]
 v_cmp_nge_f32 s[86:87],s56,v100
 v_rcp_f32 v80,v100
 v_mfma_f32_16x16x32_bf16 a[196:199],a[212:215],v[64:67],a[196:199]
 s_nop 0
 v_mov_b32 v81,v80
 v_mfma_f32_16x16x32_bf16 v[208:211],a[80:83],v[68:71],v[208:211]
 v_mul_f32 v144,v144,v80
 v_mul_f32 v145,v145,v80
 v_mfma_f32_16x16x32_bf16 v[212:215],a[84:87],v[68:71],v[212:215]
 v_mul_f32 v146,v146,v80
 v_mul_f32 v147,v147,v80
 v_mfma_f32_16x16x32_bf16 v[216:219],a[88:91],v[68:71],v[216:219]
 v_cvt_pk_bf16_f32 v0,v144,v145
 v_cvt_pk_bf16_f32 v1,v146,v147
 v_mfma_f32_16x16x32_bf16 v[220:223],a[92:95],v[68:71],v[220:223]
 v_mul_f32 v148,v148,v80
 v_mul_f32 v149,v149,v80
 v_mfma_f32_16x16x32_bf16 v[224:227],a[96:99],v[68:71],v[224:227]
 v_mul_f32 v150,v150,v80
 v_mul_f32 v151,v151,v80
 v_mfma_f32_16x16x32_bf16 v[228:231],a[100:103],v[68:71],v[228:231]
 v_cvt_pk_bf16_f32 v2,v148,v149
 v_cvt_pk_bf16_f32 v3,v150,v151
 v_mfma_f32_16x16x32_bf16 v[232:235],a[104:107],v[68:71],v[232:235]
 ds_write_b128 v97,v[0:3] offset:0
 v_mul_f32 v152,v152,v80
 v_mfma_f32_16x16x32_bf16 v[236:239],a[108:111],v[68:71],v[236:239]
 v_mul_f32 v153,v153,v80
 v_mul_f32 v154,v154,v80
 v_mfma_f32_16x16x32_bf16 a[200:203],a[212:215],v[68:71],a[200:203]
 v_mul_f32 v155,v155,v80
 v_cvt_pk_bf16_f32 v4,v152,v153
 v_mfma_f32_16x16x32_bf16 v[240:243],a[80:83],v[72:75],v[240:243]
 v_cvt_pk_bf16_f32 v5,v154,v155
 v_mul_f32 v156,v156,v80
 v_mfma_f32_16x16x32_bf16 v[244:247],a[84:87],v[72:75],v[244:247]
 v_mul_f32 v157,v157,v80
 v_mul_f32 v158,v158,v80
 v_mfma_f32_16x16x32_bf16 v[248:251],a[88:91],v[72:75],v[248:251]
 v_mul_f32 v159,v159,v80
 v_cvt_pk_bf16_f32 v6,v156,v157
 v_mfma_f32_16x16x32_bf16 v[252:255],a[92:95],v[72:75],v[252:255]
 v_cvt_pk_bf16_f32 v7,v158,v159
 ds_write_b128 v97,v[4:7] offset:1024
 v_mfma_f32_16x16x32_bf16 a[144:147],a[96:99],v[72:75],a[144:147]
 v_mul_f32 v160,v160,v80
 v_mul_f32 v161,v161,v80
 v_mfma_f32_16x16x32_bf16 a[148:151],a[100:103],v[72:75],a[148:151]
 v_mul_f32 v162,v162,v80
 v_mul_f32 v163,v163,v80
 v_mfma_f32_16x16x32_bf16 a[152:155],a[104:107],v[72:75],a[152:155]
 v_cvt_pk_bf16_f32 v8,v160,v161
 v_cvt_pk_bf16_f32 v9,v162,v163
 v_mfma_f32_16x16x32_bf16 a[156:159],a[108:111],v[72:75],a[156:159]
 v_mul_f32 v164,v164,v80
 v_mul_f32 v165,v165,v80
 v_mfma_f32_16x16x32_bf16 a[204:207],a[212:215],v[72:75],a[204:207]
 v_mul_f32 v166,v166,v80
 v_mul_f32 v167,v167,v80
 v_mfma_f32_16x16x32_bf16 a[160:163],a[80:83],v[76:79],a[160:163]
 v_cvt_pk_bf16_f32 v10,v164,v165
 v_cvt_pk_bf16_f32 v11,v166,v167
 v_mfma_f32_16x16x32_bf16 a[164:167],a[84:87],v[76:79],a[164:167]
 ds_write_b128 v97,v[8:11] offset:2048
 v_mul_f32 v168,v168,v80
 v_mfma_f32_16x16x32_bf16 a[168:171],a[88:91],v[76:79],a[168:171]
 v_mul_f32 v169,v169,v80
 v_mul_f32 v170,v170,v80
 v_mfma_f32_16x16x32_bf16 a[172:175],a[92:95],v[76:79],a[172:175]
 v_mul_f32 v171,v171,v80
 v_cvt_pk_bf16_f32 v12,v168,v169
 v_mfma_f32_16x16x32_bf16 a[176:179],a[96:99],v[76:79],a[176:179]
 v_cvt_pk_bf16_f32 v13,v170,v171
 v_mul_f32 v172,v172,v80
 v_mfma_f32_16x16x32_bf16 a[180:183],a[100:103],v[76:79],a[180:183]
 v_mul_f32 v173,v173,v80
 v_mul_f32 v174,v174,v80
 v_mfma_f32_16x16x32_bf16 a[184:187],a[104:107],v[76:79],a[184:187]
 v_mul_f32 v175,v175,v80
 v_cvt_pk_bf16_f32 v14,v172,v173
 v_mfma_f32_16x16x32_bf16 a[188:191],a[108:111],v[76:79],a[188:191]
 v_cvt_pk_bf16_f32 v15,v174,v175
 ds_write_b128 v97,v[12:15] offset:3072
 v_mfma_f32_16x16x32_bf16 a[208:211],a[212:215],v[76:79],a[208:211]
 v_accvgpr_read_b32 v101,a196
 v_cmp_nge_f32 s[88:89],s56,v101
 v_rcp_f32 v82,v101
 s_or_b64 s[86:87],s[86:87],s[88:89]
 v_mov_b32 v83,v82
 v_pk_mul_f32 v[176:177],v[176:177],v[82:83]
 v_pk_mul_f32 v[178:179],v[178:179],v[82:83]
 v_cvt_pk_bf16_f32 v16,v176,v177
 v_cvt_pk_bf16_f32 v17,v178,v179
 v_pk_mul_f32 v[180:181],v[180:181],v[82:83]
 v_pk_mul_f32 v[182:183],v[182:183],v[82:83]
 v_cvt_pk_bf16_f32 v18,v180,v181
 v_cvt_pk_bf16_f32 v19,v182,v183
 ds_write_b128 v97,v[16:19] offset:4096
 v_pk_mul_f32 v[184:185],v[184:185],v[82:83]
 v_pk_mul_f32 v[186:187],v[186:187],v[82:83]
 v_cvt_pk_bf16_f32 v20,v184,v185
 v_cvt_pk_bf16_f32 v21,v186,v187
 v_pk_mul_f32 v[188:189],v[188:189],v[82:83]
 v_pk_mul_f32 v[190:191],v[190:191],v[82:83]
 v_cvt_pk_bf16_f32 v22,v188,v189
 v_cvt_pk_bf16_f32 v23,v190,v191
 ds_write_b128 v97,v[20:23] offset:5120
 v_pk_mul_f32 v[192:193],v[192:193],v[82:83]
 v_pk_mul_f32 v[194:195],v[194:195],v[82:83]
 v_cvt_pk_bf16_f32 v24,v192,v193
 v_cvt_pk_bf16_f32 v25,v194,v195
 v_pk_mul_f32 v[196:197],v[196:197],v[82:83]
 v_pk_mul_f32 v[198:199],v[198:199],v[82:83]
 v_cvt_pk_bf16_f32 v26,v196,v197
 v_cvt_pk_bf16_f32 v27,v198,v199
 ds_write_b128 v97,v[24:27] offset:6144
 v_pk_mul_f32 v[200:201],v[200:201],v[82:83]
 v_pk_mul_f32 v[202:203],v[202:203],v[82:83]
 v_cvt_pk_bf16_f32 v28,v200,v201
 v_cvt_pk_bf16_f32 v29,v202,v203
 v_pk_mul_f32 v[204:205],v[204:205],v[82:83]
 v_pk_mul_f32 v[206:207],v[206:207],v[82:83]
 v_cvt_pk_bf16_f32 v30,v204,v205
 v_cvt_pk_bf16_f32 v31,v206,v207
 ds_write_b128 v97,v[28:31] offset:7168
 v_accvgpr_read_b32 v102,a200
 v_cmp_nge_f32 s[88:89],s56,v102
 v_rcp_f32 v84,v102
 s_or_b64 s[86:87],s[86:87],s[88:89]
 v_mov_b32 v85,v84
 v_pk_mul_f32 v[208:209],v[208:209],v[84:85]
 v_pk_mul_f32 v[210:211],v[210:211],v[84:85]
 v_cvt_pk_bf16_f32 v32,v208,v209
 v_cvt_pk_bf16_f32 v33,v210,v211
 v_pk_mul_f32 v[212:213],v[212:213],v[84:85]
 v_pk_mul_f32 v[214:215],v[214:215],v[84:85]
 v_cvt_pk_bf16_f32 v34,v212,v213
 v_cvt_pk_bf16_f32 v35,v214,v215
 ds_write_b128 v97,v[32:35] offset:8192
 v_pk_mul_f32 v[216:217],v[216:217],v[84:85]
 v_pk_mul_f32 v[218:219],v[218:219],v[84:85]
 v_cvt_pk_bf16_f32 v36,v216,v217
 v_cvt_pk_bf16_f32 v37,v218,v219
 v_pk_mul_f32 v[220:221],v[220:221],v[84:85]
 v_pk_mul_f32 v[222:223],v[222:223],v[84:85]
 v_cvt_pk_bf16_f32 v38,v220,v221
 v_cvt_pk_bf16_f32 v39,v222,v223
 ds_write_b128 v97,v[36:39] offset:9216
 v_pk_mul_f32 v[224:225],v[224:225],v[84:85]
 v_pk_mul_f32 v[226:227],v[226:227],v[84:85]
 v_cvt_pk_bf16_f32 v40,v224,v225
 v_cvt_pk_bf16_f32 v41,v226,v227
 v_pk_mul_f32 v[228:229],v[228:229],v[84:85]
 v_pk_mul_f32 v[230:231],v[230:231],v[84:85]
 v_cvt_pk_bf16_f32 v42,v228,v229
 v_cvt_pk_bf16_f32 v43,v230,v231
 ds_write_b128 v97,v[40:43] offset:10240
 v_pk_mul_f32 v[232:233],v[232:233],v[84:85]
 v_pk_mul_f32 v[234:235],v[234:235],v[84:85]
 v_cvt_pk_bf16_f32 v44,v232,v233
 v_cvt_pk_bf16_f32 v45,v234,v235
 v_pk_mul_f32 v[236:237],v[236:237],v[84:85]
 v_pk_mul_f32 v[238:239],v[238:239],v[84:85]
 v_cvt_pk_bf16_f32 v46,v236,v237
 v_cvt_pk_bf16_f32 v47,v238,v239
 ds_write_b128 v97,v[44:47] offset:11264
 v_accvgpr_read_b32 v103,a204
 v_cmp_nge_f32 s[88:89],s56,v103
 v_rcp_f32 v86,v103
 s_or_b64 s[86:87],s[86:87],s[88:89]
 v_mov_b32 v87,v86
 v_pk_mul_f32 v[240:241],v[240:241],v[86:87]
 v_pk_mul_f32 v[242:243],v[242:243],v[86:87]
 v_cvt_pk_bf16_f32 v48,v240,v241
 v_cvt_pk_bf16_f32 v49,v242,v243
 v_pk_mul_f32 v[244:245],v[244:245],v[86:87]
 v_pk_mul_f32 v[246:247],v[246:247],v[86:87]
 v_cvt_pk_bf16_f32 v50,v244,v245
 v_cvt_pk_bf16_f32 v51,v246,v247
 ds_write_b128 v97,v[48:51] offset:12288
 v_pk_mul_f32 v[248:249],v[248:249],v[86:87]
 v_pk_mul_f32 v[250:251],v[250:251],v[86:87]
 v_cvt_pk_bf16_f32 v52,v248,v249
 v_cvt_pk_bf16_f32 v53,v250,v251
 v_pk_mul_f32 v[252:253],v[252:253],v[86:87]
 v_pk_mul_f32 v[254:255],v[254:255],v[86:87]
 v_cvt_pk_bf16_f32 v54,v252,v253
 v_cvt_pk_bf16_f32 v55,v254,v255
 ds_write_b128 v97,v[52:55] offset:13312
 v_accvgpr_read_b32 v90,a144
 v_accvgpr_read_b32 v91,a145
 v_accvgpr_read_b32 v92,a146
 v_accvgpr_read_b32 v93,a147
 v_pk_mul_f32 v[90:91],v[90:91],v[86:87]
 v_pk_mul_f32 v[92:93],v[92:93],v[86:87]
 v_cvt_pk_bf16_f32 v56,v90,v91
 v_cvt_pk_bf16_f32 v57,v92,v93
 v_accvgpr_read_b32 v90,a148
 v_accvgpr_read_b32 v91,a149
 v_accvgpr_read_b32 v92,a150
 v_accvgpr_read_b32 v93,a151
 v_pk_mul_f32 v[90:91],v[90:91],v[86:87]
 v_pk_mul_f32 v[92:93],v[92:93],v[86:87]
 v_cvt_pk_bf16_f32 v58,v90,v91
 v_cvt_pk_bf16_f32 v59,v92,v93
 ds_write_b128 v97,v[56:59] offset:14336
 v_accvgpr_read_b32 v90,a152
 v_accvgpr_read_b32 v91,a153
 v_accvgpr_read_b32 v92,a154
 v_accvgpr_read_b32 v93,a155
 v_pk_mul_f32 v[90:91],v[90:91],v[86:87]
 v_pk_mul_f32 v[92:93],v[92:93],v[86:87]
 v_cvt_pk_bf16_f32 v60,v90,v91
 v_cvt_pk_bf16_f32 v61,v92,v93
 v_accvgpr_read_b32 v90,a156
 v_accvgpr_read_b32 v91,a157
 v_accvgpr_read_b32 v92,a158
 v_accvgpr_read_b32 v93,a159
 v_pk_mul_f32 v[90:91],v[90:91],v[86:87]
 v_pk_mul_f32 v[92:93],v[92:93],v[86:87]
 v_cvt_pk_bf16_f32 v62,v90,v91
 v_cvt_pk_bf16_f32 v63,v92,v93
 ds_write_b128 v97,v[60:63] offset:15360
 v_accvgpr_read_b32 v104,a208
 v_cmp_nge_f32 s[88:89],s56,v104
 v_rcp_f32 v88,v104
 s_or_b64 s[86:87],s[86:87],s[88:89]
 v_mov_b32 v89,v88
 s_cmp_lg_u64 s[86:87],0
 s_cselect_b32 s3,1,0
 v_mov_b32 v95,s3
 s_lshl_b32 s3,s4,2
 s_add_u32 s3,s3,0x24000
 v_mov_b32 v96,s3
 ds_write_b32 v96,v95
 v_accvgpr_read_b32 v90,a160
 v_accvgpr_read_b32 v91,a161
 v_accvgpr_read_b32 v92,a162
 v_accvgpr_read_b32 v93,a163
 v_pk_mul_f32 v[90:91],v[90:91],v[88:89]
 v_pk_mul_f32 v[92:93],v[92:93],v[88:89]
 v_cvt_pk_bf16_f32 v64,v90,v91
 v_cvt_pk_bf16_f32 v65,v92,v93
 v_accvgpr_read_b32 v90,a164
 v_accvgpr_read_b32 v91,a165
 v_accvgpr_read_b32 v92,a166
 v_accvgpr_read_b32 v93,a167
 v_pk_mul_f32 v[90:91],v[90:91],v[88:89]
 v_pk_mul_f32 v[92:93],v[92:93],v[88:89]
 v_cvt_pk_bf16_f32 v66,v90,v91
 v_cvt_pk_bf16_f32 v67,v92,v93
 ds_write_b128 v97,v[64:67] offset:16384
 v_accvgpr_read_b32 v90,a168
 v_accvgpr_read_b32 v91,a169
 v_accvgpr_read_b32 v92,a170
 v_accvgpr_read_b32 v93,a171
 v_pk_mul_f32 v[90:91],v[90:91],v[88:89]
 v_pk_mul_f32 v[92:93],v[92:93],v[88:89]
 v_cvt_pk_bf16_f32 v68,v90,v91
 v_cvt_pk_bf16_f32 v69,v92,v93
 v_accvgpr_read_b32 v90,a172
 v_accvgpr_read_b32 v91,a173
 v_accvgpr_read_b32 v92,a174
 v_accvgpr_read_b32 v93,a175
 v_pk_mul_f32 v[90:91],v[90:91],v[88:89]
 v_pk_mul_f32 v[92:93],v[92:93],v[88:89]
 v_cvt_pk_bf16_f32 v70,v90,v91
 v_cvt_pk_bf16_f32 v71,v92,v93
 ds_write_b128 v97,v[68:71] offset:17408
 v_accvgpr_read_b32 v90,a176
 v_accvgpr_read_b32 v91,a177
 v_accvgpr_read_b32 v92,a178
 v_accvgpr_read_b32 v93,a179
 v_pk_mul_f32 v[90:91],v[90:91],v[88:89]
 v_pk_mul_f32 v[92:93],v[92:93],v[88:89]
 v_cvt_pk_bf16_f32 v72,v90,v91
 v_cvt_pk_bf16_f32 v73,v92,v93
 v_accvgpr_read_b32 v90,a180
 v_accvgpr_read_b32 v91,a181
 v_accvgpr_read_b32 v92,a182
 v_accvgpr_read_b32 v93,a183
 v_pk_mul_f32 v[90:91],v[90:91],v[88:89]
 v_pk_mul_f32 v[92:93],v[92:93],v[88:89]
 v_cvt_pk_bf16_f32 v74,v90,v91
 v_cvt_pk_bf16_f32 v75,v92,v93
 ds_write_b128 v97,v[72:75] offset:18432
 v_accvgpr_read_b32 v90,a184
 v_accvgpr_read_b32 v91,a185
 v_accvgpr_read_b32 v92,a186
 v_accvgpr_read_b32 v93,a187
 v_pk_mul_f32 v[90:91],v[90:91],v[88:89]
 v_pk_mul_f32 v[92:93],v[92:93],v[88:89]
 v_cvt_pk_bf16_f32 v76,v90,v91
 v_cvt_pk_bf16_f32 v77,v92,v93
 v_accvgpr_read_b32 v90,a188
 v_accvgpr_read_b32 v91,a189
 v_accvgpr_read_b32 v92,a190
 v_accvgpr_read_b32 v93,a191
 v_pk_mul_f32 v[90:91],v[90:91],v[88:89]
 v_pk_mul_f32 v[92:93],v[92:93],v[88:89]
 v_cvt_pk_bf16_f32 v78,v90,v91
 v_cvt_pk_bf16_f32 v79,v92,v93
 ds_write_b128 v97,v[76:79] offset:19456
 v_mov_b32 v96,0x24000
 s_waitcnt lgkmcnt(0)
 s_barrier
 ds_read_b128 v[92:95],v96
 s_mul_i32 s3,s5,0x2080
 v_xor_b32 v84,s3,v113
 v_xor_b32 v85,32,v84
 v_xor_b32 v86,64,v84
 v_xor_b32 v87,96,v84
 v_subrev_u32 v80,0x18000,v84
 v_subrev_u32 v81,0x18000,v85
 v_subrev_u32 v82,0x18000,v86
 v_subrev_u32 v83,0x18000,v87
 v_readfirstlane_b32 s3,v136
 s_waitcnt lgkmcnt(0)
 v_or_b32 v92,v92,v93
 v_or3_b32 v92,v92,v94,v95
 s_cmp_lt_u32 s3,16
 v_readfirstlane_b32 s36,v92
 s_cbranch_scc1 L_cntspin
L_cntok:
 s_andn2_b32 s36,s36,s6
 s_cbranch_scc1 L_redo
 s_mov_b32 s6,0
 ds_read_b64_tr_b16 a[80:81],v84 offset:0
 ds_read_b64_tr_b16 a[82:83],v84 offset:4096
 ds_read_b64_tr_b16 a[84:85],v85 offset:0
 ds_read_b64_tr_b16 a[86:87],v85 offset:4096
 ds_read_b64_tr_b16 a[88:89],v84 offset:8192
 ds_read_b64_tr_b16 a[90:91],v84 offset:12288
 ds_read_b64_tr_b16 a[92:93],v85 offset:8192
 ds_read_b64_tr_b16 a[94:95],v85 offset:12288
 s_mul_i32 s3,s5,80
 s_mul_i32 s36,s61,5
 s_add_u32 s3,s3,s36
 s_lshl_b32 s3,s3,10
 v_add_u32 v88,s3,v135
 s_waitcnt lgkmcnt(0)
 v_mfma_f32_16x16x32_bf16 v[144:147],a[80:83],v[0:3],0
 ds_read_b128 a[144:147],v98 offset:0
 ds_read_b128 a[148:151],v98 offset:1024
 v_mfma_f32_16x16x32_bf16 v[152:155],a[80:83],v[16:19],0
 s_barrier
 v_mfma_f32_16x16x32_bf16 v[160:163],a[80:83],v[32:35],0
 ds_read_b64_tr_b16 a[96:97],v80 offset:0
 ds_read_b64_tr_b16 a[98:99],v80 offset:4096
 v_mfma_f32_16x16x32_bf16 v[168:171],a[80:83],v[48:51],0
 ds_read_b64_tr_b16 a[100:101],v81 offset:0
 ds_read_b64_tr_b16 a[102:103],v81 offset:4096
 v_mfma_f32_16x16x32_bf16 v[176:179],a[80:83],v[64:67],0
 ds_read_b64_tr_b16 a[104:105],v80 offset:8192
 ds_read_b64_tr_b16 a[106:107],v80 offset:12288
 v_mfma_f32_16x16x32_bf16 v[148:151],a[84:87],v[0:3],0
 ds_read_b64_tr_b16 a[108:109],v81 offset:8192
 ds_read_b64_tr_b16 a[110:111],v81 offset:12288
 v_mfma_f32_16x16x32_bf16 v[156:159],a[84:87],v[16:19],0
 s_lshl_b32 s59,s34,2
 s_add_u32 s59,s59,s45
 v_mfma_f32_16x16x32_bf16 v[164:167],a[84:87],v[32:35],0
 s_add_u32 m0,s34,0x24000
 s_add_u32 s59,s59,0x0
 v_mfma_f32_16x16x32_bf16 v[172:175],a[84:87],v[48:51],0
 buffer_load_dwordx4 v121,s[24:27],s59 offen offset:0  lds
 ds_read_b128 a[152:155],v98 offset:2048
 v_mfma_f32_16x16x32_bf16 v[180:183],a[84:87],v[64:67],0
 ds_read_b128 a[156:159],v98 offset:3072
 ds_read_b128 a[160:163],v98 offset:4096
 v_mfma_f32_16x16x32_bf16 v[144:147],a[88:91],v[4:7],v[144:147]
 ds_read_b128 a[164:167],v98 offset:5120
 ds_read_b128 a[168:171],v98 offset:6144
 v_mfma_f32_16x16x32_bf16 v[152:155],a[88:91],v[20:23],v[152:155]
 buffer_load_dwordx4 v122,s[24:27],s59 offen offset:1024  lds
 ds_read_b128 a[172:175],v98 offset:7168
 v_mfma_f32_16x16x32_bf16 v[160:163],a[88:91],v[36:39],v[160:163]
 ds_read_b128 a[176:179],v98 offset:8192
 ds_read_b128 a[180:183],v98 offset:9216
 v_mfma_f32_16x16x32_bf16 v[168:171],a[88:91],v[52:55],v[168:171]
 ds_read_b128 a[184:187],v98 offset:10240
 ds_read_b128 a[188:191],v98 offset:11264
 v_mfma_f32_16x16x32_bf16 v[176:179],a[88:91],v[68:71],v[176:179]
 buffer_load_dwordx4 v123,s[24:27],s59 offen offset:2048  lds
 ds_read_b128 a[192:195],v98 offset:12288
 v_mfma_f32_16x16x32_bf16 v[148:151],a[92:95],v[4:7],v[148:151]
 ds_read_b128 a[196:199],v98 offset:13312
 ds_read_b128 a[200:203],v98 offset:14336
 v_mfma_f32_16x16x32_bf16 v[156:159],a[92:95],v[20:23],v[156:159]
 ds_read_b128 a[204:207],v98 offset:15360
 ds_read_b128 a[208:211],v98 offset:16384
 v_mfma_f32_16x16x32_bf16 v[164:167],a[92:95],v[36:39],v[164:167]
 buffer_load_dwordx4 v124,s[24:27],s59 offen offset:3072  lds
 ds_read_b128 a[212:215],v98 offset:17408
 v_mfma_f32_16x16x32_bf16 v[172:175],a[92:95],v[52:55],v[172:175]
 ds_read_b128 a[216:219],v98 offset:18432
 ds_read_b128 a[220:223],v98 offset:19456
 v_mfma_f32_16x16x32_bf16 v[180:183],a[92:95],v[68:71],v[180:183]
 ds_read_b128 a[0:3],v97 offset:0
 ds_read_b128 a[4:7],v97 offset:1024
 s_waitcnt lgkmcnt(15)
 v_mfma_f32_16x16x32_bf16 v[144:147],a[96:99],v[8:11],v[144:147]
 ds_read_b128 a[8:11],v97 offset:2048
 ds_read_b128 a[12:15],v97 offset:3072
 v_mfma_f32_16x16x32_bf16 v[152:155],a[96:99],v[24:27],v[152:155]
 s_waitcnt vmcnt(8)
 s_barrier
 v_mfma_f32_16x16x32_bf16 v[160:163],a[96:99],v[40:43],v[160:163]
 ds_read_b64_tr_b16 a[80:81],v84 offset:16384
 ds_read_b64_tr_b16 a[82:83],v84 offset:20480
 v_mfma_f32_16x16x32_bf16 v[168:171],a[96:99],v[56:59],v[168:171]
 ds_read_b64_tr_b16 a[84:85],v85 offset:16384
 ds_read_b64_tr_b16 a[86:87],v85 offset:20480
 v_mfma_f32_16x16x32_bf16 v[176:179],a[96:99],v[72:75],v[176:179]
 ds_read_b64_tr_b16 a[88:89],v84 offset:24576
 ds_read_b64_tr_b16 a[90:91],v84 offset:28672
 v_mfma_f32_16x16x32_bf16 v[148:151],a[100:103],v[8:11],v[148:151]
 ds_read_b64_tr_b16 a[92:93],v85 offset:24576
 ds_read_b64_tr_b16 a[94:95],v85 offset:28672
 v_mfma_f32_16x16x32_bf16 v[156:159],a[100:103],v[24:27],v[156:159]
 ds_read_b128 a[16:19],v97 offset:4096
 ds_read_b128 a[20:23],v97 offset:5120
 v_mfma_f32_16x16x32_bf16 v[164:167],a[100:103],v[40:43],v[164:167]
 ds_read_b128 a[24:27],v97 offset:6144
 ds_read_b128 a[28:31],v97 offset:7168
 v_mfma_f32_16x16x32_bf16 v[172:175],a[100:103],v[56:59],v[172:175]
 ds_read_b128 a[32:35],v97 offset:8192
 ds_read_b128 a[36:39],v97 offset:9216
 v_mfma_f32_16x16x32_bf16 v[180:183],a[100:103],v[72:75],v[180:183]
 ds_read_b128 a[40:43],v97 offset:10240
 ds_read_b128 a[44:47],v97 offset:11264
 v_mfma_f32_16x16x32_bf16 v[144:147],a[104:107],v[12:15],v[144:147]
 ds_read_b128 a[48:51],v97 offset:12288
 ds_read_b128 a[52:55],v97 offset:13312
 v_mfma_f32_16x16x32_bf16 v[152:155],a[104:107],v[28:31],v[152:155]
 ds_read_b128 a[56:59],v97 offset:14336
 ds_read_b128 a[60:63],v97 offset:15360
 v_mfma_f32_16x16x32_bf16 v[160:163],a[104:107],v[44:47],v[160:163]
 ds_read_b128 a[64:67],v97 offset:16384
 ds_read_b128 a[68:71],v97 offset:17408
 v_mfma_f32_16x16x32_bf16 v[168:171],a[104:107],v[60:63],v[168:171]
 ds_read_b128 a[72:75],v97 offset:18432
 ds_read_b128 a[76:79],v97 offset:19456
 v_mfma_f32_16x16x32_bf16 v[176:179],a[104:107],v[76:79],v[176:179]
 v_mfma_f32_16x16x32_bf16 v[148:151],a[108:111],v[12:15],v[148:151]
 v_mfma_f32_16x16x32_bf16 v[156:159],a[108:111],v[28:31],v[156:159]
 v_mfma_f32_16x16x32_bf16 v[164:167],a[108:111],v[44:47],v[164:167]
 v_mfma_f32_16x16x32_bf16 v[172:175],a[108:111],v[60:63],v[172:175]
 v_mfma_f32_16x16x32_bf16 v[180:183],a[108:111],v[76:79],v[180:183]
 s_waitcnt lgkmcnt(0)
 v_mfma_f32_16x16x32_bf16 v[144:147],a[80:83],a[144:147],v[144:147]
 v_mfma_f32_16x16x32_bf16 v[152:155],a[80:83],a[160:163],v[152:155]
 s_waitcnt vmcnt(4)
 s_barrier
 v_mfma_f32_16x16x32_bf16 v[160:163],a[80:83],a[176:179],v[160:163]
 ds_read_b64_tr_b16 a[96:97],v84 offset:32768
 ds_read_b64_tr_b16 a[98:99],v84 offset:36864
 v_mfma_f32_16x16x32_bf16 v[168:171],a[80:83],a[192:195],v[168:171]
 ds_read_b64_tr_b16 a[100:101],v85 offset:32768
 ds_read_b64_tr_b16 a[102:103],v85 offset:36864
 v_mfma_f32_16x16x32_bf16 v[176:179],a[80:83],a[208:211],v[176:179]
 ds_read_b64_tr_b16 a[104:105],v84 offset:40960
 ds_read_b64_tr_b16 a[106:107],v84 offset:45056
 v_mfma_f32_16x16x32_bf16 v[148:151],a[84:87],a[144:147],v[148:151]
 ds_read_b64_tr_b16 a[108:109],v85 offset:40960
 ds_read_b64_tr_b16 a[110:111],v85 offset:45056
 v_mfma_f32_16x16x32_bf16 v[156:159],a[84:87],a[160:163],v[156:159]
 s_lshl_b32 s59,s34,2
 s_add_u32 s59,s59,s45
 v_mfma_f32_16x16x32_bf16 v[164:167],a[84:87],a[176:179],v[164:167]
 s_add_u32 m0,s34,0x4000
 s_add_u32 s59,s59,0x10000
 v_mfma_f32_16x16x32_bf16 v[172:175],a[84:87],a[192:195],v[172:175]
 buffer_load_dwordx4 v121,s[24:27],s59 offen offset:0  lds
 v_mfma_f32_16x16x32_bf16 v[180:183],a[84:87],a[208:211],v[180:183]
 v_mfma_f32_16x16x32_bf16 v[144:147],a[88:91],a[148:151],v[144:147]
 v_mfma_f32_16x16x32_bf16 v[152:155],a[88:91],a[164:167],v[152:155]
 buffer_load_dwordx4 v122,s[24:27],s59 offen offset:1024  lds
 v_mfma_f32_16x16x32_bf16 v[160:163],a[88:91],a[180:183],v[160:163]
 v_mfma_f32_16x16x32_bf16 v[168:171],a[88:91],a[196:199],v[168:171]
 v_mfma_f32_16x16x32_bf16 v[176:179],a[88:91],a[212:215],v[176:179]
 buffer_load_dwordx4 v123,s[24:27],s59 offen offset:2048  lds
 v_mfma_f32_16x16x32_bf16 v[148:151],a[92:95],a[148:151],v[148:151]
 v_mfma_f32_16x16x32_bf16 v[156:159],a[92:95],a[164:167],v[156:159]
 v_mfma_f32_16x16x32_bf16 v[164:167],a[92:95],a[180:183],v[164:167]
 buffer_load_dwordx4 v124,s[24:27],s59 offen offset:3072  lds
 s_lshl_b32 s59,s34,2
 v_mfma_f32_16x16x32_bf16 v[172:175],a[92:95],a[196:199],v[172:175]
 s_add_u32 s59,s59,s45
 s_add_u32 m0,s34,0x8000
 v_mfma_f32_16x16x32_bf16 v[180:183],a[92:95],a[212:215],v[180:183]
 s_add_u32 s59,s59,0x0
 s_waitcnt lgkmcnt(0)
 v_mfma_f32_16x16x32_bf16 v[144:147],a[96:99],a[152:155],v[144:147]
 buffer_load_dwordx4 v125,s[24:27],s59 offen offset:0  lds
 v_mfma_f32_16x16x32_bf16 v[152:155],a[96:99],a[168:171],v[152:155]
 v_mfma_f32_16x16x32_bf16 v[160:163],a[96:99],a[184:187],v[160:163]
 ds_read_b64_tr_b16 a[80:81],v86 offset:0
 ds_read_b64_tr_b16 a[82:83],v86 offset:4096
 v_mfma_f32_16x16x32_bf16 v[168:171],a[96:99],a[200:203],v[168:171]
 ds_read_b64_tr_b16 a[84:85],v87 offset:0
 ds_read_b64_tr_b16 a[86:87],v87 offset:4096
 v_mfma_f32_16x16x32_bf16 v[176:179],a[96:99],a[216:219],v[176:179]
 ds_read_b64_tr_b16 a[88:89],v86 offset:8192
 ds_read_b64_tr_b16 a[90:91],v86 offset:12288
 v_mfma_f32_16x16x32_bf16 v[148:151],a[100:103],a[152:155],v[148:151]
 ds_read_b64_tr_b16 a[92:93],v87 offset:8192
 ds_read_b64_tr_b16 a[94:95],v87 offset:12288
 v_mfma_f32_16x16x32_bf16 v[156:159],a[100:103],a[168:171],v[156:159]
 buffer_load_dwordx4 v126,s[24:27],s59 offen offset:1024  lds
 v_mfma_f32_16x16x32_bf16 v[164:167],a[100:103],a[184:187],v[164:167]
 v_mfma_f32_16x16x32_bf16 v[172:175],a[100:103],a[200:203],v[172:175]
 v_mfma_f32_16x16x32_bf16 v[180:183],a[100:103],a[216:219],v[180:183]
 buffer_load_dwordx4 v127,s[24:27],s59 offen offset:2048  lds
 v_mfma_f32_16x16x32_bf16 v[144:147],a[104:107],a[156:159],v[144:147]
 v_mfma_f32_16x16x32_bf16 v[152:155],a[104:107],a[172:175],v[152:155]
 v_mfma_f32_16x16x32_bf16 v[160:163],a[104:107],a[188:191],v[160:163]
 buffer_load_dwordx4 v128,s[24:27],s59 offen offset:3072  lds
 s_lshl_b32 s59,s34,2
 v_mfma_f32_16x16x32_bf16 v[168:171],a[104:107],a[204:207],v[168:171]
 s_add_u32 s59,s59,s45
 s_add_u32 m0,s34,0xc000
 v_mfma_f32_16x16x32_bf16 v[176:179],a[104:107],a[220:223],v[176:179]
 s_add_u32 s59,s59,0x10000
 v_mfma_f32_16x16x32_bf16 v[148:151],a[108:111],a[156:159],v[148:151]
 buffer_load_dwordx4 v125,s[24:27],s59 offen offset:0  lds
 v_mfma_f32_16x16x32_bf16 v[156:159],a[108:111],a[172:175],v[156:159]
 v_mfma_f32_16x16x32_bf16 v[164:167],a[108:111],a[188:191],v[164:167]
 v_mfma_f32_16x16x32_bf16 v[172:175],a[108:111],a[204:207],v[172:175]
 buffer_load_dwordx4 v126,s[24:27],s59 offen offset:1024  lds
 v_mfma_f32_16x16x32_bf16 v[180:183],a[108:111],a[220:223],v[180:183]
 s_waitcnt lgkmcnt(0)
 v_mfma_f32_16x16x32_bf16 v[184:187],a[80:83],v[0:3],0
 v_mfma_f32_16x16x32_bf16 v[192:195],a[80:83],v[16:19],0
 buffer_load_dwordx4 v127,s[24:27],s59 offen offset:2048  lds
 v_mfma_f32_16x16x32_bf16 v[200:203],a[80:83],v[32:35],0
 ds_read_b64_tr_b16 a[96:97],v82 offset:0
 ds_read_b64_tr_b16 a[98:99],v82 offset:4096
 v_mfma_f32_16x16x32_bf16 v[208:211],a[80:83],v[48:51],0
 ds_read_b64_tr_b16 a[100:101],v83 offset:0
 ds_read_b64_tr_b16 a[102:103],v83 offset:4096
 v_mfma_f32_16x16x32_bf16 v[216:219],a[80:83],v[64:67],0
 ds_read_b64_tr_b16 a[104:105],v82 offset:8192
 ds_read_b64_tr_b16 a[106:107],v82 offset:12288
 v_mfma_f32_16x16x32_bf16 v[188:191],a[84:87],v[0:3],0
 ds_read_b64_tr_b16 a[108:109],v83 offset:8192
 ds_read_b64_tr_b16 a[110:111],v83 offset:12288
 v_mfma_f32_16x16x32_bf16 v[196:199],a[84:87],v[16:19],0
 buffer_load_dwordx4 v128,s[24:27],s59 offen offset:3072  lds
 v_mfma_f32_16x16x32_bf16 v[204:207],a[84:87],v[32:35],0
 v_mfma_f32_16x16x32_bf16 v[212:215],a[84:87],v[48:51],0
 v_cvt_pk_bf16_f32 v144,v144,v145
 v_cvt_pk_bf16_f32 v145,v146,v147
 v_mfma_f32_16x16x32_bf16 v[220:223],a[84:87],v[64:67],0
 v_cvt_pk_bf16_f32 v146,v148,v149
 v_cvt_pk_bf16_f32 v147,v150,v151
 v_mfma_f32_16x16x32_bf16 v[184:187],a[88:91],v[4:7],v[184:187]
 s_add_u32 s58,s48,0x0
 buffer_store_dwordx4 v[144:147],v88,s[28:31],s58 offen sc1
 v_mfma_f32_16x16x32_bf16 v[192:195],a[88:91],v[20:23],v[192:195]
 v_cvt_pk_bf16_f32 v152,v152,v153
 v_cvt_pk_bf16_f32 v153,v154,v155
 v_mfma_f32_16x16x32_bf16 v[200:203],a[88:91],v[36:39],v[200:203]
 v_cvt_pk_bf16_f32 v154,v156,v157
 v_cvt_pk_bf16_f32 v155,v158,v159
 v_mfma_f32_16x16x32_bf16 v[208:211],a[88:91],v[52:55],v[208:211]
 s_add_u32 s58,s48,0x400
 buffer_store_dwordx4 v[152:155],v88,s[28:31],s58 offen sc1
 v_mfma_f32_16x16x32_bf16 v[216:219],a[88:91],v[68:71],v[216:219]
 v_cvt_pk_bf16_f32 v160,v160,v161
 v_cvt_pk_bf16_f32 v161,v162,v163
 v_mfma_f32_16x16x32_bf16 v[188:191],a[92:95],v[4:7],v[188:191]
 v_cvt_pk_bf16_f32 v162,v164,v165
 v_cvt_pk_bf16_f32 v163,v166,v167
 v_mfma_f32_16x16x32_bf16 v[196:199],a[92:95],v[20:23],v[196:199]
 s_add_u32 s58,s48,0x800
 buffer_store_dwordx4 v[160:163],v88,s[28:31],s58 offen sc1
 v_mfma_f32_16x16x32_bf16 v[204:207],a[92:95],v[36:39],v[204:207]
 v_cvt_pk_bf16_f32 v168,v168,v169
 v_cvt_pk_bf16_f32 v169,v170,v171
 v_mfma_f32_16x16x32_bf16 v[212:215],a[92:95],v[52:55],v[212:215]
 v_cvt_pk_bf16_f32 v170,v172,v173
 v_cvt_pk_bf16_f32 v171,v174,v175
 v_mfma_f32_16x16x32_bf16 v[220:223],a[92:95],v[68:71],v[220:223]
 s_add_u32 s58,s48,0xc00
 buffer_store_dwordx4 v[168:171],v88,s[28:31],s58 offen sc1
 s_waitcnt lgkmcnt(0)
 v_mfma_f32_16x16x32_bf16 v[184:187],a[96:99],v[8:11],v[184:187]
 v_cvt_pk_bf16_f32 v176,v176,v177
 v_cvt_pk_bf16_f32 v177,v178,v179
 v_mfma_f32_16x16x32_bf16 v[192:195],a[96:99],v[24:27],v[192:195]
 v_cvt_pk_bf16_f32 v178,v180,v181
 v_cvt_pk_bf16_f32 v179,v182,v183
 v_mfma_f32_16x16x32_bf16 v[200:203],a[96:99],v[40:43],v[200:203]
 ds_read_b64_tr_b16 a[80:81],v86 offset:16384
 ds_read_b64_tr_b16 a[82:83],v86 offset:20480
 v_mfma_f32_16x16x32_bf16 v[208:211],a[96:99],v[56:59],v[208:211]
 ds_read_b64_tr_b16 a[84:85],v87 offset:16384
 ds_read_b64_tr_b16 a[86:87],v87 offset:20480
 v_mfma_f32_16x16x32_bf16 v[216:219],a[96:99],v[72:75],v[216:219]
 ds_read_b64_tr_b16 a[88:89],v86 offset:24576
 ds_read_b64_tr_b16 a[90:91],v86 offset:28672
 v_mfma_f32_16x16x32_bf16 v[188:191],a[100:103],v[8:11],v[188:191]
 ds_read_b64_tr_b16 a[92:93],v87 offset:24576
 ds_read_b64_tr_b16 a[94:95],v87 offset:28672
 v_mfma_f32_16x16x32_bf16 v[196:199],a[100:103],v[24:27],v[196:199]
 s_add_u32 s58,s48,0x1000
 buffer_store_dwordx4 v[176:179],v88,s[28:31],s58 offen sc1
 v_mfma_f32_16x16x32_bf16 v[204:207],a[100:103],v[40:43],v[204:207]
 s_lshl_b32 s3,s84,4
 s_and_b32 s62,s38,12
 v_mfma_f32_16x16x32_bf16 v[212:215],a[100:103],v[56:59],v[212:215]
 s_add_u32 s3,s3,s62
 s_lshl_b32 s3,s3,8
 v_mfma_f32_16x16x32_bf16 v[220:223],a[100:103],v[72:75],v[220:223]
 v_lshrrev_b32 v248,2,v135
 v_add_u32 v226,s3,v248
 v_mfma_f32_16x16x32_bf16 v[184:187],a[104:107],v[12:15],v[184:187]
 v_lshrrev_b32 v248,4,v135
 v_and_b32 v250,7,v248
 v_mfma_f32_16x16x32_bf16 v[192:195],a[104:107],v[28:31],v[192:195]
 v_lshrrev_b32 v249,5,v248
 v_bfe_u32 v109,v248,3,2
 v_mfma_f32_16x16x32_bf16 v[200:203],a[104:107],v[44:47],v[200:203]
 v_mul_u32_u24 v253,172032,v249
 v_lshl_add_u32 v108,v250,4,v253
 v_mfma_f32_16x16x32_bf16 v[208:211],a[104:107],v[60:63],v[208:211]
 v_lshlrev_b32 v249,5,v249
 v_lshl_add_u32 v252,v250,11,v249
 v_mfma_f32_16x16x32_bf16 v[216:219],a[104:107],v[76:79],v[216:219]
 v_lshl_add_u32 v110,v109,14,v252
 v_cmp_eq_u32 vcc,0,v109
 v_mfma_f32_16x16x32_bf16 v[188:191],a[108:111],v[12:15],v[188:191]
 v_lshrrev_b32 v251,3,v248
 v_mov_b32 v255,0x40000000
 v_mfma_f32_16x16x32_bf16 v[196:199],a[108:111],v[28:31],v[196:199]
 v_cndmask_b32 v112,v255,v252,vcc
 v_mul_u32_u24 v253,172032,v251
 v_mfma_f32_16x16x32_bf16 v[204:207],a[108:111],v[44:47],v[204:207]
 v_lshl_add_u32 v111,v250,4,v253
 v_lshl_add_u32 v111,v109,8,v108
 v_mfma_f32_16x16x32_bf16 v[212:215],a[108:111],v[60:63],v[212:215]
 v_lshl_add_u32 v112,v109,3,v252
 s_mul_i32 s3,s39,327680
 v_mfma_f32_16x16x32_bf16 v[220:223],a[108:111],v[76:79],v[220:223]
 s_lshl_b32 s62,s37,10
 s_add_u32 s12,s3,s62
 s_waitcnt lgkmcnt(0)
 v_mfma_f32_16x16x32_bf16 v[184:187],a[80:83],a[144:147],v[184:187]
 s_lshl_b32 s3,s84,8
 s_add_u32 s3,s3,0x10000
 v_mfma_f32_16x16x32_bf16 v[192:195],a[80:83],a[160:163],v[192:195]
 v_min_u32 v251,1,v248
 v_lshlrev_b32 v251,30,v251
 v_mfma_f32_16x16x32_bf16 v[200:203],a[80:83],a[176:179],v[200:203]
 ds_read_b64_tr_b16 a[96:97],v86 offset:32768
 ds_read_b64_tr_b16 a[98:99],v86 offset:36864
 v_mfma_f32_16x16x32_bf16 v[208:211],a[80:83],a[192:195],v[208:211]
 ds_read_b64_tr_b16 a[100:101],v87 offset:32768
 ds_read_b64_tr_b16 a[102:103],v87 offset:36864
 v_mfma_f32_16x16x32_bf16 v[216:219],a[80:83],a[208:211],v[216:219]
 ds_read_b64_tr_b16 a[104:105],v86 offset:40960
 ds_read_b64_tr_b16 a[106:107],v86 offset:45056
 v_mfma_f32_16x16x32_bf16 v[188:191],a[84:87],a[144:147],v[188:191]
 ds_read_b64_tr_b16 a[108:109],v87 offset:40960
 ds_read_b64_tr_b16 a[110:111],v87 offset:45056
 v_mfma_f32_16x16x32_bf16 v[196:199],a[84:87],a[160:163],v[196:199]
 v_add_u32 v113,s3,v251
 v_mov_b32 v228,0x3f80
 v_mfma_f32_16x16x32_bf16 v[204:207],a[84:87],a[176:179],v[204:207]
 v_mov_b32 v229,0x3f800000
 v_mfma_f32_16x16x32_bf16 v[212:215],a[84:87],a[192:195],v[212:215]
 v_mfma_f32_16x16x32_bf16 v[220:223],a[84:87],a[208:211],v[220:223]
 v_mfma_f32_16x16x32_bf16 v[184:187],a[88:91],a[148:151],v[184:187]
 v_mfma_f32_16x16x32_bf16 v[192:195],a[88:91],a[164:167],v[192:195]
 v_mfma_f32_16x16x32_bf16 v[200:203],a[88:91],a[180:183],v[200:203]
 v_mfma_f32_16x16x32_bf16 v[208:211],a[88:91],a[196:199],v[208:211]
 v_mfma_f32_16x16x32_bf16 v[216:219],a[88:91],a[212:215],v[216:219]
 v_mfma_f32_16x16x32_bf16 v[188:191],a[92:95],a[148:151],v[188:191]
 v_mfma_f32_16x16x32_bf16 v[196:199],a[92:95],a[164:167],v[196:199]
 v_mfma_f32_16x16x32_bf16 v[204:207],a[92:95],a[180:183],v[204:207]
 v_mfma_f32_16x16x32_bf16 v[212:215],a[92:95],a[196:199],v[212:215]
 v_mfma_f32_16x16x32_bf16 v[220:223],a[92:95],a[212:215],v[220:223]
 s_waitcnt lgkmcnt(0)
 v_mfma_f32_16x16x32_bf16 v[184:187],a[96:99],a[152:155],v[184:187]
 v_mfma_f32_16x16x32_bf16 v[192:195],a[96:99],a[168:171],v[192:195]
 s_waitcnt vmcnt(17)
 s_barrier
 v_mfma_f32_16x16x32_bf16 v[200:203],a[96:99],a[184:187],v[200:203]
 ds_read_b64_tr_b16 a[80:81],v84 offset:49152
 ds_read_b64_tr_b16 a[82:83],v84 offset:53248
 v_mfma_f32_16x16x32_bf16 v[208:211],a[96:99],a[200:203],v[208:211]
 ds_read_b64_tr_b16 a[84:85],v85 offset:49152
 ds_read_b64_tr_b16 a[86:87],v85 offset:53248
 v_mfma_f32_16x16x32_bf16 v[216:219],a[96:99],a[216:219],v[216:219]
 ds_read_b64_tr_b16 a[88:89],v84 offset:57344
 ds_read_b64_tr_b16 a[90:91],v84 offset:61440
 v_mfma_f32_16x16x32_bf16 v[188:191],a[100:103],a[152:155],v[188:191]
 ds_read_b64_tr_b16 a[92:93],v85 offset:57344
 ds_read_b64_tr_b16 a[94:95],v85 offset:61440
 v_mfma_f32_16x16x32_bf16 v[196:199],a[100:103],a[168:171],v[196:199]
 s_lshl_b32 s59,s34,2
 s_add_u32 s59,s59,s46
 v_mfma_f32_16x16x32_bf16 v[204:207],a[100:103],a[184:187],v[204:207]
 s_add_u32 m0,s34,0x18000
 s_add_u32 s59,s59,0x0
 v_mfma_f32_16x16x32_bf16 v[212:215],a[100:103],a[200:203],v[212:215]
 buffer_load_dwordx4 v121,s[24:27],s59 offen offset:0  lds
 v_mfma_f32_16x16x32_bf16 v[220:223],a[100:103],a[216:219],v[220:223]
 v_mfma_f32_16x16x32_bf16 v[184:187],a[104:107],a[156:159],v[184:187]
 v_mfma_f32_16x16x32_bf16 v[192:195],a[104:107],a[172:175],v[192:195]
 buffer_load_dwordx4 v122,s[24:27],s59 offen offset:1024  lds
 v_mfma_f32_16x16x32_bf16 v[200:203],a[104:107],a[188:191],v[200:203]
 v_mfma_f32_16x16x32_bf16 v[208:211],a[104:107],a[204:207],v[208:211]
 v_mfma_f32_16x16x32_bf16 v[216:219],a[104:107],a[220:223],v[216:219]
 buffer_load_dwordx4 v123,s[24:27],s59 offen offset:2048  lds
 v_mfma_f32_16x16x32_bf16 v[188:191],a[108:111],a[156:159],v[188:191]
 v_mfma_f32_16x16x32_bf16 v[196:199],a[108:111],a[172:175],v[196:199]
 v_mfma_f32_16x16x32_bf16 v[204:207],a[108:111],a[188:191],v[204:207]
 buffer_load_dwordx4 v124,s[24:27],s59 offen offset:3072  lds
 s_lshl_b32 s59,s34,2
 v_mfma_f32_16x16x32_bf16 v[212:215],a[108:111],a[204:207],v[212:215]
 s_add_u32 s59,s59,s46
 s_add_u32 m0,s34,0x0
 v_mfma_f32_16x16x32_bf16 v[220:223],a[108:111],a[220:223],v[220:223]
 s_add_u32 s59,s59,0x10000
 s_waitcnt lgkmcnt(0)
 v_mfma_f32_16x16x32_bf16 v[0:3],a[80:83],a[0:3],0
 buffer_load_dwordx4 v121,s[24:27],s59 offen offset:0  lds
 v_mfma_f32_16x16x32_bf16 v[8:11],a[80:83],a[16:19],0
 s_waitcnt vmcnt(18)
 s_barrier
 v_mfma_f32_16x16x32_bf16 v[16:19],a[80:83],a[32:35],0
 ds_read_b64_tr_b16 a[96:97],v80 offset:16384
 ds_read_b64_tr_b16 a[98:99],v80 offset:20480
 v_mfma_f32_16x16x32_bf16 v[24:27],a[80:83],a[48:51],0
 ds_read_b64_tr_b16 a[100:101],v81 offset:16384
 ds_read_b64_tr_b16 a[102:103],v81 offset:20480
 v_mfma_f32_16x16x32_bf16 v[32:35],a[80:83],a[64:67],0
 ds_read_b64_tr_b16 a[104:105],v80 offset:24576
 ds_read_b64_tr_b16 a[106:107],v80 offset:28672
 v_mfma_f32_16x16x32_bf16 v[4:7],a[84:87],a[0:3],0
 ds_read_b64_tr_b16 a[108:109],v81 offset:24576
 ds_read_b64_tr_b16 a[110:111],v81 offset:28672
 v_mfma_f32_16x16x32_bf16 v[12:15],a[84:87],a[16:19],0
 buffer_load_dwordx4 v122,s[24:27],s59 offen offset:1024  lds
 v_mfma_f32_16x16x32_bf16 v[20:23],a[84:87],a[32:35],0
 v_mfma_f32_16x16x32_bf16 v[28:31],a[84:87],a[48:51],0
 v_mfma_f32_16x16x32_bf16 v[36:39],a[84:87],a[64:67],0
 buffer_load_dwordx4 v123,s[24:27],s59 offen offset:2048  lds
 v_cvt_pk_bf16_f32 v184,v184,v185
 v_mfma_f32_16x16x32_bf16 v[0:3],a[88:91],a[4:7],v[0:3]
 v_cvt_pk_bf16_f32 v185,v186,v187
 v_cvt_pk_bf16_f32 v186,v188,v189
 v_mfma_f32_16x16x32_bf16 v[8:11],a[88:91],a[20:23],v[8:11]
 v_cvt_pk_bf16_f32 v187,v190,v191
 s_add_u32 s58,s48,0x2800
 v_mfma_f32_16x16x32_bf16 v[16:19],a[88:91],a[36:39],v[16:19]
 buffer_load_dwordx4 v124,s[24:27],s59 offen offset:3072  lds
 s_lshl_b32 s59,s34,2
 v_mfma_f32_16x16x32_bf16 v[24:27],a[88:91],a[52:55],v[24:27]
 s_add_u32 s59,s59,s46
 s_add_u32 m0,s34,0x1c000
 v_mfma_f32_16x16x32_bf16 v[32:35],a[88:91],a[68:71],v[32:35]
 s_add_u32 s59,s59,0x0
 buffer_store_dwordx4 v[184:187],v88,s[28:31],s58 offen sc1
 v_mfma_f32_16x16x32_bf16 v[4:7],a[92:95],a[4:7],v[4:7]
 buffer_load_dwordx4 v125,s[24:27],s59 offen offset:0  lds
 v_cvt_pk_bf16_f32 v192,v192,v193
 v_mfma_f32_16x16x32_bf16 v[12:15],a[92:95],a[20:23],v[12:15]
 v_cvt_pk_bf16_f32 v193,v194,v195
 v_cvt_pk_bf16_f32 v194,v196,v197
 v_mfma_f32_16x16x32_bf16 v[20:23],a[92:95],a[36:39],v[20:23]
 v_cvt_pk_bf16_f32 v195,v198,v199
 s_add_u32 s58,s48,0x2c00
 v_mfma_f32_16x16x32_bf16 v[28:31],a[92:95],a[52:55],v[28:31]
 buffer_load_dwordx4 v126,s[24:27],s59 offen offset:1024  lds
 buffer_store_dwordx4 v[192:195],v88,s[28:31],s58 offen sc1
 v_mfma_f32_16x16x32_bf16 v[36:39],a[92:95],a[68:71],v[36:39]
 v_cvt_pk_bf16_f32 v200,v200,v201
 v_cvt_pk_bf16_f32 v201,v202,v203
 s_waitcnt lgkmcnt(0)
 v_mfma_f32_16x16x32_bf16 v[0:3],a[96:99],a[8:11],v[0:3]
 v_cvt_pk_bf16_f32 v202,v204,v205
 v_cvt_pk_bf16_f32 v203,v206,v207
 v_mfma_f32_16x16x32_bf16 v[8:11],a[96:99],a[24:27],v[8:11]
 s_waitcnt vmcnt(21)
 s_barrier
 v_mfma_f32_16x16x32_bf16 v[16:19],a[96:99],a[40:43],v[16:19]
 ds_read_b64_tr_b16 a[80:81],v80 offset:32768
 ds_read_b64_tr_b16 a[82:83],v80 offset:36864
 v_mfma_f32_16x16x32_bf16 v[24:27],a[96:99],a[56:59],v[24:27]
 ds_read_b64_tr_b16 a[84:85],v81 offset:32768
 ds_read_b64_tr_b16 a[86:87],v81 offset:36864
 v_mfma_f32_16x16x32_bf16 v[32:35],a[96:99],a[72:75],v[32:35]
 ds_read_b64_tr_b16 a[88:89],v80 offset:40960
 ds_read_b64_tr_b16 a[90:91],v80 offset:45056
 v_mfma_f32_16x16x32_bf16 v[4:7],a[100:103],a[8:11],v[4:7]
 ds_read_b64_tr_b16 a[92:93],v81 offset:40960
 ds_read_b64_tr_b16 a[94:95],v81 offset:45056
 v_mfma_f32_16x16x32_bf16 v[12:15],a[100:103],a[24:27],v[12:15]
 buffer_load_dwordx4 v127,s[24:27],s59 offen offset:2048  lds
 s_add_u32 s58,s48,0x3000
 v_mfma_f32_16x16x32_bf16 v[20:23],a[100:103],a[40:43],v[20:23]
 buffer_store_dwordx4 v[200:203],v88,s[28:31],s58 offen sc1
 v_cvt_pk_bf16_f32 v208,v208,v209
 v_mfma_f32_16x16x32_bf16 v[28:31],a[100:103],a[56:59],v[28:31]
 v_cvt_pk_bf16_f32 v209,v210,v211
 v_cvt_pk_bf16_f32 v210,v212,v213
 v_mfma_f32_16x16x32_bf16 v[36:39],a[100:103],a[72:75],v[36:39]
 buffer_load_dwordx4 v128,s[24:27],s59 offen offset:3072  lds
 s_lshl_b32 s59,s34,2
 v_mfma_f32_16x16x32_bf16 v[0:3],a[104:107],a[12:15],v[0:3]
 s_add_u32 s59,s59,s46
 s_add_u32 m0,s34,0x20000
 v_mfma_f32_16x16x32_bf16 v[8:11],a[104:107],a[28:31],v[8:11]
 s_add_u32 s59,s59,0x10000
 v_cvt_pk_bf16_f32 v211,v214,v215
 v_mfma_f32_16x16x32_bf16 v[16:19],a[104:107],a[44:47],v[16:19]
 buffer_load_dwordx4 v125,s[24:27],s59 offen offset:0  lds
 s_add_u32 s58,s48,0x3400
 v_mfma_f32_16x16x32_bf16 v[24:27],a[104:107],a[60:63],v[24:27]
 buffer_store_dwordx4 v[208:211],v88,s[28:31],s58 offen sc1
 v_cvt_pk_bf16_f32 v216,v216,v217
 v_mfma_f32_16x16x32_bf16 v[32:35],a[104:107],a[76:79],v[32:35]
 v_cvt_pk_bf16_f32 v217,v218,v219
 v_cvt_pk_bf16_f32 v218,v220,v221
 v_mfma_f32_16x16x32_bf16 v[4:7],a[108:111],a[12:15],v[4:7]
 buffer_load_dwordx4 v126,s[24:27],s59 offen offset:1024  lds
 v_cvt_pk_bf16_f32 v219,v222,v223
 v_mfma_f32_16x16x32_bf16 v[12:15],a[108:111],a[28:31],v[12:15]
 s_add_u32 s58,s48,0x3800
 buffer_store_dwordx4 v[216:219],v88,s[28:31],s58 offen sc1
 v_mfma_f32_16x16x32_bf16 v[20:23],a[108:111],a[44:47],v[20:23]
 v_mfma_f32_16x16x32_bf16 v[28:31],a[108:111],a[60:63],v[28:31]
 buffer_load_dwordx4 v127,s[24:27],s59 offen offset:2048  lds
 v_mfma_f32_16x16x32_bf16 v[36:39],a[108:111],a[76:79],v[36:39]
 s_waitcnt lgkmcnt(0)
 v_mfma_f32_16x16x32_bf16 v[0:3],a[80:83],a[144:147],v[0:3]
 v_mfma_f32_16x16x32_bf16 v[8:11],a[80:83],a[160:163],v[8:11]
 s_waitcnt vmcnt(25)
 s_barrier
 v_mfma_f32_16x16x32_bf16 v[16:19],a[80:83],a[176:179],v[16:19]
 ds_read_b64_tr_b16 a[96:97],v80 offset:49152
 ds_read_b64_tr_b16 a[98:99],v80 offset:53248
 v_mfma_f32_16x16x32_bf16 v[24:27],a[80:83],a[192:195],v[24:27]
 ds_read_b64_tr_b16 a[100:101],v81 offset:49152
 ds_read_b64_tr_b16 a[102:103],v81 offset:53248
 v_mfma_f32_16x16x32_bf16 v[32:35],a[80:83],a[208:211],v[32:35]
 ds_read_b64_tr_b16 a[104:105],v80 offset:57344
 ds_read_b64_tr_b16 a[106:107],v80 offset:61440
 v_mfma_f32_16x16x32_bf16 v[4:7],a[84:87],a[144:147],v[4:7]
 ds_read_b64_tr_b16 a[108:109],v81 offset:57344
 ds_read_b64_tr_b16 a[110:111],v81 offset:61440
 v_mfma_f32_16x16x32_bf16 v[12:15],a[84:87],a[160:163],v[12:15]
 buffer_load_dwordx4 v128,s[24:27],s59 offen offset:3072  lds
 v_mfma_f32_16x16x32_bf16 v[20:23],a[84:87],a[176:179],v[20:23]
 v_mfma_f32_16x16x32_bf16 v[28:31],a[84:87],a[192:195],v[28:31]
 v_mfma_f32_16x16x32_bf16 v[36:39],a[84:87],a[208:211],v[36:39]
 v_mfma_f32_16x16x32_bf16 v[0:3],a[88:91],a[148:151],v[0:3]
 v_mfma_f32_16x16x32_bf16 v[8:11],a[88:91],a[164:167],v[8:11]
 v_mfma_f32_16x16x32_bf16 v[16:19],a[88:91],a[180:183],v[16:19]
 v_mfma_f32_16x16x32_bf16 v[24:27],a[88:91],a[196:199],v[24:27]
 v_mfma_f32_16x16x32_bf16 v[32:35],a[88:91],a[212:215],v[32:35]
 v_mfma_f32_16x16x32_bf16 v[4:7],a[92:95],a[148:151],v[4:7]
 v_mfma_f32_16x16x32_bf16 v[12:15],a[92:95],a[164:167],v[12:15]
 v_mfma_f32_16x16x32_bf16 v[20:23],a[92:95],a[180:183],v[20:23]
 v_mfma_f32_16x16x32_bf16 v[28:31],a[92:95],a[196:199],v[28:31]
 v_mfma_f32_16x16x32_bf16 v[36:39],a[92:95],a[212:215],v[36:39]
 s_waitcnt lgkmcnt(0)
 v_mfma_f32_16x16x32_bf16 v[0:3],a[96:99],a[152:155],v[0:3]
 v_mfma_f32_16x16x32_bf16 v[8:11],a[96:99],a[168:171],v[8:11]
 v_mfma_f32_16x16x32_bf16 v[16:19],a[96:99],a[184:187],v[16:19]
 ds_read_b64_tr_b16 a[80:81],v86 offset:49152
 ds_read_b64_tr_b16 a[82:83],v86 offset:53248
 v_mfma_f32_16x16x32_bf16 v[24:27],a[96:99],a[200:203],v[24:27]
 ds_read_b64_tr_b16 a[84:85],v87 offset:49152
 ds_read_b64_tr_b16 a[86:87],v87 offset:53248
 v_mfma_f32_16x16x32_bf16 v[32:35],a[96:99],a[216:219],v[32:35]
 ds_read_b64_tr_b16 a[88:89],v86 offset:57344
 ds_read_b64_tr_b16 a[90:91],v86 offset:61440
 v_mfma_f32_16x16x32_bf16 v[4:7],a[100:103],a[152:155],v[4:7]
 ds_read_b64_tr_b16 a[92:93],v87 offset:57344
 ds_read_b64_tr_b16 a[94:95],v87 offset:61440
 v_mfma_f32_16x16x32_bf16 v[12:15],a[100:103],a[168:171],v[12:15]
 v_mfma_f32_16x16x32_bf16 v[20:23],a[100:103],a[184:187],v[20:23]
 v_mfma_f32_16x16x32_bf16 v[28:31],a[100:103],a[200:203],v[28:31]
 v_mfma_f32_16x16x32_bf16 v[36:39],a[100:103],a[216:219],v[36:39]
 v_mfma_f32_16x16x32_bf16 v[0:3],a[104:107],a[156:159],v[0:3]
 v_mfma_f32_16x16x32_bf16 v[8:11],a[104:107],a[172:175],v[8:11]
 v_mfma_f32_16x16x32_bf16 v[16:19],a[104:107],a[188:191],v[16:19]
 v_mfma_f32_16x16x32_bf16 v[24:27],a[104:107],a[204:207],v[24:27]
 v_mfma_f32_16x16x32_bf16 v[32:35],a[104:107],a[220:223],v[32:35]
 v_mfma_f32_16x16x32_bf16 v[4:7],a[108:111],a[156:159],v[4:7]
 v_mfma_f32_16x16x32_bf16 v[12:15],a[108:111],a[172:175],v[12:15]
 v_mfma_f32_16x16x32_bf16 v[20:23],a[108:111],a[188:191],v[20:23]
 v_mfma_f32_16x16x32_bf16 v[28:31],a[108:111],a[204:207],v[28:31]
 v_mfma_f32_16x16x32_bf16 v[36:39],a[108:111],a[220:223],v[36:39]
 s_waitcnt lgkmcnt(0)
 v_mfma_f32_16x16x32_bf16 v[40:43],a[80:83],a[0:3],0
 v_mfma_f32_16x16x32_bf16 v[48:51],a[80:83],a[16:19],0
 v_mfma_f32_16x16x32_bf16 v[56:59],a[80:83],a[32:35],0
 ds_read_b64_tr_b16 a[96:97],v82 offset:16384
 ds_read_b64_tr_b16 a[98:99],v82 offset:20480
 v_mfma_f32_16x16x32_bf16 v[64:67],a[80:83],a[48:51],0
 ds_read_b64_tr_b16 a[100:101],v83 offset:16384
 ds_read_b64_tr_b16 a[102:103],v83 offset:20480
 v_mfma_f32_16x16x32_bf16 v[72:75],a[80:83],a[64:67],0
 ds_read_b64_tr_b16 a[104:105],v82 offset:24576
 ds_read_b64_tr_b16 a[106:107],v82 offset:28672
 v_mfma_f32_16x16x32_bf16 v[44:47],a[84:87],a[0:3],0
 ds_read_b64_tr_b16 a[108:109],v83 offset:24576
 ds_read_b64_tr_b16 a[110:111],v83 offset:28672
 v_mfma_f32_16x16x32_bf16 v[52:55],a[84:87],a[16:19],0
 v_cvt_pk_bf16_f32 v0,v0,v1
 v_cvt_pk_bf16_f32 v1,v2,v3
 v_mfma_f32_16x16x32_bf16 v[60:63],a[84:87],a[32:35],0
 v_cvt_pk_bf16_f32 v2,v4,v5
 v_cvt_pk_bf16_f32 v3,v6,v7
 v_mfma_f32_16x16x32_bf16 v[68:71],a[84:87],a[48:51],0
 s_add_u32 s58,s49,0x0
 buffer_store_dwordx4 v[0:3],v88,s[28:31],s58 offen sc1
 v_mfma_f32_16x16x32_bf16 v[76:79],a[84:87],a[64:67],0
 v_cvt_pk_bf16_f32 v8,v8,v9
 v_cvt_pk_bf16_f32 v9,v10,v11
 v_mfma_f32_16x16x32_bf16 v[40:43],a[88:91],a[4:7],v[40:43]
 v_cvt_pk_bf16_f32 v10,v12,v13
 v_cvt_pk_bf16_f32 v11,v14,v15
 v_mfma_f32_16x16x32_bf16 v[48:51],a[88:91],a[20:23],v[48:51]
 s_add_u32 s58,s49,0x400
 buffer_store_dwordx4 v[8:11],v88,s[28:31],s58 offen sc1
 v_mfma_f32_16x16x32_bf16 v[56:59],a[88:91],a[36:39],v[56:59]
 v_cvt_pk_bf16_f32 v16,v16,v17
 v_cvt_pk_bf16_f32 v17,v18,v19
 v_mfma_f32_16x16x32_bf16 v[64:67],a[88:91],a[52:55],v[64:67]
 v_cvt_pk_bf16_f32 v18,v20,v21
 v_cvt_pk_bf16_f32 v19,v22,v23
 v_mfma_f32_16x16x32_bf16 v[72:75],a[88:91],a[68:71],v[72:75]
 s_add_u32 s58,s49,0x800
 buffer_store_dwordx4 v[16:19],v88,s[28:31],s58 offen sc1
 v_mfma_f32_16x16x32_bf16 v[44:47],a[92:95],a[4:7],v[44:47]
 v_cvt_pk_bf16_f32 v24,v24,v25
 v_cvt_pk_bf16_f32 v25,v26,v27
 v_mfma_f32_16x16x32_bf16 v[52:55],a[92:95],a[20:23],v[52:55]
 v_cvt_pk_bf16_f32 v26,v28,v29
 v_cvt_pk_bf16_f32 v27,v30,v31
 v_mfma_f32_16x16x32_bf16 v[60:63],a[92:95],a[36:39],v[60:63]
 s_add_u32 s58,s49,0xc00
 buffer_store_dwordx4 v[24:27],v88,s[28:31],s58 offen sc1
 v_mfma_f32_16x16x32_bf16 v[68:71],a[92:95],a[52:55],v[68:71]
 v_cvt_pk_bf16_f32 v32,v32,v33
 v_cvt_pk_bf16_f32 v33,v34,v35
 v_mfma_f32_16x16x32_bf16 v[76:79],a[92:95],a[68:71],v[76:79]
 v_cvt_pk_bf16_f32 v34,v36,v37
 v_cvt_pk_bf16_f32 v35,v38,v39
 s_waitcnt lgkmcnt(0)
 v_mfma_f32_16x16x32_bf16 v[40:43],a[96:99],a[8:11],v[40:43]
 s_waitcnt vmcnt(6)
 v_mov_b32 v89,1
 v_mfma_f32_16x16x32_bf16 v[48:51],a[96:99],a[24:27],v[48:51]
 buffer_store_dword v89,v137,s[72:75],0 offen sc1
 s_add_u32 s58,s49,0x1000
 v_mfma_f32_16x16x32_bf16 v[56:59],a[96:99],a[40:43],v[56:59]
 ds_read_b64_tr_b16 a[80:81],v82 offset:32768
 ds_read_b64_tr_b16 a[82:83],v82 offset:36864
 v_mfma_f32_16x16x32_bf16 v[64:67],a[96:99],a[56:59],v[64:67]
 ds_read_b64_tr_b16 a[84:85],v83 offset:32768
 ds_read_b64_tr_b16 a[86:87],v83 offset:36864
 v_mfma_f32_16x16x32_bf16 v[72:75],a[96:99],a[72:75],v[72:75]
 ds_read_b64_tr_b16 a[88:89],v82 offset:40960
 ds_read_b64_tr_b16 a[90:91],v82 offset:45056
 v_mfma_f32_16x16x32_bf16 v[44:47],a[100:103],a[8:11],v[44:47]
 ds_read_b64_tr_b16 a[92:93],v83 offset:40960
 ds_read_b64_tr_b16 a[94:95],v83 offset:45056
 v_mfma_f32_16x16x32_bf16 v[52:55],a[100:103],a[24:27],v[52:55]
 buffer_store_dwordx4 v[32:35],v88,s[28:31],s58 offen sc1
 v_mfma_f32_16x16x32_bf16 v[60:63],a[100:103],a[40:43],v[60:63]
 v_mfma_f32_16x16x32_bf16 v[68:71],a[100:103],a[56:59],v[68:71]
 v_mfma_f32_16x16x32_bf16 v[76:79],a[100:103],a[72:75],v[76:79]
 v_mfma_f32_16x16x32_bf16 v[40:43],a[104:107],a[12:15],v[40:43]
 v_mfma_f32_16x16x32_bf16 v[48:51],a[104:107],a[28:31],v[48:51]
 v_mfma_f32_16x16x32_bf16 v[56:59],a[104:107],a[44:47],v[56:59]
 v_mfma_f32_16x16x32_bf16 v[64:67],a[104:107],a[60:63],v[64:67]
 v_mfma_f32_16x16x32_bf16 v[72:75],a[104:107],a[76:79],v[72:75]
 v_mfma_f32_16x16x32_bf16 v[44:47],a[108:111],a[12:15],v[44:47]
 v_mfma_f32_16x16x32_bf16 v[52:55],a[108:111],a[28:31],v[52:55]
 v_mfma_f32_16x16x32_bf16 v[60:63],a[108:111],a[44:47],v[60:63]
 v_mfma_f32_16x16x32_bf16 v[68:71],a[108:111],a[60:63],v[68:71]
 v_mfma_f32_16x16x32_bf16 v[76:79],a[108:111],a[76:79],v[76:79]
 s_waitcnt lgkmcnt(0)
 v_mfma_f32_16x16x32_bf16 v[40:43],a[80:83],a[144:147],v[40:43]
 v_mfma_f32_16x16x32_bf16 v[48:51],a[80:83],a[160:163],v[48:51]
 v_mfma_f32_16x16x32_bf16 v[56:59],a[80:83],a[176:179],v[56:59]
 ds_read_b64_tr_b16 a[96:97],v82 offset:49152
 ds_read_b64_tr_b16 a[98:99],v82 offset:53248
 v_mfma_f32_16x16x32_bf16 v[64:67],a[80:83],a[192:195],v[64:67]
 ds_read_b64_tr_b16 a[100:101],v83 offset:49152
 ds_read_b64_tr_b16 a[102:103],v83 offset:53248
 v_mfma_f32_16x16x32_bf16 v[72:75],a[80:83],a[208:211],v[72:75]
 ds_read_b64_tr_b16 a[104:105],v82 offset:57344
 ds_read_b64_tr_b16 a[106:107],v82 offset:61440
 v_mfma_f32_16x16x32_bf16 v[44:47],a[84:87],a[144:147],v[44:47]
 ds_read_b64_tr_b16 a[108:109],v83 offset:57344
 ds_read_b64_tr_b16 a[110:111],v83 offset:61440
 v_mfma_f32_16x16x32_bf16 v[52:55],a[84:87],a[160:163],v[52:55]
 v_mfma_f32_16x16x32_bf16 v[60:63],a[84:87],a[176:179],v[60:63]
 v_mfma_f32_16x16x32_bf16 v[68:71],a[84:87],a[192:195],v[68:71]
 v_mfma_f32_16x16x32_bf16 v[76:79],a[84:87],a[208:211],v[76:79]
 v_mfma_f32_16x16x32_bf16 v[40:43],a[88:91],a[148:151],v[40:43]
 v_mfma_f32_16x16x32_bf16 v[48:51],a[88:91],a[164:167],v[48:51]
 v_mfma_f32_16x16x32_bf16 v[56:59],a[88:91],a[180:183],v[56:59]
 v_mfma_f32_16x16x32_bf16 v[64:67],a[88:91],a[196:199],v[64:67]
 v_mfma_f32_16x16x32_bf16 v[72:75],a[88:91],a[212:215],v[72:75]
 v_mfma_f32_16x16x32_bf16 v[44:47],a[92:95],a[148:151],v[44:47]
 v_mfma_f32_16x16x32_bf16 v[52:55],a[92:95],a[164:167],v[52:55]
 v_mfma_f32_16x16x32_bf16 v[60:63],a[92:95],a[180:183],v[60:63]
 v_mfma_f32_16x16x32_bf16 v[68:71],a[92:95],a[196:199],v[68:71]
 v_mfma_f32_16x16x32_bf16 v[76:79],a[92:95],a[212:215],v[76:79]
 s_waitcnt lgkmcnt(0)
 v_mfma_f32_16x16x32_bf16 v[40:43],a[96:99],a[152:155],v[40:43]
 v_mfma_f32_16x16x32_bf16 v[48:51],a[96:99],a[168:171],v[48:51]
 s_barrier
 v_mfma_f32_16x16x32_bf16 v[56:59],a[96:99],a[184:187],v[56:59]
 ds_read_b64_tr_b16 a[80:81],v84 offset:0
 ds_read_b64_tr_b16 a[82:83],v84 offset:4096
 v_mfma_f32_16x16x32_bf16 v[64:67],a[96:99],a[200:203],v[64:67]
 ds_read_b64_tr_b16 a[84:85],v85 offset:0
 ds_read_b64_tr_b16 a[86:87],v85 offset:4096
 v_mfma_f32_16x16x32_bf16 v[72:75],a[96:99],a[216:219],v[72:75]
 ds_read_b64_tr_b16 a[88:89],v84 offset:8192
 ds_read_b64_tr_b16 a[90:91],v84 offset:12288
 v_mfma_f32_16x16x32_bf16 v[44:47],a[100:103],a[152:155],v[44:47]
 ds_read_b64_tr_b16 a[92:93],v85 offset:8192
 ds_read_b64_tr_b16 a[94:95],v85 offset:12288
 v_mfma_f32_16x16x32_bf16 v[52:55],a[100:103],a[168:171],v[52:55]
 s_lshl_b32 s59,s34,2
 s_add_u32 s59,s59,s47
 v_mfma_f32_16x16x32_bf16 v[60:63],a[100:103],a[184:187],v[60:63]
 s_add_u32 m0,s34,0x24000
 s_add_u32 s59,s59,0x0
 v_mfma_f32_16x16x32_bf16 v[68:71],a[100:103],a[200:203],v[68:71]
 buffer_load_dwordx4 v121,s[24:27],s59 offen offset:0  lds
 v_mfma_f32_16x16x32_bf16 v[76:79],a[100:103],a[216:219],v[76:79]
 v_mfma_f32_16x16x32_bf16 v[40:43],a[104:107],a[156:159],v[40:43]
 v_mfma_f32_16x16x32_bf16 v[48:51],a[104:107],a[172:175],v[48:51]
 buffer_load_dwordx4 v122,s[24:27],s59 offen offset:1024  lds
 v_mfma_f32_16x16x32_bf16 v[56:59],a[104:107],a[188:191],v[56:59]
 v_mfma_f32_16x16x32_bf16 v[64:67],a[104:107],a[204:207],v[64:67]
 v_mfma_f32_16x16x32_bf16 v[72:75],a[104:107],a[220:223],v[72:75]
 buffer_load_dwordx4 v123,s[24:27],s59 offen offset:2048  lds
 v_mfma_f32_16x16x32_bf16 v[44:47],a[108:111],a[156:159],v[44:47]
 v_mfma_f32_16x16x32_bf16 v[52:55],a[108:111],a[172:175],v[52:55]
 v_mfma_f32_16x16x32_bf16 v[60:63],a[108:111],a[188:191],v[60:63]
 buffer_load_dwordx4 v124,s[24:27],s59 offen offset:3072  lds
 s_lshl_b32 s59,s34,2
 v_mfma_f32_16x16x32_bf16 v[68:71],a[108:111],a[204:207],v[68:71]
 s_add_u32 s59,s59,s47
 s_add_u32 m0,s34,0x4000
 v_mfma_f32_16x16x32_bf16 v[76:79],a[108:111],a[220:223],v[76:79]
 s_add_u32 s59,s59,0x10000
 s_waitcnt lgkmcnt(0)
 v_mfma_f32_16x16x32_bf16 v[144:147],a[80:83],a[0:3],0
 buffer_load_dwordx4 v121,s[24:27],s59 offen offset:0  lds
 v_mfma_f32_16x16x32_bf16 v[152:155],a[80:83],a[16:19],0
 s_barrier
 v_mfma_f32_16x16x32_bf16 v[160:163],a[80:83],a[32:35],0
 ds_read_b64_tr_b16 a[96:97],v80 offset:0
 ds_read_b64_tr_b16 a[98:99],v80 offset:4096
 v_mfma_f32_16x16x32_bf16 v[168:171],a[80:83],a[48:51],0
 ds_read_b64_tr_b16 a[100:101],v81 offset:0
 ds_read_b64_tr_b16 a[102:103],v81 offset:4096
 v_mfma_f32_16x16x32_bf16 v[176:179],a[80:83],a[64:67],0
 ds_read_b64_tr_b16 a[104:105],v80 offset:8192
 ds_read_b64_tr_b16 a[106:107],v80 offset:12288
 v_mfma_f32_16x16x32_bf16 v[148:151],a[84:87],a[0:3],0
 ds_read_b64_tr_b16 a[108:109],v81 offset:8192
 ds_read_b64_tr_b16 a[110:111],v81 offset:12288
 v_mfma_f32_16x16x32_bf16 v[156:159],a[84:87],a[16:19],0
 buffer_load_dwordx4 v122,s[24:27],s59 offen offset:1024  lds
 v_mfma_f32_16x16x32_bf16 v[164:167],a[84:87],a[32:35],0
 v_mfma_f32_16x16x32_bf16 v[172:175],a[84:87],a[48:51],0
 v_mfma_f32_16x16x32_bf16 v[180:183],a[84:87],a[64:67],0
 buffer_load_dwordx4 v123,s[24:27],s59 offen offset:2048  lds
 v_cvt_pk_bf16_f32 v40,v40,v41
 v_mfma_f32_16x16x32_bf16 v[144:147],a[88:91],a[4:7],v[144:147]
 v_cvt_pk_bf16_f32 v41,v42,v43
 v_cvt_pk_bf16_f32 v42,v44,v45
 v_mfma_f32_16x16x32_bf16 v[152:155],a[88:91],a[20:23],v[152:155]
 v_cvt_pk_bf16_f32 v43,v46,v47
 s_add_u32 s58,s49,0x2800
 v_mfma_f32_16x16x32_bf16 v[160:163],a[88:91],a[36:39],v[160:163]
 buffer_load_dwordx4 v124,s[24:27],s59 offen offset:3072  lds
 s_lshl_b32 s59,s34,2
 v_mfma_f32_16x16x32_bf16 v[168:171],a[88:91],a[52:55],v[168:171]
 s_add_u32 s59,s59,s47
 s_add_u32 m0,s34,0x8000
 v_mfma_f32_16x16x32_bf16 v[176:179],a[88:91],a[68:71],v[176:179]
 s_add_u32 s59,s59,0x0
 buffer_store_dwordx4 v[40:43],v88,s[28:31],s58 offen sc1
 v_mfma_f32_16x16x32_bf16 v[148:151],a[92:95],a[4:7],v[148:151]
 buffer_load_dwordx4 v125,s[24:27],s59 offen offset:0  lds
 v_cvt_pk_bf16_f32 v48,v48,v49
 v_mfma_f32_16x16x32_bf16 v[156:159],a[92:95],a[20:23],v[156:159]
 v_cvt_pk_bf16_f32 v49,v50,v51
 v_cvt_pk_bf16_f32 v50,v52,v53
 v_mfma_f32_16x16x32_bf16 v[164:167],a[92:95],a[36:39],v[164:167]
 v_cvt_pk_bf16_f32 v51,v54,v55
 s_add_u32 s58,s49,0x2c00
 v_mfma_f32_16x16x32_bf16 v[172:175],a[92:95],a[52:55],v[172:175]
 buffer_load_dwordx4 v126,s[24:27],s59 offen offset:1024  lds
 buffer_store_dwordx4 v[48:51],v88,s[28:31],s58 offen sc1
 v_mfma_f32_16x16x32_bf16 v[180:183],a[92:95],a[68:71],v[180:183]
 v_cvt_pk_bf16_f32 v56,v56,v57
 v_cvt_pk_bf16_f32 v57,v58,v59
 s_waitcnt lgkmcnt(0)
 v_mfma_f32_16x16x32_bf16 v[144:147],a[96:99],a[8:11],v[144:147]
 v_cvt_pk_bf16_f32 v58,v60,v61
 v_cvt_pk_bf16_f32 v59,v62,v63
 v_mfma_f32_16x16x32_bf16 v[152:155],a[96:99],a[24:27],v[152:155]
 s_barrier
 v_mfma_f32_16x16x32_bf16 v[160:163],a[96:99],a[40:43],v[160:163]
 ds_read_b64_tr_b16 a[80:81],v84 offset:16384
 ds_read_b64_tr_b16 a[82:83],v84 offset:20480
 v_mfma_f32_16x16x32_bf16 v[168:171],a[96:99],a[56:59],v[168:171]
 ds_read_b64_tr_b16 a[84:85],v85 offset:16384
 ds_read_b64_tr_b16 a[86:87],v85 offset:20480
 v_mfma_f32_16x16x32_bf16 v[176:179],a[96:99],a[72:75],v[176:179]
 ds_read_b64_tr_b16 a[88:89],v84 offset:24576
 ds_read_b64_tr_b16 a[90:91],v84 offset:28672
 v_mfma_f32_16x16x32_bf16 v[148:151],a[100:103],a[8:11],v[148:151]
 ds_read_b64_tr_b16 a[92:93],v85 offset:24576
 ds_read_b64_tr_b16 a[94:95],v85 offset:28672
 v_mfma_f32_16x16x32_bf16 v[156:159],a[100:103],a[24:27],v[156:159]
 buffer_load_dwordx4 v127,s[24:27],s59 offen offset:2048  lds
 s_add_u32 s58,s49,0x3000
 v_mfma_f32_16x16x32_bf16 v[164:167],a[100:103],a[40:43],v[164:167]
 buffer_store_dwordx4 v[56:59],v88,s[28:31],s58 offen sc1
 v_cvt_pk_bf16_f32 v64,v64,v65
 v_mfma_f32_16x16x32_bf16 v[172:175],a[100:103],a[56:59],v[172:175]
 v_cvt_pk_bf16_f32 v65,v66,v67
 v_cvt_pk_bf16_f32 v66,v68,v69
 v_mfma_f32_16x16x32_bf16 v[180:183],a[100:103],a[72:75],v[180:183]
 buffer_load_dwordx4 v128,s[24:27],s59 offen offset:3072  lds
 s_lshl_b32 s59,s34,2
 v_mfma_f32_16x16x32_bf16 v[144:147],a[104:107],a[12:15],v[144:147]
 s_add_u32 s59,s59,s47
 s_add_u32 m0,s34,0xc000
 v_mfma_f32_16x16x32_bf16 v[152:155],a[104:107],a[28:31],v[152:155]
 s_add_u32 s59,s59,0x10000
 v_cvt_pk_bf16_f32 v67,v70,v71
 v_mfma_f32_16x16x32_bf16 v[160:163],a[104:107],a[44:47],v[160:163]
 buffer_load_dwordx4 v125,s[24:27],s59 offen offset:0  lds
 s_add_u32 s58,s49,0x3400
 v_mfma_f32_16x16x32_bf16 v[168:171],a[104:107],a[60:63],v[168:171]
 buffer_store_dwordx4 v[64:67],v88,s[28:31],s58 offen sc1
 v_cvt_pk_bf16_f32 v72,v72,v73
 v_mfma_f32_16x16x32_bf16 v[176:179],a[104:107],a[76:79],v[176:179]
 v_cvt_pk_bf16_f32 v73,v74,v75
 v_cvt_pk_bf16_f32 v74,v76,v77
 v_mfma_f32_16x16x32_bf16 v[148:151],a[108:111],a[12:15],v[148:151]
 buffer_load_dwordx4 v126,s[24:27],s59 offen offset:1024  lds
 v_cvt_pk_bf16_f32 v75,v78,v79
 v_mfma_f32_16x16x32_bf16 v[156:159],a[108:111],a[28:31],v[156:159]
 s_add_u32 s58,s49,0x3800
 buffer_store_dwordx4 v[72:75],v88,s[28:31],s58 offen sc1
 v_mfma_f32_16x16x32_bf16 v[164:167],a[108:111],a[44:47],v[164:167]
 v_mfma_f32_16x16x32_bf16 v[172:175],a[108:111],a[60:63],v[172:175]
 buffer_load_dwordx4 v127,s[24:27],s59 offen offset:2048  lds
 v_mfma_f32_16x16x32_bf16 v[180:183],a[108:111],a[76:79],v[180:183]
 s_waitcnt lgkmcnt(0)
 v_mfma_f32_16x16x32_bf16 v[144:147],a[80:83],a[144:147],v[144:147]
 v_mfma_f32_16x16x32_bf16 v[152:155],a[80:83],a[160:163],v[152:155]
 s_waitcnt vmcnt(26)
 s_barrier
 v_mfma_f32_16x16x32_bf16 v[160:163],a[80:83],a[176:179],v[160:163]
 ds_read_b64_tr_b16 a[96:97],v84 offset:32768
 ds_read_b64_tr_b16 a[98:99],v84 offset:36864
 v_mfma_f32_16x16x32_bf16 v[168:171],a[80:83],a[192:195],v[168:171]
 ds_read_b64_tr_b16 a[100:101],v85 offset:32768
 ds_read_b64_tr_b16 a[102:103],v85 offset:36864
 v_mfma_f32_16x16x32_bf16 v[176:179],a[80:83],a[208:211],v[176:179]
 ds_read_b64_tr_b16 a[104:105],v84 offset:40960
 ds_read_b64_tr_b16 a[106:107],v84 offset:45056
 v_mfma_f32_16x16x32_bf16 v[148:151],a[84:87],a[144:147],v[148:151]
 ds_read_b64_tr_b16 a[108:109],v85 offset:40960
 ds_read_b64_tr_b16 a[110:111],v85 offset:45056
 v_mfma_f32_16x16x32_bf16 v[156:159],a[84:87],a[160:163],v[156:159]
 buffer_load_dwordx4 v128,s[24:27],s59 offen offset:3072  lds
 v_mfma_f32_16x16x32_bf16 v[164:167],a[84:87],a[176:179],v[164:167]
 v_mfma_f32_16x16x32_bf16 v[172:175],a[84:87],a[192:195],v[172:175]
 v_mfma_f32_16x16x32_bf16 v[180:183],a[84:87],a[208:211],v[180:183]
 v_mfma_f32_16x16x32_bf16 v[144:147],a[88:91],a[148:151],v[144:147]
 v_mfma_f32_16x16x32_bf16 v[152:155],a[88:91],a[164:167],v[152:155]
 v_mfma_f32_16x16x32_bf16 v[160:163],a[88:91],a[180:183],v[160:163]
 v_mfma_f32_16x16x32_bf16 v[168:171],a[88:91],a[196:199],v[168:171]
 v_mfma_f32_16x16x32_bf16 v[176:179],a[88:91],a[212:215],v[176:179]
 v_mfma_f32_16x16x32_bf16 v[148:151],a[92:95],a[148:151],v[148:151]
 v_mfma_f32_16x16x32_bf16 v[156:159],a[92:95],a[164:167],v[156:159]
 v_mfma_f32_16x16x32_bf16 v[164:167],a[92:95],a[180:183],v[164:167]
 v_mfma_f32_16x16x32_bf16 v[172:175],a[92:95],a[196:199],v[172:175]
 v_mfma_f32_16x16x32_bf16 v[180:183],a[92:95],a[212:215],v[180:183]
 s_waitcnt lgkmcnt(0)
 v_mfma_f32_16x16x32_bf16 v[144:147],a[96:99],a[152:155],v[144:147]
 v_mfma_f32_16x16x32_bf16 v[152:155],a[96:99],a[168:171],v[152:155]
 v_mfma_f32_16x16x32_bf16 v[160:163],a[96:99],a[184:187],v[160:163]
 ds_read_b64_tr_b16 a[80:81],v86 offset:0
 ds_read_b64_tr_b16 a[82:83],v86 offset:4096
 v_mfma_f32_16x16x32_bf16 v[168:171],a[96:99],a[200:203],v[168:171]
 ds_read_b64_tr_b16 a[84:85],v87 offset:0
 ds_read_b64_tr_b16 a[86:87],v87 offset:4096
 v_mfma_f32_16x16x32_bf16 v[176:179],a[96:99],a[216:219],v[176:179]
 ds_read_b64_tr_b16 a[88:89],v86 offset:8192
 ds_read_b64_tr_b16 a[90:91],v86 offset:12288
 v_mfma_f32_16x16x32_bf16 v[148:151],a[100:103],a[152:155],v[148:151]
 ds_read_b64_tr_b16 a[92:93],v87 offset:8192
 ds_read_b64_tr_b16 a[94:95],v87 offset:12288
 v_mfma_f32_16x16x32_bf16 v[156:159],a[100:103],a[168:171],v[156:159]
 v_mfma_f32_16x16x32_bf16 v[164:167],a[100:103],a[184:187],v[164:167]
 v_mfma_f32_16x16x32_bf16 v[172:175],a[100:103],a[200:203],v[172:175]
 v_mfma_f32_16x16x32_bf16 v[180:183],a[100:103],a[216:219],v[180:183]
 v_mfma_f32_16x16x32_bf16 v[144:147],a[104:107],a[156:159],v[144:147]
 v_mfma_f32_16x16x32_bf16 v[152:155],a[104:107],a[172:175],v[152:155]
 v_mfma_f32_16x16x32_bf16 v[160:163],a[104:107],a[188:191],v[160:163]
 v_mfma_f32_16x16x32_bf16 v[168:171],a[104:107],a[204:207],v[168:171]
 v_mfma_f32_16x16x32_bf16 v[176:179],a[104:107],a[220:223],v[176:179]
 v_mfma_f32_16x16x32_bf16 v[148:151],a[108:111],a[156:159],v[148:151]
 v_mfma_f32_16x16x32_bf16 v[156:159],a[108:111],a[172:175],v[156:159]
 v_mfma_f32_16x16x32_bf16 v[164:167],a[108:111],a[188:191],v[164:167]
 v_mfma_f32_16x16x32_bf16 v[172:175],a[108:111],a[204:207],v[172:175]
 v_mfma_f32_16x16x32_bf16 v[180:183],a[108:111],a[220:223],v[180:183]
 s_waitcnt lgkmcnt(0)
 v_mfma_f32_16x16x32_bf16 v[184:187],a[80:83],a[0:3],0
 v_mfma_f32_16x16x32_bf16 v[192:195],a[80:83],a[16:19],0
 v_mfma_f32_16x16x32_bf16 v[200:203],a[80:83],a[32:35],0
 ds_read_b64_tr_b16 a[96:97],v82 offset:0
 ds_read_b64_tr_b16 a[98:99],v82 offset:4096
 v_mfma_f32_16x16x32_bf16 v[208:211],a[80:83],a[48:51],0
 ds_read_b64_tr_b16 a[100:101],v83 offset:0
 ds_read_b64_tr_b16 a[102:103],v83 offset:4096
 v_mfma_f32_16x16x32_bf16 v[216:219],a[80:83],a[64:67],0
 ds_read_b64_tr_b16 a[104:105],v82 offset:8192
 ds_read_b64_tr_b16 a[106:107],v82 offset:12288
 v_mfma_f32_16x16x32_bf16 v[188:191],a[84:87],a[0:3],0
 ds_read_b64_tr_b16 a[108:109],v83 offset:8192
 ds_read_b64_tr_b16 a[110:111],v83 offset:12288
 v_mfma_f32_16x16x32_bf16 v[196:199],a[84:87],a[16:19],0
 v_cvt_pk_bf16_f32 v144,v144,v145
 v_cvt_pk_bf16_f32 v145,v146,v147
 v_mfma_f32_16x16x32_bf16 v[204:207],a[84:87],a[32:35],0
 v_cvt_pk_bf16_f32 v146,v148,v149
 v_cvt_pk_bf16_f32 v147,v150,v151
 v_mfma_f32_16x16x32_bf16 v[212:215],a[84:87],a[48:51],0
 s_add_u32 s58,s50,0x0
 buffer_store_dwordx4 v[144:147],v88,s[28:31],s58 offen sc1
 v_mfma_f32_16x16x32_bf16 v[220:223],a[84:87],a[64:67],0
 v_cvt_pk_bf16_f32 v152,v152,v153
 v_cvt_pk_bf16_f32 v153,v154,v155
 v_mfma_f32_16x16x32_bf16 v[184:187],a[88:91],a[4:7],v[184:187]
 v_cvt_pk_bf16_f32 v154,v156,v157
 v_cvt_pk_bf16_f32 v155,v158,v159
 v_mfma_f32_16x16x32_bf16 v[192:195],a[88:91],a[20:23],v[192:195]
 s_add_u32 s58,s50,0x400
 buffer_store_dwordx4 v[152:155],v88,s[28:31],s58 offen sc1
 v_mfma_f32_16x16x32_bf16 v[200:203],a[88:91],a[36:39],v[200:203]
 v_cvt_pk_bf16_f32 v160,v160,v161
 v_cvt_pk_bf16_f32 v161,v162,v163
 v_mfma_f32_16x16x32_bf16 v[208:211],a[88:91],a[52:55],v[208:211]
 v_cvt_pk_bf16_f32 v162,v164,v165
 v_cvt_pk_bf16_f32 v163,v166,v167
 v_mfma_f32_16x16x32_bf16 v[216:219],a[88:91],a[68:71],v[216:219]
 s_add_u32 s58,s50,0x800
 buffer_store_dwordx4 v[160:163],v88,s[28:31],s58 offen sc1
 v_mfma_f32_16x16x32_bf16 v[188:191],a[92:95],a[4:7],v[188:191]
 v_cvt_pk_bf16_f32 v168,v168,v169
 v_cvt_pk_bf16_f32 v169,v170,v171
 v_mfma_f32_16x16x32_bf16 v[196:199],a[92:95],a[20:23],v[196:199]
 v_cvt_pk_bf16_f32 v170,v172,v173
 v_cvt_pk_bf16_f32 v171,v174,v175
 v_mfma_f32_16x16x32_bf16 v[204:207],a[92:95],a[36:39],v[204:207]
 s_add_u32 s58,s50,0xc00
 buffer_store_dwordx4 v[168:171],v88,s[28:31],s58 offen sc1
 v_mfma_f32_16x16x32_bf16 v[212:215],a[92:95],a[52:55],v[212:215]
 v_cvt_pk_bf16_f32 v176,v176,v177
 v_cvt_pk_bf16_f32 v177,v178,v179
 v_mfma_f32_16x16x32_bf16 v[220:223],a[92:95],a[68:71],v[220:223]
 v_cvt_pk_bf16_f32 v178,v180,v181
 v_cvt_pk_bf16_f32 v179,v182,v183
 s_waitcnt lgkmcnt(0)
 v_mfma_f32_16x16x32_bf16 v[184:187],a[96:99],a[8:11],v[184:187]
 s_add_u32 s58,s50,0x1000
 buffer_store_dwordx4 v[176:179],v88,s[28:31],s58 offen sc1
 v_mfma_f32_16x16x32_bf16 v[192:195],a[96:99],a[24:27],v[192:195]
 v_mfma_f32_16x16x32_bf16 v[200:203],a[96:99],a[40:43],v[200:203]
 ds_read_b64_tr_b16 a[80:81],v86 offset:16384
 ds_read_b64_tr_b16 a[82:83],v86 offset:20480
 v_mfma_f32_16x16x32_bf16 v[208:211],a[96:99],a[56:59],v[208:211]
 ds_read_b64_tr_b16 a[84:85],v87 offset:16384
 ds_read_b64_tr_b16 a[86:87],v87 offset:20480
 v_mfma_f32_16x16x32_bf16 v[216:219],a[96:99],a[72:75],v[216:219]
 ds_read_b64_tr_b16 a[88:89],v86 offset:24576
 ds_read_b64_tr_b16 a[90:91],v86 offset:28672
 v_mfma_f32_16x16x32_bf16 v[188:191],a[100:103],a[8:11],v[188:191]
 ds_read_b64_tr_b16 a[92:93],v87 offset:24576
 ds_read_b64_tr_b16 a[94:95],v87 offset:28672
 v_mfma_f32_16x16x32_bf16 v[196:199],a[100:103],a[24:27],v[196:199]
 v_mfma_f32_16x16x32_bf16 v[204:207],a[100:103],a[40:43],v[204:207]
 v_mfma_f32_16x16x32_bf16 v[212:215],a[100:103],a[56:59],v[212:215]
 v_mfma_f32_16x16x32_bf16 v[220:223],a[100:103],a[72:75],v[220:223]
 v_mfma_f32_16x16x32_bf16 v[184:187],a[104:107],a[12:15],v[184:187]
 v_mfma_f32_16x16x32_bf16 v[192:195],a[104:107],a[28:31],v[192:195]
 v_mfma_f32_16x16x32_bf16 v[200:203],a[104:107],a[44:47],v[200:203]
 v_mfma_f32_16x16x32_bf16 v[208:211],a[104:107],a[60:63],v[208:211]
 v_mfma_f32_16x16x32_bf16 v[216:219],a[104:107],a[76:79],v[216:219]
 v_mfma_f32_16x16x32_bf16 v[188:191],a[108:111],a[12:15],v[188:191]
 v_mfma_f32_16x16x32_bf16 v[196:199],a[108:111],a[28:31],v[196:199]
 v_mfma_f32_16x16x32_bf16 v[204:207],a[108:111],a[44:47],v[204:207]
 v_mfma_f32_16x16x32_bf16 v[212:215],a[108:111],a[60:63],v[212:215]
 v_mfma_f32_16x16x32_bf16 v[220:223],a[108:111],a[76:79],v[220:223]
 s_waitcnt lgkmcnt(0)
 v_mfma_f32_16x16x32_bf16 v[184:187],a[80:83],a[144:147],v[184:187]
 v_mfma_f32_16x16x32_bf16 v[192:195],a[80:83],a[160:163],v[192:195]
 v_mfma_f32_16x16x32_bf16 v[200:203],a[80:83],a[176:179],v[200:203]
 ds_read_b64_tr_b16 a[96:97],v86 offset:32768
 ds_read_b64_tr_b16 a[98:99],v86 offset:36864
 v_mfma_f32_16x16x32_bf16 v[208:211],a[80:83],a[192:195],v[208:211]
 ds_read_b64_tr_b16 a[100:101],v87 offset:32768
 ds_read_b64_tr_b16 a[102:103],v87 offset:36864
 v_mfma_f32_16x16x32_bf16 v[216:219],a[80:83],a[208:211],v[216:219]
 ds_read_b64_tr_b16 a[104:105],v86 offset:40960
 ds_read_b64_tr_b16 a[106:107],v86 offset:45056
 v_mfma_f32_16x16x32_bf16 v[188:191],a[84:87],a[144:147],v[188:191]
 ds_read_b64_tr_b16 a[108:109],v87 offset:40960
 ds_read_b64_tr_b16 a[110:111],v87 offset:45056
 v_mfma_f32_16x16x32_bf16 v[196:199],a[84:87],a[160:163],v[196:199]
 v_mfma_f32_16x16x32_bf16 v[204:207],a[84:87],a[176:179],v[204:207]
 v_mfma_f32_16x16x32_bf16 v[212:215],a[84:87],a[192:195],v[212:215]
 v_mfma_f32_16x16x32_bf16 v[220:223],a[84:87],a[208:211],v[220:223]
 v_mfma_f32_16x16x32_bf16 v[184:187],a[88:91],a[148:151],v[184:187]
 v_mfma_f32_16x16x32_bf16 v[192:195],a[88:91],a[164:167],v[192:195]
 v_mfma_f32_16x16x32_bf16 v[200:203],a[88:91],a[180:183],v[200:203]
 v_mfma_f32_16x16x32_bf16 v[208:211],a[88:91],a[196:199],v[208:211]
 v_mfma_f32_16x16x32_bf16 v[216:219],a[88:91],a[212:215],v[216:219]
 v_mfma_f32_16x16x32_bf16 v[188:191],a[92:95],a[148:151],v[188:191]
 v_mfma_f32_16x16x32_bf16 v[196:199],a[92:95],a[164:167],v[196:199]
 v_mfma_f32_16x16x32_bf16 v[204:207],a[92:95],a[180:183],v[204:207]
 v_mfma_f32_16x16x32_bf16 v[212:215],a[92:95],a[196:199],v[212:215]
 v_mfma_f32_16x16x32_bf16 v[220:223],a[92:95],a[212:215],v[220:223]
 s_waitcnt lgkmcnt(0)
 v_mfma_f32_16x16x32_bf16 v[184:187],a[96:99],a[152:155],v[184:187]
 s_waitcnt vmcnt(7)
 v_mov_b32 v89,2
 v_mfma_f32_16x16x32_bf16 v[192:195],a[96:99],a[168:171],v[192:195]
 s_barrier
 v_mfma_f32_16x16x32_bf16 v[200:203],a[96:99],a[184:187],v[200:203]
 ds_read_b64_tr_b16 a[80:81],v84 offset:49152
 ds_read_b64_tr_b16 a[82:83],v84 offset:53248
 v_mfma_f32_16x16x32_bf16 v[208:211],a[96:99],a[200:203],v[208:211]
 ds_read_b64_tr_b16 a[84:85],v85 offset:49152
 ds_read_b64_tr_b16 a[86:87],v85 offset:53248
 v_mfma_f32_16x16x32_bf16 v[216:219],a[96:99],a[216:219],v[216:219]
 ds_read_b64_tr_b16 a[88:89],v84 offset:57344
 ds_read_b64_tr_b16 a[90:91],v84 offset:61440
 v_mfma_f32_16x16x32_bf16 v[188:191],a[100:103],a[152:155],v[188:191]
 ds_read_b64_tr_b16 a[92:93],v85 offset:57344
 ds_read_b64_tr_b16 a[94:95],v85 offset:61440
 v_mfma_f32_16x16x32_bf16 v[196:199],a[100:103],a[168:171],v[196:199]
 buffer_store_dword v89,v137,s[72:75],0 offen sc1
 v_mfma_f32_16x16x32_bf16 v[204:207],a[100:103],a[184:187],v[204:207]
 v_mfma_f32_16x16x32_bf16 v[212:215],a[100:103],a[200:203],v[212:215]
 v_mfma_f32_16x16x32_bf16 v[220:223],a[100:103],a[216:219],v[220:223]
 v_mfma_f32_16x16x32_bf16 v[184:187],a[104:107],a[156:159],v[184:187]
 v_mfma_f32_16x16x32_bf16 v[192:195],a[104:107],a[172:175],v[192:195]
 v_mfma_f32_16x16x32_bf16 v[200:203],a[104:107],a[188:191],v[200:203]
 v_mfma_f32_16x16x32_bf16 v[208:211],a[104:107],a[204:207],v[208:211]
 v_mfma_f32_16x16x32_bf16 v[216:219],a[104:107],a[220:223],v[216:219]
 v_mfma_f32_16x16x32_bf16 v[188:191],a[108:111],a[156:159],v[188:191]
 v_mfma_f32_16x16x32_bf16 v[196:199],a[108:111],a[172:175],v[196:199]
 v_mfma_f32_16x16x32_bf16 v[204:207],a[108:111],a[188:191],v[204:207]
 v_mfma_f32_16x16x32_bf16 v[212:215],a[108:111],a[204:207],v[212:215]
 v_mfma_f32_16x16x32_bf16 v[220:223],a[108:111],a[220:223],v[220:223]
 s_waitcnt lgkmcnt(0)
 v_mfma_f32_16x16x32_bf16 v[0:3],a[80:83],a[0:3],0
 v_mfma_f32_16x16x32_bf16 v[8:11],a[80:83],a[16:19],0
 s_barrier
 v_mfma_f32_16x16x32_bf16 v[16:19],a[80:83],a[32:35],0
 ds_read_b64_tr_b16 a[96:97],v80 offset:16384
 ds_read_b64_tr_b16 a[98:99],v80 offset:20480
 v_mfma_f32_16x16x32_bf16 v[24:27],a[80:83],a[48:51],0
 ds_read_b64_tr_b16 a[100:101],v81 offset:16384
 ds_read_b64_tr_b16 a[102:103],v81 offset:20480
 v_mfma_f32_16x16x32_bf16 v[32:35],a[80:83],a[64:67],0
 ds_read_b64_tr_b16 a[104:105],v80 offset:24576
 ds_read_b64_tr_b16 a[106:107],v80 offset:28672
 v_mfma_f32_16x16x32_bf16 v[4:7],a[84:87],a[0:3],0
 ds_read_b64_tr_b16 a[108:109],v81 offset:24576
 ds_read_b64_tr_b16 a[110:111],v81 offset:28672
 v_mfma_f32_16x16x32_bf16 v[12:15],a[84:87],a[16:19],0
 v_mfma_f32_16x16x32_bf16 v[20:23],a[84:87],a[32:35],0
 v_cvt_pk_bf16_f32 v184,v184,v185
 v_cvt_pk_bf16_f32 v185,v186,v187
 v_mfma_f32_16x16x32_bf16 v[28:31],a[84:87],a[48:51],0
 v_cvt_pk_bf16_f32 v186,v188,v189
 v_cvt_pk_bf16_f32 v187,v190,v191
 v_mfma_f32_16x16x32_bf16 v[36:39],a[84:87],a[64:67],0
 s_add_u32 s58,s50,0x2800
 buffer_store_dwordx4 v[184:187],v88,s[28:31],s58 offen sc1
 v_mfma_f32_16x16x32_bf16 v[0:3],a[88:91],a[4:7],v[0:3]
 v_cvt_pk_bf16_f32 v192,v192,v193
 v_cvt_pk_bf16_f32 v193,v194,v195
 v_mfma_f32_16x16x32_bf16 v[8:11],a[88:91],a[20:23],v[8:11]
 v_cvt_pk_bf16_f32 v194,v196,v197
 v_cvt_pk_bf16_f32 v195,v198,v199
 v_mfma_f32_16x16x32_bf16 v[16:19],a[88:91],a[36:39],v[16:19]
 s_add_u32 s58,s50,0x2c00
 buffer_store_dwordx4 v[192:195],v88,s[28:31],s58 offen sc1
 v_mfma_f32_16x16x32_bf16 v[24:27],a[88:91],a[52:55],v[24:27]
 v_cvt_pk_bf16_f32 v200,v200,v201
 v_cvt_pk_bf16_f32 v201,v202,v203
 v_mfma_f32_16x16x32_bf16 v[32:35],a[88:91],a[68:71],v[32:35]
 v_cvt_pk_bf16_f32 v202,v204,v205
 v_cvt_pk_bf16_f32 v203,v206,v207
 v_mfma_f32_16x16x32_bf16 v[4:7],a[92:95],a[4:7],v[4:7]
 s_add_u32 s58,s50,0x3000
 buffer_store_dwordx4 v[200:203],v88,s[28:31],s58 offen sc1
 v_mfma_f32_16x16x32_bf16 v[12:15],a[92:95],a[20:23],v[12:15]
 v_cvt_pk_bf16_f32 v208,v208,v209
 v_cvt_pk_bf16_f32 v209,v210,v211
 v_mfma_f32_16x16x32_bf16 v[20:23],a[92:95],a[36:39],v[20:23]
 v_cvt_pk_bf16_f32 v210,v212,v213
 v_cvt_pk_bf16_f32 v211,v214,v215
 v_mfma_f32_16x16x32_bf16 v[28:31],a[92:95],a[52:55],v[28:31]
 s_add_u32 s58,s50,0x3400
 buffer_store_dwordx4 v[208:211],v88,s[28:31],s58 offen sc1
 v_mfma_f32_16x16x32_bf16 v[36:39],a[92:95],a[68:71],v[36:39]
 v_cvt_pk_bf16_f32 v216,v216,v217
 v_cvt_pk_bf16_f32 v217,v218,v219
 s_waitcnt lgkmcnt(0)
 v_mfma_f32_16x16x32_bf16 v[0:3],a[96:99],a[8:11],v[0:3]
 v_cvt_pk_bf16_f32 v218,v220,v221
 v_cvt_pk_bf16_f32 v219,v222,v223
 v_mfma_f32_16x16x32_bf16 v[8:11],a[96:99],a[24:27],v[8:11]
 s_barrier
 v_mfma_f32_16x16x32_bf16 v[16:19],a[96:99],a[40:43],v[16:19]
 ds_read_b64_tr_b16 a[80:81],v80 offset:32768
 ds_read_b64_tr_b16 a[82:83],v80 offset:36864
 v_mfma_f32_16x16x32_bf16 v[24:27],a[96:99],a[56:59],v[24:27]
 ds_read_b64_tr_b16 a[84:85],v81 offset:32768
 ds_read_b64_tr_b16 a[86:87],v81 offset:36864
 v_mfma_f32_16x16x32_bf16 v[32:35],a[96:99],a[72:75],v[32:35]
 ds_read_b64_tr_b16 a[88:89],v80 offset:40960
 ds_read_b64_tr_b16 a[90:91],v80 offset:45056
 v_mfma_f32_16x16x32_bf16 v[4:7],a[100:103],a[8:11],v[4:7]
 ds_read_b64_tr_b16 a[92:93],v81 offset:40960
 ds_read_b64_tr_b16 a[94:95],v81 offset:45056
 v_mfma_f32_16x16x32_bf16 v[12:15],a[100:103],a[24:27],v[12:15]
 s_add_u32 s58,s50,0x3800
 buffer_store_dwordx4 v[216:219],v88,s[28:31],s58 offen sc1
 v_mfma_f32_16x16x32_bf16 v[20:23],a[100:103],a[40:43],v[20:23]
 v_mfma_f32_16x16x32_bf16 v[28:31],a[100:103],a[56:59],v[28:31]
 v_mfma_f32_16x16x32_bf16 v[36:39],a[100:103],a[72:75],v[36:39]
 v_mfma_f32_16x16x32_bf16 v[0:3],a[104:107],a[12:15],v[0:3]
 v_mfma_f32_16x16x32_bf16 v[8:11],a[104:107],a[28:31],v[8:11]
 v_mfma_f32_16x16x32_bf16 v[16:19],a[104:107],a[44:47],v[16:19]
 v_mfma_f32_16x16x32_bf16 v[24:27],a[104:107],a[60:63],v[24:27]
 v_mfma_f32_16x16x32_bf16 v[32:35],a[104:107],a[76:79],v[32:35]
 v_mfma_f32_16x16x32_bf16 v[4:7],a[108:111],a[12:15],v[4:7]
 v_mfma_f32_16x16x32_bf16 v[12:15],a[108:111],a[28:31],v[12:15]
 v_mfma_f32_16x16x32_bf16 v[20:23],a[108:111],a[44:47],v[20:23]
 v_mfma_f32_16x16x32_bf16 v[28:31],a[108:111],a[60:63],v[28:31]
 v_mfma_f32_16x16x32_bf16 v[36:39],a[108:111],a[76:79],v[36:39]
 s_waitcnt lgkmcnt(0)
 v_mfma_f32_16x16x32_bf16 v[0:3],a[80:83],a[144:147],v[0:3]
 v_mfma_f32_16x16x32_bf16 v[8:11],a[80:83],a[160:163],v[8:11]
 s_waitcnt vmcnt(11)
 s_barrier
 v_mfma_f32_16x16x32_bf16 v[16:19],a[80:83],a[176:179],v[16:19]
 ds_read_b64_tr_b16 a[96:97],v80 offset:49152
 ds_read_b64_tr_b16 a[98:99],v80 offset:53248
 v_mfma_f32_16x16x32_bf16 v[24:27],a[80:83],a[192:195],v[24:27]
 ds_read_b64_tr_b16 a[100:101],v81 offset:49152
 ds_read_b64_tr_b16 a[102:103],v81 offset:53248
 v_mfma_f32_16x16x32_bf16 v[32:35],a[80:83],a[208:211],v[32:35]
 ds_read_b64_tr_b16 a[104:105],v80 offset:57344
 ds_read_b64_tr_b16 a[106:107],v80 offset:61440
 v_mfma_f32_16x16x32_bf16 v[4:7],a[84:87],a[144:147],v[4:7]
 ds_read_b64_tr_b16 a[108:109],v81 offset:57344
 ds_read_b64_tr_b16 a[110:111],v81 offset:61440
 v_mfma_f32_16x16x32_bf16 v[12:15],a[84:87],a[160:163],v[12:15]
 v_mfma_f32_16x16x32_bf16 v[20:23],a[84:87],a[176:179],v[20:23]
 v_mfma_f32_16x16x32_bf16 v[28:31],a[84:87],a[192:195],v[28:31]
 v_mfma_f32_16x16x32_bf16 v[36:39],a[84:87],a[208:211],v[36:39]
 v_mfma_f32_16x16x32_bf16 v[0:3],a[88:91],a[148:151],v[0:3]
 v_mfma_f32_16x16x32_bf16 v[8:11],a[88:91],a[164:167],v[8:11]
 v_mfma_f32_16x16x32_bf16 v[16:19],a[88:91],a[180:183],v[16:19]
 v_mfma_f32_16x16x32_bf16 v[24:27],a[88:91],a[196:199],v[24:27]
 v_mfma_f32_16x16x32_bf16 v[32:35],a[88:91],a[212:215],v[32:35]
 v_mfma_f32_16x16x32_bf16 v[4:7],a[92:95],a[148:151],v[4:7]
 v_mfma_f32_16x16x32_bf16 v[12:15],a[92:95],a[164:167],v[12:15]
 v_mfma_f32_16x16x32_bf16 v[20:23],a[92:95],a[180:183],v[20:23]
 v_mfma_f32_16x16x32_bf16 v[28:31],a[92:95],a[196:199],v[28:31]
 v_mfma_f32_16x16x32_bf16 v[36:39],a[92:95],a[212:215],v[36:39]
 s_waitcnt lgkmcnt(0)
 v_mfma_f32_16x16x32_bf16 v[0:3],a[96:99],a[152:155],v[0:3]
 v_mfma_f32_16x16x32_bf16 v[8:11],a[96:99],a[168:171],v[8:11]
 v_mfma_f32_16x16x32_bf16 v[16:19],a[96:99],a[184:187],v[16:19]
 ds_read_b64_tr_b16 a[80:81],v86 offset:49152
 ds_read_b64_tr_b16 a[82:83],v86 offset:53248
 v_mfma_f32_16x16x32_bf16 v[24:27],a[96:99],a[200:203],v[24:27]
 ds_read_b64_tr_b16 a[84:85],v87 offset:49152
 ds_read_b64_tr_b16 a[86:87],v87 offset:53248
 v_mfma_f32_16x16x32_bf16 v[32:35],a[96:99],a[216:219],v[32:35]
 ds_read_b64_tr_b16 a[88:89],v86 offset:57344
 ds_read_b64_tr_b16 a[90:91],v86 offset:61440
 v_mfma_f32_16x16x32_bf16 v[4:7],a[100:103],a[152:155],v[4:7]
 ds_read_b64_tr_b16 a[92:93],v87 offset:57344
 ds_read_b64_tr_b16 a[94:95],v87 offset:61440
 v_mfma_f32_16x16x32_bf16 v[12:15],a[100:103],a[168:171],v[12:15]
 v_mfma_f32_16x16x32_bf16 v[20:23],a[100:103],a[184:187],v[20:23]
 v_mfma_f32_16x16x32_bf16 v[28:31],a[100:103],a[200:203],v[28:31]
 v_mfma_f32_16x16x32_bf16 v[36:39],a[100:103],a[216:219],v[36:39]
 v_mfma_f32_16x16x32_bf16 v[0:3],a[104:107],a[156:159],v[0:3]
 v_mfma_f32_16x16x32_bf16 v[8:11],a[104:107],a[172:175],v[8:11]
 v_mfma_f32_16x16x32_bf16 v[16:19],a[104:107],a[188:191],v[16:19]
 v_mfma_f32_16x16x32_bf16 v[24:27],a[104:107],a[204:207],v[24:27]
 v_mfma_f32_16x16x32_bf16 v[32:35],a[104:107],a[220:223],v[32:35]
 v_mfma_f32_16x16x32_bf16 v[4:7],a[108:111],a[156:159],v[4:7]
 v_mfma_f32_16x16x32_bf16 v[12:15],a[108:111],a[172:175],v[12:15]
 v_mfma_f32_16x16x32_bf16 v[20:23],a[108:111],a[188:191],v[20:23]
 v_mfma_f32_16x16x32_bf16 v[28:31],a[108:111],a[204:207],v[28:31]
 v_mfma_f32_16x16x32_bf16 v[36:39],a[108:111],a[220:223],v[36:39]
 s_waitcnt lgkmcnt(0)
 v_mfma_f32_16x16x32_bf16 v[40:43],a[80:83],a[0:3],0
 v_mfma_f32_16x16x32_bf16 v[48:51],a[80:83],a[16:19],0
 v_mfma_f32_16x16x32_bf16 v[56:59],a[80:83],a[32:35],0
 ds_read_b64_tr_b16 a[96:97],v82 offset:16384
 ds_read_b64_tr_b16 a[98:99],v82 offset:20480
 v_mfma_f32_16x16x32_bf16 v[64:67],a[80:83],a[48:51],0
 ds_read_b64_tr_b16 a[100:101],v83 offset:16384
 ds_read_b64_tr_b16 a[102:103],v83 offset:20480
 v_mfma_f32_16x16x32_bf16 v[72:75],a[80:83],a[64:67],0
 ds_read_b64_tr_b16 a[104:105],v82 offset:24576
 ds_read_b64_tr_b16 a[106:107],v82 offset:28672
 v_mfma_f32_16x16x32_bf16 v[44:47],a[84:87],a[0:3],0
 ds_read_b64_tr_b16 a[108:109],v83 offset:24576
 ds_read_b64_tr_b16 a[110:111],v83 offset:28672
 v_mfma_f32_16x16x32_bf16 v[52:55],a[84:87],a[16:19],0
 v_cvt_pk_bf16_f32 v0,v0,v1
 v_cvt_pk_bf16_f32 v1,v2,v3
 v_mfma_f32_16x16x32_bf16 v[60:63],a[84:87],a[32:35],0
 v_cvt_pk_bf16_f32 v2,v4,v5
 v_cvt_pk_bf16_f32 v3,v6,v7
 v_mfma_f32_16x16x32_bf16 v[68:71],a[84:87],a[48:51],0
 s_add_u32 s58,s51,0x0
 buffer_store_dwordx4 v[0:3],v88,s[28:31],s58 offen sc1
 v_mfma_f32_16x16x32_bf16 v[76:79],a[84:87],a[64:67],0
 v_cvt_pk_bf16_f32 v8,v8,v9
 v_cvt_pk_bf16_f32 v9,v10,v11
 v_mfma_f32_16x16x32_bf16 v[40:43],a[88:91],a[4:7],v[40:43]
 v_cvt_pk_bf16_f32 v10,v12,v13
 v_cvt_pk_bf16_f32 v11,v14,v15
 v_mfma_f32_16x16x32_bf16 v[48:51],a[88:91],a[20:23],v[48:51]
 s_add_u32 s58,s51,0x400
 buffer_store_dwordx4 v[8:11],v88,s[28:31],s58 offen sc1
 v_mfma_f32_16x16x32_bf16 v[56:59],a[88:91],a[36:39],v[56:59]
 v_cvt_pk_bf16_f32 v16,v16,v17
 v_cvt_pk_bf16_f32 v17,v18,v19
 v_mfma_f32_16x16x32_bf16 v[64:67],a[88:91],a[52:55],v[64:67]
 v_cvt_pk_bf16_f32 v18,v20,v21
 v_cvt_pk_bf16_f32 v19,v22,v23
 v_mfma_f32_16x16x32_bf16 v[72:75],a[88:91],a[68:71],v[72:75]
 s_add_u32 s58,s51,0x800
 buffer_store_dwordx4 v[16:19],v88,s[28:31],s58 offen sc1
 v_mfma_f32_16x16x32_bf16 v[44:47],a[92:95],a[4:7],v[44:47]
 v_cvt_pk_bf16_f32 v24,v24,v25
 v_cvt_pk_bf16_f32 v25,v26,v27
 v_mfma_f32_16x16x32_bf16 v[52:55],a[92:95],a[20:23],v[52:55]
 v_cvt_pk_bf16_f32 v26,v28,v29
 v_cvt_pk_bf16_f32 v27,v30,v31
 v_mfma_f32_16x16x32_bf16 v[60:63],a[92:95],a[36:39],v[60:63]
 s_add_u32 s58,s51,0xc00
 buffer_store_dwordx4 v[24:27],v88,s[28:31],s58 offen sc1
 v_mfma_f32_16x16x32_bf16 v[68:71],a[92:95],a[52:55],v[68:71]
 v_cvt_pk_bf16_f32 v32,v32,v33
 v_cvt_pk_bf16_f32 v33,v34,v35
 v_mfma_f32_16x16x32_bf16 v[76:79],a[92:95],a[68:71],v[76:79]
 v_cvt_pk_bf16_f32 v34,v36,v37
 v_cvt_pk_bf16_f32 v35,v38,v39
 s_waitcnt lgkmcnt(0)
 v_mfma_f32_16x16x32_bf16 v[40:43],a[96:99],a[8:11],v[40:43]
 s_add_u32 s58,s51,0x1000
 buffer_store_dwordx4 v[32:35],v88,s[28:31],s58 offen sc1
 v_mfma_f32_16x16x32_bf16 v[48:51],a[96:99],a[24:27],v[48:51]
 v_mfma_f32_16x16x32_bf16 v[56:59],a[96:99],a[40:43],v[56:59]
 ds_read_b64_tr_b16 a[80:81],v82 offset:32768
 ds_read_b64_tr_b16 a[82:83],v82 offset:36864
 v_mfma_f32_16x16x32_bf16 v[64:67],a[96:99],a[56:59],v[64:67]
 ds_read_b64_tr_b16 a[84:85],v83 offset:32768
 ds_read_b64_tr_b16 a[86:87],v83 offset:36864
 v_mfma_f32_16x16x32_bf16 v[72:75],a[96:99],a[72:75],v[72:75]
 ds_read_b64_tr_b16 a[88:89],v82 offset:40960
 ds_read_b64_tr_b16 a[90:91],v82 offset:45056
 v_mfma_f32_16x16x32_bf16 v[44:47],a[100:103],a[8:11],v[44:47]
 ds_read_b64_tr_b16 a[92:93],v83 offset:40960
 ds_read_b64_tr_b16 a[94:95],v83 offset:45056
 v_mfma_f32_16x16x32_bf16 v[52:55],a[100:103],a[24:27],v[52:55]
 v_mfma_f32_16x16x32_bf16 v[60:63],a[100:103],a[40:43],v[60:63]
 v_mfma_f32_16x16x32_bf16 v[68:71],a[100:103],a[56:59],v[68:71]
 v_mfma_f32_16x16x32_bf16 v[76:79],a[100:103],a[72:75],v[76:79]
 v_mfma_f32_16x16x32_bf16 v[40:43],a[104:107],a[12:15],v[40:43]
 v_mfma_f32_16x16x32_bf16 v[48:51],a[104:107],a[28:31],v[48:51]
 v_mfma_f32_16x16x32_bf16 v[56:59],a[104:107],a[44:47],v[56:59]
 v_mfma_f32_16x16x32_bf16 v[64:67],a[104:107],a[60:63],v[64:67]
 v_mfma_f32_16x16x32_bf16 v[72:75],a[104:107],a[76:79],v[72:75]
 v_mfma_f32_16x16x32_bf16 v[44:47],a[108:111],a[12:15],v[44:47]
 v_mfma_f32_16x16x32_bf16 v[52:55],a[108:111],a[28:31],v[52:55]
 v_mfma_f32_16x16x32_bf16 v[60:63],a[108:111],a[44:47],v[60:63]
 v_mfma_f32_16x16x32_bf16 v[68:71],a[108:111],a[60:63],v[68:71]
 v_mfma_f32_16x16x32_bf16 v[76:79],a[108:111],a[76:79],v[76:79]
 s_waitcnt lgkmcnt(0)
 v_mfma_f32_16x16x32_bf16 v[40:43],a[80:83],a[144:147],v[40:43]
 buffer_load_dword v227,v226,s[72:75],0 offen sc1
 v_mfma_f32_16x16x32_bf16 v[48:51],a[80:83],a[160:163],v[48:51]
 v_mfma_f32_16x16x32_bf16 v[56:59],a[80:83],a[176:179],v[56:59]
 ds_read_b64_tr_b16 a[96:97],v82 offset:49152
 ds_read_b64_tr_b16 a[98:99],v82 offset:53248
 v_mfma_f32_16x16x32_bf16 v[64:67],a[80:83],a[192:195],v[64:67]
 ds_read_b64_tr_b16 a[100:101],v83 offset:49152
 ds_read_b64_tr_b16 a[102:103],v83 offset:53248
 v_mfma_f32_16x16x32_bf16 v[72:75],a[80:83],a[208:211],v[72:75]
 ds_read_b64_tr_b16 a[104:105],v82 offset:57344
 ds_read_b64_tr_b16 a[106:107],v82 offset:61440
 v_mfma_f32_16x16x32_bf16 v[44:47],a[84:87],a[144:147],v[44:47]
 ds_read_b64_tr_b16 a[108:109],v83 offset:57344
 ds_read_b64_tr_b16 a[110:111],v83 offset:61440
 v_mfma_f32_16x16x32_bf16 v[52:55],a[84:87],a[160:163],v[52:55]
 v_mfma_f32_16x16x32_bf16 v[60:63],a[84:87],a[176:179],v[60:63]
 v_mfma_f32_16x16x32_bf16 v[68:71],a[84:87],a[192:195],v[68:71]
 v_mfma_f32_16x16x32_bf16 v[76:79],a[84:87],a[208:211],v[76:79]
 v_mfma_f32_16x16x32_bf16 v[40:43],a[88:91],a[148:151],v[40:43]
 v_mfma_f32_16x16x32_bf16 v[48:51],a[88:91],a[164:167],v[48:51]
 v_mfma_f32_16x16x32_bf16 v[56:59],a[88:91],a[180:183],v[56:59]
 v_mfma_f32_16x16x32_bf16 v[64:67],a[88:91],a[196:199],v[64:67]
 v_mfma_f32_16x16x32_bf16 v[72:75],a[88:91],a[212:215],v[72:75]
 v_mfma_f32_16x16x32_bf16 v[44:47],a[92:95],a[148:151],v[44:47]
 v_mfma_f32_16x16x32_bf16 v[52:55],a[92:95],a[164:167],v[52:55]
 v_mfma_f32_16x16x32_bf16 v[60:63],a[92:95],a[180:183],v[60:63]
 v_mfma_f32_16x16x32_bf16 v[68:71],a[92:95],a[196:199],v[68:71]
 v_mfma_f32_16x16x32_bf16 v[76:79],a[92:95],a[212:215],v[76:79]
 s_waitcnt lgkmcnt(0)
 v_mfma_f32_16x16x32_bf16 v[40:43],a[96:99],a[152:155],v[40:43]
 v_mfma_f32_16x16x32_bf16 v[48:51],a[96:99],a[168:171],v[48:51]
 v_mfma_f32_16x16x32_bf16 v[56:59],a[96:99],a[184:187],v[56:59]
 v_mfma_f32_16x16x32_bf16 v[64:67],a[96:99],a[200:203],v[64:67]
 v_mfma_f32_16x16x32_bf16 v[72:75],a[96:99],a[216:219],v[72:75]
 v_mfma_f32_16x16x32_bf16 v[44:47],a[100:103],a[152:155],v[44:47]
 v_mfma_f32_16x16x32_bf16 v[52:55],a[100:103],a[168:171],v[52:55]
 v_mfma_f32_16x16x32_bf16 v[60:63],a[100:103],a[184:187],v[60:63]
 v_mfma_f32_16x16x32_bf16 v[68:71],a[100:103],a[200:203],v[68:71]
 v_mfma_f32_16x16x32_bf16 v[76:79],a[100:103],a[216:219],v[76:79]
 v_mfma_f32_16x16x32_bf16 v[40:43],a[104:107],a[156:159],v[40:43]
 v_mfma_f32_16x16x32_bf16 v[48:51],a[104:107],a[172:175],v[48:51]
 v_mfma_f32_16x16x32_bf16 v[56:59],a[104:107],a[188:191],v[56:59]
 v_mfma_f32_16x16x32_bf16 v[64:67],a[104:107],a[204:207],v[64:67]
 v_mfma_f32_16x16x32_bf16 v[72:75],a[104:107],a[220:223],v[72:75]
 v_mfma_f32_16x16x32_bf16 v[44:47],a[108:111],a[156:159],v[44:47]
 v_mfma_f32_16x16x32_bf16 v[52:55],a[108:111],a[172:175],v[52:55]
 v_mfma_f32_16x16x32_bf16 v[60:63],a[108:111],a[188:191],v[60:63]
 v_mfma_f32_16x16x32_bf16 v[68:71],a[108:111],a[204:207],v[68:71]
 v_mfma_f32_16x16x32_bf16 v[76:79],a[108:111],a[220:223],v[76:79]
 s_nop 3
 v_cvt_pk_bf16_f32 v40,v40,v41
 v_cvt_pk_bf16_f32 v41,v42,v43
 v_cvt_pk_bf16_f32 v42,v44,v45
 v_cvt_pk_bf16_f32 v43,v46,v47
 s_add_u32 s58,s51,0x2800
 buffer_store_dwordx4 v[40:43],v88,s[28:31],s58 offen sc1
 v_cvt_pk_bf16_f32 v48,v48,v49
 v_cvt_pk_bf16_f32 v49,v50,v51
 v_cvt_pk_bf16_f32 v50,v52,v53
 v_cvt_pk_bf16_f32 v51,v54,v55
 s_add_u32 s58,s51,0x2c00
 buffer_store_dwordx4 v[48:51],v88,s[28:31],s58 offen sc1
 v_cvt_pk_bf16_f32 v56,v56,v57
 v_cvt_pk_bf16_f32 v57,v58,v59
 v_cvt_pk_bf16_f32 v58,v60,v61
 v_cvt_pk_bf16_f32 v59,v62,v63
 s_add_u32 s58,s51,0x3000
 buffer_store_dwordx4 v[56:59],v88,s[28:31],s58 offen sc1
 v_cvt_pk_bf16_f32 v64,v64,v65
 v_cvt_pk_bf16_f32 v65,v66,v67
 v_cvt_pk_bf16_f32 v66,v68,v69
 v_cvt_pk_bf16_f32 v67,v70,v71
 s_add_u32 s58,s51,0x3400
 buffer_store_dwordx4 v[64:67],v88,s[28:31],s58 offen sc1
 v_cvt_pk_bf16_f32 v72,v72,v73
 v_cvt_pk_bf16_f32 v73,v74,v75
 v_cvt_pk_bf16_f32 v74,v76,v77
 v_cvt_pk_bf16_f32 v75,v78,v79
 s_add_u32 s58,s51,0x3800
 buffer_store_dwordx4 v[72:75],v88,s[28:31],s58 offen sc1
 s_mov_b32 s7,0
 v_mov_b32 v114,3
 buffer_atomic_add v114,v113,s[72:75],0 offen sc0
 s_waitcnt vmcnt(1)
 v_mov_b32 v89,4
 buffer_store_dword v89,v137,s[72:75],0 offen sc1
 s_waitcnt vmcnt(1)
 v_readfirstlane_b32 s13,v114
 s_add_u32 s14,s13,1
 s_cmp_ge_u32 s13,320
 s_cbranch_scc1 L_end
 s_mul_i32 s15,s13,52429
 s_lshr_b32 s15,s15,22
 s_add_u32 s15,s15,1
 v_cmp_gt_u32 vcc,s15,v227
 s_cbranch_vccnz L_spinP
L_gotP:
 s_sub_u32 s3,s15,1
 s_mul_i32 s36,s3,80
 s_sub_u32 s36,s13,s36
 s_add_u32 s3,s3,s39
 s_and_b32 s3,s3,3
 s_bfe_u32 s62,s36,0x10001
 s_lshl_b32 s62,s62,2
 s_add_u32 s3,s3,s62
 s_lshl_b32 s3,s3,1
 s_and_b32 s62,s36,1
 s_add_u32 s3,s3,s62
 s_lshr_b32 s36,s36,2
 s_lshl_b32 s62,s3,6
 s_lshl_b32 s63,s36,14
 s_add_u32 s62,s62,s63
 s_add_u32 s62,s62,s12
 v_add_u32 v116,s62,v112
 s_mul_i32 s3,s3,10
 s_lshr_b32 s62,s36,1
 s_add_u32 s3,s3,s62
 s_lshl_b32 s3,s3,10
 s_and_b32 s36,s36,1
 s_lshl_b32 s36,s36,7
 s_add_u32 s3,s3,s36
 v_add_u32 v224,s3,v111
 s_mov_b32 s58,0x0
 buffer_load_dwordx4 v[144:147],v224,s[96:99],s58 offen sc1
 s_mov_b32 s58,0x54000
 buffer_load_dwordx4 v[148:151],v224,s[96:99],s58 offen sc1
 s_mov_b32 s58,0xa8000
 buffer_load_dwordx4 v[152:155],v224,s[96:99],s58 offen sc1
 s_mov_b32 s58,0xfc000
 buffer_load_dwordx4 v[156:159],v224,s[96:99],s58 offen sc1
 s_mov_b32 s58,0x150000
 buffer_load_dwordx4 v[160:163],v224,s[96:99],s58 offen sc1
 s_mov_b32 s58,0x1a4000
 buffer_load_dwordx4 v[164:167],v224,s[96:99],s58 offen sc1
 s_mov_b32 s58,0x1f8000
 buffer_load_dwordx4 v[168:171],v224,s[96:99],s58 offen sc1
 s_mov_b32 s58,0x24c000
 buffer_load_dwordx4 v[172:175],v224,s[96:99],s58 offen sc1
 s_cmp_ge_u32 s14,320
 s_cbranch_scc1 L_rlast0
 s_mul_i32 s15,s14,52429
 s_lshr_b32 s15,s15,22
 s_add_u32 s15,s15,1
 v_cmp_gt_u32 vcc,s15,v227
 s_cbranch_vccnz L_spinQ
L_gotQ:
 s_sub_u32 s3,s15,1
 s_mul_i32 s36,s3,80
 s_sub_u32 s36,s14,s36
 s_add_u32 s3,s3,s39
 s_and_b32 s3,s3,3
 s_bfe_u32 s62,s36,0x10001
 s_lshl_b32 s62,s62,2
 s_add_u32 s3,s3,s62
 s_lshl_b32 s3,s3,1
 s_and_b32 s62,s36,1
 s_add_u32 s3,s3,s62
 s_lshr_b32 s36,s36,2
 s_lshl_b32 s62,s3,6
 s_lshl_b32 s63,s36,14
 s_add_u32 s62,s62,s63
 s_add_u32 s62,s62,s12
 v_add_u32 v118,s62,v112
 s_mul_i32 s3,s3,10
 s_lshr_b32 s62,s36,1
 s_add_u32 s3,s3,s62
 s_lshl_b32 s3,s3,10
 s_and_b32 s36,s36,1
 s_lshl_b32 s36,s36,7
 s_add_u32 s3,s3,s36
 v_add_u32 v224,s3,v111
 s_mov_b32 s58,0x0
 buffer_load_dwordx4 v[184:187],v224,s[96:99],s58 offen sc1
 s_mov_b32 s58,0x54000
 buffer_load_dwordx4 v[188:191],v224,s[96:99],s58 offen sc1
 s_mov_b32 s58,0xa8000
 buffer_load_dwordx4 v[192:195],v224,s[96:99],s58 offen sc1
 s_mov_b32 s58,0xfc000
 buffer_load_dwordx4 v[196:199],v224,s[96:99],s58 offen sc1
 s_mov_b32 s58,0x150000
 buffer_load_dwordx4 v[200:203],v224,s[96:99],s58 offen sc1
 s_mov_b32 s58,0x1a4000
 buffer_load_dwordx4 v[204:207],v224,s[96:99],s58 offen sc1
 s_mov_b32 s58,0x1f8000
 buffer_load_dwordx4 v[208:211],v224,s[96:99],s58 offen sc1
 s_mov_b32 s58,0x24c000
 buffer_load_dwordx4 v[212:215],v224,s[96:99],s58 offen sc1
 s_add_u32 s14,s14,1
L_rb0:
 s_add_u32 s7,s7,1
 s_cmp_gt_u32 s7,400
 s_cbranch_scc1 L_rf0
 s_cmp_ge_u32 s14,320
 s_cbranch_scc1 L_rf0
 s_mul_i32 s15,s14,52429
 s_lshr_b32 s15,s15,22
 s_add_u32 s15,s15,1
 s_waitcnt vmcnt(9)
 v_cmp_gt_u32 vcc,s15,v227
 s_cbranch_vccnz L_spinB0
L_gotB0:
 s_sub_u32 s3,s15,1
 s_mul_i32 s36,s3,80
 s_sub_u32 s36,s14,s36
 s_add_u32 s3,s3,s39
 s_and_b32 s3,s3,3
 s_bfe_u32 s62,s36,0x10001
 s_lshl_b32 s62,s62,2
 s_add_u32 s3,s3,s62
 s_lshl_b32 s3,s3,1
 s_and_b32 s62,s36,1
 s_add_u32 s3,s3,s62
 s_lshr_b32 s36,s36,2
 s_lshl_b32 s62,s3,6
 s_lshl_b32 s63,s36,14
 s_add_u32 s62,s62,s63
 s_add_u32 s62,s62,s12
 v_add_u32 v90,s62,v112
 s_mul_i32 s3,s3,10
 s_lshr_b32 s62,s36,1
 s_add_u32 s3,s3,s62
 s_lshl_b32 s3,s3,10
 s_and_b32 s36,s36,1
 s_lshl_b32 s36,s36,7
 s_add_u32 s3,s3,s36
 v_add_u32 v224,s3,v111
 v_mov_b32 v114,1
 buffer_atomic_add v114,v113,s[72:75],0 offen sc0
 buffer_load_dword v227,v226,s[72:75],0 offen sc1
 s_mov_b32 s58,0x0
 buffer_load_dwordx4 v[0:3],v224,s[96:99],s58 offen sc1
 s_mov_b32 s58,0x54000
 buffer_load_dwordx4 v[4:7],v224,s[96:99],s58 offen sc1
 s_mov_b32 s58,0xa8000
 buffer_load_dwordx4 v[8:11],v224,s[96:99],s58 offen sc1
 s_mov_b32 s58,0xfc000
 buffer_load_dwordx4 v[12:15],v224,s[96:99],s58 offen sc1
 s_mov_b32 s58,0x150000
 buffer_load_dwordx4 v[16:19],v224,s[96:99],s58 offen sc1
 s_mov_b32 s58,0x1a4000
 buffer_load_dwordx4 v[20:23],v224,s[96:99],s58 offen sc1
 s_mov_b32 s58,0x1f8000
 buffer_load_dwordx4 v[24:27],v224,s[96:99],s58 offen sc1
 s_mov_b32 s58,0x24c000
 buffer_load_dwordx4 v[28:31],v224,s[96:99],s58 offen sc1
 s_waitcnt vmcnt(22)
 v_lshlrev_b32 v232,16,v144
 v_and_b32 v233,0xffff0000,v144
 v_lshlrev_b32 v234,16,v145
 v_and_b32 v235,0xffff0000,v145
 v_lshlrev_b32 v236,16,v146
 v_and_b32 v237,0xffff0000,v146
 v_lshlrev_b32 v238,16,v147
 v_and_b32 v239,0xffff0000,v147
 v_dot2c_f32_bf16 v232,v148,v228
 v_dot2c_f32_bf16 v233,v148,v229
 v_dot2c_f32_bf16 v234,v149,v228
 v_dot2c_f32_bf16 v235,v149,v229
 v_dot2c_f32_bf16 v236,v150,v228
 v_dot2c_f32_bf16 v237,v150,v229
 v_dot2c_f32_bf16 v238,v151,v228
 v_dot2c_f32_bf16 v239,v151,v229
 v_dot2c_f32_bf16 v232,v152,v228
 v_dot2c_f32_bf16 v233,v152,v229
 v_dot2c_f32_bf16 v234,v153,v228
 v_dot2c_f32_bf16 v235,v153,v229
 v_dot2c_f32_bf16 v236,v154,v228
 v_dot2c_f32_bf16 v237,v154,v229
 v_dot2c_f32_bf16 v238,v155,v228
 v_dot2c_f32_bf16 v239,v155,v229
 v_dot2c_f32_bf16 v232,v156,v228
 v_dot2c_f32_bf16 v233,v156,v229
 v_dot2c_f32_bf16 v234,v157,v228
 v_dot2c_f32_bf16 v235,v157,v229
 v_dot2c_f32_bf16 v236,v158,v228
 v_dot2c_f32_bf16 v237,v158,v229
 v_dot2c_f32_bf16 v238,v159,v228
 v_dot2c_f32_bf16 v239,v159,v229
 s_waitcnt vmcnt(18)
 v_dot2c_f32_bf16 v232,v160,v228
 v_dot2c_f32_bf16 v233,v160,v229
 v_dot2c_f32_bf16 v234,v161,v228
 v_dot2c_f32_bf16 v235,v161,v229
 v_dot2c_f32_bf16 v236,v162,v228
 v_dot2c_f32_bf16 v237,v162,v229
 v_dot2c_f32_bf16 v238,v163,v228
 v_dot2c_f32_bf16 v239,v163,v229
 v_dot2c_f32_bf16 v232,v164,v228
 v_dot2c_f32_bf16 v233,v164,v229
 v_dot2c_f32_bf16 v234,v165,v228
 v_dot2c_f32_bf16 v235,v165,v229
 v_dot2c_f32_bf16 v236,v166,v228
 v_dot2c_f32_bf16 v237,v166,v229
 v_dot2c_f32_bf16 v238,v167,v228
 v_dot2c_f32_bf16 v239,v167,v229
 v_dot2c_f32_bf16 v232,v168,v228
 v_dot2c_f32_bf16 v233,v168,v229
 v_dot2c_f32_bf16 v234,v169,v228
 v_dot2c_f32_bf16 v235,v169,v229
 v_dot2c_f32_bf16 v236,v170,v228
 v_dot2c_f32_bf16 v237,v170,v229
 v_dot2c_f32_bf16 v238,v171,v228
 v_dot2c_f32_bf16 v239,v171,v229
 v_dot2c_f32_bf16 v232,v172,v228
 v_dot2c_f32_bf16 v233,v172,v229
 v_dot2c_f32_bf16 v234,v173,v228
 v_dot2c_f32_bf16 v235,v173,v229
 v_dot2c_f32_bf16 v236,v174,v228
 v_dot2c_f32_bf16 v237,v174,v229
 v_dot2c_f32_bf16 v238,v175,v228
 v_dot2c_f32_bf16 v239,v175,v229
 s_nop 2
 v_permlane32_swap_b32 v232,v236
 v_permlane32_swap_b32 v233,v237
 v_permlane32_swap_b32 v234,v238
 v_permlane32_swap_b32 v235,v239
 v_add_f32 v232,v232,v236
 v_add_f32 v233,v233,v237
 v_add_f32 v234,v234,v238
 v_add_f32 v235,v235,v239
 v_cvt_pk_bf16_f32 v100,v232,v233
 v_cvt_pk_bf16_f32 v101,v234,v235
 buffer_store_dwordx2 v[100:101],v116,s[80:83],0 offen
 s_waitcnt vmcnt(10)
 v_readfirstlane_b32 s14,v114
L_rb1:
 s_add_u32 s7,s7,1
 s_cmp_gt_u32 s7,400
 s_cbranch_scc1 L_rf1
 s_cmp_ge_u32 s14,320
 s_cbranch_scc1 L_rf1
 s_mul_i32 s15,s14,52429
 s_lshr_b32 s15,s15,22
 s_add_u32 s15,s15,1
 s_waitcnt vmcnt(9)
 v_cmp_gt_u32 vcc,s15,v227
 s_cbranch_vccnz L_spinB1
L_gotB1:
 s_sub_u32 s3,s15,1
 s_mul_i32 s36,s3,80
 s_sub_u32 s36,s14,s36
 s_add_u32 s3,s3,s39
 s_and_b32 s3,s3,3
 s_bfe_u32 s62,s36,0x10001
 s_lshl_b32 s62,s62,2
 s_add_u32 s3,s3,s62
 s_lshl_b32 s3,s3,1
 s_and_b32 s62,s36,1
 s_add_u32 s3,s3,s62
 s_lshr_b32 s36,s36,2
 s_lshl_b32 s62,s3,6
 s_lshl_b32 s63,s36,14
 s_add_u32 s62,s62,s63
 s_add_u32 s62,s62,s12
 v_add_u32 v116,s62,v112
 s_mul_i32 s3,s3,10
 s_lshr_b32 s62,s36,1
 s_add_u32 s3,s3,s62
 s_lshl_b32 s3,s3,10
 s_and_b32 s36,s36,1
 s_lshl_b32 s36,s36,7
 s_add_u32 s3,s3,s36
 v_add_u32 v224,s3,v111
 v_mov_b32 v114,1
 buffer_atomic_add v114,v113,s[72:75],0 offen sc0
 buffer_load_dword v227,v226,s[72:75],0 offen sc1
 s_mov_b32 s58,0x0
 buffer_load_dwordx4 v[144:147],v224,s[96:99],s58 offen sc1
 s_mov_b32 s58,0x54000
 buffer_load_dwordx4 v[148:151],v224,s[96:99],s58 offen sc1
 s_mov_b32 s58,0xa8000
 buffer_load_dwordx4 v[152:155],v224,s[96:99],s58 offen sc1
 s_mov_b32 s58,0xfc000
 buffer_load_dwordx4 v[156:159],v224,s[96:99],s58 offen sc1
 s_mov_b32 s58,0x150000
 buffer_load_dwordx4 v[160:163],v224,s[96:99],s58 offen sc1
 s_mov_b32 s58,0x1a4000
 buffer_load_dwordx4 v[164:167],v224,s[96:99],s58 offen sc1
 s_mov_b32 s58,0x1f8000
 buffer_load_dwordx4 v[168:171],v224,s[96:99],s58 offen sc1
 s_mov_b32 s58,0x24c000
 buffer_load_dwordx4 v[172:175],v224,s[96:99],s58 offen sc1
 v_lshlrev_b32 v232,16,v184
 v_and_b32 v233,0xffff0000,v184
 v_lshlrev_b32 v234,16,v185
 v_and_b32 v235,0xffff0000,v185
 v_lshlrev_b32 v236,16,v186
 v_and_b32 v237,0xffff0000,v186
 v_lshlrev_b32 v238,16,v187
 v_and_b32 v239,0xffff0000,v187
 v_dot2c_f32_bf16 v232,v188,v228
 v_dot2c_f32_bf16 v233,v188,v229
 v_dot2c_f32_bf16 v234,v189,v228
 v_dot2c_f32_bf16 v235,v189,v229
 v_dot2c_f32_bf16 v236,v190,v228
 v_dot2c_f32_bf16 v237,v190,v229
 v_dot2c_f32_bf16 v238,v191,v228
 v_dot2c_f32_bf16 v239,v191,v229
 v_dot2c_f32_bf16 v232,v192,v228
 v_dot2c_f32_bf16 v233,v192,v229
 v_dot2c_f32_bf16 v234,v193,v228
 v_dot2c_f32_bf16 v235,v193,v229
 v_dot2c_f32_bf16 v236,v194,v228
 v_dot2c_f32_bf16 v237,v194,v229
 v_dot2c_f32_bf16 v238,v195,v228
 v_dot2c_f32_bf16 v239,v195,v229
 v_dot2c_f32_bf16 v232,v196,v228
 v_dot2c_f32_bf16 v233,v196,v229
 v_dot2c_f32_bf16 v234,v197,v228
 v_dot2c_f32_bf16 v235,v197,v229
 v_dot2c_f32_bf16 v236,v198,v228
 v_dot2c_f32_bf16 v237,v198,v229
 v_dot2c_f32_bf16 v238,v199,v228
 v_dot2c_f32_bf16 v239,v199,v229
 v_dot2c_f32_bf16 v232,v200,v228
 v_dot2c_f32_bf16 v233,v200,v229
 v_dot2c_f32_bf16 v234,v201,v228
 v_dot2c_f32_bf16 v235,v201,v229
 v_dot2c_f32_bf16 v236,v202,v228
 v_dot2c_f32_bf16 v237,v202,v229
 v_dot2c_f32_bf16 v238,v203,v228
 v_dot2c_f32_bf16 v239,v203,v229
 v_dot2c_f32_bf16 v232,v204,v228
 v_dot2c_f32_bf16 v233,v204,v229
 v_dot2c_f32_bf16 v234,v205,v228
 v_dot2c_f32_bf16 v235,v205,v229
 v_dot2c_f32_bf16 v236,v206,v228
 v_dot2c_f32_bf16 v237,v206,v229
 v_dot2c_f32_bf16 v238,v207,v228
 v_dot2c_f32_bf16 v239,v207,v229
 v_dot2c_f32_bf16 v232,v208,v228
 v_dot2c_f32_bf16 v233,v208,v229
 v_dot2c_f32_bf16 v234,v209,v228
 v_dot2c_f32_bf16 v235,v209,v229
 v_dot2c_f32_bf16 v236,v210,v228
 v_dot2c_f32_bf16 v237,v210,v229
 v_dot2c_f32_bf16 v238,v211,v228
 v_dot2c_f32_bf16 v239,v211,v229
 v_dot2c_f32_bf16 v232,v212,v228
 v_dot2c_f32_bf16 v233,v212,v229
 v_dot2c_f32_bf16 v234,v213,v228
 v_dot2c_f32_bf16 v235,v213,v229
 v_dot2c_f32_bf16 v236,v214,v228
 v_dot2c_f32_bf16 v237,v214,v229
 v_dot2c_f32_bf16 v238,v215,v228
 v_dot2c_f32_bf16 v239,v215,v229
 s_nop 2
 v_permlane32_swap_b32 v232,v236
 v_permlane32_swap_b32 v233,v237
 v_permlane32_swap_b32 v234,v238
 v_permlane32_swap_b32 v235,v239
 v_add_f32 v232,v232,v236
 v_add_f32 v233,v233,v237
 v_add_f32 v234,v234,v238
 v_add_f32 v235,v235,v239
 v_cvt_pk_bf16_f32 v104,v232,v233
 v_cvt_pk_bf16_f32 v105,v234,v235
 buffer_store_dwordx2 v[104:105],v118,s[80:83],0 offen
 s_waitcnt vmcnt(10)
 v_readfirstlane_b32 s14,v114
L_rb2:
 s_add_u32 s7,s7,1
 s_cmp_gt_u32 s7,400
 s_cbranch_scc1 L_rf2
 s_cmp_ge_u32 s14,320
 s_cbranch_scc1 L_rf2
 s_mul_i32 s15,s14,52429
 s_lshr_b32 s15,s15,22
 s_add_u32 s15,s15,1
 s_waitcnt vmcnt(9)
 v_cmp_gt_u32 vcc,s15,v227
 s_cbranch_vccnz L_spinB2
L_gotB2:
 s_sub_u32 s3,s15,1
 s_mul_i32 s36,s3,80
 s_sub_u32 s36,s14,s36
 s_add_u32 s3,s3,s39
 s_and_b32 s3,s3,3
 s_bfe_u32 s62,s36,0x10001
 s_lshl_b32 s62,s62,2
 s_add_u32 s3,s3,s62
 s_lshl_b32 s3,s3,1
 s_and_b32 s62,s36,1
 s_add_u32 s3,s3,s62
 s_lshr_b32 s36,s36,2
 s_lshl_b32 s62,s3,6
 s_lshl_b32 s63,s36,14
 s_add_u32 s62,s62,s63
 s_add_u32 s62,s62,s12
 v_add_u32 v118,s62,v112
 s_mul_i32 s3,s3,10
 s_lshr_b32 s62,s36,1
 s_add_u32 s3,s3,s62
 s_lshl_b32 s3,s3,10
 s_and_b32 s36,s36,1
 s_lshl_b32 s36,s36,7
 s_add_u32 s3,s3,s36
 v_add_u32 v224,s3,v111
 v_mov_b32 v114,1
 buffer_atomic_add v114,v113,s[72:75],0 offen sc0
 buffer_load_dword v227,v226,s[72:75],0 offen sc1
 s_mov_b32 s58,0x0
 buffer_load_dwordx4 v[184:187],v224,s[96:99],s58 offen sc1
 s_mov_b32 s58,0x54000
 buffer_load_dwordx4 v[188:191],v224,s[96:99],s58 offen sc1
 s_mov_b32 s58,0xa8000
 buffer_load_dwordx4 v[192:195],v224,s[96:99],s58 offen sc1
 s_mov_b32 s58,0xfc000
 buffer_load_dwordx4 v[196:199],v224,s[96:99],s58 offen sc1
 s_mov_b32 s58,0x150000
 buffer_load_dwordx4 v[200:203],v224,s[96:99],s58 offen sc1
 s_mov_b32 s58,0x1a4000
 buffer_load_dwordx4 v[204:207],v224,s[96:99],s58 offen sc1
 s_mov_b32 s58,0x1f8000
 buffer_load_dwordx4 v[208:211],v224,s[96:99],s58 offen sc1
 s_mov_b32 s58,0x24c000
 buffer_load_dwordx4 v[212:215],v224,s[96:99],s58 offen sc1
 v_lshlrev_b32 v232,16,v0
 v_and_b32 v233,0xffff0000,v0
 v_lshlrev_b32 v234,16,v1
 v_and_b32 v235,0xffff0000,v1
 v_lshlrev_b32 v236,16,v2
 v_and_b32 v237,0xffff0000,v2
 v_lshlrev_b32 v238,16,v3
 v_and_b32 v239,0xffff0000,v3
 v_dot2c_f32_bf16 v232,v4,v228
 v_dot2c_f32_bf16 v233,v4,v229
 v_dot2c_f32_bf16 v234,v5,v228
 v_dot2c_f32_bf16 v235,v5,v229
 v_dot2c_f32_bf16 v236,v6,v228
 v_dot2c_f32_bf16 v237,v6,v229
 v_dot2c_f32_bf16 v238,v7,v228
 v_dot2c_f32_bf16 v239,v7,v229
 v_dot2c_f32_bf16 v232,v8,v228
 v_dot2c_f32_bf16 v233,v8,v229
 v_dot2c_f32_bf16 v234,v9,v228
 v_dot2c_f32_bf16 v235,v9,v229
 v_dot2c_f32_bf16 v236,v10,v228
 v_dot2c_f32_bf16 v237,v10,v229
 v_dot2c_f32_bf16 v238,v11,v228
 v_dot2c_f32_bf16 v239,v11,v229
 v_dot2c_f32_bf16 v232,v12,v228
 v_dot2c_f32_bf16 v233,v12,v229
 v_dot2c_f32_bf16 v234,v13,v228
 v_dot2c_f32_bf16 v235,v13,v229
 v_dot2c_f32_bf16 v236,v14,v228
 v_dot2c_f32_bf16 v237,v14,v229
 v_dot2c_f32_bf16 v238,v15,v228
 v_dot2c_f32_bf16 v239,v15,v229
 v_dot2c_f32_bf16 v232,v16,v228
 v_dot2c_f32_bf16 v233,v16,v229
 v_dot2c_f32_bf16 v234,v17,v228
 v_dot2c_f32_bf16 v235,v17,v229
 v_dot2c_f32_bf16 v236,v18,v228
 v_dot2c_f32_bf16 v237,v18,v229
 v_dot2c_f32_bf16 v238,v19,v228
 v_dot2c_f32_bf16 v239,v19,v229
 v_dot2c_f32_bf16 v232,v20,v228
 v_dot2c_f32_bf16 v233,v20,v229
 v_dot2c_f32_bf16 v234,v21,v228
 v_dot2c_f32_bf16 v235,v21,v229
 v_dot2c_f32_bf16 v236,v22,v228
 v_dot2c_f32_bf16 v237,v22,v229
 v_dot2c_f32_bf16 v238,v23,v228
 v_dot2c_f32_bf16 v239,v23,v229
 v_dot2c_f32_bf16 v232,v24,v228
 v_dot2c_f32_bf16 v233,v24,v229
 v_dot2c_f32_bf16 v234,v25,v228
 v_dot2c_f32_bf16 v235,v25,v229
 v_dot2c_f32_bf16 v236,v26,v228
 v_dot2c_f32_bf16 v237,v26,v229
 v_dot2c_f32_bf16 v238,v27,v228
 v_dot2c_f32_bf16 v239,v27,v229
 v_dot2c_f32_bf16 v232,v28,v228
 v_dot2c_f32_bf16 v233,v28,v229
 v_dot2c_f32_bf16 v234,v29,v228
 v_dot2c_f32_bf16 v235,v29,v229
 v_dot2c_f32_bf16 v236,v30,v228
 v_dot2c_f32_bf16 v237,v30,v229
 v_dot2c_f32_bf16 v238,v31,v228
 v_dot2c_f32_bf16 v239,v31,v229
 s_nop 2
 v_permlane32_swap_b32 v232,v236
 v_permlane32_swap_b32 v233,v237
 v_permlane32_swap_b32 v234,v238
 v_permlane32_swap_b32 v235,v239
 v_add_f32 v232,v232,v236
 v_add_f32 v233,v233,v237
 v_add_f32 v234,v234,v238
 v_add_f32 v235,v235,v239
 v_cvt_pk_bf16_f32 v92,v232,v233
 v_cvt_pk_bf16_f32 v93,v234,v235
 buffer_store_dwordx2 v[92:93],v90,s[80:83],0 offen
 s_waitcnt vmcnt(10)
 v_readfirstlane_b32 s14,v114
 s_branch L_rb0
L_rf0:
 s_waitcnt vmcnt(12)
 v_lshlrev_b32 v232,16,v144
 v_and_b32 v233,0xffff0000,v144
 v_lshlrev_b32 v234,16,v145
 v_and_b32 v235,0xffff0000,v145
 v_lshlrev_b32 v236,16,v146
 v_and_b32 v237,0xffff0000,v146
 v_lshlrev_b32 v238,16,v147
 v_and_b32 v239,0xffff0000,v147
 v_dot2c_f32_bf16 v232,v148,v228
 v_dot2c_f32_bf16 v233,v148,v229
 v_dot2c_f32_bf16 v234,v149,v228
 v_dot2c_f32_bf16 v235,v149,v229
 v_dot2c_f32_bf16 v236,v150,v228
 v_dot2c_f32_bf16 v237,v150,v229
 v_dot2c_f32_bf16 v238,v151,v228
 v_dot2c_f32_bf16 v239,v151,v229
 v_dot2c_f32_bf16 v232,v152,v228
 v_dot2c_f32_bf16 v233,v152,v229
 v_dot2c_f32_bf16 v234,v153,v228
 v_dot2c_f32_bf16 v235,v153,v229
 v_dot2c_f32_bf16 v236,v154,v228
 v_dot2c_f32_bf16 v237,v154,v229
 v_dot2c_f32_bf16 v238,v155,v228
 v_dot2c_f32_bf16 v239,v155,v229
 v_dot2c_f32_bf16 v232,v156,v228
 v_dot2c_f32_bf16 v233,v156,v229
 v_dot2c_f32_bf16 v234,v157,v228
 v_dot2c_f32_bf16 v235,v157,v229
 v_dot2c_f32_bf16 v236,v158,v228
 v_dot2c_f32_bf16 v237,v158,v229
 v_dot2c_f32_bf16 v238,v159,v228
 v_dot2c_f32_bf16 v239,v159,v229
 s_waitcnt vmcnt(8)
 v_dot2c_f32_bf16 v232,v160,v228
 v_dot2c_f32_bf16 v233,v160,v229
 v_dot2c_f32_bf16 v234,v161,v228
 v_dot2c_f32_bf16 v235,v161,v229
 v_dot2c_f32_bf16 v236,v162,v228
 v_dot2c_f32_bf16 v237,v162,v229
 v_dot2c_f32_bf16 v238,v163,v228
 v_dot2c_f32_bf16 v239,v163,v229
 v_dot2c_f32_bf16 v232,v164,v228
 v_dot2c_f32_bf16 v233,v164,v229
 v_dot2c_f32_bf16 v234,v165,v228
 v_dot2c_f32_bf16 v235,v165,v229
 v_dot2c_f32_bf16 v236,v166,v228
 v_dot2c_f32_bf16 v237,v166,v229
 v_dot2c_f32_bf16 v238,v167,v228
 v_dot2c_f32_bf16 v239,v167,v229
 v_dot2c_f32_bf16 v232,v168,v228
 v_dot2c_f32_bf16 v233,v168,v229
 v_dot2c_f32_bf16 v234,v169,v228
 v_dot2c_f32_bf16 v235,v169,v229
 v_dot2c_f32_bf16 v236,v170,v228
 v_dot2c_f32_bf16 v237,v170,v229
 v_dot2c_f32_bf16 v238,v171,v228
 v_dot2c_f32_bf16 v239,v171,v229
 v_dot2c_f32_bf16 v232,v172,v228
 v_dot2c_f32_bf16 v233,v172,v229
 v_dot2c_f32_bf16 v234,v173,v228
 v_dot2c_f32_bf16 v235,v173,v229
 v_dot2c_f32_bf16 v236,v174,v228
 v_dot2c_f32_bf16 v237,v174,v229
 v_dot2c_f32_bf16 v238,v175,v228
 v_dot2c_f32_bf16 v239,v175,v229
 s_nop 2
 v_permlane32_swap_b32 v232,v236
 v_permlane32_swap_b32 v233,v237
 v_permlane32_swap_b32 v234,v238
 v_permlane32_swap_b32 v235,v239
 v_add_f32 v232,v232,v236
 v_add_f32 v233,v233,v237
 v_add_f32 v234,v234,v238
 v_add_f32 v235,v235,v239
 v_cvt_pk_bf16_f32 v100,v232,v233
 v_cvt_pk_bf16_f32 v101,v234,v235
 buffer_store_dwordx2 v[100:101],v116,s[80:83],0 offen
 s_waitcnt vmcnt(5)
 v_lshlrev_b32 v232,16,v184
 v_and_b32 v233,0xffff0000,v184
 v_lshlrev_b32 v234,16,v185
 v_and_b32 v235,0xffff0000,v185
 v_lshlrev_b32 v236,16,v186
 v_and_b32 v237,0xffff0000,v186
 v_lshlrev_b32 v238,16,v187
 v_and_b32 v239,0xffff0000,v187
 v_dot2c_f32_bf16 v232,v188,v228
 v_dot2c_f32_bf16 v233,v188,v229
 v_dot2c_f32_bf16 v234,v189,v228
 v_dot2c_f32_bf16 v235,v189,v229
 v_dot2c_f32_bf16 v236,v190,v228
 v_dot2c_f32_bf16 v237,v190,v229
 v_dot2c_f32_bf16 v238,v191,v228
 v_dot2c_f32_bf16 v239,v191,v229
 v_dot2c_f32_bf16 v232,v192,v228
 v_dot2c_f32_bf16 v233,v192,v229
 v_dot2c_f32_bf16 v234,v193,v228
 v_dot2c_f32_bf16 v235,v193,v229
 v_dot2c_f32_bf16 v236,v194,v228
 v_dot2c_f32_bf16 v237,v194,v229
 v_dot2c_f32_bf16 v238,v195,v228
 v_dot2c_f32_bf16 v239,v195,v229
 v_dot2c_f32_bf16 v232,v196,v228
 v_dot2c_f32_bf16 v233,v196,v229
 v_dot2c_f32_bf16 v234,v197,v228
 v_dot2c_f32_bf16 v235,v197,v229
 v_dot2c_f32_bf16 v236,v198,v228
 v_dot2c_f32_bf16 v237,v198,v229
 v_dot2c_f32_bf16 v238,v199,v228
 v_dot2c_f32_bf16 v239,v199,v229
 s_waitcnt vmcnt(1)
 v_dot2c_f32_bf16 v232,v200,v228
 v_dot2c_f32_bf16 v233,v200,v229
 v_dot2c_f32_bf16 v234,v201,v228
 v_dot2c_f32_bf16 v235,v201,v229
 v_dot2c_f32_bf16 v236,v202,v228
 v_dot2c_f32_bf16 v237,v202,v229
 v_dot2c_f32_bf16 v238,v203,v228
 v_dot2c_f32_bf16 v239,v203,v229
 v_dot2c_f32_bf16 v232,v204,v228
 v_dot2c_f32_bf16 v233,v204,v229
 v_dot2c_f32_bf16 v234,v205,v228
 v_dot2c_f32_bf16 v235,v205,v229
 v_dot2c_f32_bf16 v236,v206,v228
 v_dot2c_f32_bf16 v237,v206,v229
 v_dot2c_f32_bf16 v238,v207,v228
 v_dot2c_f32_bf16 v239,v207,v229
 v_dot2c_f32_bf16 v232,v208,v228
 v_dot2c_f32_bf16 v233,v208,v229
 v_dot2c_f32_bf16 v234,v209,v228
 v_dot2c_f32_bf16 v235,v209,v229
 v_dot2c_f32_bf16 v236,v210,v228
 v_dot2c_f32_bf16 v237,v210,v229
 v_dot2c_f32_bf16 v238,v211,v228
 v_dot2c_f32_bf16 v239,v211,v229
 v_dot2c_f32_bf16 v232,v212,v228
 v_dot2c_f32_bf16 v233,v212,v229
 v_dot2c_f32_bf16 v234,v213,v228
 v_dot2c_f32_bf16 v235,v213,v229
 v_dot2c_f32_bf16 v236,v214,v228
 v_dot2c_f32_bf16 v237,v214,v229
 v_dot2c_f32_bf16 v238,v215,v228
 v_dot2c_f32_bf16 v239,v215,v229
 s_nop 2
 v_permlane32_swap_b32 v232,v236
 v_permlane32_swap_b32 v233,v237
 v_permlane32_swap_b32 v234,v238
 v_permlane32_swap_b32 v235,v239
 v_add_f32 v232,v232,v236
 v_add_f32 v233,v233,v237
 v_add_f32 v234,v234,v238
 v_add_f32 v235,v235,v239
 v_cvt_pk_bf16_f32 v104,v232,v233
 v_cvt_pk_bf16_f32 v105,v234,v235
 buffer_store_dwordx2 v[104:105],v118,s[80:83],0 offen
 s_branch L_end
L_rf1:
 v_lshlrev_b32 v232,16,v184
 v_and_b32 v233,0xffff0000,v184
 v_lshlrev_b32 v234,16,v185
 v_and_b32 v235,0xffff0000,v185
 v_lshlrev_b32 v236,16,v186
 v_and_b32 v237,0xffff0000,v186
 v_lshlrev_b32 v238,16,v187
 v_and_b32 v239,0xffff0000,v187
 v_dot2c_f32_bf16 v232,v188,v228
 v_dot2c_f32_bf16 v233,v188,v229
 v_dot2c_f32_bf16 v234,v189,v228
 v_dot2c_f32_bf16 v235,v189,v229
 v_dot2c_f32_bf16 v236,v190,v228
 v_dot2c_f32_bf16 v237,v190,v229
 v_dot2c_f32_bf16 v238,v191,v228
 v_dot2c_f32_bf16 v239,v191,v229
 v_dot2c_f32_bf16 v232,v192,v228
 v_dot2c_f32_bf16 v233,v192,v229
 v_dot2c_f32_bf16 v234,v193,v228
 v_dot2c_f32_bf16 v235,v193,v229
 v_dot2c_f32_bf16 v236,v194,v228
 v_dot2c_f32_bf16 v237,v194,v229
 v_dot2c_f32_bf16 v238,v195,v228
 v_dot2c_f32_bf16 v239,v195,v229
 v_dot2c_f32_bf16 v232,v196,v228
 v_dot2c_f32_bf16 v233,v196,v229
 v_dot2c_f32_bf16 v234,v197,v228
 v_dot2c_f32_bf16 v235,v197,v229
 v_dot2c_f32_bf16 v236,v198,v228
 v_dot2c_f32_bf16 v237,v198,v229
 v_dot2c_f32_bf16 v238,v199,v228
 v_dot2c_f32_bf16 v239,v199,v229
 v_dot2c_f32_bf16 v232,v200,v228
 v_dot2c_f32_bf16 v233,v200,v229
 v_dot2c_f32_bf16 v234,v201,v228
 v_dot2c_f32_bf16 v235,v201,v229
 v_dot2c_f32_bf16 v236,v202,v228
 v_dot2c_f32_bf16 v237,v202,v229
 v_dot2c_f32_bf16 v238,v203,v228
 v_dot2c_f32_bf16 v239,v203,v229
 v_dot2c_f32_bf16 v232,v204,v228
 v_dot2c_f32_bf16 v233,v204,v229
 v_dot2c_f32_bf16 v234,v205,v228
 v_dot2c_f32_bf16 v235,v205,v229
 v_dot2c_f32_bf16 v236,v206,v228
 v_dot2c_f32_bf16 v237,v206,v229
 v_dot2c_f32_bf16 v238,v207,v228
 v_dot2c_f32_bf16 v239,v207,v229
 v_dot2c_f32_bf16 v232,v208,v228
 v_dot2c_f32_bf16 v233,v208,v229
 v_dot2c_f32_bf16 v234,v209,v228
 v_dot2c_f32_bf16 v235,v209,v229
 v_dot2c_f32_bf16 v236,v210,v228
 v_dot2c_f32_bf16 v237,v210,v229
 v_dot2c_f32_bf16 v238,v211,v228
 v_dot2c_f32_bf16 v239,v211,v229
 v_dot2c_f32_bf16 v232,v212,v228
 v_dot2c_f32_bf16 v233,v212,v229
 v_dot2c_f32_bf16 v234,v213,v228
 v_dot2c_f32_bf16 v235,v213,v229
 v_dot2c_f32_bf16 v236,v214,v228
 v_dot2c_f32_bf16 v237,v214,v229
 v_dot2c_f32_bf16 v238,v215,v228
 v_dot2c_f32_bf16 v239,v215,v229
 s_nop 2
 v_permlane32_swap_b32 v232,v236
 v_permlane32_swap_b32 v233,v237
 v_permlane32_swap_b32 v234,v238
 v_permlane32_swap_b32 v235,v239
 v_add_f32 v232,v232,v236
 v_add_f32 v233,v233,v237
 v_add_f32 v234,v234,v238
 v_add_f32 v235,v235,v239
 v_cvt_pk_bf16_f32 v104,v232,v233
 v_cvt_pk_bf16_f32 v105,v234,v235
 buffer_store_dwordx2 v[104:105],v118,s[80:83],0 offen
 s_waitcnt vmcnt(6)
 v_lshlrev_b32 v232,16,v0
 v_and_b32 v233,0xffff0000,v0
 v_lshlrev_b32 v234,16,v1
 v_and_b32 v235,0xffff0000,v1
 v_lshlrev_b32 v236,16,v2
 v_and_b32 v237,0xffff0000,v2
 v_lshlrev_b32 v238,16,v3
 v_and_b32 v239,0xffff0000,v3
 v_dot2c_f32_bf16 v232,v4,v228
 v_dot2c_f32_bf16 v233,v4,v229
 v_dot2c_f32_bf16 v234,v5,v228
 v_dot2c_f32_bf16 v235,v5,v229
 v_dot2c_f32_bf16 v236,v6,v228
 v_dot2c_f32_bf16 v237,v6,v229
 v_dot2c_f32_bf16 v238,v7,v228
 v_dot2c_f32_bf16 v239,v7,v229
 v_dot2c_f32_bf16 v232,v8,v228
 v_dot2c_f32_bf16 v233,v8,v229
 v_dot2c_f32_bf16 v234,v9,v228
 v_dot2c_f32_bf16 v235,v9,v229
 v_dot2c_f32_bf16 v236,v10,v228
 v_dot2c_f32_bf16 v237,v10,v229
 v_dot2c_f32_bf16 v238,v11,v228
 v_dot2c_f32_bf16 v239,v11,v229
 v_dot2c_f32_bf16 v232,v12,v228
 v_dot2c_f32_bf16 v233,v12,v229
 v_dot2c_f32_bf16 v234,v13,v228
 v_dot2c_f32_bf16 v235,v13,v229
 v_dot2c_f32_bf16 v236,v14,v228
 v_dot2c_f32_bf16 v237,v14,v229
 v_dot2c_f32_bf16 v238,v15,v228
 v_dot2c_f32_bf16 v239,v15,v229
 s_waitcnt vmcnt(2)
 v_dot2c_f32_bf16 v232,v16,v228
 v_dot2c_f32_bf16 v233,v16,v229
 v_dot2c_f32_bf16 v234,v17,v228
 v_dot2c_f32_bf16 v235,v17,v229
 v_dot2c_f32_bf16 v236,v18,v228
 v_dot2c_f32_bf16 v237,v18,v229
 v_dot2c_f32_bf16 v238,v19,v228
 v_dot2c_f32_bf16 v239,v19,v229
 v_dot2c_f32_bf16 v232,v20,v228
 v_dot2c_f32_bf16 v233,v20,v229
 v_dot2c_f32_bf16 v234,v21,v228
 v_dot2c_f32_bf16 v235,v21,v229
 v_dot2c_f32_bf16 v236,v22,v228
 v_dot2c_f32_bf16 v237,v22,v229
 v_dot2c_f32_bf16 v238,v23,v228
 v_dot2c_f32_bf16 v239,v23,v229
 v_dot2c_f32_bf16 v232,v24,v228
 v_dot2c_f32_bf16 v233,v24,v229
 v_dot2c_f32_bf16 v234,v25,v228
 v_dot2c_f32_bf16 v235,v25,v229
 v_dot2c_f32_bf16 v236,v26,v228
 v_dot2c_f32_bf16 v237,v26,v229
 v_dot2c_f32_bf16 v238,v27,v228
 v_dot2c_f32_bf16 v239,v27,v229
 v_dot2c_f32_bf16 v232,v28,v228
 v_dot2c_f32_bf16 v233,v28,v229
 v_dot2c_f32_bf16 v234,v29,v228
 v_dot2c_f32_bf16 v235,v29,v229
 v_dot2c_f32_bf16 v236,v30,v228
 v_dot2c_f32_bf16 v237,v30,v229
 v_dot2c_f32_bf16 v238,v31,v228
 v_dot2c_f32_bf16 v239,v31,v229
 s_nop 2
 v_permlane32_swap_b32 v232,v236
 v_permlane32_swap_b32 v233,v237
 v_permlane32_swap_b32 v234,v238
 v_permlane32_swap_b32 v235,v239
 v_add_f32 v232,v232,v236
 v_add_f32 v233,v233,v237
 v_add_f32 v234,v234,v238
 v_add_f32 v235,v235,v239
 v_cvt_pk_bf16_f32 v92,v232,v233
 v_cvt_pk_bf16_f32 v93,v234,v235
 buffer_store_dwordx2 v[92:93],v90,s[80:83],0 offen
 s_branch L_end
L_rf2:
 v_lshlrev_b32 v232,16,v0
 v_and_b32 v233,0xffff0000,v0
 v_lshlrev_b32 v234,16,v1
 v_and_b32 v235,0xffff0000,v1
 v_lshlrev_b32 v236,16,v2
 v_and_b32 v237,0xffff0000,v2
 v_lshlrev_b32 v238,16,v3
 v_and_b32 v239,0xffff0000,v3
 v_dot2c_f32_bf16 v232,v4,v228
 v_dot2c_f32_bf16 v233,v4,v229
 v_dot2c_f32_bf16 v234,v5,v228
 v_dot2c_f32_bf16 v235,v5,v229
 v_dot2c_f32_bf16 v236,v6,v228
 v_dot2c_f32_bf16 v237,v6,v229
 v_dot2c_f32_bf16 v238,v7,v228
 v_dot2c_f32_bf16 v239,v7,v229
 v_dot2c_f32_bf16 v232,v8,v228
 v_dot2c_f32_bf16 v233,v8,v229
 v_dot2c_f32_bf16 v234,v9,v228
 v_dot2c_f32_bf16 v235,v9,v229
 v_dot2c_f32_bf16 v236,v10,v228
 v_dot2c_f32_bf16 v237,v10,v229
 v_dot2c_f32_bf16 v238,v11,v228
 v_dot2c_f32_bf16 v239,v11,v229
 v_dot2c_f32_bf16 v232,v12,v228
 v_dot2c_f32_bf16 v233,v12,v229
 v_dot2c_f32_bf16 v234,v13,v228
 v_dot2c_f32_bf16 v235,v13,v229
 v_dot2c_f32_bf16 v236,v14,v228
 v_dot2c_f32_bf16 v237,v14,v229
 v_dot2c_f32_bf16 v238,v15,v228
 v_dot2c_f32_bf16 v239,v15,v229
 v_dot2c_f32_bf16 v232,v16,v228
 v_dot2c_f32_bf16 v233,v16,v229
 v_dot2c_f32_bf16 v234,v17,v228
 v_dot2c_f32_bf16 v235,v17,v229
 v_dot2c_f32_bf16 v236,v18,v228
 v_dot2c_f32_bf16 v237,v18,v229
 v_dot2c_f32_bf16 v238,v19,v228
 v_dot2c_f32_bf16 v239,v19,v229
 v_dot2c_f32_bf16 v232,v20,v228
 v_dot2c_f32_bf16 v233,v20,v229
 v_dot2c_f32_bf16 v234,v21,v228
 v_dot2c_f32_bf16 v235,v21,v229
 v_dot2c_f32_bf16 v236,v22,v228
 v_dot2c_f32_bf16 v237,v22,v229
 v_dot2c_f32_bf16 v238,v23,v228
 v_dot2c_f32_bf16 v239,v23,v229
 v_dot2c_f32_bf16 v232,v24,v228
 v_dot2c_f32_bf16 v233,v24,v229
 v_dot2c_f32_bf16 v234,v25,v228
 v_dot2c_f32_bf16 v235,v25,v229
 v_dot2c_f32_bf16 v236,v26,v228
 v_dot2c_f32_bf16 v237,v26,v229
 v_dot2c_f32_bf16 v238,v27,v228
 v_dot2c_f32_bf16 v239,v27,v229
 v_dot2c_f32_bf16 v232,v28,v228
 v_dot2c_f32_bf16 v233,v28,v229
 v_dot2c_f32_bf16 v234,v29,v228
 v_dot2c_f32_bf16 v235,v29,v229
 v_dot2c_f32_bf16 v236,v30,v228
 v_dot2c_f32_bf16 v237,v30,v229
 v_dot2c_f32_bf16 v238,v31,v228
 v_dot2c_f32_bf16 v239,v31,v229
 s_nop 2
 v_permlane32_swap_b32 v232,v236
 v_permlane32_swap_b32 v233,v237
 v_permlane32_swap_b32 v234,v238
 v_permlane32_swap_b32 v235,v239
 v_add_f32 v232,v232,v236
 v_add_f32 v233,v233,v237
 v_add_f32 v234,v234,v238
 v_add_f32 v235,v235,v239
 v_cvt_pk_bf16_f32 v92,v232,v233
 v_cvt_pk_bf16_f32 v93,v234,v235
 buffer_store_dwordx2 v[92:93],v90,s[80:83],0 offen
L_rlast0:
 s_waitcnt vmcnt(4)
 v_lshlrev_b32 v232,16,v144
 v_and_b32 v233,0xffff0000,v144
 v_lshlrev_b32 v234,16,v145
 v_and_b32 v235,0xffff0000,v145
 v_lshlrev_b32 v236,16,v146
 v_and_b32 v237,0xffff0000,v146
 v_lshlrev_b32 v238,16,v147
 v_and_b32 v239,0xffff0000,v147
 v_dot2c_f32_bf16 v232,v148,v228
 v_dot2c_f32_bf16 v233,v148,v229
 v_dot2c_f32_bf16 v234,v149,v228
 v_dot2c_f32_bf16 v235,v149,v229
 v_dot2c_f32_bf16 v236,v150,v228
 v_dot2c_f32_bf16 v237,v150,v229
 v_dot2c_f32_bf16 v238,v151,v228
 v_dot2c_f32_bf16 v239,v151,v229
 v_dot2c_f32_bf16 v232,v152,v228
 v_dot2c_f32_bf16 v233,v152,v229
 v_dot2c_f32_bf16 v234,v153,v228
 v_dot2c_f32_bf16 v235,v153,v229
 v_dot2c_f32_bf16 v236,v154,v228
 v_dot2c_f32_bf16 v237,v154,v229
 v_dot2c_f32_bf16 v238,v155,v228
 v_dot2c_f32_bf16 v239,v155,v229
 v_dot2c_f32_bf16 v232,v156,v228
 v_dot2c_f32_bf16 v233,v156,v229
 v_dot2c_f32_bf16 v234,v157,v228
 v_dot2c_f32_bf16 v235,v157,v229
 v_dot2c_f32_bf16 v236,v158,v228
 v_dot2c_f32_bf16 v237,v158,v229
 v_dot2c_f32_bf16 v238,v159,v228
 v_dot2c_f32_bf16 v239,v159,v229
 s_waitcnt vmcnt(0)
 v_dot2c_f32_bf16 v232,v160,v228
 v_dot2c_f32_bf16 v233,v160,v229
 v_dot2c_f32_bf16 v234,v161,v228
 v_dot2c_f32_bf16 v235,v161,v229
 v_dot2c_f32_bf16 v236,v162,v228
 v_dot2c_f32_bf16 v237,v162,v229
 v_dot2c_f32_bf16 v238,v163,v228
 v_dot2c_f32_bf16 v239,v163,v229
 v_dot2c_f32_bf16 v232,v164,v228
 v_dot2c_f32_bf16 v233,v164,v229
 v_dot2c_f32_bf16 v234,v165,v228
 v_dot2c_f32_bf16 v235,v165,v229
 v_dot2c_f32_bf16 v236,v166,v228
 v_dot2c_f32_bf16 v237,v166,v229
 v_dot2c_f32_bf16 v238,v167,v228
 v_dot2c_f32_bf16 v239,v167,v229
 v_dot2c_f32_bf16 v232,v168,v228
 v_dot2c_f32_bf16 v233,v168,v229
 v_dot2c_f32_bf16 v234,v169,v228
 v_dot2c_f32_bf16 v235,v169,v229
 v_dot2c_f32_bf16 v236,v170,v228
 v_dot2c_f32_bf16 v237,v170,v229
 v_dot2c_f32_bf16 v238,v171,v228
 v_dot2c_f32_bf16 v239,v171,v229
 v_dot2c_f32_bf16 v232,v172,v228
 v_dot2c_f32_bf16 v233,v172,v229
 v_dot2c_f32_bf16 v234,v173,v228
 v_dot2c_f32_bf16 v235,v173,v229
 v_dot2c_f32_bf16 v236,v174,v228
 v_dot2c_f32_bf16 v237,v174,v229
 v_dot2c_f32_bf16 v238,v175,v228
 v_dot2c_f32_bf16 v239,v175,v229
 s_nop 2
 v_permlane32_swap_b32 v232,v236
 v_permlane32_swap_b32 v233,v237
 v_permlane32_swap_b32 v234,v238
 v_permlane32_swap_b32 v235,v239
 v_add_f32 v232,v232,v236
 v_add_f32 v233,v233,v237
 v_add_f32 v234,v234,v238
 v_add_f32 v235,v235,v239
 v_cvt_pk_bf16_f32 v100,v232,v233
 v_cvt_pk_bf16_f32 v101,v234,v235
 buffer_store_dwordx2 v[100:101],v116,s[80:83],0 offen
L_end:
L_done:
 s_endpgm
L_spinP:
 s_mov_b32 s35,0
L_spinP_l:
 s_sleep 8
 buffer_load_dword v227,v226,s[72:75],0 offen sc1
 s_waitcnt vmcnt(0)
 s_add_u32 s35,s35,1
 s_cmp_gt_u32 s35,0x40000
 s_cbranch_scc1 L_gotP
 v_cmp_gt_u32 vcc,s15,v227
 s_cbranch_vccnz L_spinP_l
 s_branch L_gotP
L_spinB0:
 s_mov_b32 s35,0
L_spinB0_l:
 s_sleep 8
 buffer_load_dword v227,v226,s[72:75],0 offen sc1
 s_waitcnt vmcnt(0)
 s_add_u32 s35,s35,1
 s_cmp_gt_u32 s35,0x40000
 s_cbranch_scc1 L_gotB0
 v_cmp_gt_u32 vcc,s15,v227
 s_cbranch_vccnz L_spinB0_l
 s_branch L_gotB0
L_spinB1:
 s_mov_b32 s35,0
L_spinB1_l:
 s_sleep 8
 buffer_load_dword v227,v226,s[72:75],0 offen sc1
 s_waitcnt vmcnt(0)
 s_add_u32 s35,s35,1
 s_cmp_gt_u32 s35,0x40000
 s_cbranch_scc1 L_gotB1
 v_cmp_gt_u32 vcc,s15,v227
 s_cbranch_vccnz L_spinB1_l
 s_branch L_gotB1
L_spinQ:
 s_mov_b32 s35,0
L_spinQ_l:
 s_sleep 8
 buffer_load_dword v227,v226,s[72:75],0 offen sc1
 s_waitcnt vmcnt(0)
 s_add_u32 s35,s35,1
 s_cmp_gt_u32 s35,0x40000
 s_cbranch_scc1 L_gotQ
 v_cmp_gt_u32 vcc,s15,v227
 s_cbranch_vccnz L_spinQ_l
 s_branch L_gotQ
L_spinB2:
 s_mov_b32 s35,0
L_spinB2_l:
 s_sleep 8
 buffer_load_dword v227,v226,s[72:75],0 offen sc1
 s_waitcnt vmcnt(0)
 s_add_u32 s35,s35,1
 s_cmp_gt_u32 s35,0x40000
 s_cbranch_scc1 L_gotB2
 v_cmp_gt_u32 vcc,s15,v227
 s_cbranch_vccnz L_spinB2_l
 s_branch L_gotB2
L_cntspin:
 s_lshl_b32 s58,s84,3
L_cntspin2:
 s_mov_b32 s35,0
L_cntspin2_l:
 s_sleep 8
 buffer_load_dword v136,off,s[76:79],s58 offset:128 sc1
 s_waitcnt vmcnt(0)
 s_add_u32 s35,s35,1
 s_cmp_gt_u32 s35,0x40000
 s_cbranch_scc1 L_cntok
 v_readfirstlane_b32 s3,v136
 s_cmp_lt_u32 s3,16
 s_cbranch_scc1 L_cntspin2_l
 s_branch L_cntok
L_redo:
 s_mov_b32 s6,1
 s_waitcnt vmcnt(0) lgkmcnt(0)
 s_barrier
 v_lshrrev_b32 v56,4,v135
 v_and_b32 v57,15,v56
 v_and_b32 v56,48,v56
 v_lshl_add_u32 v56,v57,8,v56
 v_add_u32 v57,0x1000,v56
 v_mov_b32 v100,0xff800000
 v_mov_b32 v101,0xff800000
 v_mov_b32 v102,0xff800000
 v_mov_b32 v103,0xff800000
 v_mov_b32 v104,0xff800000
 s_mov_b32 s58,0
L_redo_loop:
 buffer_load_dwordx4 a[80:83],v56,s[16:19],s58 offen offset:0
 buffer_load_dwordx4 a[84:87],v56,s[16:19],s58 offen offset:64
 buffer_load_dwordx4 a[88:91],v56,s[16:19],s58 offen offset:128
 buffer_load_dwordx4 a[92:95],v56,s[16:19],s58 offen offset:192
 buffer_load_dwordx4 a[96:99],v57,s[16:19],s58 offen offset:0
 buffer_load_dwordx4 a[100:103],v57,s[16:19],s58 offen offset:64
 buffer_load_dwordx4 a[104:107],v57,s[16:19],s58 offen offset:128
 buffer_load_dwordx4 a[108:111],v57,s[16:19],s58 offen offset:192
 s_waitcnt vmcnt(0)
 v_mfma_f32_16x16x32_bf16 v[0:3],a[80:83],a[0:3],0
 v_mfma_f32_16x16x32_bf16 v[4:7],a[96:99],a[0:3],0
 v_mfma_f32_16x16x32_bf16 v[0:3],a[84:87],a[4:7],v[0:3]
 v_mfma_f32_16x16x32_bf16 v[4:7],a[100:103],a[4:7],v[4:7]
 v_mfma_f32_16x16x32_bf16 v[0:3],a[88:91],a[8:11],v[0:3]
 v_mfma_f32_16x16x32_bf16 v[4:7],a[104:107],a[8:11],v[4:7]
 v_mfma_f32_16x16x32_bf16 v[0:3],a[92:95],a[12:15],v[0:3]
 v_mfma_f32_16x16x32_bf16 v[4:7],a[108:111],a[12:15],v[4:7]
 v_mfma_f32_16x16x32_bf16 v[8:11],a[80:83],a[16:19],0
 v_mfma_f32_16x16x32_bf16 v[12:15],a[96:99],a[16:19],0
 v_mfma_f32_16x16x32_bf16 v[8:11],a[84:87],a[20:23],v[8:11]
 v_mfma_f32_16x16x32_bf16 v[12:15],a[100:103],a[20:23],v[12:15]
 v_mfma_f32_16x16x32_bf16 v[8:11],a[88:91],a[24:27],v[8:11]
 v_mfma_f32_16x16x32_bf16 v[12:15],a[104:107],a[24:27],v[12:15]
 v_mfma_f32_16x16x32_bf16 v[8:11],a[92:95],a[28:31],v[8:11]
 v_mfma_f32_16x16x32_bf16 v[12:15],a[108:111],a[28:31],v[12:15]
 v_mfma_f32_16x16x32_bf16 v[16:19],a[80:83],a[32:35],0
 v_mfma_f32_16x16x32_bf16 v[20:23],a[96:99],a[32:35],0
 v_mfma_f32_16x16x32_bf16 v[16:19],a[84:87],a[36:39],v[16:19]
 v_mfma_f32_16x16x32_bf16 v[20:23],a[100:103],a[36:39],v[20:23]
 v_mfma_f32_16x16x32_bf16 v[16:19],a[88:91],a[40:43],v[16:19]
 v_mfma_f32_16x16x32_bf16 v[20:23],a[104:107],a[40:43],v[20:23]
 v_mfma_f32_16x16x32_bf16 v[16:19],a[92:95],a[44:47],v[16:19]
 v_mfma_f32_16x16x32_bf16 v[20:23],a[108:111],a[44:47],v[20:23]
 v_mfma_f32_16x16x32_bf16 v[24:27],a[80:83],a[48:51],0
 v_mfma_f32_16x16x32_bf16 v[28:31],a[96:99],a[48:51],0
 v_mfma_f32_16x16x32_bf16 v[24:27],a[84:87],a[52:55],v[24:27]
 v_mfma_f32_16x16x32_bf16 v[28:31],a[100:103],a[52:55],v[28:31]
 v_mfma_f32_16x16x32_bf16 v[24:27],a[88:91],a[56:59],v[24:27]
 v_mfma_f32_16x16x32_bf16 v[28:31],a[104:107],a[56:59],v[28:31]
 v_mfma_f32_16x16x32_bf16 v[24:27],a[92:95],a[60:63],v[24:27]
 v_mfma_f32_16x16x32_bf16 v[28:31],a[108:111],a[60:63],v[28:31]
 v_mfma_f32_16x16x32_bf16 v[32:35],a[80:83],a[64:67],0
 v_mfma_f32_16x16x32_bf16 v[36:39],a[96:99],a[64:67],0
 v_mfma_f32_16x16x32_bf16 v[32:35],a[84:87],a[68:71],v[32:35]
 v_mfma_f32_16x16x32_bf16 v[36:39],a[100:103],a[68:71],v[36:39]
 v_mfma_f32_16x16x32_bf16 v[32:35],a[88:91],a[72:75],v[32:35]
 v_mfma_f32_16x16x32_bf16 v[36:39],a[104:107],a[72:75],v[36:39]
 v_mfma_f32_16x16x32_bf16 v[32:35],a[92:95],a[76:79],v[32:35]
 v_mfma_f32_16x16x32_bf16 v[36:39],a[108:111],a[76:79],v[36:39]
 s_nop 7
 v_max3_f32 v100,v100,v0,v1
 v_max3_f32 v100,v100,v2,v3
 v_max3_f32 v100,v100,v4,v5
 v_max3_f32 v100,v100,v6,v7
 v_max3_f32 v101,v101,v8,v9
 v_max3_f32 v101,v101,v10,v11
 v_max3_f32 v101,v101,v12,v13
 v_max3_f32 v101,v101,v14,v15
 v_max3_f32 v102,v102,v16,v17
 v_max3_f32 v102,v102,v18,v19
 v_max3_f32 v102,v102,v20,v21
 v_max3_f32 v102,v102,v22,v23
 v_max3_f32 v103,v103,v24,v25
 v_max3_f32 v103,v103,v26,v27
 v_max3_f32 v103,v103,v28,v29
 v_max3_f32 v103,v103,v30,v31
 v_max3_f32 v104,v104,v32,v33
 v_max3_f32 v104,v104,v34,v35
 v_max3_f32 v104,v104,v36,v37
 v_max3_f32 v104,v104,v38,v39
 s_add_u32 s58,s58,0x2000
 s_cmp_lt_u32 s58,0x40000
 s_cbranch_scc1 L_redo_loop
 v_mov_b32 v48,v100
 v_mov_b32 v49,v101
 v_mov_b32 v50,v102
 v_mov_b32 v51,v103
 v_mov_b32 v52,v104
 v_permlane32_swap_b32 v48,v100
 v_permlane32_swap_b32 v49,v101
 v_permlane32_swap_b32 v50,v102
 v_permlane32_swap_b32 v51,v103
 v_permlane32_swap_b32 v52,v104
 v_max_f32 v100,v100,v48
 v_max_f32 v101,v101,v49
 v_max_f32 v102,v102,v50
 v_max_f32 v103,v103,v51
 v_max_f32 v104,v104,v52
 v_mov_b32 v48,v100
 v_mov_b32 v49,v101
 v_mov_b32 v50,v102
 v_mov_b32 v51,v103
 v_mov_b32 v52,v104
 v_permlane16_swap_b32 v48,v100
 v_permlane16_swap_b32 v49,v101
 v_permlane16_swap_b32 v50,v102
 v_permlane16_swap_b32 v51,v103
 v_permlane16_swap_b32 v52,v104
 v_max_f32 v100,v100,v48
 v_max_f32 v101,v101,v49
 v_max_f32 v102,v102,v50
 v_max_f32 v103,v103,v51
 v_max_f32 v104,v104,v52
 v_sub_f32 v80,0,v100
 v_sub_f32 v84,0,v101
 v_sub_f32 v88,0,v102
 v_sub_f32 v92,0,v103
 v_sub_f32 v96,0,v104
 v_mov_b32 v81,v80
 v_mov_b32 v82,v80
 v_mov_b32 v83,v80
 v_mov_b32 v85,v84
 v_mov_b32 v86,v84
 v_mov_b32 v87,v84
 v_mov_b32 v89,v88
 v_mov_b32 v90,v88
 v_mov_b32 v91,v88
 v_mov_b32 v93,v92
 v_mov_b32 v94,v92
 v_mov_b32 v95,v92
 v_mov_b32 v97,v96
 v_mov_b32 v98,v96
 v_mov_b32 v99,v96
 s_mul_i32 s3,s5,0x2000
 s_lshl_b32 s36,s61,12
 s_add_u32 s57,s3,s36
 v_subrev_u32 v121,0x4000,v113
 v_subrev_u32 v122,0x4000,v114
 v_subrev_u32 v123,0x4000,v115
 v_subrev_u32 v124,0x4000,v116
 v_subrev_u32 v125,0x4000,v117
 v_subrev_u32 v126,0x4000,v118
 v_subrev_u32 v127,0x4000,v119
 v_subrev_u32 v128,0x4000,v120
 s_add_u32 m0,s34,0x0
 s_xor_b32 s32,s57,0x0
 buffer_load_dwordx4 v129,s[16:19],s32 offen offset:0 nt lds
 buffer_load_dwordx4 v130,s[16:19],s32 offen offset:1024 nt lds
 buffer_load_dwordx4 v131,s[16:19],s32 offen offset:2048 nt lds
 buffer_load_dwordx4 v132,s[16:19],s32 offen offset:3072 nt lds
 s_add_u32 m0,s34,0x20000
 s_xor_b32 s33,s57,0x0
 buffer_load_dwordx4 v133,s[20:23],s33 offen offset:0 nt lds
 buffer_load_dwordx4 v134,s[20:23],s33 offen offset:1024 nt lds
 buffer_load_dwordx4 v133,s[20:23],s33 offen offset:2048 nt lds
 buffer_load_dwordx4 v134,s[20:23],s33 offen offset:3072 nt lds
 s_add_u32 m0,s34,0x4000
 s_xor_b32 s32,s57,0x2000
 buffer_load_dwordx4 v129,s[16:19],s32 offen offset:0 nt lds
 buffer_load_dwordx4 v130,s[16:19],s32 offen offset:1024 nt lds
 buffer_load_dwordx4 v131,s[16:19],s32 offen offset:2048 nt lds
 buffer_load_dwordx4 v132,s[16:19],s32 offen offset:3072 nt lds
 s_add_u32 m0,s34,0x24000
 s_xor_b32 s33,s57,0x2000
 buffer_load_dwordx4 v133,s[20:23],s33 offen offset:0 nt lds
 buffer_load_dwordx4 v134,s[20:23],s33 offen offset:1024 nt lds
 buffer_load_dwordx4 v133,s[20:23],s33 offen offset:2048 nt lds
 buffer_load_dwordx4 v134,s[20:23],s33 offen offset:3072 nt lds
 s_add_u32 m0,s34,0x8000
 s_xor_b32 s32,s57,0x4000
 buffer_load_dwordx4 v129,s[16:19],s32 offen offset:0 nt lds
 buffer_load_dwordx4 v130,s[16:19],s32 offen offset:1024 nt lds
 buffer_load_dwordx4 v131,s[16:19],s32 offen offset:2048 nt lds
 buffer_load_dwordx4 v132,s[16:19],s32 offen offset:3072 nt lds
 s_add_u32 m0,s34,0x14000
 s_xor_b32 s33,s57,0x4000
 buffer_load_dwordx4 v133,s[20:23],s33 offen offset:0 nt lds
 buffer_load_dwordx4 v134,s[20:23],s33 offen offset:1024 nt lds
 buffer_load_dwordx4 v133,s[20:23],s33 offen offset:2048 nt lds
 buffer_load_dwordx4 v134,s[20:23],s33 offen offset:3072 nt lds
 s_add_u32 m0,s34,0xc000
 s_xor_b32 s32,s57,0x6000
 buffer_load_dwordx4 v129,s[16:19],s32 offen offset:0 nt lds
 buffer_load_dwordx4 v130,s[16:19],s32 offen offset:1024 nt lds
 buffer_load_dwordx4 v131,s[16:19],s32 offen offset:2048 nt lds
 buffer_load_dwordx4 v132,s[16:19],s32 offen offset:3072 nt lds
 s_add_u32 m0,s34,0x18000
 s_xor_b32 s33,s57,0x6000
 buffer_load_dwordx4 v133,s[20:23],s33 offen offset:0 nt lds
 buffer_load_dwordx4 v134,s[20:23],s33 offen offset:1024 nt lds
 buffer_load_dwordx4 v133,s[20:23],s33 offen offset:2048 nt lds
 buffer_load_dwordx4 v134,s[20:23],s33 offen offset:3072 nt lds
 s_add_u32 m0,s34,0x10000
 s_xor_b32 s32,s57,0x8000
 buffer_load_dwordx4 v129,s[16:19],s32 offen offset:0 nt lds
 buffer_load_dwordx4 v130,s[16:19],s32 offen offset:1024 nt lds
 buffer_load_dwordx4 v131,s[16:19],s32 offen offset:2048 nt lds
 buffer_load_dwordx4 v132,s[16:19],s32 offen offset:3072 nt lds
 s_add_u32 m0,s34,0x1c000
 s_xor_b32 s33,s57,0x8000
 buffer_load_dwordx4 v133,s[20:23],s33 offen offset:0 nt lds
 buffer_load_dwordx4 v134,s[20:23],s33 offen offset:1024 nt lds
 buffer_load_dwordx4 v133,s[20:23],s33 offen offset:2048 nt lds
 buffer_load_dwordx4 v134,s[20:23],s33 offen offset:3072 nt lds
 v_mov_b32 v138,0x40000000
 s_waitcnt vmcnt(36)
 s_barrier
 ds_read_b128 a[80:83],v105 offset:0
 ds_read_b128 a[96:99],v105 offset:4096
 ds_read_b128 a[84:87],v106 offset:0
 ds_read_b128 a[100:103],v106 offset:4096
 ds_read_b128 a[88:91],v107 offset:0
 ds_read_b128 a[104:107],v107 offset:4096
 ds_read_b128 a[92:95],v108 offset:0
 ds_read_b128 a[108:111],v108 offset:4096
 s_waitcnt lgkmcnt(0)
 v_mfma_f32_16x16x32_bf16 v[0:3],a[80:83],a[0:3],v[80:83]
 v_mfma_f32_16x16x32_bf16 v[4:7],a[96:99],a[0:3],v[80:83]
 v_mfma_f32_16x16x32_bf16 v[0:3],a[84:87],a[4:7],v[0:3]
 v_mfma_f32_16x16x32_bf16 v[4:7],a[100:103],a[4:7],v[4:7]
 v_mfma_f32_16x16x32_bf16 v[0:3],a[88:91],a[8:11],v[0:3]
 v_mfma_f32_16x16x32_bf16 v[4:7],a[104:107],a[8:11],v[4:7]
 v_mfma_f32_16x16x32_bf16 v[0:3],a[92:95],a[12:15],v[0:3]
 v_mfma_f32_16x16x32_bf16 v[4:7],a[108:111],a[12:15],v[4:7]
 v_mfma_f32_16x16x32_bf16 v[8:11],a[80:83],a[16:19],v[84:87]
 v_mfma_f32_16x16x32_bf16 v[12:15],a[96:99],a[16:19],v[84:87]
 v_mfma_f32_16x16x32_bf16 v[8:11],a[84:87],a[20:23],v[8:11]
 v_mfma_f32_16x16x32_bf16 v[12:15],a[100:103],a[20:23],v[12:15]
 v_mfma_f32_16x16x32_bf16 v[8:11],a[88:91],a[24:27],v[8:11]
 v_mfma_f32_16x16x32_bf16 v[12:15],a[104:107],a[24:27],v[12:15]
 v_mfma_f32_16x16x32_bf16 v[8:11],a[92:95],a[28:31],v[8:11]
 v_mfma_f32_16x16x32_bf16 v[12:15],a[108:111],a[28:31],v[12:15]
 v_mfma_f32_16x16x32_bf16 v[16:19],a[80:83],a[32:35],v[88:91]
 v_mfma_f32_16x16x32_bf16 v[20:23],a[96:99],a[32:35],v[88:91]
 v_mfma_f32_16x16x32_bf16 v[16:19],a[84:87],a[36:39],v[16:19]
 v_mfma_f32_16x16x32_bf16 v[20:23],a[100:103],a[36:39],v[20:23]
 v_mfma_f32_16x16x32_bf16 v[16:19],a[88:91],a[40:43],v[16:19]
 v_mfma_f32_16x16x32_bf16 v[20:23],a[104:107],a[40:43],v[20:23]
 v_mfma_f32_16x16x32_bf16 v[16:19],a[92:95],a[44:47],v[16:19]
 v_mfma_f32_16x16x32_bf16 v[20:23],a[108:111],a[44:47],v[20:23]
 v_mfma_f32_16x16x32_bf16 v[24:27],a[80:83],a[48:51],v[92:95]
 v_mfma_f32_16x16x32_bf16 v[28:31],a[96:99],a[48:51],v[92:95]
 v_mfma_f32_16x16x32_bf16 v[24:27],a[84:87],a[52:55],v[24:27]
 v_mfma_f32_16x16x32_bf16 v[28:31],a[100:103],a[52:55],v[28:31]
 v_mfma_f32_16x16x32_bf16 v[24:27],a[88:91],a[56:59],v[24:27]
 v_mfma_f32_16x16x32_bf16 v[28:31],a[104:107],a[56:59],v[28:31]
 v_mfma_f32_16x16x32_bf16 v[24:27],a[92:95],a[60:63],v[24:27]
 v_mfma_f32_16x16x32_bf16 v[28:31],a[108:111],a[60:63],v[28:31]
 v_mfma_f32_16x16x32_bf16 v[32:35],a[80:83],a[64:67],v[96:99]
 v_mfma_f32_16x16x32_bf16 v[36:39],a[96:99],a[64:67],v[96:99]
 v_mfma_f32_16x16x32_bf16 v[32:35],a[84:87],a[68:71],v[32:35]
 v_mfma_f32_16x16x32_bf16 v[36:39],a[100:103],a[68:71],v[36:39]
 v_mfma_f32_16x16x32_bf16 v[32:35],a[88:91],a[72:75],v[32:35]
 v_mfma_f32_16x16x32_bf16 v[36:39],a[104:107],a[72:75],v[36:39]
 v_mfma_f32_16x16x32_bf16 v[32:35],a[92:95],a[76:79],v[32:35]
 v_mfma_f32_16x16x32_bf16 v[36:39],a[108:111],a[76:79],v[36:39]
 s_nop 7
 s_branch L_s0
L_code_end:
.section .rodata,"a"
.p2align 6
.amdhsa_kernel concat_heads__gqa_block_cached__gqa_block_cached__near_ridge_kernel
  .amdhsa_next_free_vgpr 512
  .amdhsa_next_free_sgpr 102
  .amdhsa_accum_offset 256
  .amdhsa_group_segment_fixed_size 0
  .amdhsa_kernarg_size 104
  .amdhsa_user_sgpr_count 2
  .amdhsa_user_sgpr_kernarg_segment_ptr 1
  .amdhsa_system_sgpr_workgroup_id_x 1
  .amdhsa_float_denorm_mode_32 3
.end_amdhsa_kernel
```
